```python
import torch

def _softmax(x, axis=-1):
    return torch.softmax(x, dim=axis)
def _gelu(x):
    return torch.nn.functional.gelu(x, approximate="tanh")
def _silu(x):
    return torch.nn.functional.silu(x)
def _sigmoid(x):
    return torch.sigmoid(x)
def _layernorm(x, axis=-1, eps=1e-5):
    m = x.mean(dim=axis, keepdim=True)
    v = x.var(dim=axis, keepdim=True, unbiased=False)
    return (x - m) / torch.sqrt(v + eps)
def _scatter_add(tgt, idx, src, axis=0):
    return tgt.clone().index_add_(axis, idx, src)
def _segment_sum(src, seg, n):
    out = torch.zeros((n,) + src.shape[1:], dtype=src.dtype)
    return out.index_add_(0, seg, src)
def _pad(x, pw):
    flat = tuple(v for pair in reversed(pw) for v in pair)
    return torch.nn.functional.pad(x, flat)

kernel_name = 'parallel_sum__grouped_kv_mqa__glu_gated_bilinear__prompt'

def setup_inputs():

    _w = (lambda a: (lambda t: t.to(torch.bfloat16) if t.is_floating_point() else t)(torch.as_tensor(a)))
    def _A_setup():
        B, S, D, H = 1, 2048, 576, 32
        Dh = D // H
        return {
            "x": _w((lambda *s: torch.randn(*s, dtype=torch.bfloat16) * 0.05)(B, S, D)),
            "wq": _w((lambda *s: torch.randn(*s, dtype=torch.bfloat16) * 0.05)(D, H * Dh)),
            "wk": _w((lambda *s: torch.randn(*s, dtype=torch.bfloat16) * 0.05)(D, Dh)),
            "wv": _w((lambda *s: torch.randn(*s, dtype=torch.bfloat16) * 0.05)(D, Dh)),
            "wo": _w((lambda *s: torch.randn(*s, dtype=torch.bfloat16) * 0.05)(H * Dh, D)),
        }
    _A_in = _A_setup()

    def _B_setup():
        B, S, D, F = 1, 2048, 576, 4608
        return {
            "x": _w((lambda *s: torch.randn(*s, dtype=torch.bfloat16) * 0.05)(B, S, D)),
            "w_gate": _w((lambda *s: torch.randn(*s, dtype=torch.bfloat16) * 0.4)(D, F) * (D ** -0.5)),
            "w_up": _w((lambda *s: torch.randn(*s, dtype=torch.bfloat16) * 0.4)(D, F) * (D ** -0.5)),
            "w_down": _w((lambda *s: torch.randn(*s, dtype=torch.bfloat16) * 0.4)(F, D) * (F ** -0.5)),
        }
    _B_in = _B_setup()

    return {
        "A_x": _A_in["x"],
        "A_wq": _A_in["wq"],
        "A_wk": _A_in["wk"],
        "A_wv": _A_in["wv"],
        "A_wo": _A_in["wo"],
        "B_x": _B_in["x"],
        "B_w_gate": _B_in["w_gate"],
        "B_w_up": _B_in["w_up"],
        "B_w_down": _B_in["w_down"],
    }

def reference(A_x, A_wq, A_wk, A_wv, A_wo, B_x, B_w_gate, B_w_up, B_w_down):
    def _A_ref(x, wq, wk, wv, wo):
        B, S, D = x.shape
        H = 32
        Dh = D // H
        q = (lambda x, *d: x.permute(*d))((x @ wq).reshape(B, S, H, Dh), 0, 2, 1, 3)
        k = x @ wk
        v = x @ wv
        scores = torch.einsum("bhqd,bkd->bhqk", q, k) * (Dh ** -0.5)
        p = _softmax(scores, axis=-1)
        o = torch.einsum("bhqk,bkd->bhqd", p, v)
        return (lambda x, *d: x.permute(*d))(o, 0, 2, 1, 3).reshape(B, S, H * Dh) @ wo

    def _B_ref(x, w_gate, w_up, w_down):
        g = torch.einsum("bsd,df->bsf", x, w_gate)
        u = torch.einsum("bsd,df->bsf", x, w_up)
        h = g * u
        return torch.einsum("bsf,fd->bsd", h, w_down)

    x = A_x
    xn = _layernorm(x, axis=-1)
    return x + _A_ref(xn, A_wq, A_wk, A_wv, A_wo) + _B_ref(xn, B_w_gate, B_w_up, B_w_down)
```

```asm
; @launch grid=(256,1,1) block=(256,1,1) lds=163840
.amdgcn_target "amdgcn-amd-amdhsa--gfx950"
.text
.globl parallel_sum__grouped_kv_mqa__glu_gated_bilinear__prompt_kernel
.p2align 8
.type parallel_sum__grouped_kv_mqa__glu_gated_bilinear__prompt_kernel,@function
parallel_sum__grouped_kv_mqa__glu_gated_bilinear__prompt_kernel:
L_main_start:
    s_cmp_ge_u32 s2, 256
    s_cbranch_scc1 L_main_end
    s_load_dwordx16 s[4:19], s[0:1], 0
    s_load_dwordx8 s[20:27], s[0:1], 64
    s_getpc_b64 s[70:71]
L_pc0:
    s_lshr_b32 s65, s2, 3
    s_lshl_b32 s65, s65, 4
    v_lshrrev_b32 v2, 6, v0
    v_lshl_add_u32 v2, v2, 2, s65
    v_and_b32 v61, 3, v0
    v_add_u32 v2, v2, v61
    v_bfe_u32 v61, v0, 2, 1
    v_lshl_add_u32 v2, v61, 9, v2
    v_lshlrev_b32 v2, 7, v2
    v_min_u32 v2, 0xfa58, v2
    s_mov_b64 exec, 0xff
    global_load_dword v35, v2, s[70:71]
    s_mov_b64 exec, -1
    v_lshrrev_b32 v2, 6, v0
    v_and_b32 v1, 63, v0
    v_readfirstlane_b32 s52, v2
    s_and_b32 s62, s2, 1
    s_lshl_b32 s62, s62, 3
    s_lshr_b32 s63, s2, 3
    s_and_b32 s64, s63, 7
    s_add_u32 s54, s62, s64
    s_lshr_b32 s53, s63, 3
    s_and_b32 s62, s2, 7
    s_lshr_b32 s62, s62, 1
    s_lshl_b32 s62, s62, 2
    s_add_u32 s53, s53, s62
    v_lshrrev_b32 v32, 3, v1
    v_and_b32 v33, 7, v1
    s_lshl_b32 s62, s53, 7
    s_lshl_b32 s63, s52, 5
    s_add_u32 s62, s62, s63
    v_add_u32 v34, s62, v32
    v_mul_u32_u24 v34, 1152, v34
    v_lshl_add_u32 v34, v33, 4, v34
    s_and_b32 s91, s54, 1
    s_mul_i32 s90, s91, 9216
    s_sub_u32 s62, 9216, s90
    s_add_u32 s60, s90, 18432
    s_add_u32 s69, s62, 18432
    s_waitcnt lgkmcnt(0)
    s_mov_b32 s28, s4
    s_mov_b32 s29, s5
    s_mov_b32 s30, 2359296
    s_mov_b32 s31, 0x20000
    buffer_load_dwordx4 v[64:67], v34, s[28:31], s90 offen offset:0
    buffer_load_dwordx4 v[68:71], v34, s[28:31], s90 offen offset:128
    buffer_load_dwordx4 v[72:75], v34, s[28:31], s90 offen offset:256
    buffer_load_dwordx4 v[76:79], v34, s[28:31], s90 offen offset:384
    buffer_load_dwordx4 v[80:83], v34, s[28:31], s90 offen offset:512
    buffer_load_dwordx4 v[84:87], v34, s[28:31], s90 offen offset:640
    buffer_load_dwordx4 v[88:91], v34, s[28:31], s90 offen offset:768
    buffer_load_dwordx4 v[92:95], v34, s[28:31], s90 offen offset:896
    buffer_load_dwordx4 v[96:99], v34, s[28:31], s90 offen offset:1024
    s_lshl_b32 s63, s2, 2
    s_add_u32 s63, s63, s52
    s_mul_i32 s63, s63, 768
    v_lshl_add_u32 v62, v1, 7, s63
    v_min_u32 v62, 663548, v62
    s_mov_b64 exec, 63
    global_load_dword v35, v62, s[6:7]
    s_mov_b64 exec, -1
    s_lshr_b32 s55, s52, 1
    buffer_load_dwordx4 v[100:103], v34, s[28:31], s62 offen offset:0
    s_and_b32 s56, s52, 1
    s_mov_b32 s44, s26
    s_mov_b32 s45, s27
    s_mov_b32 s46, 51380224
    s_mov_b32 s47, 0x20000
    s_mul_i32 s59, s52, 3072
    s_sub_u32 s61, s54, s53
    s_and_b32 s61, s61, 15
    s_mov_b32 s66, 0x3f803f80
    s_mov_b32 s67, 0x00003f80
    s_mov_b32 s68, 0x3f800000
    s_lshl_b32 s63, s53, 11
    s_lshl_b32 s64, s54, 7
    s_add_u32 s63, s63, s64
    s_add_u32 s63, s63, 40370176
    s_mul_i32 s65, s53, 6144
    s_add_u32 s65, s65, 30720
    s_add_u32 s65, s65, s63
    buffer_load_dwordx4 v[104:107], v34, s[28:31], s62 offen offset:128
    v_lshl_add_u32 v36, v0, 11, s65
    v_mov_b32 v37, s63
    v_cmp_eq_u32 vcc, 0, v0
    v_mov_b32 v2, 0
    s_nop 0
    v_cndmask_b32 v36, v36, v37, vcc
    v_cmp_gt_u32 vcc, 5, v0
    v_mov_b32 v37, 2146435072
    s_nop 0
    v_cndmask_b32 v36, v37, v36, vcc
    buffer_store_dword v2, v36, s[44:47], 0 offen sc1
    v_lshrrev_b32 v39, 2, v33
    v_and_b32 v40, 3, v33
    v_lshlrev_b32 v39, 10, v39
    v_lshl_add_u32 v39, v40, 8, v39
    v_xor_b32 v40, v32, v33
    v_lshl_add_u32 v39, v40, 4, v39
    s_mul_i32 s63, s52, 18432
    buffer_load_dwordx4 v[108:111], v34, s[28:31], s62 offen offset:256
    v_add_u32 v44, s63, v39
    s_lshl_b32 s63, s52, 7
    s_add_u32 s63, s63, 159744
    v_lshl_add_u32 v45, v32, 2, s63
    s_lshl_b32 s63, s91, 7
    v_or_b32 v44, s63, v44
    v_xor_b32 v222, 128, v44
    s_lshl_b32 s63, s91, 5
    v_or_b32 v45, s63, v45
    v_xor_b32 v223, 32, v45
    v_and_b32 v36, 6, v32
    v_xor_b32 v36, v36, v33
    v_and_b32 v37, 4, v32
    v_add_u32 v37, v37, v32
    s_mul_i32 s63, s54, 72
    v_lshrrev_b32 v38, 2, v36
    v_mul_u32_u24 v38, 36, v38
    v_and_b32 v39, 1, v36
    buffer_load_dwordx4 v[112:115], v34, s[28:31], s62 offen offset:384
    v_lshlrev_b32 v39, 4, v39
    v_and_b32 v40, 2, v36
    v_cmp_ne_u32 vcc, 0, v40
    v_mov_b32 v41, 20
    v_mov_b32 v28, 1152
    v_cndmask_b32 v39, v39, v41, vcc
    v_add3_u32 v38, v38, v39, s63
    v_mov_b32 v40, s6
    v_mov_b32 v41, s7
    s_cmp_lt_u32 s61, 3
    s_cbranch_scc1 L_kvaddr
L_nokv:
    v_mul_u32_u24 v214, 96, v28
    v_mov_b32 v215, 0
    v_mov_b32 v43, 0
    s_mul_i32 s57, s54, 288
    s_and_b32 s63, s54, 1
    s_lshl_b32 s64, s63, 5
    s_xor_b32 s63, s63, 1
    s_lshl_b32 s63, s63, 8
    buffer_load_dwordx4 v[116:119], v34, s[28:31], s62 offen offset:512
    s_add_u32 s58, s57, s63
    s_add_u32 s57, s57, s64
    s_mul_i32 s63, s52, 3
    s_add_u32 s63, s63, 0
    s_and_b32 s64, s63, -2
    s_add_u32 s63, s63, s64
    s_lshl_b32 s63, s63, 2
    v_add_u32 v39, s63, v37
    v_mad_u32_u24 v42, v39, v28, v38
    v_lshl_add_u64 v[208:209], v[42:43], 0, v[40:41]
    v_mul_u32_u24 v10, 9216, v39
    v_lshl_add_u32 v10, v36, 4, v10
    s_lshl_b32 s65, s57, 1
    s_sub_u32 s65, s65, 0
    v_add_u32 v10, s65, v10
    s_mul_i32 s63, s52, 3
    s_add_u32 s63, s63, 1
    s_and_b32 s64, s63, -2
    s_add_u32 s63, s63, s64
    buffer_load_dwordx4 v[120:123], v34, s[28:31], s62 offen offset:640
    s_lshl_b32 s63, s63, 2
    v_add_u32 v39, s63, v37
    v_mad_u32_u24 v42, v39, v28, v38
    v_lshl_add_u64 v[210:211], v[42:43], 0, v[40:41]
    v_mul_u32_u24 v11, 9216, v39
    v_lshl_add_u32 v11, v36, 4, v11
    s_lshl_b32 s65, s57, 1
    s_sub_u32 s65, s65, 1024
    v_add_u32 v11, s65, v11
    s_mul_i32 s63, s52, 3
    s_add_u32 s63, s63, 2
    s_and_b32 s64, s63, -2
    s_add_u32 s63, s63, s64
    s_lshl_b32 s63, s63, 2
    v_add_u32 v39, s63, v37
    v_mad_u32_u24 v42, v39, v28, v38
    v_lshl_add_u64 v[212:213], v[42:43], 0, v[40:41]
    v_mul_u32_u24 v12, 9216, v39
    buffer_load_dwordx4 v[124:127], v34, s[28:31], s62 offen offset:768
    v_lshl_add_u32 v12, v36, 4, v12
    s_lshl_b32 s65, s57, 1
    s_sub_u32 s65, s65, 2048
    v_add_u32 v12, s65, v12
    v_mov_b32 v42, 4294966272
    v_mov_b32 v43, -1
    v_lshl_add_u64 v[210:211], v[210:211], 0, v[42:43]
    v_lshl_add_u64 v[212:213], v[42:43], 1, v[212:213]
    v_lshrrev_b32 v36, 4, v1
    v_bfe_u32 v37, v1, 2, 2
    v_and_b32 v38, 3, v1
    v_bfe_u32 v39, v1, 3, 2
    s_lshl_b32 s63, s56, 1
    v_xor_b32 v39, s63, v39
    v_lshlrev_b32 v39, 5, v39
    v_lshl_add_u32 v39, v38, 3, v39
    v_lshrrev_b32 v40, 2, v1
    v_and_b32 v41, 8, v40
    buffer_load_dwordx4 v[128:131], v34, s[28:31], s62 offen offset:896
    v_add_u32 v40, v40, v41
    v_lshl_add_u32 v41, v40, 7, v39
    v_add_u32 v4, 49152, v41
    v_xor_b32 v5, 32, v4
    v_add_u32 v6, 110592, v41
    v_xor_b32 v7, 32, v6
    v_and_b32 v39, 7, v1
    v_xor_b32 v39, v39, v36
    v_and_b32 v40, 8, v1
    v_or_b32 v39, v39, v40
    v_lshlrev_b32 v39, 4, v39
    v_lshl_add_u32 v39, v36, 8, v39
    s_mul_i32 s63, s55, 36864
    v_add_u32 v216, s63, v39
    v_xor_b32 v217, 64, v216
    v_and_b32 v39, 15, v1
    s_lshl_b32 s63, s55, 8
    s_add_u32 s63, s63, 159744
    buffer_load_dwordx4 v[132:135], v34, s[28:31], s62 offen offset:1024
    v_lshl_add_u32 v218, v39, 2, s63
    s_mov_b32 s32, s16
    s_mov_b32 s33, s17
    s_mov_b32 s34, 5308416
    s_mov_b32 s35, 0x20000
    s_mov_b32 s36, s18
    s_mov_b32 s37, s19
    s_mov_b32 s38, 5308416
    s_mov_b32 s39, 0x20000
    s_mov_b32 s40, s20
    s_mov_b32 s41, s21
    s_mov_b32 s42, 5308416
    s_mov_b32 s43, 0x20000
    s_cmp_ge_u32 s52, 2
    s_cselect_b32 s48, s18, s16
    s_cselect_b32 s49, s19, s17
    s_mov_b32 s50, 5308416
    s_mov_b32 s51, 0x20000
    s_lshl_b32 s62, s2, 1
    s_add_u32 s62, s62, s56
    s_mul_i32 s62, s62, 18
    v_min_u32 v60, 17, v1
    v_add_u32 v60, s62, v60
    v_lshrrev_b32 v61, 4, v60
    v_mul_u32_u24 v61, 9216, v61
    v_and_b32 v62, 15, v60
    v_mul_u32_u24 v62, 576, v62
    v_and_b32 v60, 1, v60
    v_lshlrev_b32 v63, 6, v60
    v_add3_u32 v219, v61, v62, v63
    s_waitcnt vmcnt(11)
    v_mov_b32 v46, 0
    v_mov_b32 v47, 0
    v_dot2c_f32_bf16 v46, s66, v64
    v_dot2c_f32_bf16 v47, s66, v65
    v_dot2c_f32_bf16 v46, s66, v66
    v_dot2c_f32_bf16 v47, s66, v67
    v_dot2c_f32_bf16 v46, s66, v68
    v_dot2c_f32_bf16 v47, s66, v69
    v_dot2c_f32_bf16 v46, s66, v70
    v_dot2c_f32_bf16 v47, s66, v71
    v_dot2c_f32_bf16 v46, s66, v72
    v_dot2c_f32_bf16 v47, s66, v73
    v_dot2c_f32_bf16 v46, s66, v74
    v_dot2c_f32_bf16 v47, s66, v75
    v_dot2c_f32_bf16 v46, s66, v76
    v_dot2c_f32_bf16 v47, s66, v77
    v_dot2c_f32_bf16 v46, s66, v78
    v_dot2c_f32_bf16 v47, s66, v79
    v_dot2c_f32_bf16 v46, s66, v80
    v_dot2c_f32_bf16 v47, s66, v81
    v_dot2c_f32_bf16 v46, s66, v82
    buffer_load_dwordx4 v[136:139], v34, s[28:31], s60 offen offset:0
    v_dot2c_f32_bf16 v47, s66, v83
    v_dot2c_f32_bf16 v46, s66, v84
    v_dot2c_f32_bf16 v47, s66, v85
    v_dot2c_f32_bf16 v46, s66, v86
    v_dot2c_f32_bf16 v47, s66, v87
    v_dot2c_f32_bf16 v46, s66, v88
    v_dot2c_f32_bf16 v47, s66, v89
    v_dot2c_f32_bf16 v46, s66, v90
    v_dot2c_f32_bf16 v47, s66, v91
    v_dot2c_f32_bf16 v46, s66, v92
    v_dot2c_f32_bf16 v47, s66, v93
    v_dot2c_f32_bf16 v46, s66, v94
    v_dot2c_f32_bf16 v47, s66, v95
    v_dot2c_f32_bf16 v46, s66, v96
    v_dot2c_f32_bf16 v47, s66, v97
    v_dot2c_f32_bf16 v46, s66, v98
    v_dot2c_f32_bf16 v47, s66, v99
    s_nop 2
    v_add_f32 v46, v46, v47
    s_nop 1
    v_add_f32_dpp v47, v46, v46 quad_perm:[1,0,3,2] row_mask:0xf bank_mask:0xf
    buffer_load_dwordx4 v[140:143], v34, s[28:31], s60 offen offset:128
    s_nop 1
    v_add_f32_dpp v46, v47, v47 quad_perm:[2,3,0,1] row_mask:0xf bank_mask:0xf
    s_nop 1
    v_add_f32_dpp v47, v46, v46 row_half_mirror row_mask:0xf bank_mask:0xf
    v_mul_f32 v48, 987991609, v47
    v_cvt_pk_bf16_f32 v49, v48, v48
    v_and_b32 v49, 0xffff0000, v49
    v_sub_f32 v62, v48, v49
    v_xor_b32 v49, 0x80000000, v49
    v_dot2_f32_bf16 v52, v64, s67, v49
    v_dot2_f32_bf16 v53, v64, s68, v49
    v_dot2_f32_bf16 v54, v65, s67, v49
    v_dot2_f32_bf16 v55, v65, s68, v49
    v_dot2_f32_bf16 v56, v66, s67, v49
    v_dot2_f32_bf16 v57, v66, s68, v49
    v_cvt_pk_bf16_f32 v64, v52, v53
    v_dot2_f32_bf16 v58, v67, s67, v49
    v_dot2_f32_bf16 v59, v67, s68, v49
    v_cvt_pk_bf16_f32 v65, v54, v55
    v_mov_b32 v60, 0
    buffer_load_dwordx4 v[144:147], v34, s[28:31], s60 offen offset:256
    v_mov_b32 v61, 0
    v_dot2c_f32_bf16 v60, v64, v64
    v_dot2_f32_bf16 v52, v68, s67, v49
    v_dot2_f32_bf16 v53, v68, s68, v49
    v_cvt_pk_bf16_f32 v66, v56, v57
    v_dot2c_f32_bf16 v61, v65, v65
    v_dot2_f32_bf16 v54, v69, s67, v49
    v_dot2_f32_bf16 v55, v69, s68, v49
    v_cvt_pk_bf16_f32 v67, v58, v59
    v_dot2c_f32_bf16 v60, v66, v66
    v_dot2_f32_bf16 v56, v70, s67, v49
    v_dot2_f32_bf16 v57, v70, s68, v49
    v_cvt_pk_bf16_f32 v68, v52, v53
    v_dot2c_f32_bf16 v61, v67, v67
    ds_write_b128 v44, v[64:67] offset:0
    v_dot2_f32_bf16 v58, v71, s67, v49
    v_dot2_f32_bf16 v59, v71, s68, v49
    v_cvt_pk_bf16_f32 v69, v54, v55
    v_dot2c_f32_bf16 v60, v68, v68
    v_dot2_f32_bf16 v52, v72, s67, v49
    v_dot2_f32_bf16 v53, v72, s68, v49
    buffer_load_dwordx4 v[148:151], v34, s[28:31], s60 offen offset:384
    v_cvt_pk_bf16_f32 v70, v56, v57
    v_dot2c_f32_bf16 v61, v69, v69
    v_dot2_f32_bf16 v54, v73, s67, v49
    v_dot2_f32_bf16 v55, v73, s68, v49
    v_cvt_pk_bf16_f32 v71, v58, v59
    v_dot2c_f32_bf16 v60, v70, v70
    v_dot2_f32_bf16 v56, v74, s67, v49
    v_dot2_f32_bf16 v57, v74, s68, v49
    v_cvt_pk_bf16_f32 v72, v52, v53
    v_dot2c_f32_bf16 v61, v71, v71
    ds_write_b128 v44, v[68:71] offset:2048
    v_dot2_f32_bf16 v58, v75, s67, v49
    v_dot2_f32_bf16 v59, v75, s68, v49
    v_cvt_pk_bf16_f32 v73, v54, v55
    v_dot2c_f32_bf16 v60, v72, v72
    v_dot2_f32_bf16 v52, v76, s67, v49
    v_dot2_f32_bf16 v53, v76, s68, v49
    v_cvt_pk_bf16_f32 v74, v56, v57
    v_dot2c_f32_bf16 v61, v73, v73
    v_dot2_f32_bf16 v54, v77, s67, v49
    v_dot2_f32_bf16 v55, v77, s68, v49
    buffer_load_dwordx4 v[152:155], v34, s[28:31], s60 offen offset:512
    v_cvt_pk_bf16_f32 v75, v58, v59
    v_dot2c_f32_bf16 v60, v74, v74
    v_dot2_f32_bf16 v56, v78, s67, v49
    v_dot2_f32_bf16 v57, v78, s68, v49
    v_cvt_pk_bf16_f32 v76, v52, v53
    v_dot2c_f32_bf16 v61, v75, v75
    ds_write_b128 v44, v[72:75] offset:4096
    v_dot2_f32_bf16 v58, v79, s67, v49
    v_dot2_f32_bf16 v59, v79, s68, v49
    v_cvt_pk_bf16_f32 v77, v54, v55
    v_dot2c_f32_bf16 v60, v76, v76
    v_dot2_f32_bf16 v52, v80, s67, v49
    v_dot2_f32_bf16 v53, v80, s68, v49
    v_cvt_pk_bf16_f32 v78, v56, v57
    v_dot2c_f32_bf16 v61, v77, v77
    v_dot2_f32_bf16 v54, v81, s67, v49
    v_dot2_f32_bf16 v55, v81, s68, v49
    v_cvt_pk_bf16_f32 v79, v58, v59
    v_dot2c_f32_bf16 v60, v78, v78
    v_dot2_f32_bf16 v56, v82, s67, v49
    buffer_load_dwordx4 v[156:159], v34, s[28:31], s60 offen offset:640
    v_dot2_f32_bf16 v57, v82, s68, v49
    v_cvt_pk_bf16_f32 v80, v52, v53
    v_dot2c_f32_bf16 v61, v79, v79
    ds_write_b128 v44, v[76:79] offset:6144
    v_dot2_f32_bf16 v58, v83, s67, v49
    v_dot2_f32_bf16 v59, v83, s68, v49
    v_cvt_pk_bf16_f32 v81, v54, v55
    v_dot2c_f32_bf16 v60, v80, v80
    v_dot2_f32_bf16 v52, v84, s67, v49
    v_dot2_f32_bf16 v53, v84, s68, v49
    v_cvt_pk_bf16_f32 v82, v56, v57
    v_dot2c_f32_bf16 v61, v81, v81
    v_dot2_f32_bf16 v54, v85, s67, v49
    v_dot2_f32_bf16 v55, v85, s68, v49
    v_cvt_pk_bf16_f32 v83, v58, v59
    v_dot2c_f32_bf16 v60, v82, v82
    v_dot2_f32_bf16 v56, v86, s67, v49
    v_dot2_f32_bf16 v57, v86, s68, v49
    v_cvt_pk_bf16_f32 v84, v52, v53
    v_dot2c_f32_bf16 v61, v83, v83
    ds_write_b128 v44, v[80:83] offset:8192
    buffer_load_dwordx4 v[160:163], v34, s[28:31], s60 offen offset:768
    v_dot2_f32_bf16 v58, v87, s67, v49
    v_dot2_f32_bf16 v59, v87, s68, v49
    v_cvt_pk_bf16_f32 v85, v54, v55
    v_dot2c_f32_bf16 v60, v84, v84
    v_dot2_f32_bf16 v52, v88, s67, v49
    v_dot2_f32_bf16 v53, v88, s68, v49
    v_cvt_pk_bf16_f32 v86, v56, v57
    v_dot2c_f32_bf16 v61, v85, v85
    v_dot2_f32_bf16 v54, v89, s67, v49
    v_dot2_f32_bf16 v55, v89, s68, v49
    v_cvt_pk_bf16_f32 v87, v58, v59
    v_dot2c_f32_bf16 v60, v86, v86
    v_dot2_f32_bf16 v56, v90, s67, v49
    v_dot2_f32_bf16 v57, v90, s68, v49
    v_cvt_pk_bf16_f32 v88, v52, v53
    v_dot2c_f32_bf16 v61, v87, v87
    ds_write_b128 v44, v[84:87] offset:10240
    v_dot2_f32_bf16 v58, v91, s67, v49
    v_dot2_f32_bf16 v59, v91, s68, v49
    v_cvt_pk_bf16_f32 v89, v54, v55
    v_dot2c_f32_bf16 v60, v88, v88
    buffer_load_dwordx4 v[164:167], v34, s[28:31], s60 offen offset:896
    v_dot2_f32_bf16 v52, v92, s67, v49
    v_dot2_f32_bf16 v53, v92, s68, v49
    v_cvt_pk_bf16_f32 v90, v56, v57
    v_dot2c_f32_bf16 v61, v89, v89
    v_dot2_f32_bf16 v54, v93, s67, v49
    v_dot2_f32_bf16 v55, v93, s68, v49
    v_cvt_pk_bf16_f32 v91, v58, v59
    v_dot2c_f32_bf16 v60, v90, v90
    v_dot2_f32_bf16 v56, v94, s67, v49
    v_dot2_f32_bf16 v57, v94, s68, v49
    v_cvt_pk_bf16_f32 v92, v52, v53
    v_dot2c_f32_bf16 v61, v91, v91
    ds_write_b128 v44, v[88:91] offset:12288
    v_dot2_f32_bf16 v58, v95, s67, v49
    v_dot2_f32_bf16 v59, v95, s68, v49
    v_cvt_pk_bf16_f32 v93, v54, v55
    v_dot2c_f32_bf16 v60, v92, v92
    v_dot2_f32_bf16 v52, v96, s67, v49
    v_dot2_f32_bf16 v53, v96, s68, v49
    v_cvt_pk_bf16_f32 v94, v56, v57
    buffer_load_dwordx4 v[168:171], v34, s[28:31], s60 offen offset:1024
    v_dot2c_f32_bf16 v61, v93, v93
    v_dot2_f32_bf16 v54, v97, s67, v49
    v_dot2_f32_bf16 v55, v97, s68, v49
    v_cvt_pk_bf16_f32 v95, v58, v59
    v_dot2c_f32_bf16 v60, v94, v94
    v_dot2_f32_bf16 v56, v98, s67, v49
    v_dot2_f32_bf16 v57, v98, s68, v49
    v_cvt_pk_bf16_f32 v96, v52, v53
    v_dot2c_f32_bf16 v61, v95, v95
    ds_write_b128 v44, v[92:95] offset:14336
    v_dot2_f32_bf16 v58, v99, s67, v49
    v_dot2_f32_bf16 v59, v99, s68, v49
    v_cvt_pk_bf16_f32 v97, v54, v55
    v_dot2c_f32_bf16 v60, v96, v96
    s_nop 1
    v_cvt_pk_bf16_f32 v98, v56, v57
    v_dot2c_f32_bf16 v61, v97, v97
    s_nop 1
    v_cvt_pk_bf16_f32 v99, v58, v59
    v_dot2c_f32_bf16 v60, v98, v98
    v_dot2c_f32_bf16 v61, v99, v99
    ds_write_b128 v44, v[96:99] offset:16384
    s_waitcnt vmcnt(9)
    v_mov_b32 v46, 0
    v_mov_b32 v47, 0
    v_dot2c_f32_bf16 v46, s66, v100
    v_add_f32 v60, v60, v61
    v_dot2c_f32_bf16 v47, s66, v101
    v_dot2c_f32_bf16 v46, s66, v102
    v_dot2c_f32_bf16 v47, s66, v103
    v_add_f32_dpp v61, v60, v60 quad_perm:[1,0,3,2] row_mask:0xf bank_mask:0xf
    v_dot2c_f32_bf16 v46, s66, v104
    v_dot2c_f32_bf16 v47, s66, v105
    v_dot2c_f32_bf16 v46, s66, v106
    v_add_f32_dpp v60, v61, v61 quad_perm:[2,3,0,1] row_mask:0xf bank_mask:0xf
    v_dot2c_f32_bf16 v47, s66, v107
    v_dot2c_f32_bf16 v46, s66, v108
    v_dot2c_f32_bf16 v47, s66, v109
    v_add_f32_dpp v61, v60, v60 row_half_mirror row_mask:0xf bank_mask:0xf
    v_dot2c_f32_bf16 v46, s66, v110
    v_mul_f32 v60, 987991609, v61
    v_dot2c_f32_bf16 v47, s66, v111
    v_fma_f32 v60, -v62, v62, v60
    v_dot2c_f32_bf16 v46, s66, v112
    v_max_f32 v60, 0, v60
    v_dot2c_f32_bf16 v47, s66, v113
    buffer_load_dwordx4 v[172:175], v34, s[28:31], s69 offen offset:0
    v_cvt_pk_bf16_f32 v60, v60, v60
    v_dot2c_f32_bf16 v46, s66, v114
    v_and_b32 v60, 0xffff0000, v60
    v_dot2c_f32_bf16 v47, s66, v115
    v_add_f32 v60, 925353388, v60
    v_dot2c_f32_bf16 v46, s66, v116
    v_cvt_pk_bf16_f32 v60, v60, v60
    v_dot2c_f32_bf16 v47, s66, v117
    v_and_b32 v60, 0xffff0000, v60
    v_dot2c_f32_bf16 v46, s66, v118
    v_sqrt_f32 v60, v60
    v_dot2c_f32_bf16 v47, s66, v119
    v_dot2c_f32_bf16 v46, s66, v120
    v_cvt_pk_bf16_f32 v60, v60, v60
    v_dot2c_f32_bf16 v47, s66, v121
    v_and_b32 v60, 0xffff0000, v60
    v_dot2c_f32_bf16 v46, s66, v122
    v_rcp_f32 v60, v60
    v_dot2c_f32_bf16 v47, s66, v123
    v_dot2c_f32_bf16 v46, s66, v124
    ds_write_b32 v45, v60 offset:0
    v_dot2c_f32_bf16 v47, s66, v125
    buffer_load_dwordx4 v[176:179], v34, s[28:31], s69 offen offset:128
    v_dot2c_f32_bf16 v46, s66, v126
    v_dot2c_f32_bf16 v47, s66, v127
    v_dot2c_f32_bf16 v46, s66, v128
    v_dot2c_f32_bf16 v47, s66, v129
    v_dot2c_f32_bf16 v46, s66, v130
    v_dot2c_f32_bf16 v47, s66, v131
    v_dot2c_f32_bf16 v46, s66, v132
    v_dot2c_f32_bf16 v47, s66, v133
    v_dot2c_f32_bf16 v46, s66, v134
    v_dot2c_f32_bf16 v47, s66, v135
    s_nop 2
    v_add_f32 v46, v46, v47
    s_nop 1
    v_add_f32_dpp v47, v46, v46 quad_perm:[1,0,3,2] row_mask:0xf bank_mask:0xf
    s_nop 1
    v_add_f32_dpp v46, v47, v47 quad_perm:[2,3,0,1] row_mask:0xf bank_mask:0xf
    s_nop 1
    v_add_f32_dpp v47, v46, v46 row_half_mirror row_mask:0xf bank_mask:0xf
    v_mul_f32 v48, 987991609, v47
    v_cvt_pk_bf16_f32 v49, v48, v48
    v_and_b32 v49, 0xffff0000, v49
    v_sub_f32 v63, v48, v49
    v_xor_b32 v49, 0x80000000, v49
    buffer_load_dwordx4 v[180:183], v34, s[28:31], s69 offen offset:256
    v_dot2_f32_bf16 v52, v100, s67, v49
    v_dot2_f32_bf16 v53, v100, s68, v49
    v_dot2_f32_bf16 v54, v101, s67, v49
    v_dot2_f32_bf16 v55, v101, s68, v49
    v_dot2_f32_bf16 v56, v102, s67, v49
    v_dot2_f32_bf16 v57, v102, s68, v49
    v_cvt_pk_bf16_f32 v100, v52, v53
    v_dot2_f32_bf16 v58, v103, s67, v49
    v_dot2_f32_bf16 v59, v103, s68, v49
    v_cvt_pk_bf16_f32 v101, v54, v55
    v_mov_b32 v60, 0
    v_mov_b32 v61, 0
    v_dot2c_f32_bf16 v60, v100, v100
    v_dot2_f32_bf16 v52, v104, s67, v49
    v_dot2_f32_bf16 v53, v104, s68, v49
    v_cvt_pk_bf16_f32 v102, v56, v57
    v_dot2c_f32_bf16 v61, v101, v101
    v_dot2_f32_bf16 v54, v105, s67, v49
    v_dot2_f32_bf16 v55, v105, s68, v49
    v_cvt_pk_bf16_f32 v103, v58, v59
    v_dot2c_f32_bf16 v60, v102, v102
    v_dot2_f32_bf16 v56, v106, s67, v49
    buffer_load_dwordx4 v[184:187], v34, s[28:31], s69 offen offset:384
    v_dot2_f32_bf16 v57, v106, s68, v49
    v_cvt_pk_bf16_f32 v104, v52, v53
    v_dot2c_f32_bf16 v61, v103, v103
    ds_write_b128 v222, v[100:103] offset:0
    v_dot2_f32_bf16 v58, v107, s67, v49
    v_dot2_f32_bf16 v59, v107, s68, v49
    v_cvt_pk_bf16_f32 v105, v54, v55
    v_dot2c_f32_bf16 v60, v104, v104
    v_dot2_f32_bf16 v52, v108, s67, v49
    v_dot2_f32_bf16 v53, v108, s68, v49
    v_cvt_pk_bf16_f32 v106, v56, v57
    v_dot2c_f32_bf16 v61, v105, v105
    v_dot2_f32_bf16 v54, v109, s67, v49
    v_dot2_f32_bf16 v55, v109, s68, v49
    v_cvt_pk_bf16_f32 v107, v58, v59
    v_dot2c_f32_bf16 v60, v106, v106
    v_dot2_f32_bf16 v56, v110, s67, v49
    v_dot2_f32_bf16 v57, v110, s68, v49
    v_cvt_pk_bf16_f32 v108, v52, v53
    v_dot2c_f32_bf16 v61, v107, v107
    ds_write_b128 v222, v[104:107] offset:2048
    v_dot2_f32_bf16 v58, v111, s67, v49
    v_dot2_f32_bf16 v59, v111, s68, v49
    buffer_load_dwordx4 v[188:191], v34, s[28:31], s69 offen offset:512
    v_cvt_pk_bf16_f32 v109, v54, v55
    v_dot2c_f32_bf16 v60, v108, v108
    v_dot2_f32_bf16 v52, v112, s67, v49
    v_dot2_f32_bf16 v53, v112, s68, v49
    v_cvt_pk_bf16_f32 v110, v56, v57
    v_dot2c_f32_bf16 v61, v109, v109
    v_dot2_f32_bf16 v54, v113, s67, v49
    v_dot2_f32_bf16 v55, v113, s68, v49
    v_cvt_pk_bf16_f32 v111, v58, v59
    v_dot2c_f32_bf16 v60, v110, v110
    v_dot2_f32_bf16 v56, v114, s67, v49
    v_dot2_f32_bf16 v57, v114, s68, v49
    v_cvt_pk_bf16_f32 v112, v52, v53
    v_dot2c_f32_bf16 v61, v111, v111
    ds_write_b128 v222, v[108:111] offset:4096
    v_dot2_f32_bf16 v58, v115, s67, v49
    v_dot2_f32_bf16 v59, v115, s68, v49
    v_cvt_pk_bf16_f32 v113, v54, v55
    v_dot2c_f32_bf16 v60, v112, v112
    v_dot2_f32_bf16 v52, v116, s67, v49
    v_dot2_f32_bf16 v53, v116, s68, v49
    v_cvt_pk_bf16_f32 v114, v56, v57
    buffer_load_dwordx4 v[192:195], v34, s[28:31], s69 offen offset:640
    v_dot2c_f32_bf16 v61, v113, v113
    v_dot2_f32_bf16 v54, v117, s67, v49
    v_dot2_f32_bf16 v55, v117, s68, v49
    v_cvt_pk_bf16_f32 v115, v58, v59
    v_dot2c_f32_bf16 v60, v114, v114
    v_dot2_f32_bf16 v56, v118, s67, v49
    v_dot2_f32_bf16 v57, v118, s68, v49
    v_cvt_pk_bf16_f32 v116, v52, v53
    v_dot2c_f32_bf16 v61, v115, v115
    ds_write_b128 v222, v[112:115] offset:6144
    v_dot2_f32_bf16 v58, v119, s67, v49
    v_dot2_f32_bf16 v59, v119, s68, v49
    v_cvt_pk_bf16_f32 v117, v54, v55
    v_dot2c_f32_bf16 v60, v116, v116
    v_dot2_f32_bf16 v52, v120, s67, v49
    v_dot2_f32_bf16 v53, v120, s68, v49
    v_cvt_pk_bf16_f32 v118, v56, v57
    v_dot2c_f32_bf16 v61, v117, v117
    v_dot2_f32_bf16 v54, v121, s67, v49
    v_dot2_f32_bf16 v55, v121, s68, v49
    v_cvt_pk_bf16_f32 v119, v58, v59
    v_dot2c_f32_bf16 v60, v118, v118
    buffer_load_dwordx4 v[196:199], v34, s[28:31], s69 offen offset:768
    v_dot2_f32_bf16 v56, v122, s67, v49
    v_dot2_f32_bf16 v57, v122, s68, v49
    v_cvt_pk_bf16_f32 v120, v52, v53
    v_dot2c_f32_bf16 v61, v119, v119
    ds_write_b128 v222, v[116:119] offset:8192
    v_dot2_f32_bf16 v58, v123, s67, v49
    v_dot2_f32_bf16 v59, v123, s68, v49
    v_cvt_pk_bf16_f32 v121, v54, v55
    v_dot2c_f32_bf16 v60, v120, v120
    v_dot2_f32_bf16 v52, v124, s67, v49
    v_dot2_f32_bf16 v53, v124, s68, v49
    v_cvt_pk_bf16_f32 v122, v56, v57
    v_dot2c_f32_bf16 v61, v121, v121
    v_dot2_f32_bf16 v54, v125, s67, v49
    v_dot2_f32_bf16 v55, v125, s68, v49
    v_cvt_pk_bf16_f32 v123, v58, v59
    v_dot2c_f32_bf16 v60, v122, v122
    v_dot2_f32_bf16 v56, v126, s67, v49
    v_dot2_f32_bf16 v57, v126, s68, v49
    v_cvt_pk_bf16_f32 v124, v52, v53
    v_dot2c_f32_bf16 v61, v123, v123
    ds_write_b128 v222, v[120:123] offset:10240
    v_dot2_f32_bf16 v58, v127, s67, v49
    buffer_load_dwordx4 v[200:203], v34, s[28:31], s69 offen offset:896
    v_dot2_f32_bf16 v59, v127, s68, v49
    v_cvt_pk_bf16_f32 v125, v54, v55
    v_dot2c_f32_bf16 v60, v124, v124
    v_dot2_f32_bf16 v52, v128, s67, v49
    v_dot2_f32_bf16 v53, v128, s68, v49
    v_cvt_pk_bf16_f32 v126, v56, v57
    v_dot2c_f32_bf16 v61, v125, v125
    v_dot2_f32_bf16 v54, v129, s67, v49
    v_dot2_f32_bf16 v55, v129, s68, v49
    v_cvt_pk_bf16_f32 v127, v58, v59
    v_dot2c_f32_bf16 v60, v126, v126
    v_dot2_f32_bf16 v56, v130, s67, v49
    v_dot2_f32_bf16 v57, v130, s68, v49
    v_cvt_pk_bf16_f32 v128, v52, v53
    v_dot2c_f32_bf16 v61, v127, v127
    ds_write_b128 v222, v[124:127] offset:12288
    v_dot2_f32_bf16 v58, v131, s67, v49
    v_dot2_f32_bf16 v59, v131, s68, v49
    v_cvt_pk_bf16_f32 v129, v54, v55
    v_dot2c_f32_bf16 v60, v128, v128
    v_dot2_f32_bf16 v52, v132, s67, v49
    v_dot2_f32_bf16 v53, v132, s68, v49
    buffer_load_dwordx4 v[204:207], v34, s[28:31], s69 offen offset:1024
    v_cvt_pk_bf16_f32 v130, v56, v57
    v_dot2c_f32_bf16 v61, v129, v129
    v_dot2_f32_bf16 v54, v133, s67, v49
    v_dot2_f32_bf16 v55, v133, s68, v49
    v_cvt_pk_bf16_f32 v131, v58, v59
    v_dot2c_f32_bf16 v60, v130, v130
    v_dot2_f32_bf16 v56, v134, s67, v49
    v_dot2_f32_bf16 v57, v134, s68, v49
    v_cvt_pk_bf16_f32 v132, v52, v53
    v_dot2c_f32_bf16 v61, v131, v131
    ds_write_b128 v222, v[128:131] offset:14336
    v_dot2_f32_bf16 v58, v135, s67, v49
    v_dot2_f32_bf16 v59, v135, s68, v49
    v_cvt_pk_bf16_f32 v133, v54, v55
    v_dot2c_f32_bf16 v60, v132, v132
    s_nop 1
    v_cvt_pk_bf16_f32 v134, v56, v57
    v_dot2c_f32_bf16 v61, v133, v133
    s_nop 1
    v_cvt_pk_bf16_f32 v135, v58, v59
    v_dot2c_f32_bf16 v60, v134, v134
    v_dot2c_f32_bf16 v61, v135, v135
    ds_write_b128 v222, v[132:135] offset:16384
    s_waitcnt lgkmcnt(0)
    s_barrier
    s_waitcnt vmcnt(9)
    v_mov_b32 v46, 0
    v_mov_b32 v47, 0
    v_dot2c_f32_bf16 v46, s66, v136
    v_add_f32 v60, v60, v61
    v_dot2c_f32_bf16 v47, s66, v137
    ds_read_b128 a[0:3], v216 offset:0
    v_dot2c_f32_bf16 v46, s66, v138
    v_dot2c_f32_bf16 v47, s66, v139
    v_add_f32_dpp v61, v60, v60 quad_perm:[1,0,3,2] row_mask:0xf bank_mask:0xf
    v_dot2c_f32_bf16 v46, s66, v140
    s_add_u32 m0, s59, 147456
    v_dot2c_f32_bf16 v47, s66, v141
    v_dot2c_f32_bf16 v46, s66, v142
    v_add_f32_dpp v60, v61, v61 quad_perm:[2,3,0,1] row_mask:0xf bank_mask:0xf
    v_dot2c_f32_bf16 v47, s66, v143
    ds_read_b128 a[8:11], v216 offset:18432
    v_dot2c_f32_bf16 v46, s66, v144
    v_dot2c_f32_bf16 v47, s66, v145
    v_add_f32_dpp v61, v60, v60 row_half_mirror row_mask:0xf bank_mask:0xf
    v_dot2c_f32_bf16 v46, s66, v146
    ds_read_b128 a[16:19], v217 offset:1024
    v_mul_f32 v60, 987991609, v61
    v_dot2c_f32_bf16 v47, s66, v147
    v_fma_f32 v60, -v63, v63, v60
    v_dot2c_f32_bf16 v46, s66, v148
    v_max_f32 v60, 0, v60
    ds_read_b128 a[24:27], v217 offset:19456
    v_dot2c_f32_bf16 v47, s66, v149
    v_cvt_pk_bf16_f32 v60, v60, v60
    v_dot2c_f32_bf16 v46, s66, v150
    v_and_b32 v60, 0xffff0000, v60
    global_load_lds_dwordx4 v[208:209], off offset:0
    v_lshl_add_u64 v[208:209], v[208:209], 0, v[214:215]
    v_dot2c_f32_bf16 v47, s66, v151
    v_add_f32 v60, 925353388, v60
    v_dot2c_f32_bf16 v46, s66, v152
    v_cvt_pk_bf16_f32 v60, v60, v60
    ds_read_b128 a[32:35], v216 offset:2048
    v_dot2c_f32_bf16 v47, s66, v153
    v_and_b32 v60, 0xffff0000, v60
    v_dot2c_f32_bf16 v46, s66, v154
    v_sqrt_f32 v60, v60
    ds_read_b128 a[40:43], v216 offset:20480
    v_dot2c_f32_bf16 v47, s66, v155
    v_dot2c_f32_bf16 v46, s66, v156
    v_cvt_pk_bf16_f32 v60, v60, v60
    v_dot2c_f32_bf16 v47, s66, v157
    ds_read_b128 a[48:51], v217 offset:3072
    v_and_b32 v60, 0xffff0000, v60
    v_dot2c_f32_bf16 v46, s66, v158
    v_rcp_f32 v60, v60
    v_dot2c_f32_bf16 v47, s66, v159
    v_dot2c_f32_bf16 v46, s66, v160
    global_load_lds_dwordx4 v[210:211], off offset:1024
    v_lshl_add_u64 v[210:211], v[210:211], 0, v[214:215]
    ds_write_b32 v223, v60 offset:0
    v_dot2c_f32_bf16 v47, s66, v161
    v_dot2c_f32_bf16 v46, s66, v162
    v_dot2c_f32_bf16 v47, s66, v163
    ds_read_b128 a[56:59], v217 offset:21504
    v_dot2c_f32_bf16 v46, s66, v164
    v_dot2c_f32_bf16 v47, s66, v165
    v_dot2c_f32_bf16 v46, s66, v166
    v_dot2c_f32_bf16 v47, s66, v167
    ds_read_b128 a[64:67], v216 offset:4096
    v_dot2c_f32_bf16 v46, s66, v168
    v_dot2c_f32_bf16 v47, s66, v169
    v_dot2c_f32_bf16 v46, s66, v170
    v_dot2c_f32_bf16 v47, s66, v171
    ds_read_b128 a[72:75], v216 offset:22528
    s_nop 2
    v_add_f32 v46, v46, v47
    s_nop 1
    v_add_f32_dpp v47, v46, v46 quad_perm:[1,0,3,2] row_mask:0xf bank_mask:0xf
    global_load_lds_dwordx4 v[212:213], off offset:2048
    v_lshl_add_u64 v[212:213], v[212:213], 0, v[214:215]
    s_nop 1
    v_add_f32_dpp v46, v47, v47 quad_perm:[2,3,0,1] row_mask:0xf bank_mask:0xf
    s_nop 1
    v_add_f32_dpp v47, v46, v46 row_half_mirror row_mask:0xf bank_mask:0xf
    v_mul_f32 v48, 987991609, v47
    ds_read_b128 a[80:83], v217 offset:5120
    v_cvt_pk_bf16_f32 v49, v48, v48
    v_and_b32 v49, 0xffff0000, v49
    v_sub_f32 v62, v48, v49
    v_xor_b32 v49, 0x80000000, v49
    ds_read_b128 a[88:91], v217 offset:23552
    v_dot2_f32_bf16 v52, v136, s67, v49
    v_dot2_f32_bf16 v53, v136, s68, v49
    v_dot2_f32_bf16 v54, v137, s67, v49
    v_dot2_f32_bf16 v55, v137, s68, v49
    ds_read_b128 a[96:99], v216 offset:6144
    v_dot2_f32_bf16 v56, v138, s67, v49
    v_dot2_f32_bf16 v57, v138, s68, v49
    v_cvt_pk_bf16_f32 v136, v52, v53
    v_dot2_f32_bf16 v58, v139, s67, v49
    s_add_u32 m0, s59, 73728
    v_dot2_f32_bf16 v59, v139, s68, v49
    v_cvt_pk_bf16_f32 v137, v54, v55
    v_mov_b32 v60, 0
    v_mov_b32 v61, 0
    ds_read_b128 a[104:107], v216 offset:24576
    v_dot2c_f32_bf16 v60, v136, v136
    v_dot2_f32_bf16 v52, v140, s67, v49
    v_dot2_f32_bf16 v53, v140, s68, v49
    v_cvt_pk_bf16_f32 v138, v56, v57
    v_dot2c_f32_bf16 v61, v137, v137
    ds_read_b128 a[112:115], v217 offset:7168
    v_dot2_f32_bf16 v54, v141, s67, v49
    v_dot2_f32_bf16 v55, v141, s68, v49
    v_cvt_pk_bf16_f32 v139, v58, v59
    v_dot2c_f32_bf16 v60, v138, v138
    ds_read_b128 a[120:123], v217 offset:25600
    v_dot2_f32_bf16 v56, v142, s67, v49
    v_dot2_f32_bf16 v57, v142, s68, v49
    v_cvt_pk_bf16_f32 v140, v52, v53
    v_dot2c_f32_bf16 v61, v139, v139
    global_load_lds_dwordx4 v[208:209], off offset:0
    v_lshl_add_u64 v[208:209], v[208:209], 0, v[214:215]
    v_dot2_f32_bf16 v58, v143, s67, v49
    v_dot2_f32_bf16 v59, v143, s68, v49
    v_cvt_pk_bf16_f32 v141, v54, v55
    v_dot2c_f32_bf16 v60, v140, v140
    ds_read_b128 a[128:131], v216 offset:8192
    v_dot2_f32_bf16 v52, v144, s67, v49
    v_dot2_f32_bf16 v53, v144, s68, v49
    v_cvt_pk_bf16_f32 v142, v56, v57
    v_dot2c_f32_bf16 v61, v141, v141
    ds_read_b128 a[136:139], v216 offset:26624
    v_dot2_f32_bf16 v54, v145, s67, v49
    v_dot2_f32_bf16 v55, v145, s68, v49
    v_cvt_pk_bf16_f32 v143, v58, v59
    v_dot2c_f32_bf16 v60, v142, v142
    v_dot2_f32_bf16 v56, v146, s67, v49
    ds_read_b128 a[144:147], v217 offset:9216
    v_dot2_f32_bf16 v57, v146, s68, v49
    v_cvt_pk_bf16_f32 v144, v52, v53
    v_dot2c_f32_bf16 v61, v143, v143
    v_dot2_f32_bf16 v58, v147, s67, v49
    global_load_lds_dwordx4 v[210:211], off offset:1024
    v_lshl_add_u64 v[210:211], v[210:211], 0, v[214:215]
    v_dot2_f32_bf16 v59, v147, s68, v49
    v_cvt_pk_bf16_f32 v145, v54, v55
    v_dot2c_f32_bf16 v60, v144, v144
    v_dot2_f32_bf16 v52, v148, s67, v49
    ds_read_b128 a[152:155], v217 offset:27648
    v_dot2_f32_bf16 v53, v148, s68, v49
    v_cvt_pk_bf16_f32 v146, v56, v57
    v_dot2c_f32_bf16 v61, v145, v145
    v_dot2_f32_bf16 v54, v149, s67, v49
    ds_read_b128 a[160:163], v216 offset:10240
    v_dot2_f32_bf16 v55, v149, s68, v49
    v_cvt_pk_bf16_f32 v147, v58, v59
    v_dot2c_f32_bf16 v60, v146, v146
    v_dot2_f32_bf16 v56, v150, s67, v49
    ds_read_b128 a[168:171], v216 offset:28672
    v_dot2_f32_bf16 v57, v150, s68, v49
    v_cvt_pk_bf16_f32 v148, v52, v53
    v_dot2c_f32_bf16 v61, v147, v147
    v_dot2_f32_bf16 v58, v151, s67, v49
    v_dot2_f32_bf16 v59, v151, s68, v49
    global_load_lds_dwordx4 v[212:213], off offset:2048
    v_lshl_add_u64 v[212:213], v[212:213], 0, v[214:215]
    v_cvt_pk_bf16_f32 v149, v54, v55
    v_dot2c_f32_bf16 v60, v148, v148
    v_dot2_f32_bf16 v52, v152, s67, v49
    v_dot2_f32_bf16 v53, v152, s68, v49
    ds_read_b128 a[176:179], v217 offset:11264
    v_cvt_pk_bf16_f32 v150, v56, v57
    v_dot2c_f32_bf16 v61, v149, v149
    v_dot2_f32_bf16 v54, v153, s67, v49
    v_dot2_f32_bf16 v55, v153, s68, v49
    ds_read_b128 a[184:187], v217 offset:29696
    v_cvt_pk_bf16_f32 v151, v58, v59
    v_dot2c_f32_bf16 v60, v150, v150
    v_dot2_f32_bf16 v56, v154, s67, v49
    v_dot2_f32_bf16 v57, v154, s68, v49
    ds_read_b128 a[192:195], v216 offset:12288
    v_cvt_pk_bf16_f32 v152, v52, v53
    v_dot2c_f32_bf16 v61, v151, v151
    v_dot2_f32_bf16 v58, v155, s67, v49
    v_dot2_f32_bf16 v59, v155, s68, v49
    v_cvt_pk_bf16_f32 v153, v54, v55
    s_add_u32 m0, s59, 86016
    v_dot2c_f32_bf16 v60, v152, v152
    v_dot2_f32_bf16 v52, v156, s67, v49
    v_dot2_f32_bf16 v53, v156, s68, v49
    v_cvt_pk_bf16_f32 v154, v56, v57
    ds_read_b128 a[200:203], v216 offset:30720
    v_dot2c_f32_bf16 v61, v153, v153
    v_dot2_f32_bf16 v54, v157, s67, v49
    v_dot2_f32_bf16 v55, v157, s68, v49
    v_cvt_pk_bf16_f32 v155, v58, v59
    ds_read_b128 a[208:211], v217 offset:13312
    v_dot2c_f32_bf16 v60, v154, v154
    v_dot2_f32_bf16 v56, v158, s67, v49
    v_dot2_f32_bf16 v57, v158, s68, v49
    v_cvt_pk_bf16_f32 v156, v52, v53
    ds_read_b128 a[216:219], v217 offset:31744
    v_dot2c_f32_bf16 v61, v155, v155
    v_dot2_f32_bf16 v58, v159, s67, v49
    v_dot2_f32_bf16 v59, v159, s68, v49
    v_cvt_pk_bf16_f32 v157, v54, v55
    global_load_lds_dwordx4 v[208:209], off offset:0
    v_lshl_add_u64 v[208:209], v[208:209], 0, v[214:215]
    v_dot2c_f32_bf16 v60, v156, v156
    v_dot2_f32_bf16 v52, v160, s67, v49
    v_dot2_f32_bf16 v53, v160, s68, v49
    v_cvt_pk_bf16_f32 v158, v56, v57
    v_dot2c_f32_bf16 v61, v157, v157
    ds_read_b128 a[224:227], v216 offset:14336
    v_dot2_f32_bf16 v54, v161, s67, v49
    v_dot2_f32_bf16 v55, v161, s68, v49
    v_cvt_pk_bf16_f32 v159, v58, v59
    v_dot2c_f32_bf16 v60, v158, v158
    ds_read_b128 a[232:235], v216 offset:32768
    v_dot2_f32_bf16 v56, v162, s67, v49
    v_dot2_f32_bf16 v57, v162, s68, v49
    v_cvt_pk_bf16_f32 v160, v52, v53
    v_dot2c_f32_bf16 v61, v159, v159
    ds_read_b128 a[240:243], v217 offset:15360
    v_dot2_f32_bf16 v58, v163, s67, v49
    v_dot2_f32_bf16 v59, v163, s68, v49
    v_cvt_pk_bf16_f32 v161, v54, v55
    v_dot2c_f32_bf16 v60, v160, v160
    global_load_lds_dwordx4 v[210:211], off offset:1024
    v_lshl_add_u64 v[210:211], v[210:211], 0, v[214:215]
    v_dot2_f32_bf16 v52, v164, s67, v49
    v_dot2_f32_bf16 v53, v164, s68, v49
    v_cvt_pk_bf16_f32 v162, v56, v57
    v_dot2c_f32_bf16 v61, v161, v161
    ds_read_b128 a[248:251], v217 offset:33792
    v_dot2_f32_bf16 v54, v165, s67, v49
    v_dot2_f32_bf16 v55, v165, s68, v49
    v_cvt_pk_bf16_f32 v163, v58, v59
    v_dot2c_f32_bf16 v60, v162, v162
    v_dot2_f32_bf16 v56, v166, s67, v49
    ds_read_b128 v[224:227], v216 offset:16384
    v_dot2_f32_bf16 v57, v166, s68, v49
    v_cvt_pk_bf16_f32 v164, v52, v53
    v_dot2c_f32_bf16 v61, v163, v163
    v_dot2_f32_bf16 v58, v167, s67, v49
    ds_read_b128 v[232:235], v216 offset:34816
    v_dot2_f32_bf16 v59, v167, s68, v49
    v_cvt_pk_bf16_f32 v165, v54, v55
    v_dot2c_f32_bf16 v60, v164, v164
    v_dot2_f32_bf16 v52, v168, s67, v49
    global_load_lds_dwordx4 v[212:213], off offset:2048
    v_lshl_add_u64 v[212:213], v[212:213], 0, v[214:215]
    v_dot2_f32_bf16 v53, v168, s68, v49
    v_cvt_pk_bf16_f32 v166, v56, v57
    v_dot2c_f32_bf16 v61, v165, v165
    v_dot2_f32_bf16 v54, v169, s67, v49
    ds_read_b128 v[240:243], v217 offset:17408
    v_dot2_f32_bf16 v55, v169, s68, v49
    v_cvt_pk_bf16_f32 v167, v58, v59
    v_dot2c_f32_bf16 v60, v166, v166
    v_dot2_f32_bf16 v56, v170, s67, v49
    ds_read_b128 v[248:251], v217 offset:35840
    v_dot2_f32_bf16 v57, v170, s68, v49
    v_cvt_pk_bf16_f32 v168, v52, v53
    v_dot2c_f32_bf16 v61, v167, v167
    v_dot2_f32_bf16 v58, v171, s67, v49
    v_dot2_f32_bf16 v59, v171, s68, v49
    v_cvt_pk_bf16_f32 v169, v54, v55
    v_dot2c_f32_bf16 v60, v168, v168
    s_nop 1
    v_cvt_pk_bf16_f32 v170, v56, v57
    v_dot2c_f32_bf16 v61, v169, v169
    s_nop 1
    v_cvt_pk_bf16_f32 v171, v58, v59
    v_dot2c_f32_bf16 v60, v170, v170
    v_dot2c_f32_bf16 v61, v171, v171
    s_waitcnt lgkmcnt(0)
    s_barrier
    buffer_load_dword v2, v219, s[48:51], 0 offen
    s_waitcnt vmcnt(10)
    v_mov_b32 v46, 0
    v_mov_b32 v47, 0
    v_dot2c_f32_bf16 v46, s66, v172
    v_add_f32 v60, v60, v61
    v_dot2c_f32_bf16 v47, s66, v173
    v_dot2c_f32_bf16 v46, s66, v174
    v_dot2c_f32_bf16 v47, s66, v175
    v_add_f32_dpp v61, v60, v60 quad_perm:[1,0,3,2] row_mask:0xf bank_mask:0xf
    v_dot2c_f32_bf16 v46, s66, v176
    v_dot2c_f32_bf16 v47, s66, v177
    v_dot2c_f32_bf16 v46, s66, v178
    v_add_f32_dpp v60, v61, v61 quad_perm:[2,3,0,1] row_mask:0xf bank_mask:0xf
    v_dot2c_f32_bf16 v47, s66, v179
    v_dot2c_f32_bf16 v46, s66, v180
    v_dot2c_f32_bf16 v47, s66, v181
    v_add_f32_dpp v61, v60, v60 row_half_mirror row_mask:0xf bank_mask:0xf
    v_dot2c_f32_bf16 v46, s66, v182
    v_mul_f32 v60, 987991609, v61
    ds_write_b128 v44, v[136:139] offset:0
    v_dot2c_f32_bf16 v47, s66, v183
    v_fma_f32 v60, -v62, v62, v60
    v_dot2c_f32_bf16 v46, s66, v184
    v_max_f32 v60, 0, v60
    v_dot2c_f32_bf16 v47, s66, v185
    v_cvt_pk_bf16_f32 v60, v60, v60
    v_dot2c_f32_bf16 v46, s66, v186
    v_and_b32 v60, 0xffff0000, v60
    v_dot2c_f32_bf16 v47, s66, v187
    v_add_f32 v60, 925353388, v60
    v_dot2c_f32_bf16 v46, s66, v188
    v_cvt_pk_bf16_f32 v60, v60, v60
    v_dot2c_f32_bf16 v47, s66, v189
    v_and_b32 v60, 0xffff0000, v60
    v_dot2c_f32_bf16 v46, s66, v190
    v_sqrt_f32 v60, v60
    v_dot2c_f32_bf16 v47, s66, v191
    s_add_u32 m0, s59, 98304
    v_dot2c_f32_bf16 v46, s66, v192
    v_cvt_pk_bf16_f32 v60, v60, v60
    v_dot2c_f32_bf16 v47, s66, v193
    v_and_b32 v60, 0xffff0000, v60
    v_dot2c_f32_bf16 v46, s66, v194
    v_rcp_f32 v60, v60
    v_dot2c_f32_bf16 v47, s66, v195
    v_dot2c_f32_bf16 v46, s66, v196
    ds_write_b32 v45, v60 offset:64
    v_dot2c_f32_bf16 v47, s66, v197
    v_dot2c_f32_bf16 v46, s66, v198
    v_dot2c_f32_bf16 v47, s66, v199
    v_dot2c_f32_bf16 v46, s66, v200
    v_dot2c_f32_bf16 v47, s66, v201
    v_dot2c_f32_bf16 v46, s66, v202
    v_dot2c_f32_bf16 v47, s66, v203
    v_dot2c_f32_bf16 v46, s66, v204
    v_dot2c_f32_bf16 v47, s66, v205
    ds_write_b128 v44, v[140:143] offset:2048
    v_dot2c_f32_bf16 v46, s66, v206
    v_dot2c_f32_bf16 v47, s66, v207
    s_nop 2
    v_add_f32 v46, v46, v47
    s_nop 1
    v_add_f32_dpp v47, v46, v46 quad_perm:[1,0,3,2] row_mask:0xf bank_mask:0xf
    s_nop 1
    v_add_f32_dpp v46, v47, v47 quad_perm:[2,3,0,1] row_mask:0xf bank_mask:0xf
    s_nop 1
    v_add_f32_dpp v47, v46, v46 row_half_mirror row_mask:0xf bank_mask:0xf
    v_mul_f32 v48, 987991609, v47
    v_cvt_pk_bf16_f32 v49, v48, v48
    v_and_b32 v49, 0xffff0000, v49
    v_sub_f32 v63, v48, v49
    v_xor_b32 v49, 0x80000000, v49
    v_dot2_f32_bf16 v52, v172, s67, v49
    v_dot2_f32_bf16 v53, v172, s68, v49
    ds_write_b128 v44, v[144:147] offset:4096
    v_dot2_f32_bf16 v54, v173, s67, v49
    v_dot2_f32_bf16 v55, v173, s68, v49
    v_dot2_f32_bf16 v56, v174, s67, v49
    v_dot2_f32_bf16 v57, v174, s68, v49
    v_cvt_pk_bf16_f32 v172, v52, v53
    v_dot2_f32_bf16 v58, v175, s67, v49
    v_dot2_f32_bf16 v59, v175, s68, v49
    v_cvt_pk_bf16_f32 v173, v54, v55
    v_mov_b32 v60, 0
    v_mov_b32 v61, 0
    v_dot2c_f32_bf16 v60, v172, v172
    v_dot2_f32_bf16 v52, v176, s67, v49
    v_dot2_f32_bf16 v53, v176, s68, v49
    v_cvt_pk_bf16_f32 v174, v56, v57
    v_dot2c_f32_bf16 v61, v173, v173
    v_dot2_f32_bf16 v54, v177, s67, v49
    v_dot2_f32_bf16 v55, v177, s68, v49
    v_cvt_pk_bf16_f32 v175, v58, v59
    global_load_lds_dwordx4 v[208:209], off offset:0
    v_lshl_add_u64 v[208:209], v[208:209], 0, v[214:215]
    v_dot2c_f32_bf16 v60, v174, v174
    v_dot2_f32_bf16 v56, v178, s67, v49
    v_dot2_f32_bf16 v57, v178, s68, v49
    v_cvt_pk_bf16_f32 v176, v52, v53
    v_dot2c_f32_bf16 v61, v175, v175
    ds_write_b128 v222, v[172:175] offset:0
    v_dot2_f32_bf16 v58, v179, s67, v49
    v_dot2_f32_bf16 v59, v179, s68, v49
    v_cvt_pk_bf16_f32 v177, v54, v55
    v_dot2c_f32_bf16 v60, v176, v176
    v_dot2_f32_bf16 v52, v180, s67, v49
    v_dot2_f32_bf16 v53, v180, s68, v49
    v_cvt_pk_bf16_f32 v178, v56, v57
    v_dot2c_f32_bf16 v61, v177, v177
    v_dot2_f32_bf16 v54, v181, s67, v49
    v_dot2_f32_bf16 v55, v181, s68, v49
    v_cvt_pk_bf16_f32 v179, v58, v59
    ds_write_b128 v44, v[148:151] offset:6144
    v_dot2c_f32_bf16 v60, v178, v178
    v_dot2_f32_bf16 v56, v182, s67, v49
    v_dot2_f32_bf16 v57, v182, s68, v49
    v_cvt_pk_bf16_f32 v180, v52, v53
    v_dot2c_f32_bf16 v61, v179, v179
    ds_write_b128 v222, v[176:179] offset:2048
    v_dot2_f32_bf16 v58, v183, s67, v49
    v_dot2_f32_bf16 v59, v183, s68, v49
    v_cvt_pk_bf16_f32 v181, v54, v55
    v_dot2c_f32_bf16 v60, v180, v180
    v_dot2_f32_bf16 v52, v184, s67, v49
    v_dot2_f32_bf16 v53, v184, s68, v49
    v_cvt_pk_bf16_f32 v182, v56, v57
    v_dot2c_f32_bf16 v61, v181, v181
    v_dot2_f32_bf16 v54, v185, s67, v49
    v_dot2_f32_bf16 v55, v185, s68, v49
    v_cvt_pk_bf16_f32 v183, v58, v59
    v_dot2c_f32_bf16 v60, v182, v182
    ds_write_b128 v44, v[152:155] offset:8192
    v_dot2_f32_bf16 v56, v186, s67, v49
    v_dot2_f32_bf16 v57, v186, s68, v49
    v_cvt_pk_bf16_f32 v184, v52, v53
    v_dot2c_f32_bf16 v61, v183, v183
    ds_write_b128 v222, v[180:183] offset:4096
    v_dot2_f32_bf16 v58, v187, s67, v49
    v_dot2_f32_bf16 v59, v187, s68, v49
    v_cvt_pk_bf16_f32 v185, v54, v55
    v_dot2c_f32_bf16 v60, v184, v184
    v_dot2_f32_bf16 v52, v188, s67, v49
    v_dot2_f32_bf16 v53, v188, s68, v49
    v_cvt_pk_bf16_f32 v186, v56, v57
    v_dot2c_f32_bf16 v61, v185, v185
    v_dot2_f32_bf16 v54, v189, s67, v49
    v_dot2_f32_bf16 v55, v189, s68, v49
    v_cvt_pk_bf16_f32 v187, v58, v59
    v_dot2c_f32_bf16 v60, v186, v186
    global_load_lds_dwordx4 v[210:211], off offset:1024
    v_lshl_add_u64 v[210:211], v[210:211], 0, v[214:215]
    v_dot2_f32_bf16 v56, v190, s67, v49
    v_dot2_f32_bf16 v57, v190, s68, v49
    v_cvt_pk_bf16_f32 v188, v52, v53
    v_dot2c_f32_bf16 v61, v187, v187
    ds_write_b128 v222, v[184:187] offset:6144
    v_dot2_f32_bf16 v58, v191, s67, v49
    v_dot2_f32_bf16 v59, v191, s68, v49
    v_cvt_pk_bf16_f32 v189, v54, v55
    v_dot2c_f32_bf16 v60, v188, v188
    v_dot2_f32_bf16 v52, v192, s67, v49
    v_dot2_f32_bf16 v53, v192, s68, v49
    v_cvt_pk_bf16_f32 v190, v56, v57
    v_dot2c_f32_bf16 v61, v189, v189
    v_dot2_f32_bf16 v54, v193, s67, v49
    v_dot2_f32_bf16 v55, v193, s68, v49
    v_cvt_pk_bf16_f32 v191, v58, v59
    v_dot2c_f32_bf16 v60, v190, v190
    v_dot2_f32_bf16 v56, v194, s67, v49
    ds_write_b128 v44, v[156:159] offset:10240
    v_dot2_f32_bf16 v57, v194, s68, v49
    v_cvt_pk_bf16_f32 v192, v52, v53
    v_dot2c_f32_bf16 v61, v191, v191
    ds_write_b128 v222, v[188:191] offset:8192
    v_dot2_f32_bf16 v58, v195, s67, v49
    v_dot2_f32_bf16 v59, v195, s68, v49
    v_cvt_pk_bf16_f32 v193, v54, v55
    v_dot2c_f32_bf16 v60, v192, v192
    v_dot2_f32_bf16 v52, v196, s67, v49
    v_dot2_f32_bf16 v53, v196, s68, v49
    v_cvt_pk_bf16_f32 v194, v56, v57
    v_dot2c_f32_bf16 v61, v193, v193
    v_dot2_f32_bf16 v54, v197, s67, v49
    v_dot2_f32_bf16 v55, v197, s68, v49
    v_cvt_pk_bf16_f32 v195, v58, v59
    v_dot2c_f32_bf16 v60, v194, v194
    v_dot2_f32_bf16 v56, v198, s67, v49
    ds_write_b128 v44, v[160:163] offset:12288
    v_dot2_f32_bf16 v57, v198, s68, v49
    v_cvt_pk_bf16_f32 v196, v52, v53
    v_dot2c_f32_bf16 v61, v195, v195
    ds_write_b128 v222, v[192:195] offset:10240
    v_dot2_f32_bf16 v58, v199, s67, v49
    v_dot2_f32_bf16 v59, v199, s68, v49
    v_cvt_pk_bf16_f32 v197, v54, v55
    v_dot2c_f32_bf16 v60, v196, v196
    v_dot2_f32_bf16 v52, v200, s67, v49
    v_dot2_f32_bf16 v53, v200, s68, v49
    v_cvt_pk_bf16_f32 v198, v56, v57
    v_dot2c_f32_bf16 v61, v197, v197
    v_dot2_f32_bf16 v54, v201, s67, v49
    v_dot2_f32_bf16 v55, v201, s68, v49
    v_cvt_pk_bf16_f32 v199, v58, v59
    v_dot2c_f32_bf16 v60, v198, v198
    v_dot2_f32_bf16 v56, v202, s67, v49
    v_dot2_f32_bf16 v57, v202, s68, v49
    global_load_lds_dwordx4 v[212:213], off offset:2048
    v_lshl_add_u64 v[212:213], v[212:213], 0, v[214:215]
    v_cvt_pk_bf16_f32 v200, v52, v53
    v_dot2c_f32_bf16 v61, v199, v199
    ds_write_b128 v222, v[196:199] offset:12288
    v_dot2_f32_bf16 v58, v203, s67, v49
    v_dot2_f32_bf16 v59, v203, s68, v49
    v_cvt_pk_bf16_f32 v201, v54, v55
    v_dot2c_f32_bf16 v60, v200, v200
    v_dot2_f32_bf16 v52, v204, s67, v49
    v_dot2_f32_bf16 v53, v204, s68, v49
    v_cvt_pk_bf16_f32 v202, v56, v57
    v_dot2c_f32_bf16 v61, v201, v201
    v_dot2_f32_bf16 v54, v205, s67, v49
    v_dot2_f32_bf16 v55, v205, s68, v49
    v_cvt_pk_bf16_f32 v203, v58, v59
    v_dot2c_f32_bf16 v60, v202, v202
    v_dot2_f32_bf16 v56, v206, s67, v49
    v_dot2_f32_bf16 v57, v206, s68, v49
    ds_write_b128 v44, v[164:167] offset:14336
    v_cvt_pk_bf16_f32 v204, v52, v53
    v_dot2c_f32_bf16 v61, v203, v203
    ds_write_b128 v222, v[200:203] offset:14336
    v_dot2_f32_bf16 v58, v207, s67, v49
    v_dot2_f32_bf16 v59, v207, s68, v49
    v_cvt_pk_bf16_f32 v205, v54, v55
    v_dot2c_f32_bf16 v60, v204, v204
    s_nop 1
    v_cvt_pk_bf16_f32 v206, v56, v57
    v_dot2c_f32_bf16 v61, v205, v205
    s_nop 1
    v_cvt_pk_bf16_f32 v207, v58, v59
    v_dot2c_f32_bf16 v60, v206, v206
    v_dot2c_f32_bf16 v61, v207, v207
    ds_write_b128 v222, v[204:207] offset:16384
    s_nop 2
    v_add_f32 v60, v60, v61
    s_nop 1
    ds_write_b128 v44, v[168:171] offset:16384
    v_add_f32_dpp v61, v60, v60 quad_perm:[1,0,3,2] row_mask:0xf bank_mask:0xf
    s_nop 1
    v_add_f32_dpp v60, v61, v61 quad_perm:[2,3,0,1] row_mask:0xf bank_mask:0xf
    s_nop 1
    v_add_f32_dpp v61, v60, v60 row_half_mirror row_mask:0xf bank_mask:0xf
    v_mul_f32 v60, 987991609, v61
    v_fma_f32 v60, -v63, v63, v60
    v_max_f32 v60, 0, v60
    v_cvt_pk_bf16_f32 v60, v60, v60
    v_and_b32 v60, 0xffff0000, v60
    v_add_f32 v60, 925353388, v60
    v_cvt_pk_bf16_f32 v60, v60, v60
    v_and_b32 v60, 0xffff0000, v60
    v_sqrt_f32 v60, v60
    s_nop 0
    v_cvt_pk_bf16_f32 v60, v60, v60
    v_and_b32 v60, 0xffff0000, v60
    v_rcp_f32 v60, v60
    s_nop 0
    ds_write_b32 v223, v60 offset:64
    s_waitcnt vmcnt(10) lgkmcnt(0)
    s_barrier
    ds_read_b64_tr_b16 v[128:129], v6 offset:36864
    ds_read_b64_tr_b16 v[130:131], v6 offset:37888
    ds_read_b64_tr_b16 v[132:133], v6 offset:40960
    ds_read_b64_tr_b16 v[134:135], v6 offset:41984
    ds_read_b64_tr_b16 v[136:137], v6 offset:45056
    ds_read_b64_tr_b16 v[138:139], v6 offset:46080
    ds_read_b128 a[4:7], v216 offset:0
    ds_read_b128 a[20:23], v217 offset:1024
    ds_read_b128 a[36:39], v216 offset:2048
    ds_read_b128 a[12:15], v216 offset:18432
    ds_read_b128 a[28:31], v217 offset:19456
    ds_read_b128 a[44:47], v216 offset:20480
    ds_read_b32 v16, v218 offset:0
    ds_read_b32 v17, v218 offset:64
    ds_read_b32 v18, v218 offset:128
    ds_read_b32 v19, v218 offset:192
    s_waitcnt lgkmcnt(10)
    v_mfma_f32_16x16x32_bf16 v[96:99], v[128:131], a[0:3], 0
    ds_read_b128 a[52:55], v217 offset:3072
    ds_read_b128 a[60:63], v217 offset:21504
    v_mfma_f32_16x16x32_bf16 v[96:99], v[132:135], a[16:19], v[96:99]
    ds_read_b64_tr_b16 v[140:141], v7 offset:36864
    ds_read_b128 a[68:71], v216 offset:4096
    v_mfma_f32_16x16x32_bf16 v[96:99], v[136:139], a[32:35], v[96:99]
    ds_read_b64_tr_b16 v[142:143], v7 offset:37888
    ds_read_b128 a[76:79], v216 offset:22528
    s_waitcnt lgkmcnt(13)
    v_mfma_f32_16x16x32_bf16 v[100:103], v[136:139], a[36:39], 0
    ds_read_b64_tr_b16 v[144:145], v7 offset:40960
    ds_read_b128 a[84:87], v217 offset:5120
    v_mfma_f32_16x16x32_bf16 v[100:103], v[132:135], a[20:23], v[100:103]
    ds_read_b64_tr_b16 v[146:147], v7 offset:41984
    s_add_u32 m0, s59, 110592
    v_mfma_f32_16x16x32_bf16 v[100:103], v[128:131], a[4:7], v[100:103]
    global_load_lds_dwordx4 v[208:209], off offset:0
    s_waitcnt lgkmcnt(9)
    v_mfma_f32_16x16x32_bf16 v[104:107], v[128:131], a[8:11], 0
    ds_read_b64_tr_b16 v[148:149], v7 offset:45056
    v_lshl_add_u64 v[208:209], v[208:209], 0, v[214:215]
    v_mfma_f32_16x16x32_bf16 v[104:107], v[132:135], a[24:27], v[104:107]
    ds_read_b64_tr_b16 v[150:151], v7 offset:46080
    ds_read_b128 a[92:95], v217 offset:23552
    v_mfma_f32_16x16x32_bf16 v[104:107], v[136:139], a[40:43], v[104:107]
    global_load_lds_dwordx4 v[210:211], off offset:1024
    v_mfma_f32_16x16x32_bf16 v[108:111], v[136:139], a[44:47], 0
    v_lshl_add_u64 v[210:211], v[210:211], 0, v[214:215]
    v_mul_f32 v20, 1051597459, v16
    v_mfma_f32_16x16x32_bf16 v[108:111], v[132:135], a[28:31], v[108:111]
    global_load_lds_dwordx4 v[212:213], off offset:2048
    v_mfma_f32_16x16x32_bf16 v[108:111], v[128:131], a[12:15], v[108:111]
    s_waitcnt lgkmcnt(1)
    s_mov_b32 s60, 0
    v_mfma_f32_16x16x32_bf16 v[112:115], v[140:143], a[0:3], 0
    s_waitcnt vmcnt(10)
    s_barrier
    v_mfma_f32_16x16x32_bf16 v[112:115], v[144:147], a[16:19], v[112:115]
    ds_read_b64_tr_b16 v[128:129], v4 offset:24576
    s_add_u32 m0, s59, 147456
    v_mfma_f32_16x16x32_bf16 v[112:115], v[148:151], a[32:35], v[112:115]
    buffer_load_dwordx4 v10, s[32:35], s60 offen offset:0  lds
    v_mfma_f32_16x16x32_bf16 v[116:119], v[148:151], a[36:39], 0
    ds_read_b64_tr_b16 v[130:131], v4 offset:25600
    v_mul_f32 v21, 1051597459, v17
    v_mfma_f32_16x16x32_bf16 v[116:119], v[144:147], a[20:23], v[116:119]
    ds_read_b64_tr_b16 v[132:133], v4 offset:28672
    v_mul_f32 v22, 1051597459, v18
    v_mfma_f32_16x16x32_bf16 v[116:119], v[140:143], a[4:7], v[116:119]
    ds_read_b64_tr_b16 v[134:135], v4 offset:29696
    v_mul_f32 v23, 1051597459, v19
    v_mfma_f32_16x16x32_bf16 v[120:123], v[140:143], a[8:11], 0
    ds_read_b64_tr_b16 v[136:137], v4 offset:32768
    v_bfe_u32 v160, v1, 5, 1
    v_mfma_f32_16x16x32_bf16 v[120:123], v[144:147], a[24:27], v[120:123]
    buffer_load_dwordx4 v11, s[32:35], s60 offen offset:1024  lds
    v_mfma_f32_16x16x32_bf16 v[120:123], v[148:151], a[40:43], v[120:123]
    ds_read_b64_tr_b16 v[138:139], v4 offset:33792
    v_lshlrev_b32 v160, 8, v160
    v_mfma_f32_16x16x32_bf16 v[124:127], v[148:151], a[44:47], 0
    v_and_b32 v161, 31, v1
    v_lshl_add_u32 v160, v161, 2, v160
    v_mfma_f32_16x16x32_bf16 v[124:127], v[144:147], a[28:31], v[124:127]
    v_lshl_add_u64 v[212:213], v[212:213], 0, v[214:215]
    s_lshl_b32 s62, s52, 9
    v_mfma_f32_16x16x32_bf16 v[124:127], v[140:143], a[12:15], v[124:127]
    s_waitcnt lgkmcnt(0)
    s_add_u32 s62, s62, 143488
    v_mfma_f32_16x16x32_bf16 v[96:99], v[128:131], a[48:51], v[96:99]
    buffer_load_dwordx4 v12, s[32:35], s60 offen offset:2048  lds
    v_mfma_f32_16x16x32_bf16 v[96:99], v[132:135], a[64:67], v[96:99]
    ds_read_b64_tr_b16 v[140:141], v5 offset:24576
    ds_read_b128 a[100:103], v216 offset:6144
    v_mfma_f32_16x16x32_bf16 v[96:99], v[136:139], a[80:83], v[96:99]
    ds_read_b64_tr_b16 v[142:143], v5 offset:25600
    ds_read_b128 a[108:111], v216 offset:24576
    v_mfma_f32_16x16x32_bf16 v[100:103], v[136:139], a[84:87], v[100:103]
    ds_read_b64_tr_b16 v[144:145], v5 offset:28672
    ds_read_b128 a[116:119], v217 offset:7168
    v_mfma_f32_16x16x32_bf16 v[100:103], v[132:135], a[68:71], v[100:103]
    ds_read_b64_tr_b16 v[146:147], v5 offset:29696
    s_add_u32 m0, s59, 122880
    v_mfma_f32_16x16x32_bf16 v[100:103], v[128:131], a[52:55], v[100:103]
    global_load_lds_dwordx4 v[208:209], off offset:0
    v_mfma_f32_16x16x32_bf16 v[104:107], v[128:131], a[56:59], v[104:107]
    ds_read_b64_tr_b16 v[148:149], v5 offset:32768
    ds_read_b128 a[124:127], v217 offset:25600
    v_mfma_f32_16x16x32_bf16 v[104:107], v[132:135], a[72:75], v[104:107]
    ds_read_b64_tr_b16 v[150:151], v5 offset:33792
    ds_read_b128 a[132:135], v216 offset:8192
    v_mfma_f32_16x16x32_bf16 v[104:107], v[136:139], a[88:91], v[104:107]
    global_load_lds_dwordx4 v[210:211], off offset:1024
    v_mfma_f32_16x16x32_bf16 v[108:111], v[136:139], a[92:95], v[108:111]
    ds_read_b128 a[140:143], v216 offset:26624
    v_add_u32 v160, s62, v160
    v_mfma_f32_16x16x32_bf16 v[108:111], v[132:135], a[76:79], v[108:111]
    global_load_lds_dwordx4 v[212:213], off offset:2048
    v_mfma_f32_16x16x32_bf16 v[108:111], v[128:131], a[60:63], v[108:111]
    s_waitcnt lgkmcnt(2)
    s_mov_b32 s60, 0
    v_mfma_f32_16x16x32_bf16 v[112:115], v[140:143], a[48:51], v[112:115]
    s_waitcnt vmcnt(13)
    s_barrier
    v_mfma_f32_16x16x32_bf16 v[112:115], v[144:147], a[64:67], v[112:115]
    ds_read_b64_tr_b16 v[128:129], v4 offset:36864
    s_add_u32 m0, s59, 73728
    v_mfma_f32_16x16x32_bf16 v[112:115], v[148:151], a[80:83], v[112:115]
    buffer_load_dwordx4 v10, s[36:39], s60 offen offset:0  lds
    v_mfma_f32_16x16x32_bf16 v[116:119], v[148:151], a[84:87], v[116:119]
    ds_read_b64_tr_b16 v[130:131], v4 offset:37888
    v_mov_b32 v161, 0
    v_mfma_f32_16x16x32_bf16 v[116:119], v[144:147], a[68:71], v[116:119]
    ds_read_b64_tr_b16 v[132:133], v4 offset:40960
    ds_write_b32 v160, v161
    v_mfma_f32_16x16x32_bf16 v[116:119], v[140:143], a[52:55], v[116:119]
    ds_read_b64_tr_b16 v[134:135], v4 offset:41984
    v_mfma_f32_16x16x32_bf16 v[120:123], v[140:143], a[56:59], v[120:123]
    ds_read_b64_tr_b16 v[136:137], v4 offset:45056
    v_and_b32 v160, 15, v1
    v_mfma_f32_16x16x32_bf16 v[120:123], v[144:147], a[72:75], v[120:123]
    buffer_load_dwordx4 v11, s[36:39], s60 offen offset:1024  lds
    v_mfma_f32_16x16x32_bf16 v[120:123], v[148:151], a[88:91], v[120:123]
    ds_read_b64_tr_b16 v[138:139], v4 offset:46080
    v_lshrrev_b32 v161, 4, v1
    v_mfma_f32_16x16x32_bf16 v[124:127], v[148:151], a[92:95], v[124:127]
    s_lshl_b32 s62, s56, 2
    s_lshl_b32 s63, s55, 1
    v_mfma_f32_16x16x32_bf16 v[124:127], v[144:147], a[76:79], v[124:127]
    s_add_u32 s62, s62, s63
    s_lshl_b32 s63, s62, 10
    v_mfma_f32_16x16x32_bf16 v[124:127], v[140:143], a[60:63], v[124:127]
    s_waitcnt lgkmcnt(0)
    s_add_u32 s63, s63, 135168
    v_mfma_f32_16x16x32_bf16 v[96:99], v[128:131], a[96:99], v[96:99]
    buffer_load_dwordx4 v12, s[36:39], s60 offen offset:2048  lds
    v_mfma_f32_16x16x32_bf16 v[96:99], v[132:135], a[112:115], v[96:99]
    ds_read_b64_tr_b16 v[140:141], v5 offset:36864
    ds_read_b128 a[148:151], v217 offset:9216
    v_mfma_f32_16x16x32_bf16 v[96:99], v[136:139], a[128:131], v[96:99]
    ds_read_b64_tr_b16 v[142:143], v5 offset:37888
    ds_read_b128 a[156:159], v217 offset:27648
    v_mfma_f32_16x16x32_bf16 v[100:103], v[136:139], a[132:135], v[100:103]
    ds_read_b64_tr_b16 v[144:145], v5 offset:40960
    ds_read_b128 a[164:167], v216 offset:10240
    v_mfma_f32_16x16x32_bf16 v[100:103], v[132:135], a[116:119], v[100:103]
    ds_read_b64_tr_b16 v[146:147], v5 offset:41984
    ds_read_b128 a[172:175], v216 offset:28672
    v_mfma_f32_16x16x32_bf16 v[100:103], v[128:131], a[100:103], v[100:103]
    ds_read_b128 a[180:183], v217 offset:11264
    ds_read_b128 a[188:191], v217 offset:29696
    v_mfma_f32_16x16x32_bf16 v[104:107], v[128:131], a[104:107], v[104:107]
    ds_read_b64_tr_b16 v[148:149], v5 offset:45056
    s_lshl_b32 s62, s62, 8
    v_mfma_f32_16x16x32_bf16 v[104:107], v[132:135], a[120:123], v[104:107]
    ds_read_b64_tr_b16 v[150:151], v5 offset:46080
    s_add_u32 s62, s62, 143360
    v_mfma_f32_16x16x32_bf16 v[104:107], v[136:139], a[136:139], v[104:107]
    v_lshlrev_b32 v158, 5, v160
    v_lshl_add_u32 v158, v161, 3, v158
    v_mfma_f32_16x16x32_bf16 v[108:111], v[136:139], a[140:143], v[108:111]
    v_add_u32 v158, s63, v158
    v_lshl_add_u32 v159, v160, 2, s62
    v_mfma_f32_16x16x32_bf16 v[108:111], v[132:135], a[124:127], v[108:111]
    v_cmp_eq_u32 vcc, 1, v161
    v_mov_b32 v162, 145408
    v_mfma_f32_16x16x32_bf16 v[108:111], v[128:131], a[108:111], v[108:111]
    s_waitcnt lgkmcnt(0)
    s_mov_b32 s60, 884736
    v_mfma_f32_16x16x32_bf16 v[112:115], v[140:143], a[96:99], v[112:115]
    s_waitcnt vmcnt(12)
    s_barrier
    v_mfma_f32_16x16x32_bf16 v[112:115], v[144:147], a[112:115], v[112:115]
    ds_read_b64_tr_b16 v[128:129], v4 offset:49152
    s_add_u32 m0, s59, 86016
    v_mfma_f32_16x16x32_bf16 v[112:115], v[148:151], a[128:131], v[112:115]
    buffer_load_dwordx4 v10, s[32:35], s60 offen offset:0  lds
    v_mfma_f32_16x16x32_bf16 v[116:119], v[148:151], a[132:135], v[116:119]
    ds_read_b64_tr_b16 v[130:131], v4 offset:50176
    v_lshl_add_u32 v162, v160, 2, v162
    v_mfma_f32_16x16x32_bf16 v[116:119], v[144:147], a[116:119], v[116:119]
    ds_read_b64_tr_b16 v[132:133], v4 offset:53248
    v_cndmask_b32 v159, v162, v159, vcc
    v_mfma_f32_16x16x32_bf16 v[116:119], v[140:143], a[100:103], v[116:119]
    ds_read_b64_tr_b16 v[134:135], v4 offset:54272
    v_mfma_f32_16x16x32_bf16 v[120:123], v[140:143], a[104:107], v[120:123]
    ds_read_b64_tr_b16 v[136:137], v4 offset:57344
    v_mfma_f32_16x16x32_bf16 v[120:123], v[144:147], a[120:123], v[120:123]
    buffer_load_dwordx4 v11, s[32:35], s60 offen offset:1024  lds
    v_mfma_f32_16x16x32_bf16 v[120:123], v[148:151], a[136:139], v[120:123]
    ds_read_b64_tr_b16 v[138:139], v4 offset:58368
    v_mfma_f32_16x16x32_bf16 v[124:127], v[148:151], a[140:143], v[124:127]
    v_mfma_f32_16x16x32_bf16 v[124:127], v[144:147], a[124:127], v[124:127]
    v_mfma_f32_16x16x32_bf16 v[124:127], v[140:143], a[108:111], v[124:127]
    s_waitcnt lgkmcnt(0)
    v_mfma_f32_16x16x32_bf16 v[96:99], v[128:131], a[144:147], v[96:99]
    buffer_load_dwordx4 v12, s[32:35], s60 offen offset:2048  lds
    v_mfma_f32_16x16x32_bf16 v[96:99], v[132:135], a[160:163], v[96:99]
    ds_read_b64_tr_b16 v[140:141], v5 offset:49152
    ds_read_b128 a[196:199], v216 offset:12288
    v_mfma_f32_16x16x32_bf16 v[96:99], v[136:139], a[176:179], v[96:99]
    ds_read_b64_tr_b16 v[142:143], v5 offset:50176
    ds_read_b128 a[204:207], v216 offset:30720
    v_mfma_f32_16x16x32_bf16 v[100:103], v[136:139], a[180:183], v[100:103]
    ds_read_b64_tr_b16 v[144:145], v5 offset:53248
    ds_read_b128 a[212:215], v217 offset:13312
    v_mfma_f32_16x16x32_bf16 v[100:103], v[132:135], a[164:167], v[100:103]
    ds_read_b64_tr_b16 v[146:147], v5 offset:54272
    ds_read_b128 a[220:223], v217 offset:31744
    v_mfma_f32_16x16x32_bf16 v[100:103], v[128:131], a[148:151], v[100:103]
    ds_read_b128 a[228:231], v216 offset:14336
    ds_read_b128 a[236:239], v216 offset:32768
    v_mfma_f32_16x16x32_bf16 v[104:107], v[128:131], a[152:155], v[104:107]
    ds_read_b64_tr_b16 v[148:149], v5 offset:57344
    s_lshl_b32 s4, s54, 4
    v_mfma_f32_16x16x32_bf16 v[104:107], v[132:135], a[168:171], v[104:107]
    ds_read_b64_tr_b16 v[150:151], v5 offset:58368
    s_add_u32 s4, s4, s53
    v_mfma_f32_16x16x32_bf16 v[104:107], v[136:139], a[184:187], v[104:107]
    s_lshl_b32 s4, s4, 2
    s_add_u32 s4, s4, s52
    v_mfma_f32_16x16x32_bf16 v[108:111], v[136:139], a[188:191], v[108:111]
    s_mul_i32 s5, s4, 41
    s_mul_i32 s4, s4, 6
    v_mfma_f32_16x16x32_bf16 v[108:111], v[132:135], a[172:175], v[108:111]
    v_min_u32 v220, 13, v1
    v_add_u32 v220, s5, v220
    v_mfma_f32_16x16x32_bf16 v[108:111], v[128:131], a[156:159], v[108:111]
    s_waitcnt lgkmcnt(0)
    s_mov_b32 s60, 884736
    v_mfma_f32_16x16x32_bf16 v[112:115], v[140:143], a[144:147], v[112:115]
    s_waitcnt vmcnt(12)
    s_barrier
    v_mfma_f32_16x16x32_bf16 v[112:115], v[144:147], a[160:163], v[112:115]
    ds_read_b64_tr_b16 v[128:129], v6 offset:0
    s_add_u32 m0, s59, 98304
    v_mfma_f32_16x16x32_bf16 v[112:115], v[148:151], a[176:179], v[112:115]
    buffer_load_dwordx4 v10, s[36:39], s60 offen offset:0  lds
    v_mfma_f32_16x16x32_bf16 v[116:119], v[148:151], a[180:183], v[116:119]
    ds_read_b64_tr_b16 v[130:131], v6 offset:1024
    v_lshlrev_b32 v220, 7, v220
    v_mfma_f32_16x16x32_bf16 v[116:119], v[144:147], a[164:167], v[116:119]
    ds_read_b64_tr_b16 v[132:133], v6 offset:4096
    v_min_u32 v221, 5, v1
    v_mfma_f32_16x16x32_bf16 v[116:119], v[140:143], a[148:151], v[116:119]
    ds_read_b64_tr_b16 v[134:135], v6 offset:5120
    v_add_u32 v221, s4, v221
    v_mfma_f32_16x16x32_bf16 v[120:123], v[140:143], a[152:155], v[120:123]
    ds_read_b64_tr_b16 v[136:137], v6 offset:8192
    v_lshlrev_b32 v221, 7, v221
    v_mfma_f32_16x16x32_bf16 v[120:123], v[144:147], a[168:171], v[120:123]
    buffer_load_dwordx4 v11, s[36:39], s60 offen offset:1024  lds
    v_mfma_f32_16x16x32_bf16 v[120:123], v[148:151], a[184:187], v[120:123]
    ds_read_b64_tr_b16 v[138:139], v6 offset:9216
    v_min_u32 v221, 663548, v221
    v_mfma_f32_16x16x32_bf16 v[124:127], v[148:151], a[188:191], v[124:127]
    v_mfma_f32_16x16x32_bf16 v[124:127], v[144:147], a[172:175], v[124:127]
    v_mfma_f32_16x16x32_bf16 v[124:127], v[140:143], a[156:159], v[124:127]
    s_waitcnt lgkmcnt(0)
    v_mfma_f32_16x16x32_bf16 v[96:99], v[128:131], a[192:195], v[96:99]
    buffer_load_dwordx4 v12, s[36:39], s60 offen offset:2048  lds
    v_mfma_f32_16x16x32_bf16 v[96:99], v[132:135], a[208:211], v[96:99]
    ds_read_b64_tr_b16 v[140:141], v7 offset:0
    ds_read_b128 a[244:247], v217 offset:15360
    v_mfma_f32_16x16x32_bf16 v[96:99], v[136:139], a[224:227], v[96:99]
    ds_read_b64_tr_b16 v[142:143], v7 offset:1024
    ds_read_b128 a[252:255], v217 offset:33792
    v_mfma_f32_16x16x32_bf16 v[100:103], v[136:139], a[228:231], v[100:103]
    ds_read_b64_tr_b16 v[144:145], v7 offset:4096
    ds_read_b128 v[228:231], v216 offset:16384
    v_mfma_f32_16x16x32_bf16 v[100:103], v[132:135], a[212:215], v[100:103]
    ds_read_b64_tr_b16 v[146:147], v7 offset:5120
    ds_read_b128 v[236:239], v216 offset:34816
    v_mfma_f32_16x16x32_bf16 v[100:103], v[128:131], a[196:199], v[100:103]
    ds_read_b128 v[244:247], v217 offset:17408
    ds_read_b128 v[252:255], v217 offset:35840
    v_mfma_f32_16x16x32_bf16 v[104:107], v[128:131], a[200:203], v[104:107]
    ds_read_b64_tr_b16 v[148:149], v7 offset:8192
    v_mfma_f32_16x16x32_bf16 v[104:107], v[132:135], a[216:219], v[104:107]
    ds_read_b64_tr_b16 v[150:151], v7 offset:9216
    v_mfma_f32_16x16x32_bf16 v[104:107], v[136:139], a[232:235], v[104:107]
    v_mfma_f32_16x16x32_bf16 v[108:111], v[136:139], a[236:239], v[108:111]
    buffer_load_dword v2, v219, s[48:51], 0 offen offset:128
    v_mfma_f32_16x16x32_bf16 v[108:111], v[132:135], a[220:223], v[108:111]
    v_mfma_f32_16x16x32_bf16 v[108:111], v[128:131], a[204:207], v[108:111]
    s_waitcnt lgkmcnt(0)
    s_mov_b32 s60, 1769472
    v_mfma_f32_16x16x32_bf16 v[112:115], v[140:143], a[192:195], v[112:115]
    s_waitcnt vmcnt(10)
    s_barrier
    v_mfma_f32_16x16x32_bf16 v[112:115], v[144:147], a[208:211], v[112:115]
    ds_read_b64_tr_b16 v[128:129], v6 offset:12288
    s_add_u32 m0, s59, 110592
    v_mfma_f32_16x16x32_bf16 v[112:115], v[148:151], a[224:227], v[112:115]
    buffer_load_dwordx4 v10, s[32:35], s60 offen offset:0  lds
    v_mfma_f32_16x16x32_bf16 v[116:119], v[148:151], a[228:231], v[116:119]
    ds_read_b64_tr_b16 v[130:131], v6 offset:13312
    v_mfma_f32_16x16x32_bf16 v[116:119], v[144:147], a[212:215], v[116:119]
    ds_read_b64_tr_b16 v[132:133], v6 offset:16384
    v_mfma_f32_16x16x32_bf16 v[116:119], v[140:143], a[196:199], v[116:119]
    ds_read_b64_tr_b16 v[134:135], v6 offset:17408
    v_mfma_f32_16x16x32_bf16 v[120:123], v[140:143], a[200:203], v[120:123]
    ds_read_b64_tr_b16 v[136:137], v6 offset:20480
    v_mfma_f32_16x16x32_bf16 v[120:123], v[144:147], a[216:219], v[120:123]
    buffer_load_dwordx4 v11, s[32:35], s60 offen offset:1024  lds
    v_mfma_f32_16x16x32_bf16 v[120:123], v[148:151], a[232:235], v[120:123]
    ds_read_b64_tr_b16 v[138:139], v6 offset:21504
    v_mfma_f32_16x16x32_bf16 v[124:127], v[148:151], a[236:239], v[124:127]
    v_mfma_f32_16x16x32_bf16 v[124:127], v[144:147], a[220:223], v[124:127]
    v_mfma_f32_16x16x32_bf16 v[124:127], v[140:143], a[204:207], v[124:127]
    s_waitcnt lgkmcnt(0)
    v_mfma_f32_16x16x32_bf16 v[96:99], v[128:131], a[240:243], v[96:99]
    buffer_load_dwordx4 v12, s[32:35], s60 offen offset:2048  lds
    v_mfma_f32_16x16x32_bf16 v[96:99], v[132:135], v[224:227], v[96:99]
    ds_read_b64_tr_b16 v[140:141], v7 offset:12288
    v_mfma_f32_16x16x32_bf16 v[96:99], v[136:139], v[240:243], v[96:99]
    ds_read_b64_tr_b16 v[142:143], v7 offset:13312
    v_mfma_f32_16x16x32_bf16 v[100:103], v[136:139], v[244:247], v[100:103]
    ds_read_b64_tr_b16 v[144:145], v7 offset:16384
    v_mfma_f32_16x16x32_bf16 v[100:103], v[132:135], v[228:231], v[100:103]
    ds_read_b64_tr_b16 v[146:147], v7 offset:17408
    v_mfma_f32_16x16x32_bf16 v[100:103], v[128:131], a[244:247], v[100:103]
    v_mfma_f32_16x16x32_bf16 v[104:107], v[128:131], a[248:251], v[104:107]
    ds_read_b64_tr_b16 v[148:149], v7 offset:20480
    v_mfma_f32_16x16x32_bf16 v[104:107], v[132:135], v[232:235], v[104:107]
    ds_read_b64_tr_b16 v[150:151], v7 offset:21504
    v_mfma_f32_16x16x32_bf16 v[104:107], v[136:139], v[248:251], v[104:107]
    v_mfma_f32_16x16x32_bf16 v[108:111], v[136:139], v[252:255], v[108:111]
    v_mfma_f32_16x16x32_bf16 v[108:111], v[132:135], v[236:239], v[108:111]
    v_mul_f32 v160, v20, v96
    v_mul_f32 v161, v20, v97
    v_mfma_f32_16x16x32_bf16 v[108:111], v[128:131], a[252:255], v[108:111]
    s_waitcnt lgkmcnt(0)
    s_mov_b32 s60, 1769472
    v_mfma_f32_16x16x32_bf16 v[112:115], v[140:143], a[240:243], v[112:115]
    s_barrier
    v_mfma_f32_16x16x32_bf16 v[112:115], v[144:147], v[224:227], v[112:115]
    ds_read_b64_tr_b16 v[128:129], v6 offset:36864
    s_add_u32 m0, s59, 122880
    v_mfma_f32_16x16x32_bf16 v[112:115], v[148:151], v[240:243], v[112:115]
    buffer_load_dwordx4 v10, s[36:39], s60 offen offset:0  lds
    v_mfma_f32_16x16x32_bf16 v[116:119], v[148:151], v[244:247], v[116:119]
    ds_read_b64_tr_b16 v[130:131], v6 offset:37888
    v_mul_f32 v162, v20, v98
    v_mfma_f32_16x16x32_bf16 v[116:119], v[144:147], v[228:231], v[116:119]
    ds_read_b64_tr_b16 v[132:133], v6 offset:40960
    v_mul_f32 v163, v20, v99
    v_mfma_f32_16x16x32_bf16 v[116:119], v[140:143], a[244:247], v[116:119]
    ds_read_b64_tr_b16 v[134:135], v6 offset:41984
    v_cvt_pk_bf16_f32 v160, v160, v161
    v_mfma_f32_16x16x32_bf16 v[120:123], v[140:143], a[248:251], v[120:123]
    ds_read_b64_tr_b16 v[136:137], v6 offset:45056
    v_cvt_pk_bf16_f32 v161, v162, v163
    v_mfma_f32_16x16x32_bf16 v[120:123], v[144:147], v[232:235], v[120:123]
    buffer_load_dwordx4 v11, s[36:39], s60 offen offset:1024  lds
    v_mfma_f32_16x16x32_bf16 v[120:123], v[148:151], v[248:251], v[120:123]
    ds_read_b64_tr_b16 v[138:139], v6 offset:46080
    v_mfma_f32_16x16x32_bf16 v[124:127], v[148:151], v[252:255], v[124:127]
    v_mfma_f32_16x16x32_bf16 v[124:127], v[144:147], v[236:239], v[124:127]
    ds_write_b64 v158, v[160:161] offset:0
    v_mfma_f32_16x16x32_bf16 v[124:127], v[140:143], a[252:255], v[124:127]
    s_waitcnt lgkmcnt(1)
    v_mul_f32 v164, v21, v100
    v_mfma_f32_16x16x32_bf16 v[32:35], v[128:131], a[0:3], 0
    buffer_load_dwordx4 v12, s[36:39], s60 offen offset:2048  lds
    v_mfma_f32_16x16x32_bf16 v[32:35], v[132:135], a[16:19], v[32:35]
    ds_read_b64_tr_b16 v[140:141], v7 offset:36864
    v_mul_f32 v165, v21, v101
    v_mfma_f32_16x16x32_bf16 v[32:35], v[136:139], a[32:35], v[32:35]
    ds_read_b64_tr_b16 v[142:143], v7 offset:37888
    v_mul_f32 v166, v21, v102
    v_mfma_f32_16x16x32_bf16 v[36:39], v[136:139], a[36:39], 0
    ds_read_b64_tr_b16 v[144:145], v7 offset:40960
    v_mul_f32 v167, v21, v103
    v_mfma_f32_16x16x32_bf16 v[36:39], v[132:135], a[20:23], v[36:39]
    ds_read_b64_tr_b16 v[146:147], v7 offset:41984
    v_cvt_pk_bf16_f32 v164, v164, v165
    v_mfma_f32_16x16x32_bf16 v[36:39], v[128:131], a[4:7], v[36:39]
    buffer_load_dword v2, v220, s[40:43], 0 offen offset:0
    v_mfma_f32_16x16x32_bf16 v[40:43], v[128:131], a[8:11], 0
    ds_read_b64_tr_b16 v[148:149], v7 offset:45056
    v_cvt_pk_bf16_f32 v165, v166, v167
    v_mfma_f32_16x16x32_bf16 v[40:43], v[132:135], a[24:27], v[40:43]
    ds_read_b64_tr_b16 v[150:151], v7 offset:46080
    v_mfma_f32_16x16x32_bf16 v[40:43], v[136:139], a[40:43], v[40:43]
    v_mfma_f32_16x16x32_bf16 v[44:47], v[136:139], a[44:47], 0
    v_mfma_f32_16x16x32_bf16 v[44:47], v[132:135], a[28:31], v[44:47]
    ds_write_b64 v158, v[164:165] offset:512
    v_mfma_f32_16x16x32_bf16 v[44:47], v[128:131], a[12:15], v[44:47]
    s_waitcnt lgkmcnt(1)
    s_mov_b32 s60, 2654208
    v_mfma_f32_16x16x32_bf16 v[48:51], v[140:143], a[0:3], 0
    s_waitcnt vmcnt(14)
    s_barrier
    v_mfma_f32_16x16x32_bf16 v[48:51], v[144:147], a[16:19], v[48:51]
    ds_read_b64_tr_b16 v[128:129], v4 offset:24576
    s_add_u32 m0, s59, 147456
    v_mfma_f32_16x16x32_bf16 v[48:51], v[148:151], a[32:35], v[48:51]
    buffer_load_dwordx4 v10, s[32:35], s60 offen offset:0  lds
    v_mfma_f32_16x16x32_bf16 v[52:55], v[148:151], a[36:39], 0
    ds_read_b64_tr_b16 v[130:131], v4 offset:25600
    v_mul_f32 v168, v22, v104
    v_mfma_f32_16x16x32_bf16 v[52:55], v[144:147], a[20:23], v[52:55]
    ds_read_b64_tr_b16 v[132:133], v4 offset:28672
    v_mul_f32 v169, v22, v105
    v_mfma_f32_16x16x32_bf16 v[52:55], v[140:143], a[4:7], v[52:55]
    ds_read_b64_tr_b16 v[134:135], v4 offset:29696
    v_mul_f32 v170, v22, v106
    v_mfma_f32_16x16x32_bf16 v[56:59], v[140:143], a[8:11], 0
    ds_read_b64_tr_b16 v[136:137], v4 offset:32768
    v_mul_f32 v171, v22, v107
    v_mfma_f32_16x16x32_bf16 v[56:59], v[144:147], a[24:27], v[56:59]
    buffer_load_dwordx4 v11, s[32:35], s60 offen offset:1024  lds
    v_mfma_f32_16x16x32_bf16 v[56:59], v[148:151], a[40:43], v[56:59]
    ds_read_b64_tr_b16 v[138:139], v4 offset:33792
    v_cvt_pk_bf16_f32 v168, v168, v169
    v_mfma_f32_16x16x32_bf16 v[60:63], v[148:151], a[44:47], 0
    v_cvt_pk_bf16_f32 v169, v170, v171
    v_mfma_f32_16x16x32_bf16 v[60:63], v[144:147], a[28:31], v[60:63]
    ds_write_b64 v158, v[168:169] offset:1024
    v_mfma_f32_16x16x32_bf16 v[60:63], v[140:143], a[12:15], v[60:63]
    s_waitcnt lgkmcnt(1)
    v_mul_f32 v172, v23, v108
    v_mfma_f32_16x16x32_bf16 v[64:67], v[128:131], a[0:3], 0
    buffer_load_dwordx4 v12, s[32:35], s60 offen offset:2048  lds
    v_mfma_f32_16x16x32_bf16 v[64:67], v[132:135], a[16:19], v[64:67]
    ds_read_b64_tr_b16 v[140:141], v5 offset:24576
    v_mul_f32 v173, v23, v109
    v_mfma_f32_16x16x32_bf16 v[64:67], v[136:139], a[32:35], v[64:67]
    ds_read_b64_tr_b16 v[142:143], v5 offset:25600
    v_mul_f32 v174, v23, v110
    v_mfma_f32_16x16x32_bf16 v[68:71], v[136:139], a[36:39], 0
    ds_read_b64_tr_b16 v[144:145], v5 offset:28672
    v_mul_f32 v175, v23, v111
    v_mfma_f32_16x16x32_bf16 v[68:71], v[132:135], a[20:23], v[68:71]
    ds_read_b64_tr_b16 v[146:147], v5 offset:29696
    v_cvt_pk_bf16_f32 v172, v172, v173
    v_mfma_f32_16x16x32_bf16 v[68:71], v[128:131], a[4:7], v[68:71]
    v_cvt_pk_bf16_f32 v173, v174, v175
    v_mfma_f32_16x16x32_bf16 v[72:75], v[128:131], a[8:11], 0
    ds_read_b64_tr_b16 v[148:149], v5 offset:32768
    v_mfma_f32_16x16x32_bf16 v[72:75], v[132:135], a[24:27], v[72:75]
    ds_read_b64_tr_b16 v[150:151], v5 offset:33792
    v_mfma_f32_16x16x32_bf16 v[72:75], v[136:139], a[40:43], v[72:75]
    v_mfma_f32_16x16x32_bf16 v[76:79], v[136:139], a[44:47], 0
    v_mfma_f32_16x16x32_bf16 v[76:79], v[132:135], a[28:31], v[76:79]
    ds_write_b64 v158, v[172:173] offset:1536
    v_mfma_f32_16x16x32_bf16 v[76:79], v[128:131], a[12:15], v[76:79]
    s_waitcnt lgkmcnt(1)
    s_mov_b32 s60, 2654208
    v_mfma_f32_16x16x32_bf16 v[80:83], v[140:143], a[0:3], 0
    s_waitcnt vmcnt(14)
    s_barrier
    v_mfma_f32_16x16x32_bf16 v[80:83], v[144:147], a[16:19], v[80:83]
    ds_read_b64_tr_b16 v[128:129], v4 offset:36864
    s_add_u32 m0, s59, 73728
    v_mfma_f32_16x16x32_bf16 v[80:83], v[148:151], a[32:35], v[80:83]
    buffer_load_dwordx4 v10, s[36:39], s60 offen offset:0  lds
    v_mfma_f32_16x16x32_bf16 v[84:87], v[148:151], a[36:39], 0
    ds_read_b64_tr_b16 v[130:131], v4 offset:37888
    v_mul_f32 v176, v20, v114
    v_mfma_f32_16x16x32_bf16 v[84:87], v[144:147], a[20:23], v[84:87]
    ds_read_b64_tr_b16 v[132:133], v4 offset:40960
    v_mul_f32 v177, v20, v115
    v_mfma_f32_16x16x32_bf16 v[84:87], v[140:143], a[4:7], v[84:87]
    ds_read_b64_tr_b16 v[134:135], v4 offset:41984
    v_cvt_pk_bf16_f32 v176, v176, v177
    v_mfma_f32_16x16x32_bf16 v[88:91], v[140:143], a[8:11], 0
    ds_read_b64_tr_b16 v[136:137], v4 offset:45056
    v_mfma_f32_16x16x32_bf16 v[88:91], v[144:147], a[24:27], v[88:91]
    buffer_load_dwordx4 v11, s[36:39], s60 offen offset:1024  lds
    v_mfma_f32_16x16x32_bf16 v[88:91], v[148:151], a[40:43], v[88:91]
    ds_read_b64_tr_b16 v[138:139], v4 offset:46080
    v_mfma_f32_16x16x32_bf16 v[92:95], v[148:151], a[44:47], 0
    v_mfma_f32_16x16x32_bf16 v[92:95], v[144:147], a[28:31], v[92:95]
    ds_write_b32 v159, v176 offset:0
    v_mfma_f32_16x16x32_bf16 v[92:95], v[140:143], a[12:15], v[92:95]
    s_waitcnt lgkmcnt(1)
    v_mul_f32 v178, v21, v118
    s_cmp_lt_u32 s61, 3
    s_cbranch_scc1 L_kv_blk
L_kv_skip:
    v_mfma_f32_16x16x32_bf16 v[32:35], v[128:131], a[48:51], v[32:35]
    buffer_load_dwordx4 v12, s[36:39], s60 offen offset:2048  lds
    v_mfma_f32_16x16x32_bf16 v[32:35], v[132:135], a[64:67], v[32:35]
    ds_read_b64_tr_b16 v[140:141], v5 offset:36864
    v_mul_f32 v179, v21, v119
    v_mfma_f32_16x16x32_bf16 v[32:35], v[136:139], a[80:83], v[32:35]
    ds_read_b64_tr_b16 v[142:143], v5 offset:37888
    v_cvt_pk_bf16_f32 v178, v178, v179
    v_mfma_f32_16x16x32_bf16 v[36:39], v[136:139], a[84:87], v[36:39]
    ds_read_b64_tr_b16 v[144:145], v5 offset:40960
    s_lshl_b32 s69, s52, 4
    v_mfma_f32_16x16x32_bf16 v[36:39], v[132:135], a[68:71], v[36:39]
    ds_read_b64_tr_b16 v[146:147], v5 offset:41984
    s_add_u32 s66, s69, s61
    v_mfma_f32_16x16x32_bf16 v[36:39], v[128:131], a[52:55], v[36:39]
    s_add_u32 s67, s69, s54
    v_mfma_f32_16x16x32_bf16 v[40:43], v[128:131], a[56:59], v[40:43]
    ds_read_b64_tr_b16 v[148:149], v5 offset:45056
    v_mfma_f32_16x16x32_bf16 v[40:43], v[132:135], a[72:75], v[40:43]
    ds_read_b64_tr_b16 v[150:151], v5 offset:46080
    v_mfma_f32_16x16x32_bf16 v[40:43], v[136:139], a[88:91], v[40:43]
    v_mfma_f32_16x16x32_bf16 v[44:47], v[136:139], a[92:95], v[44:47]
    v_mfma_f32_16x16x32_bf16 v[44:47], v[132:135], a[76:79], v[44:47]
    ds_write_b32 v159, v178 offset:64
    v_mfma_f32_16x16x32_bf16 v[44:47], v[128:131], a[60:63], v[44:47]
    s_waitcnt lgkmcnt(1)
    s_mov_b32 s60, 3538944
    v_mfma_f32_16x16x32_bf16 v[48:51], v[140:143], a[48:51], v[48:51]
    s_waitcnt vmcnt(14)
    s_barrier
    v_mfma_f32_16x16x32_bf16 v[48:51], v[144:147], a[64:67], v[48:51]
    ds_read_b64_tr_b16 v[128:129], v4 offset:49152
    s_add_u32 m0, s59, 86016
    v_mfma_f32_16x16x32_bf16 v[48:51], v[148:151], a[80:83], v[48:51]
    buffer_load_dwordx4 v10, s[32:35], s60 offen offset:0  lds
    v_mfma_f32_16x16x32_bf16 v[52:55], v[148:151], a[84:87], v[52:55]
    ds_read_b64_tr_b16 v[130:131], v4 offset:50176
    v_mul_f32 v180, v22, v122
    v_mfma_f32_16x16x32_bf16 v[52:55], v[144:147], a[68:71], v[52:55]
    ds_read_b64_tr_b16 v[132:133], v4 offset:53248
    v_mul_f32 v181, v22, v123
    v_mfma_f32_16x16x32_bf16 v[52:55], v[140:143], a[52:55], v[52:55]
    ds_read_b64_tr_b16 v[134:135], v4 offset:54272
    v_cvt_pk_bf16_f32 v180, v180, v181
    v_mfma_f32_16x16x32_bf16 v[56:59], v[140:143], a[56:59], v[56:59]
    ds_read_b64_tr_b16 v[136:137], v4 offset:57344
    v_mfma_f32_16x16x32_bf16 v[56:59], v[144:147], a[72:75], v[56:59]
    buffer_load_dwordx4 v11, s[32:35], s60 offen offset:1024  lds
    v_mfma_f32_16x16x32_bf16 v[56:59], v[148:151], a[88:91], v[56:59]
    ds_read_b64_tr_b16 v[138:139], v4 offset:58368
    v_mfma_f32_16x16x32_bf16 v[60:63], v[148:151], a[92:95], v[60:63]
    v_mfma_f32_16x16x32_bf16 v[60:63], v[144:147], a[76:79], v[60:63]
    ds_write_b32 v159, v180 offset:256
    v_mfma_f32_16x16x32_bf16 v[60:63], v[140:143], a[60:63], v[60:63]
    s_waitcnt lgkmcnt(1)
    v_mul_f32 v182, v23, v126
    v_mfma_f32_16x16x32_bf16 v[64:67], v[128:131], a[48:51], v[64:67]
    buffer_load_dwordx4 v12, s[32:35], s60 offen offset:2048  lds
    v_mfma_f32_16x16x32_bf16 v[64:67], v[132:135], a[64:67], v[64:67]
    ds_read_b64_tr_b16 v[140:141], v5 offset:49152
    v_mul_f32 v183, v23, v127
    v_mfma_f32_16x16x32_bf16 v[64:67], v[136:139], a[80:83], v[64:67]
    ds_read_b64_tr_b16 v[142:143], v5 offset:50176
    v_cvt_pk_bf16_f32 v182, v182, v183
    v_mfma_f32_16x16x32_bf16 v[68:71], v[136:139], a[84:87], v[68:71]
    ds_read_b64_tr_b16 v[144:145], v5 offset:53248
    v_mfma_f32_16x16x32_bf16 v[68:71], v[132:135], a[68:71], v[68:71]
    ds_read_b64_tr_b16 v[146:147], v5 offset:54272
    v_mfma_f32_16x16x32_bf16 v[68:71], v[128:131], a[52:55], v[68:71]
    v_mfma_f32_16x16x32_bf16 v[72:75], v[128:131], a[56:59], v[72:75]
    ds_read_b64_tr_b16 v[148:149], v5 offset:57344
    v_mfma_f32_16x16x32_bf16 v[72:75], v[132:135], a[72:75], v[72:75]
    ds_read_b64_tr_b16 v[150:151], v5 offset:58368
    v_mfma_f32_16x16x32_bf16 v[72:75], v[136:139], a[88:91], v[72:75]
    v_mfma_f32_16x16x32_bf16 v[76:79], v[136:139], a[92:95], v[76:79]
    v_mfma_f32_16x16x32_bf16 v[76:79], v[132:135], a[76:79], v[76:79]
    ds_write_b32 v159, v182 offset:320
    v_mfma_f32_16x16x32_bf16 v[76:79], v[128:131], a[60:63], v[76:79]
    s_waitcnt lgkmcnt(1)
    s_mov_b32 s60, 3538944
    v_mfma_f32_16x16x32_bf16 v[80:83], v[140:143], a[48:51], v[80:83]
    s_waitcnt vmcnt(13)
    s_barrier
    v_mfma_f32_16x16x32_bf16 v[80:83], v[144:147], a[64:67], v[80:83]
    ds_read_b64_tr_b16 v[128:129], v6 offset:0
    s_add_u32 m0, s59, 98304
    v_mfma_f32_16x16x32_bf16 v[80:83], v[148:151], a[80:83], v[80:83]
    buffer_load_dwordx4 v10, s[36:39], s60 offen offset:0  lds
    v_mfma_f32_16x16x32_bf16 v[84:87], v[148:151], a[84:87], v[84:87]
    ds_read_b64_tr_b16 v[130:131], v6 offset:1024
    v_mul_f32 v20, v16, v16
    v_mfma_f32_16x16x32_bf16 v[84:87], v[144:147], a[68:71], v[84:87]
    ds_read_b64_tr_b16 v[132:133], v6 offset:4096
    v_mul_f32 v21, v17, v17
    v_mfma_f32_16x16x32_bf16 v[84:87], v[140:143], a[52:55], v[84:87]
    ds_read_b64_tr_b16 v[134:135], v6 offset:5120
    v_mul_f32 v22, v18, v18
    v_mfma_f32_16x16x32_bf16 v[88:91], v[140:143], a[56:59], v[88:91]
    ds_read_b64_tr_b16 v[136:137], v6 offset:8192
    v_mul_f32 v23, v19, v19
    v_mfma_f32_16x16x32_bf16 v[88:91], v[144:147], a[72:75], v[88:91]
    buffer_load_dwordx4 v11, s[36:39], s60 offen offset:1024  lds
    v_mfma_f32_16x16x32_bf16 v[88:91], v[148:151], a[88:91], v[88:91]
    ds_read_b64_tr_b16 v[138:139], v6 offset:9216
    v_mfma_f32_16x16x32_bf16 v[92:95], v[148:151], a[92:95], v[92:95]
    v_mfma_f32_16x16x32_bf16 v[92:95], v[144:147], a[76:79], v[92:95]
    v_mfma_f32_16x16x32_bf16 v[92:95], v[140:143], a[60:63], v[92:95]
    s_waitcnt lgkmcnt(0)
    v_mfma_f32_16x16x32_bf16 v[32:35], v[128:131], a[96:99], v[32:35]
    buffer_load_dwordx4 v12, s[36:39], s60 offen offset:2048  lds
    v_mfma_f32_16x16x32_bf16 v[32:35], v[132:135], a[112:115], v[32:35]
    ds_read_b64_tr_b16 v[140:141], v7 offset:0
    v_lshrrev_b32 v160, 4, v1
    v_mfma_f32_16x16x32_bf16 v[32:35], v[136:139], a[128:131], v[32:35]
    ds_read_b64_tr_b16 v[142:143], v7 offset:1024
    v_bfe_u32 v161, v1, 2, 2
    v_mfma_f32_16x16x32_bf16 v[36:39], v[136:139], a[132:135], v[36:39]
    ds_read_b64_tr_b16 v[144:145], v7 offset:4096
    v_and_b32 v162, 3, v1
    v_mfma_f32_16x16x32_bf16 v[36:39], v[132:135], a[116:119], v[36:39]
    ds_read_b64_tr_b16 v[146:147], v7 offset:5120
    v_lshl_add_u32 v163, v160, 3, v161
    v_mfma_f32_16x16x32_bf16 v[36:39], v[128:131], a[100:103], v[36:39]
    buffer_load_dword v2, v220, s[40:43], 0 offen offset:1792
    v_mfma_f32_16x16x32_bf16 v[40:43], v[128:131], a[104:107], v[40:43]
    ds_read_b64_tr_b16 v[148:149], v7 offset:8192
    v_lshlrev_b32 v163, 6, v163
    v_mfma_f32_16x16x32_bf16 v[40:43], v[132:135], a[120:123], v[40:43]
    ds_read_b64_tr_b16 v[150:151], v7 offset:9216
    v_and_b32 v160, 1, v160
    v_mfma_f32_16x16x32_bf16 v[40:43], v[136:139], a[136:139], v[40:43]
    v_xor_b32 v160, s56, v160
    v_lshl_add_u32 v163, v160, 5, v163
    v_mfma_f32_16x16x32_bf16 v[44:47], v[136:139], a[140:143], v[44:47]
    v_lshl_add_u32 v163, v162, 3, v163
    v_add_u32 v8, 49152, v163
    v_mfma_f32_16x16x32_bf16 v[44:47], v[132:135], a[124:127], v[44:47]
    v_add_u32 v9, 110592, v163
    v_lshrrev_b32 v163, 2, v1
    v_mfma_f32_16x16x32_bf16 v[44:47], v[128:131], a[108:111], v[44:47]
    s_waitcnt lgkmcnt(0)
    s_mov_b32 s60, 4423680
    v_mfma_f32_16x16x32_bf16 v[48:51], v[140:143], a[96:99], v[48:51]
    s_waitcnt vmcnt(14)
    s_barrier
    v_mfma_f32_16x16x32_bf16 v[48:51], v[144:147], a[112:115], v[48:51]
    ds_read_b64_tr_b16 v[128:129], v6 offset:12288
    s_add_u32 m0, s59, 110592
    v_mfma_f32_16x16x32_bf16 v[48:51], v[148:151], a[128:131], v[48:51]
    buffer_load_dwordx4 v10, s[32:35], s60 offen offset:0  lds
    v_mfma_f32_16x16x32_bf16 v[52:55], v[148:151], a[132:135], v[52:55]
    ds_read_b64_tr_b16 v[130:131], v6 offset:13312
    v_bfe_u32 v160, v1, 5, 1
    v_mfma_f32_16x16x32_bf16 v[52:55], v[144:147], a[116:119], v[52:55]
    ds_read_b64_tr_b16 v[132:133], v6 offset:16384
    v_lshlrev_b32 v160, 1, v160
    v_mfma_f32_16x16x32_bf16 v[52:55], v[140:143], a[100:103], v[52:55]
    ds_read_b64_tr_b16 v[134:135], v6 offset:17408
    v_xor_b32 v160, v160, v162
    v_mfma_f32_16x16x32_bf16 v[56:59], v[140:143], a[104:107], v[56:59]
    ds_read_b64_tr_b16 v[136:137], v6 offset:20480
    s_mul_i32 s62, s56, 48
    v_mfma_f32_16x16x32_bf16 v[56:59], v[144:147], a[120:123], v[56:59]
    buffer_load_dwordx4 v11, s[32:35], s60 offen offset:1024  lds
    v_mfma_f32_16x16x32_bf16 v[56:59], v[148:151], a[136:139], v[56:59]
    ds_read_b64_tr_b16 v[138:139], v6 offset:21504
    v_add_u32 v163, s62, v163
    v_mfma_f32_16x16x32_bf16 v[60:63], v[148:151], a[140:143], v[60:63]
    v_mul_u32_u24 v163, 9216, v163
    v_lshl_add_u32 v163, v160, 4, v163
    v_mfma_f32_16x16x32_bf16 v[60:63], v[144:147], a[124:127], v[60:63]
    s_lshl_b32 s62, s58, 1
    v_add_u32 v13, s62, v163
    v_mfma_f32_16x16x32_bf16 v[60:63], v[140:143], a[108:111], v[60:63]
    s_waitcnt lgkmcnt(0)
    v_add_u32 v14, 146432, v13
    v_mfma_f32_16x16x32_bf16 v[64:67], v[128:131], a[96:99], v[64:67]
    buffer_load_dwordx4 v12, s[32:35], s60 offen offset:2048  lds
    v_mfma_f32_16x16x32_bf16 v[64:67], v[132:135], a[112:115], v[64:67]
    ds_read_b64_tr_b16 v[140:141], v7 offset:12288
    v_add_u32 v15, 292864, v13
    v_mfma_f32_16x16x32_bf16 v[64:67], v[136:139], a[128:131], v[64:67]
    ds_read_b64_tr_b16 v[142:143], v7 offset:13312
    s_lshl_b32 s62, s55, 12
    v_mfma_f32_16x16x32_bf16 v[68:71], v[136:139], a[132:135], v[68:71]
    ds_read_b64_tr_b16 v[144:145], v7 offset:16384
    v_lshl_add_u32 v25, v1, 4, s62
    v_mfma_f32_16x16x32_bf16 v[68:71], v[132:135], a[116:119], v[68:71]
    ds_read_b64_tr_b16 v[146:147], v7 offset:17408
    v_add_u32 v26, 65536, v25
    v_mfma_f32_16x16x32_bf16 v[68:71], v[128:131], a[100:103], v[68:71]
    s_lshl_b32 s63, s56, 13
    v_add_u32 v24, s63, v25
    v_mfma_f32_16x16x32_bf16 v[72:75], v[128:131], a[104:107], v[72:75]
    ds_read_b64_tr_b16 v[148:149], v7 offset:20480
    s_lshl_b32 s62, s54, 4
    v_mfma_f32_16x16x32_bf16 v[72:75], v[132:135], a[120:123], v[72:75]
    ds_read_b64_tr_b16 v[150:151], v7 offset:21504
    s_add_u32 s62, s62, s53
    v_mfma_f32_16x16x32_bf16 v[72:75], v[136:139], a[136:139], v[72:75]
    s_lshl_b32 s62, s62, 2
    s_add_u32 s62, s62, s52
    v_mfma_f32_16x16x32_bf16 v[76:79], v[136:139], a[140:143], v[76:79]
    s_mul_i32 s62, s62, 36864
    v_lshl_add_u32 v27, v1, 4, s62
    v_mfma_f32_16x16x32_bf16 v[76:79], v[132:135], a[124:127], v[76:79]
    v_mfma_f32_16x16x32_bf16 v[76:79], v[128:131], a[108:111], v[76:79]
    s_waitcnt lgkmcnt(0)
    s_mov_b32 s60, 4423680
    v_mfma_f32_16x16x32_bf16 v[80:83], v[140:143], a[96:99], v[80:83]
    s_waitcnt vmcnt(13)
    s_barrier
    v_mfma_f32_16x16x32_bf16 v[80:83], v[144:147], a[112:115], v[80:83]
    ds_read_b64_tr_b16 v[128:129], v6 offset:36864
    s_add_u32 m0, s59, 122880
    v_mfma_f32_16x16x32_bf16 v[80:83], v[148:151], a[128:131], v[80:83]
    buffer_load_dwordx4 v10, s[36:39], s60 offen offset:0  lds
    v_mfma_f32_16x16x32_bf16 v[84:87], v[148:151], a[132:135], v[84:87]
    ds_read_b64_tr_b16 v[130:131], v6 offset:37888
    v_mfma_f32_16x16x32_bf16 v[84:87], v[144:147], a[116:119], v[84:87]
    ds_read_b64_tr_b16 v[132:133], v6 offset:40960
    v_mfma_f32_16x16x32_bf16 v[84:87], v[140:143], a[100:103], v[84:87]
    ds_read_b64_tr_b16 v[134:135], v6 offset:41984
    v_mfma_f32_16x16x32_bf16 v[88:91], v[140:143], a[104:107], v[88:91]
    ds_read_b64_tr_b16 v[136:137], v6 offset:45056
    v_mfma_f32_16x16x32_bf16 v[88:91], v[144:147], a[120:123], v[88:91]
    buffer_load_dwordx4 v11, s[36:39], s60 offen offset:1024  lds
    v_mfma_f32_16x16x32_bf16 v[88:91], v[148:151], a[136:139], v[88:91]
    ds_read_b64_tr_b16 v[138:139], v6 offset:46080
    v_mfma_f32_16x16x32_bf16 v[92:95], v[148:151], a[140:143], v[92:95]
    v_mfma_f32_16x16x32_bf16 v[92:95], v[144:147], a[124:127], v[92:95]
    v_mfma_f32_16x16x32_bf16 v[92:95], v[140:143], a[108:111], v[92:95]
    s_waitcnt lgkmcnt(0)
    v_mfma_f32_16x16x32_bf16 v[32:35], v[128:131], a[144:147], v[32:35]
    buffer_load_dwordx4 v12, s[36:39], s60 offen offset:2048  lds
    v_mfma_f32_16x16x32_bf16 v[32:35], v[132:135], a[160:163], v[32:35]
    ds_read_b64_tr_b16 v[140:141], v7 offset:36864
    v_mfma_f32_16x16x32_bf16 v[32:35], v[136:139], a[176:179], v[32:35]
    ds_read_b64_tr_b16 v[142:143], v7 offset:37888
    v_mfma_f32_16x16x32_bf16 v[36:39], v[136:139], a[180:183], v[36:39]
    ds_read_b64_tr_b16 v[144:145], v7 offset:40960
    v_mfma_f32_16x16x32_bf16 v[36:39], v[132:135], a[164:167], v[36:39]
    ds_read_b64_tr_b16 v[146:147], v7 offset:41984
    v_mfma_f32_16x16x32_bf16 v[36:39], v[128:131], a[148:151], v[36:39]
    v_mfma_f32_16x16x32_bf16 v[40:43], v[128:131], a[152:155], v[40:43]
    ds_read_b64_tr_b16 v[148:149], v7 offset:45056
    v_mfma_f32_16x16x32_bf16 v[40:43], v[132:135], a[168:171], v[40:43]
    ds_read_b64_tr_b16 v[150:151], v7 offset:46080
    v_mfma_f32_16x16x32_bf16 v[40:43], v[136:139], a[184:187], v[40:43]
    v_mfma_f32_16x16x32_bf16 v[44:47], v[136:139], a[188:191], v[44:47]
    v_mfma_f32_16x16x32_bf16 v[44:47], v[132:135], a[172:175], v[44:47]
    v_mfma_f32_16x16x32_bf16 v[44:47], v[128:131], a[156:159], v[44:47]
    s_waitcnt lgkmcnt(0)
    s_mov_b32 s60, 128
    v_mfma_f32_16x16x32_bf16 v[48:51], v[140:143], a[144:147], v[48:51]
    s_waitcnt vmcnt(13)
    s_barrier
    v_mfma_f32_16x16x32_bf16 v[48:51], v[144:147], a[160:163], v[48:51]
    ds_read_b64_tr_b16 v[128:129], v4 offset:24576
    s_add_u32 m0, s59, 147456
    v_mfma_f32_16x16x32_bf16 v[48:51], v[148:151], a[176:179], v[48:51]
    buffer_load_dwordx4 v10, s[32:35], s60 offen offset:0  lds
    v_mfma_f32_16x16x32_bf16 v[52:55], v[148:151], a[180:183], v[52:55]
    ds_read_b64_tr_b16 v[130:131], v4 offset:25600
    v_mfma_f32_16x16x32_bf16 v[52:55], v[144:147], a[164:167], v[52:55]
    ds_read_b64_tr_b16 v[132:133], v4 offset:28672
    v_mfma_f32_16x16x32_bf16 v[52:55], v[140:143], a[148:151], v[52:55]
    ds_read_b64_tr_b16 v[134:135], v4 offset:29696
    v_mfma_f32_16x16x32_bf16 v[56:59], v[140:143], a[152:155], v[56:59]
    ds_read_b64_tr_b16 v[136:137], v4 offset:32768
    v_mfma_f32_16x16x32_bf16 v[56:59], v[144:147], a[168:171], v[56:59]
    buffer_load_dwordx4 v11, s[32:35], s60 offen offset:1024  lds
    v_mfma_f32_16x16x32_bf16 v[56:59], v[148:151], a[184:187], v[56:59]
    ds_read_b64_tr_b16 v[138:139], v4 offset:33792
    v_mfma_f32_16x16x32_bf16 v[60:63], v[148:151], a[188:191], v[60:63]
    v_mfma_f32_16x16x32_bf16 v[60:63], v[144:147], a[172:175], v[60:63]
    v_mfma_f32_16x16x32_bf16 v[60:63], v[140:143], a[156:159], v[60:63]
    s_waitcnt lgkmcnt(0)
    v_mfma_f32_16x16x32_bf16 v[64:67], v[128:131], a[144:147], v[64:67]
    buffer_load_dwordx4 v12, s[32:35], s60 offen offset:2048  lds
    v_mfma_f32_16x16x32_bf16 v[64:67], v[132:135], a[160:163], v[64:67]
    ds_read_b64_tr_b16 v[140:141], v5 offset:24576
    v_mfma_f32_16x16x32_bf16 v[64:67], v[136:139], a[176:179], v[64:67]
    ds_read_b64_tr_b16 v[142:143], v5 offset:25600
    v_mfma_f32_16x16x32_bf16 v[68:71], v[136:139], a[180:183], v[68:71]
    ds_read_b64_tr_b16 v[144:145], v5 offset:28672
    v_mfma_f32_16x16x32_bf16 v[68:71], v[132:135], a[164:167], v[68:71]
    ds_read_b64_tr_b16 v[146:147], v5 offset:29696
    v_mfma_f32_16x16x32_bf16 v[68:71], v[128:131], a[148:151], v[68:71]
    v_mfma_f32_16x16x32_bf16 v[72:75], v[128:131], a[152:155], v[72:75]
    ds_read_b64_tr_b16 v[148:149], v5 offset:32768
    v_mfma_f32_16x16x32_bf16 v[72:75], v[132:135], a[168:171], v[72:75]
    ds_read_b64_tr_b16 v[150:151], v5 offset:33792
    v_mfma_f32_16x16x32_bf16 v[72:75], v[136:139], a[184:187], v[72:75]
    v_mfma_f32_16x16x32_bf16 v[76:79], v[136:139], a[188:191], v[76:79]
    v_mfma_f32_16x16x32_bf16 v[76:79], v[132:135], a[172:175], v[76:79]
    v_mfma_f32_16x16x32_bf16 v[76:79], v[128:131], a[156:159], v[76:79]
    s_waitcnt lgkmcnt(0)
    s_mov_b32 s60, 128
    v_mfma_f32_16x16x32_bf16 v[80:83], v[140:143], a[144:147], v[80:83]
    s_waitcnt vmcnt(13)
    s_barrier
    v_mfma_f32_16x16x32_bf16 v[80:83], v[144:147], a[160:163], v[80:83]
    ds_read_b64_tr_b16 v[128:129], v4 offset:36864
    s_add_u32 m0, s59, 73728
    v_mfma_f32_16x16x32_bf16 v[80:83], v[148:151], a[176:179], v[80:83]
    buffer_load_dwordx4 v10, s[36:39], s60 offen offset:0  lds
    v_mfma_f32_16x16x32_bf16 v[84:87], v[148:151], a[180:183], v[84:87]
    ds_read_b64_tr_b16 v[130:131], v4 offset:37888
    v_mfma_f32_16x16x32_bf16 v[84:87], v[144:147], a[164:167], v[84:87]
    ds_read_b64_tr_b16 v[132:133], v4 offset:40960
    v_mfma_f32_16x16x32_bf16 v[84:87], v[140:143], a[148:151], v[84:87]
    ds_read_b64_tr_b16 v[134:135], v4 offset:41984
    v_mfma_f32_16x16x32_bf16 v[88:91], v[140:143], a[152:155], v[88:91]
    ds_read_b64_tr_b16 v[136:137], v4 offset:45056
    v_mfma_f32_16x16x32_bf16 v[88:91], v[144:147], a[168:171], v[88:91]
    buffer_load_dwordx4 v11, s[36:39], s60 offen offset:1024  lds
    v_mfma_f32_16x16x32_bf16 v[88:91], v[148:151], a[184:187], v[88:91]
    ds_read_b64_tr_b16 v[138:139], v4 offset:46080
    v_mfma_f32_16x16x32_bf16 v[92:95], v[148:151], a[188:191], v[92:95]
    v_mfma_f32_16x16x32_bf16 v[92:95], v[144:147], a[172:175], v[92:95]
    v_mfma_f32_16x16x32_bf16 v[92:95], v[140:143], a[156:159], v[92:95]
    s_waitcnt lgkmcnt(0)
    v_mfma_f32_16x16x32_bf16 v[32:35], v[128:131], a[192:195], v[32:35]
    buffer_load_dwordx4 v12, s[36:39], s60 offen offset:2048  lds
    v_mfma_f32_16x16x32_bf16 v[32:35], v[132:135], a[208:211], v[32:35]
    ds_read_b64_tr_b16 v[140:141], v5 offset:36864
    v_mfma_f32_16x16x32_bf16 v[32:35], v[136:139], a[224:227], v[32:35]
    ds_read_b64_tr_b16 v[142:143], v5 offset:37888
    v_mfma_f32_16x16x32_bf16 v[36:39], v[136:139], a[228:231], v[36:39]
    ds_read_b64_tr_b16 v[144:145], v5 offset:40960
    v_mfma_f32_16x16x32_bf16 v[36:39], v[132:135], a[212:215], v[36:39]
    ds_read_b64_tr_b16 v[146:147], v5 offset:41984
    v_mfma_f32_16x16x32_bf16 v[36:39], v[128:131], a[196:199], v[36:39]
    buffer_load_dword v2, v220, s[40:43], 0 offen offset:3584
    v_mfma_f32_16x16x32_bf16 v[40:43], v[128:131], a[200:203], v[40:43]
    ds_read_b64_tr_b16 v[148:149], v5 offset:45056
    v_mfma_f32_16x16x32_bf16 v[40:43], v[132:135], a[216:219], v[40:43]
    ds_read_b64_tr_b16 v[150:151], v5 offset:46080
    v_mfma_f32_16x16x32_bf16 v[40:43], v[136:139], a[232:235], v[40:43]
    v_mfma_f32_16x16x32_bf16 v[44:47], v[136:139], a[236:239], v[44:47]
    buffer_load_dword v2, v219, s[48:51], 0 offen offset:256
    v_mfma_f32_16x16x32_bf16 v[44:47], v[132:135], a[220:223], v[44:47]
    v_mfma_f32_16x16x32_bf16 v[44:47], v[128:131], a[204:207], v[44:47]
    s_waitcnt lgkmcnt(0)
    s_mov_b32 s60, 884864
    v_mfma_f32_16x16x32_bf16 v[48:51], v[140:143], a[192:195], v[48:51]
    s_waitcnt vmcnt(15)
    s_barrier
    s_cmp_eq_u32 s66, 0
    s_cbranch_scc1 L_sigB0
L_sigB0_done:
    v_mfma_f32_16x16x32_bf16 v[48:51], v[144:147], a[208:211], v[48:51]
    ds_read_b64_tr_b16 v[128:129], v4 offset:49152
    s_add_u32 m0, s59, 86016
    v_mfma_f32_16x16x32_bf16 v[48:51], v[148:151], a[224:227], v[48:51]
    buffer_load_dwordx4 v10, s[32:35], s60 offen offset:0  lds
    v_mfma_f32_16x16x32_bf16 v[52:55], v[148:151], a[228:231], v[52:55]
    ds_read_b64_tr_b16 v[130:131], v4 offset:50176
    v_mfma_f32_16x16x32_bf16 v[52:55], v[144:147], a[212:215], v[52:55]
    ds_read_b64_tr_b16 v[132:133], v4 offset:53248
    v_mfma_f32_16x16x32_bf16 v[52:55], v[140:143], a[196:199], v[52:55]
    ds_read_b64_tr_b16 v[134:135], v4 offset:54272
    v_mfma_f32_16x16x32_bf16 v[56:59], v[140:143], a[200:203], v[56:59]
    ds_read_b64_tr_b16 v[136:137], v4 offset:57344
    v_mfma_f32_16x16x32_bf16 v[56:59], v[144:147], a[216:219], v[56:59]
    buffer_load_dwordx4 v11, s[32:35], s60 offen offset:1024  lds
    v_mfma_f32_16x16x32_bf16 v[56:59], v[148:151], a[232:235], v[56:59]
    ds_read_b64_tr_b16 v[138:139], v4 offset:58368
    v_mfma_f32_16x16x32_bf16 v[60:63], v[148:151], a[236:239], v[60:63]
    v_mfma_f32_16x16x32_bf16 v[60:63], v[144:147], a[220:223], v[60:63]
    v_mfma_f32_16x16x32_bf16 v[60:63], v[140:143], a[204:207], v[60:63]
    s_waitcnt lgkmcnt(0)
    v_mfma_f32_16x16x32_bf16 v[64:67], v[128:131], a[192:195], v[64:67]
    buffer_load_dwordx4 v12, s[32:35], s60 offen offset:2048  lds
    v_mfma_f32_16x16x32_bf16 v[64:67], v[132:135], a[208:211], v[64:67]
    ds_read_b64_tr_b16 v[140:141], v5 offset:49152
    v_mfma_f32_16x16x32_bf16 v[64:67], v[136:139], a[224:227], v[64:67]
    ds_read_b64_tr_b16 v[142:143], v5 offset:50176
    v_mfma_f32_16x16x32_bf16 v[68:71], v[136:139], a[228:231], v[68:71]
    ds_read_b64_tr_b16 v[144:145], v5 offset:53248
    v_mfma_f32_16x16x32_bf16 v[68:71], v[132:135], a[212:215], v[68:71]
    ds_read_b64_tr_b16 v[146:147], v5 offset:54272
    v_mfma_f32_16x16x32_bf16 v[68:71], v[128:131], a[196:199], v[68:71]
    v_mfma_f32_16x16x32_bf16 v[72:75], v[128:131], a[200:203], v[72:75]
    ds_read_b64_tr_b16 v[148:149], v5 offset:57344
    v_mfma_f32_16x16x32_bf16 v[72:75], v[132:135], a[216:219], v[72:75]
    ds_read_b64_tr_b16 v[150:151], v5 offset:58368
    v_mfma_f32_16x16x32_bf16 v[72:75], v[136:139], a[232:235], v[72:75]
    v_mfma_f32_16x16x32_bf16 v[76:79], v[136:139], a[236:239], v[76:79]
    v_mfma_f32_16x16x32_bf16 v[76:79], v[132:135], a[220:223], v[76:79]
    v_mfma_f32_16x16x32_bf16 v[76:79], v[128:131], a[204:207], v[76:79]
    s_waitcnt lgkmcnt(0)
    s_mov_b32 s60, 884864
    v_mfma_f32_16x16x32_bf16 v[80:83], v[140:143], a[192:195], v[80:83]
    s_waitcnt vmcnt(14)
    s_barrier
    s_cmp_eq_u32 s66, 1
    s_cbranch_scc1 L_sigB1
L_sigB1_done:
    v_mfma_f32_16x16x32_bf16 v[80:83], v[144:147], a[208:211], v[80:83]
    ds_read_b64_tr_b16 v[128:129], v6 offset:0
    s_add_u32 m0, s59, 98304
    v_mfma_f32_16x16x32_bf16 v[80:83], v[148:151], a[224:227], v[80:83]
    buffer_load_dwordx4 v10, s[36:39], s60 offen offset:0  lds
    v_mfma_f32_16x16x32_bf16 v[84:87], v[148:151], a[228:231], v[84:87]
    ds_read_b64_tr_b16 v[130:131], v6 offset:1024
    v_mfma_f32_16x16x32_bf16 v[84:87], v[144:147], a[212:215], v[84:87]
    ds_read_b64_tr_b16 v[132:133], v6 offset:4096
    v_mfma_f32_16x16x32_bf16 v[84:87], v[140:143], a[196:199], v[84:87]
    ds_read_b64_tr_b16 v[134:135], v6 offset:5120
    v_mfma_f32_16x16x32_bf16 v[88:91], v[140:143], a[200:203], v[88:91]
    ds_read_b64_tr_b16 v[136:137], v6 offset:8192
    v_mfma_f32_16x16x32_bf16 v[88:91], v[144:147], a[216:219], v[88:91]
    buffer_load_dwordx4 v11, s[36:39], s60 offen offset:1024  lds
    v_mfma_f32_16x16x32_bf16 v[88:91], v[148:151], a[232:235], v[88:91]
    ds_read_b64_tr_b16 v[138:139], v6 offset:9216
    v_mfma_f32_16x16x32_bf16 v[92:95], v[148:151], a[236:239], v[92:95]
    v_mfma_f32_16x16x32_bf16 v[92:95], v[144:147], a[220:223], v[92:95]
    v_mfma_f32_16x16x32_bf16 v[92:95], v[140:143], a[204:207], v[92:95]
    s_waitcnt lgkmcnt(0)
    v_mfma_f32_16x16x32_bf16 v[32:35], v[128:131], a[240:243], v[32:35]
    buffer_load_dwordx4 v12, s[36:39], s60 offen offset:2048  lds
    v_mfma_f32_16x16x32_bf16 v[32:35], v[132:135], v[224:227], v[32:35]
    ds_read_b64_tr_b16 v[140:141], v7 offset:0
    v_mfma_f32_16x16x32_bf16 v[32:35], v[136:139], v[240:243], v[32:35]
    ds_read_b64_tr_b16 v[142:143], v7 offset:1024
    v_mfma_f32_16x16x32_bf16 v[36:39], v[136:139], v[244:247], v[36:39]
    ds_read_b64_tr_b16 v[144:145], v7 offset:4096
    v_mfma_f32_16x16x32_bf16 v[36:39], v[132:135], v[228:231], v[36:39]
    ds_read_b64_tr_b16 v[146:147], v7 offset:5120
    v_mfma_f32_16x16x32_bf16 v[36:39], v[128:131], a[244:247], v[36:39]
    v_mfma_f32_16x16x32_bf16 v[40:43], v[128:131], a[248:251], v[40:43]
    ds_read_b64_tr_b16 v[148:149], v7 offset:8192
    v_mfma_f32_16x16x32_bf16 v[40:43], v[132:135], v[232:235], v[40:43]
    ds_read_b64_tr_b16 v[150:151], v7 offset:9216
    v_mfma_f32_16x16x32_bf16 v[40:43], v[136:139], v[248:251], v[40:43]
    v_mfma_f32_16x16x32_bf16 v[44:47], v[136:139], v[252:255], v[44:47]
    v_mfma_f32_16x16x32_bf16 v[44:47], v[132:135], v[236:239], v[44:47]
    v_mul_f32 v32, v20, v32
    v_mul_f32 v33, v20, v33
    v_mfma_f32_16x16x32_bf16 v[44:47], v[128:131], a[252:255], v[44:47]
    s_waitcnt lgkmcnt(0)
    s_mov_b32 s60, 1769600
    v_mfma_f32_16x16x32_bf16 v[48:51], v[140:143], a[240:243], v[48:51]
    s_waitcnt vmcnt(14)
    s_barrier
    s_cmp_eq_u32 s66, 2
    s_cbranch_scc1 L_sigB2
L_sigB2_done:
    v_mfma_f32_16x16x32_bf16 v[48:51], v[144:147], v[224:227], v[48:51]
    ds_read_b64_tr_b16 v[128:129], v6 offset:12288
    s_add_u32 m0, s59, 110592
    v_mfma_f32_16x16x32_bf16 v[48:51], v[148:151], v[240:243], v[48:51]
    buffer_load_dwordx4 v10, s[32:35], s60 offen offset:0  lds
    v_mfma_f32_16x16x32_bf16 v[52:55], v[148:151], v[244:247], v[52:55]
    ds_read_b64_tr_b16 v[130:131], v6 offset:13312
    v_mul_f32 v34, v20, v34
    v_mfma_f32_16x16x32_bf16 v[52:55], v[144:147], v[228:231], v[52:55]
    ds_read_b64_tr_b16 v[132:133], v6 offset:16384
    v_mul_f32 v35, v20, v35
    v_mfma_f32_16x16x32_bf16 v[52:55], v[140:143], a[244:247], v[52:55]
    ds_read_b64_tr_b16 v[134:135], v6 offset:17408
    v_mul_f32 v36, v21, v36
    v_mfma_f32_16x16x32_bf16 v[56:59], v[140:143], a[248:251], v[56:59]
    ds_read_b64_tr_b16 v[136:137], v6 offset:20480
    v_mul_f32 v37, v21, v37
    v_mfma_f32_16x16x32_bf16 v[56:59], v[144:147], v[232:235], v[56:59]
    buffer_load_dwordx4 v11, s[32:35], s60 offen offset:1024  lds
    v_mfma_f32_16x16x32_bf16 v[56:59], v[148:151], v[248:251], v[56:59]
    ds_read_b64_tr_b16 v[138:139], v6 offset:21504
    v_mul_f32 v38, v21, v38
    v_mfma_f32_16x16x32_bf16 v[60:63], v[148:151], v[252:255], v[60:63]
    v_mul_f32 v39, v21, v39
    v_mul_f32 v40, v22, v40
    v_mfma_f32_16x16x32_bf16 v[60:63], v[144:147], v[236:239], v[60:63]
    v_mul_f32 v41, v22, v41
    v_mul_f32 v42, v22, v42
    v_mfma_f32_16x16x32_bf16 v[60:63], v[140:143], a[252:255], v[60:63]
    s_waitcnt lgkmcnt(0)
    v_mul_f32 v43, v22, v43
    v_mfma_f32_16x16x32_bf16 v[64:67], v[128:131], a[240:243], v[64:67]
    buffer_load_dwordx4 v12, s[32:35], s60 offen offset:2048  lds
    v_mfma_f32_16x16x32_bf16 v[64:67], v[132:135], v[224:227], v[64:67]
    ds_read_b64_tr_b16 v[140:141], v7 offset:12288
    v_mul_f32 v44, v23, v44
    v_mfma_f32_16x16x32_bf16 v[64:67], v[136:139], v[240:243], v[64:67]
    ds_read_b64_tr_b16 v[142:143], v7 offset:13312
    v_mul_f32 v45, v23, v45
    v_mfma_f32_16x16x32_bf16 v[68:71], v[136:139], v[244:247], v[68:71]
    ds_read_b64_tr_b16 v[144:145], v7 offset:16384
    v_mul_f32 v46, v23, v46
    v_mfma_f32_16x16x32_bf16 v[68:71], v[132:135], v[228:231], v[68:71]
    ds_read_b64_tr_b16 v[146:147], v7 offset:17408
    v_mul_f32 v47, v23, v47
    v_mfma_f32_16x16x32_bf16 v[68:71], v[128:131], a[244:247], v[68:71]
    v_mul_f32 v48, v20, v48
    v_mul_f32 v49, v20, v49
    v_mfma_f32_16x16x32_bf16 v[72:75], v[128:131], a[248:251], v[72:75]
    ds_read_b64_tr_b16 v[148:149], v7 offset:20480
    v_mul_f32 v50, v20, v50
    v_mfma_f32_16x16x32_bf16 v[72:75], v[132:135], v[232:235], v[72:75]
    ds_read_b64_tr_b16 v[150:151], v7 offset:21504
    v_mul_f32 v51, v20, v51
    v_mfma_f32_16x16x32_bf16 v[72:75], v[136:139], v[248:251], v[72:75]
    v_mul_f32 v52, v21, v52
    v_mul_f32 v53, v21, v53
    v_mfma_f32_16x16x32_bf16 v[76:79], v[136:139], v[252:255], v[76:79]
    v_mul_f32 v54, v21, v54
    v_mul_f32 v55, v21, v55
    v_mfma_f32_16x16x32_bf16 v[76:79], v[132:135], v[236:239], v[76:79]
    v_mul_f32 v56, v22, v56
    v_mul_f32 v57, v22, v57
    v_mfma_f32_16x16x32_bf16 v[76:79], v[128:131], a[252:255], v[76:79]
    s_waitcnt lgkmcnt(0)
    s_mov_b32 s60, 1769600
    v_mfma_f32_16x16x32_bf16 v[80:83], v[140:143], a[240:243], v[80:83]
    s_waitcnt vmcnt(14)
    s_barrier
    s_cmp_eq_u32 s67, 0
    s_cbranch_scc1 L_sigA0
L_sigA0_done:
    v_mfma_f32_16x16x32_bf16 v[80:83], v[144:147], v[224:227], v[80:83]
    ds_read_b64_tr_b16 v[128:129], v6 offset:36864
    s_add_u32 m0, s59, 122880
    v_mfma_f32_16x16x32_bf16 v[80:83], v[148:151], v[240:243], v[80:83]
    buffer_load_dwordx4 v10, s[36:39], s60 offen offset:0  lds
    v_mfma_f32_16x16x32_bf16 v[84:87], v[148:151], v[244:247], v[84:87]
    ds_read_b64_tr_b16 v[130:131], v6 offset:37888
    v_mul_f32 v58, v22, v58
    v_mfma_f32_16x16x32_bf16 v[84:87], v[144:147], v[228:231], v[84:87]
    ds_read_b64_tr_b16 v[132:133], v6 offset:40960
    v_mul_f32 v59, v22, v59
    v_mfma_f32_16x16x32_bf16 v[84:87], v[140:143], a[244:247], v[84:87]
    ds_read_b64_tr_b16 v[134:135], v6 offset:41984
    v_mul_f32 v60, v23, v60
    v_mfma_f32_16x16x32_bf16 v[88:91], v[140:143], a[248:251], v[88:91]
    ds_read_b64_tr_b16 v[136:137], v6 offset:45056
    v_mul_f32 v61, v23, v61
    v_mfma_f32_16x16x32_bf16 v[88:91], v[144:147], v[232:235], v[88:91]
    buffer_load_dwordx4 v11, s[36:39], s60 offen offset:1024  lds
    v_mfma_f32_16x16x32_bf16 v[88:91], v[148:151], v[248:251], v[88:91]
    ds_read_b64_tr_b16 v[138:139], v6 offset:46080
    v_mul_f32 v62, v23, v62
    v_mfma_f32_16x16x32_bf16 v[92:95], v[148:151], v[252:255], v[92:95]
    v_mul_f32 v63, v23, v63
    v_mul_f32 v32, v32, v64
    v_mfma_f32_16x16x32_bf16 v[92:95], v[144:147], v[236:239], v[92:95]
    v_mul_f32 v33, v33, v65
    v_mul_f32 v34, v34, v66
    v_mfma_f32_16x16x32_bf16 v[92:95], v[140:143], a[252:255], v[92:95]
    s_waitcnt lgkmcnt(0)
    v_mul_f32 v35, v35, v67
    v_mfma_f32_16x16x32_bf16 v[96:99], v[128:131], a[0:3], 0
    buffer_load_dwordx4 v12, s[36:39], s60 offen offset:2048  lds
    v_mfma_f32_16x16x32_bf16 v[96:99], v[132:135], a[16:19], v[96:99]
    ds_read_b64_tr_b16 v[140:141], v7 offset:36864
    v_mul_f32 v36, v36, v68
    v_mfma_f32_16x16x32_bf16 v[96:99], v[136:139], a[32:35], v[96:99]
    ds_read_b64_tr_b16 v[142:143], v7 offset:37888
    v_mul_f32 v37, v37, v69
    v_mfma_f32_16x16x32_bf16 v[100:103], v[136:139], a[36:39], 0
    ds_read_b64_tr_b16 v[144:145], v7 offset:40960
    v_mul_f32 v38, v38, v70
    v_mfma_f32_16x16x32_bf16 v[100:103], v[132:135], a[20:23], v[100:103]
    ds_read_b64_tr_b16 v[146:147], v7 offset:41984
    v_mul_f32 v39, v39, v71
    v_mfma_f32_16x16x32_bf16 v[100:103], v[128:131], a[4:7], v[100:103]
    v_mul_f32 v40, v40, v72
    v_mul_f32 v41, v41, v73
    v_mfma_f32_16x16x32_bf16 v[104:107], v[128:131], a[8:11], 0
    ds_read_b64_tr_b16 v[148:149], v7 offset:45056
    v_mul_f32 v42, v42, v74
    v_mfma_f32_16x16x32_bf16 v[104:107], v[132:135], a[24:27], v[104:107]
    ds_read_b64_tr_b16 v[150:151], v7 offset:46080
    v_mul_f32 v43, v43, v75
    v_mfma_f32_16x16x32_bf16 v[104:107], v[136:139], a[40:43], v[104:107]
    v_mul_f32 v44, v44, v76
    v_mul_f32 v45, v45, v77
    v_mfma_f32_16x16x32_bf16 v[108:111], v[136:139], a[44:47], 0
    v_mul_f32 v46, v46, v78
    v_mul_f32 v47, v47, v79
    v_mfma_f32_16x16x32_bf16 v[108:111], v[132:135], a[28:31], v[108:111]
    v_mul_f32 v48, v48, v80
    v_mul_f32 v49, v49, v81
    v_mfma_f32_16x16x32_bf16 v[108:111], v[128:131], a[12:15], v[108:111]
    s_waitcnt lgkmcnt(0)
    s_mov_b32 s60, 2654336
    v_mfma_f32_16x16x32_bf16 v[112:115], v[140:143], a[0:3], 0
    s_waitcnt vmcnt(14)
    s_barrier
    v_mfma_f32_16x16x32_bf16 v[112:115], v[144:147], a[16:19], v[112:115]
    ds_read_b64_tr_b16 v[128:129], v4 offset:24576
    s_add_u32 m0, s59, 147456
    v_mfma_f32_16x16x32_bf16 v[112:115], v[148:151], a[32:35], v[112:115]
    buffer_load_dwordx4 v10, s[32:35], s60 offen offset:0  lds
    v_mfma_f32_16x16x32_bf16 v[116:119], v[148:151], a[36:39], 0
    ds_read_b64_tr_b16 v[130:131], v4 offset:25600
    v_mul_f32 v50, v50, v82
    v_mfma_f32_16x16x32_bf16 v[116:119], v[144:147], a[20:23], v[116:119]
    ds_read_b64_tr_b16 v[132:133], v4 offset:28672
    v_mul_f32 v51, v51, v83
    v_mfma_f32_16x16x32_bf16 v[116:119], v[140:143], a[4:7], v[116:119]
    ds_read_b64_tr_b16 v[134:135], v4 offset:29696
    v_mul_f32 v52, v52, v84
    v_mfma_f32_16x16x32_bf16 v[120:123], v[140:143], a[8:11], 0
    ds_read_b64_tr_b16 v[136:137], v4 offset:32768
    v_mul_f32 v53, v53, v85
    v_mfma_f32_16x16x32_bf16 v[120:123], v[144:147], a[24:27], v[120:123]
    buffer_load_dwordx4 v11, s[32:35], s60 offen offset:1024  lds
    v_mfma_f32_16x16x32_bf16 v[120:123], v[148:151], a[40:43], v[120:123]
    ds_read_b64_tr_b16 v[138:139], v4 offset:33792
    v_mul_f32 v54, v54, v86
    v_mfma_f32_16x16x32_bf16 v[124:127], v[148:151], a[44:47], 0
    v_mul_f32 v55, v55, v87
    v_mul_f32 v56, v56, v88
    v_mfma_f32_16x16x32_bf16 v[124:127], v[144:147], a[28:31], v[124:127]
    v_mul_f32 v57, v57, v89
    v_mul_f32 v58, v58, v90
    v_mfma_f32_16x16x32_bf16 v[124:127], v[140:143], a[12:15], v[124:127]
    s_waitcnt lgkmcnt(0)
    v_mul_f32 v59, v59, v91
    v_mfma_f32_16x16x32_bf16 v[64:67], v[128:131], a[0:3], 0
    buffer_load_dwordx4 v12, s[32:35], s60 offen offset:2048  lds
    v_mfma_f32_16x16x32_bf16 v[64:67], v[132:135], a[16:19], v[64:67]
    ds_read_b64_tr_b16 v[140:141], v5 offset:24576
    v_mul_f32 v60, v60, v92
    v_mfma_f32_16x16x32_bf16 v[64:67], v[136:139], a[32:35], v[64:67]
    ds_read_b64_tr_b16 v[142:143], v5 offset:25600
    v_mul_f32 v61, v61, v93
    v_mfma_f32_16x16x32_bf16 v[68:71], v[136:139], a[36:39], 0
    ds_read_b64_tr_b16 v[144:145], v5 offset:28672
    v_mul_f32 v62, v62, v94
    v_mfma_f32_16x16x32_bf16 v[68:71], v[132:135], a[20:23], v[68:71]
    ds_read_b64_tr_b16 v[146:147], v5 offset:29696
    v_mul_f32 v63, v63, v95
    v_mfma_f32_16x16x32_bf16 v[68:71], v[128:131], a[4:7], v[68:71]
    v_cvt_pk_bf16_f32 v32, v32, v33
    v_mfma_f32_16x16x32_bf16 v[72:75], v[128:131], a[8:11], 0
    ds_read_b64_tr_b16 v[148:149], v5 offset:32768
    v_cvt_pk_bf16_f32 v33, v34, v35
    v_mfma_f32_16x16x32_bf16 v[72:75], v[132:135], a[24:27], v[72:75]
    ds_read_b64_tr_b16 v[150:151], v5 offset:33792
    v_cvt_pk_bf16_f32 v34, v48, v49
    v_mfma_f32_16x16x32_bf16 v[72:75], v[136:139], a[40:43], v[72:75]
    v_cvt_pk_bf16_f32 v35, v50, v51
    v_mfma_f32_16x16x32_bf16 v[76:79], v[136:139], a[44:47], 0
    v_mfma_f32_16x16x32_bf16 v[76:79], v[132:135], a[28:31], v[76:79]
    ds_write_b128 v24, v[32:35] offset:0
    v_mfma_f32_16x16x32_bf16 v[76:79], v[128:131], a[12:15], v[76:79]
    s_waitcnt lgkmcnt(1)
    s_mov_b32 s60, 2654336
    v_mfma_f32_16x16x32_bf16 v[80:83], v[140:143], a[0:3], 0
    s_waitcnt vmcnt(12)
    s_barrier
    s_cmp_eq_u32 s67, 1
    s_cbranch_scc1 L_sigA1
L_sigA1_done:
    v_mfma_f32_16x16x32_bf16 v[80:83], v[144:147], a[16:19], v[80:83]
    ds_read_b64_tr_b16 v[128:129], v4 offset:36864
    s_add_u32 m0, s59, 73728
    v_mfma_f32_16x16x32_bf16 v[80:83], v[148:151], a[32:35], v[80:83]
    buffer_load_dwordx4 v10, s[36:39], s60 offen offset:0  lds
    v_mfma_f32_16x16x32_bf16 v[84:87], v[148:151], a[36:39], 0
    ds_read_b64_tr_b16 v[130:131], v4 offset:37888
    v_cvt_pk_bf16_f32 v36, v36, v37
    v_mfma_f32_16x16x32_bf16 v[84:87], v[144:147], a[20:23], v[84:87]
    ds_read_b64_tr_b16 v[132:133], v4 offset:40960
    v_cvt_pk_bf16_f32 v37, v38, v39
    v_mfma_f32_16x16x32_bf16 v[84:87], v[140:143], a[4:7], v[84:87]
    ds_read_b64_tr_b16 v[134:135], v4 offset:41984
    v_cvt_pk_bf16_f32 v38, v52, v53
    v_mfma_f32_16x16x32_bf16 v[88:91], v[140:143], a[8:11], 0
    ds_read_b64_tr_b16 v[136:137], v4 offset:45056
    v_cvt_pk_bf16_f32 v39, v54, v55
    v_mfma_f32_16x16x32_bf16 v[88:91], v[144:147], a[24:27], v[88:91]
    buffer_load_dwordx4 v11, s[36:39], s60 offen offset:1024  lds
    v_mfma_f32_16x16x32_bf16 v[88:91], v[148:151], a[40:43], v[88:91]
    ds_read_b64_tr_b16 v[138:139], v4 offset:46080
    v_mfma_f32_16x16x32_bf16 v[92:95], v[148:151], a[44:47], 0
    v_mfma_f32_16x16x32_bf16 v[92:95], v[144:147], a[28:31], v[92:95]
    ds_write_b128 v24, v[36:39] offset:1024
    v_mfma_f32_16x16x32_bf16 v[92:95], v[140:143], a[12:15], v[92:95]
    s_waitcnt lgkmcnt(1)
    v_cvt_pk_bf16_f32 v40, v40, v41
    v_mfma_f32_16x16x32_bf16 v[96:99], v[128:131], a[48:51], v[96:99]
    buffer_load_dwordx4 v12, s[36:39], s60 offen offset:2048  lds
    v_mfma_f32_16x16x32_bf16 v[96:99], v[132:135], a[64:67], v[96:99]
    ds_read_b64_tr_b16 v[140:141], v5 offset:36864
    v_cvt_pk_bf16_f32 v41, v42, v43
    v_mfma_f32_16x16x32_bf16 v[96:99], v[136:139], a[80:83], v[96:99]
    ds_read_b64_tr_b16 v[142:143], v5 offset:37888
    v_cvt_pk_bf16_f32 v42, v56, v57
    v_mfma_f32_16x16x32_bf16 v[100:103], v[136:139], a[84:87], v[100:103]
    ds_read_b64_tr_b16 v[144:145], v5 offset:40960
    v_cvt_pk_bf16_f32 v43, v58, v59
    v_mfma_f32_16x16x32_bf16 v[100:103], v[132:135], a[68:71], v[100:103]
    ds_read_b64_tr_b16 v[146:147], v5 offset:41984
    s_getpc_b64 s[70:71]
L_pc1:
    v_mfma_f32_16x16x32_bf16 v[100:103], v[128:131], a[52:55], v[100:103]
    global_load_dword v2, v221, s[12:13]
    v_mfma_f32_16x16x32_bf16 v[104:107], v[128:131], a[56:59], v[104:107]
    ds_read_b64_tr_b16 v[148:149], v5 offset:45056
    s_lshr_b32 s68, s2, 3
    v_mfma_f32_16x16x32_bf16 v[104:107], v[132:135], a[72:75], v[104:107]
    ds_read_b64_tr_b16 v[150:151], v5 offset:46080
    s_mul_i32 s68, s68, 1024
    v_mfma_f32_16x16x32_bf16 v[104:107], v[136:139], a[88:91], v[104:107]
    s_add_u32 s68, s68, 1024
    v_min_u32 v0, 7, v1
    v_mfma_f32_16x16x32_bf16 v[108:111], v[136:139], a[92:95], v[108:111]
    v_lshl_add_u32 v0, v0, 7, s68
    v_min_u32 v0, 0xba20, v0
    v_mfma_f32_16x16x32_bf16 v[108:111], v[132:135], a[76:79], v[108:111]
    ds_write_b128 v24, v[40:43] offset:2048
    v_mfma_f32_16x16x32_bf16 v[108:111], v[128:131], a[60:63], v[108:111]
    s_waitcnt lgkmcnt(1)
    s_mov_b32 s60, 3539072
    v_mfma_f32_16x16x32_bf16 v[112:115], v[140:143], a[48:51], v[112:115]
    s_waitcnt vmcnt(13)
    s_barrier
    v_mfma_f32_16x16x32_bf16 v[112:115], v[144:147], a[64:67], v[112:115]
    ds_read_b64_tr_b16 v[128:129], v4 offset:49152
    s_add_u32 m0, s59, 86016
    v_mfma_f32_16x16x32_bf16 v[112:115], v[148:151], a[80:83], v[112:115]
    buffer_load_dwordx4 v10, s[32:35], s60 offen offset:0  lds
    v_mfma_f32_16x16x32_bf16 v[116:119], v[148:151], a[84:87], v[116:119]
    ds_read_b64_tr_b16 v[130:131], v4 offset:50176
    v_cvt_pk_bf16_f32 v44, v44, v45
    v_mfma_f32_16x16x32_bf16 v[116:119], v[144:147], a[68:71], v[116:119]
    ds_read_b64_tr_b16 v[132:133], v4 offset:53248
    v_cvt_pk_bf16_f32 v45, v46, v47
    v_mfma_f32_16x16x32_bf16 v[116:119], v[140:143], a[52:55], v[116:119]
    ds_read_b64_tr_b16 v[134:135], v4 offset:54272
    v_cvt_pk_bf16_f32 v46, v60, v61
    v_mfma_f32_16x16x32_bf16 v[120:123], v[140:143], a[56:59], v[120:123]
    ds_read_b64_tr_b16 v[136:137], v4 offset:57344
    v_cvt_pk_bf16_f32 v47, v62, v63
    v_mfma_f32_16x16x32_bf16 v[120:123], v[144:147], a[72:75], v[120:123]
    buffer_load_dwordx4 v11, s[32:35], s60 offen offset:1024  lds
    v_mfma_f32_16x16x32_bf16 v[120:123], v[148:151], a[88:91], v[120:123]
    ds_read_b64_tr_b16 v[138:139], v4 offset:58368
    v_mfma_f32_16x16x32_bf16 v[124:127], v[148:151], a[92:95], v[124:127]
    v_mfma_f32_16x16x32_bf16 v[124:127], v[144:147], a[76:79], v[124:127]
    ds_write_b128 v24, v[44:47] offset:3072
    v_mfma_f32_16x16x32_bf16 v[124:127], v[140:143], a[60:63], v[124:127]
    s_waitcnt lgkmcnt(1)
    v_mfma_f32_16x16x32_bf16 v[64:67], v[128:131], a[48:51], v[64:67]
    buffer_load_dwordx4 v12, s[32:35], s60 offen offset:2048  lds
    v_mfma_f32_16x16x32_bf16 v[64:67], v[132:135], a[64:67], v[64:67]
    ds_read_b64_tr_b16 v[140:141], v5 offset:49152
    v_mfma_f32_16x16x32_bf16 v[64:67], v[136:139], a[80:83], v[64:67]
    ds_read_b64_tr_b16 v[142:143], v5 offset:50176
    v_mfma_f32_16x16x32_bf16 v[68:71], v[136:139], a[84:87], v[68:71]
    ds_read_b64_tr_b16 v[144:145], v5 offset:53248
    v_mfma_f32_16x16x32_bf16 v[68:71], v[132:135], a[68:71], v[68:71]
    ds_read_b64_tr_b16 v[146:147], v5 offset:54272
    v_mfma_f32_16x16x32_bf16 v[68:71], v[128:131], a[52:55], v[68:71]
    global_load_dword v0, v0, s[70:71]
    v_mfma_f32_16x16x32_bf16 v[72:75], v[128:131], a[56:59], v[72:75]
    ds_read_b64_tr_b16 v[148:149], v5 offset:57344
    v_mfma_f32_16x16x32_bf16 v[72:75], v[132:135], a[72:75], v[72:75]
    ds_read_b64_tr_b16 v[150:151], v5 offset:58368
    v_mfma_f32_16x16x32_bf16 v[72:75], v[136:139], a[88:91], v[72:75]
    v_mfma_f32_16x16x32_bf16 v[76:79], v[136:139], a[92:95], v[76:79]
    v_mfma_f32_16x16x32_bf16 v[76:79], v[132:135], a[76:79], v[76:79]
    v_mfma_f32_16x16x32_bf16 v[76:79], v[128:131], a[60:63], v[76:79]
    s_waitcnt lgkmcnt(0)
    s_mov_b32 s60, 3539072
    v_mfma_f32_16x16x32_bf16 v[80:83], v[140:143], a[48:51], v[80:83]
    s_waitcnt vmcnt(14)
    s_barrier
    s_cmp_eq_u32 s67, 2
    s_cbranch_scc1 L_sigA2
L_sigA2_done:
    v_mfma_f32_16x16x32_bf16 v[80:83], v[144:147], a[64:67], v[80:83]
    ds_read_b64_tr_b16 v[128:129], v6 offset:0
    s_add_u32 m0, s59, 98304
    v_mfma_f32_16x16x32_bf16 v[80:83], v[148:151], a[80:83], v[80:83]
    buffer_load_dwordx4 v10, s[36:39], s60 offen offset:0  lds
    v_mfma_f32_16x16x32_bf16 v[84:87], v[148:151], a[84:87], v[84:87]
    ds_read_b64_tr_b16 v[130:131], v6 offset:1024
    v_mfma_f32_16x16x32_bf16 v[84:87], v[144:147], a[68:71], v[84:87]
    ds_read_b64_tr_b16 v[132:133], v6 offset:4096
    v_mfma_f32_16x16x32_bf16 v[84:87], v[140:143], a[52:55], v[84:87]
    ds_read_b64_tr_b16 v[134:135], v6 offset:5120
    v_mfma_f32_16x16x32_bf16 v[88:91], v[140:143], a[56:59], v[88:91]
    ds_read_b64_tr_b16 v[136:137], v6 offset:8192
    v_mfma_f32_16x16x32_bf16 v[88:91], v[144:147], a[72:75], v[88:91]
    buffer_load_dwordx4 v11, s[36:39], s60 offen offset:1024  lds
    v_mfma_f32_16x16x32_bf16 v[88:91], v[148:151], a[88:91], v[88:91]
    ds_read_b64_tr_b16 v[138:139], v6 offset:9216
    v_mfma_f32_16x16x32_bf16 v[92:95], v[148:151], a[92:95], v[92:95]
    v_mfma_f32_16x16x32_bf16 v[92:95], v[144:147], a[76:79], v[92:95]
    v_mfma_f32_16x16x32_bf16 v[92:95], v[140:143], a[60:63], v[92:95]
    s_waitcnt lgkmcnt(0)
    v_mfma_f32_16x16x32_bf16 v[96:99], v[128:131], a[96:99], v[96:99]
    buffer_load_dwordx4 v12, s[36:39], s60 offen offset:2048  lds
    v_mfma_f32_16x16x32_bf16 v[96:99], v[132:135], a[112:115], v[96:99]
    ds_read_b64_tr_b16 v[140:141], v7 offset:0
    v_mfma_f32_16x16x32_bf16 v[96:99], v[136:139], a[128:131], v[96:99]
    ds_read_b64_tr_b16 v[142:143], v7 offset:1024
    v_mfma_f32_16x16x32_bf16 v[100:103], v[136:139], a[132:135], v[100:103]
    ds_read_b64_tr_b16 v[144:145], v7 offset:4096
    v_mfma_f32_16x16x32_bf16 v[100:103], v[132:135], a[116:119], v[100:103]
    ds_read_b64_tr_b16 v[146:147], v7 offset:5120
    v_mfma_f32_16x16x32_bf16 v[100:103], v[128:131], a[100:103], v[100:103]
    v_mfma_f32_16x16x32_bf16 v[104:107], v[128:131], a[104:107], v[104:107]
    ds_read_b64_tr_b16 v[148:149], v7 offset:8192
    v_mfma_f32_16x16x32_bf16 v[104:107], v[132:135], a[120:123], v[104:107]
    ds_read_b64_tr_b16 v[150:151], v7 offset:9216
    v_mfma_f32_16x16x32_bf16 v[104:107], v[136:139], a[136:139], v[104:107]
    v_mfma_f32_16x16x32_bf16 v[108:111], v[136:139], a[140:143], v[108:111]
    v_mfma_f32_16x16x32_bf16 v[108:111], v[132:135], a[124:127], v[108:111]
    v_mfma_f32_16x16x32_bf16 v[108:111], v[128:131], a[108:111], v[108:111]
    s_waitcnt lgkmcnt(0)
    s_mov_b32 s60, 4423808
    v_mfma_f32_16x16x32_bf16 v[112:115], v[140:143], a[96:99], v[112:115]
    s_waitcnt vmcnt(14)
    s_barrier
    v_mfma_f32_16x16x32_bf16 v[112:115], v[144:147], a[112:115], v[112:115]
    ds_read_b64_tr_b16 v[128:129], v6 offset:12288
    s_add_u32 m0, s59, 110592
    v_mfma_f32_16x16x32_bf16 v[112:115], v[148:151], a[128:131], v[112:115]
    buffer_load_dwordx4 v10, s[32:35], s60 offen offset:0  lds
    v_mfma_f32_16x16x32_bf16 v[116:119], v[148:151], a[132:135], v[116:119]
    ds_read_b64_tr_b16 v[130:131], v6 offset:13312
    v_mfma_f32_16x16x32_bf16 v[116:119], v[144:147], a[116:119], v[116:119]
    ds_read_b64_tr_b16 v[132:133], v6 offset:16384
    v_mfma_f32_16x16x32_bf16 v[116:119], v[140:143], a[100:103], v[116:119]
    ds_read_b64_tr_b16 v[134:135], v6 offset:17408
    v_mfma_f32_16x16x32_bf16 v[120:123], v[140:143], a[104:107], v[120:123]
    ds_read_b64_tr_b16 v[136:137], v6 offset:20480
    v_mfma_f32_16x16x32_bf16 v[120:123], v[144:147], a[120:123], v[120:123]
    buffer_load_dwordx4 v11, s[32:35], s60 offen offset:1024  lds
    v_mfma_f32_16x16x32_bf16 v[120:123], v[148:151], a[136:139], v[120:123]
    ds_read_b64_tr_b16 v[138:139], v6 offset:21504
    v_mfma_f32_16x16x32_bf16 v[124:127], v[148:151], a[140:143], v[124:127]
    v_mfma_f32_16x16x32_bf16 v[124:127], v[144:147], a[124:127], v[124:127]
    v_mfma_f32_16x16x32_bf16 v[124:127], v[140:143], a[108:111], v[124:127]
    s_waitcnt lgkmcnt(0)
    v_mfma_f32_16x16x32_bf16 v[64:67], v[128:131], a[96:99], v[64:67]
    buffer_load_dwordx4 v12, s[32:35], s60 offen offset:2048  lds
    v_mfma_f32_16x16x32_bf16 v[64:67], v[132:135], a[112:115], v[64:67]
    ds_read_b64_tr_b16 v[140:141], v7 offset:12288
    v_mfma_f32_16x16x32_bf16 v[64:67], v[136:139], a[128:131], v[64:67]
    ds_read_b64_tr_b16 v[142:143], v7 offset:13312
    v_mfma_f32_16x16x32_bf16 v[68:71], v[136:139], a[132:135], v[68:71]
    ds_read_b64_tr_b16 v[144:145], v7 offset:16384
    v_mfma_f32_16x16x32_bf16 v[68:71], v[132:135], a[116:119], v[68:71]
    ds_read_b64_tr_b16 v[146:147], v7 offset:17408
    v_mfma_f32_16x16x32_bf16 v[68:71], v[128:131], a[100:103], v[68:71]
    v_mfma_f32_16x16x32_bf16 v[72:75], v[128:131], a[104:107], v[72:75]
    ds_read_b64_tr_b16 v[148:149], v7 offset:20480
    v_mfma_f32_16x16x32_bf16 v[72:75], v[132:135], a[120:123], v[72:75]
    ds_read_b64_tr_b16 v[150:151], v7 offset:21504
    v_mfma_f32_16x16x32_bf16 v[72:75], v[136:139], a[136:139], v[72:75]
    v_mfma_f32_16x16x32_bf16 v[76:79], v[136:139], a[140:143], v[76:79]
    v_mfma_f32_16x16x32_bf16 v[76:79], v[132:135], a[124:127], v[76:79]
    v_mfma_f32_16x16x32_bf16 v[76:79], v[128:131], a[108:111], v[76:79]
    s_waitcnt lgkmcnt(0)
    s_mov_b32 s60, 4423808
    v_mfma_f32_16x16x32_bf16 v[80:83], v[140:143], a[96:99], v[80:83]
    s_waitcnt vmcnt(14)
    s_barrier
    s_cmp_eq_u32 s67, 3
    s_cbranch_scc1 L_sigA3
L_sigA3_done:
    v_mfma_f32_16x16x32_bf16 v[80:83], v[144:147], a[112:115], v[80:83]
    ds_read_b64_tr_b16 v[128:129], v6 offset:36864
    s_add_u32 m0, s59, 122880
    v_mfma_f32_16x16x32_bf16 v[80:83], v[148:151], a[128:131], v[80:83]
    buffer_load_dwordx4 v10, s[36:39], s60 offen offset:0  lds
    v_mfma_f32_16x16x32_bf16 v[84:87], v[148:151], a[132:135], v[84:87]
    ds_read_b64_tr_b16 v[130:131], v6 offset:37888
    v_mfma_f32_16x16x32_bf16 v[84:87], v[144:147], a[116:119], v[84:87]
    ds_read_b64_tr_b16 v[132:133], v6 offset:40960
    v_mfma_f32_16x16x32_bf16 v[84:87], v[140:143], a[100:103], v[84:87]
    ds_read_b64_tr_b16 v[134:135], v6 offset:41984
    v_mfma_f32_16x16x32_bf16 v[88:91], v[140:143], a[104:107], v[88:91]
    ds_read_b64_tr_b16 v[136:137], v6 offset:45056
    v_mfma_f32_16x16x32_bf16 v[88:91], v[144:147], a[120:123], v[88:91]
    buffer_load_dwordx4 v11, s[36:39], s60 offen offset:1024  lds
    v_mfma_f32_16x16x32_bf16 v[88:91], v[148:151], a[136:139], v[88:91]
    ds_read_b64_tr_b16 v[138:139], v6 offset:46080
    v_mfma_f32_16x16x32_bf16 v[92:95], v[148:151], a[140:143], v[92:95]
    v_mfma_f32_16x16x32_bf16 v[92:95], v[144:147], a[124:127], v[92:95]
    v_mfma_f32_16x16x32_bf16 v[92:95], v[140:143], a[108:111], v[92:95]
    s_waitcnt lgkmcnt(0)
    v_mfma_f32_16x16x32_bf16 v[96:99], v[128:131], a[144:147], v[96:99]
    buffer_load_dwordx4 v12, s[36:39], s60 offen offset:2048  lds
    v_mfma_f32_16x16x32_bf16 v[96:99], v[132:135], a[160:163], v[96:99]
    ds_read_b64_tr_b16 v[140:141], v7 offset:36864
    v_mfma_f32_16x16x32_bf16 v[96:99], v[136:139], a[176:179], v[96:99]
    ds_read_b64_tr_b16 v[142:143], v7 offset:37888
    v_mfma_f32_16x16x32_bf16 v[100:103], v[136:139], a[180:183], v[100:103]
    ds_read_b64_tr_b16 v[144:145], v7 offset:40960
    v_mfma_f32_16x16x32_bf16 v[100:103], v[132:135], a[164:167], v[100:103]
    ds_read_b64_tr_b16 v[146:147], v7 offset:41984
    v_mfma_f32_16x16x32_bf16 v[100:103], v[128:131], a[148:151], v[100:103]
    buffer_load_dword v2, v219, s[48:51], 0 offen offset:384
    v_mfma_f32_16x16x32_bf16 v[104:107], v[128:131], a[152:155], v[104:107]
    ds_read_b64_tr_b16 v[148:149], v7 offset:45056
    v_mfma_f32_16x16x32_bf16 v[104:107], v[132:135], a[168:171], v[104:107]
    ds_read_b64_tr_b16 v[150:151], v7 offset:46080
    v_mfma_f32_16x16x32_bf16 v[104:107], v[136:139], a[184:187], v[104:107]
    v_mfma_f32_16x16x32_bf16 v[108:111], v[136:139], a[188:191], v[108:111]
    v_mfma_f32_16x16x32_bf16 v[108:111], v[132:135], a[172:175], v[108:111]
    v_mfma_f32_16x16x32_bf16 v[108:111], v[128:131], a[156:159], v[108:111]
    s_waitcnt lgkmcnt(0)
    s_mov_b32 s60, 256
    v_mfma_f32_16x16x32_bf16 v[112:115], v[140:143], a[144:147], v[112:115]
    s_waitcnt vmcnt(15)
    s_barrier
    v_mfma_f32_16x16x32_bf16 v[112:115], v[144:147], a[160:163], v[112:115]
    ds_read_b64_tr_b16 v[128:129], v4 offset:24576
    s_add_u32 m0, s59, 147456
    v_mfma_f32_16x16x32_bf16 v[112:115], v[148:151], a[176:179], v[112:115]
    buffer_load_dwordx4 v10, s[32:35], s60 offen offset:0  lds
    v_mfma_f32_16x16x32_bf16 v[116:119], v[148:151], a[180:183], v[116:119]
    ds_read_b64_tr_b16 v[130:131], v4 offset:25600
    v_mfma_f32_16x16x32_bf16 v[116:119], v[144:147], a[164:167], v[116:119]
    ds_read_b64_tr_b16 v[132:133], v4 offset:28672
    v_mfma_f32_16x16x32_bf16 v[116:119], v[140:143], a[148:151], v[116:119]
    ds_read_b64_tr_b16 v[134:135], v4 offset:29696
    v_mfma_f32_16x16x32_bf16 v[120:123], v[140:143], a[152:155], v[120:123]
    ds_read_b64_tr_b16 v[136:137], v4 offset:32768
    v_mfma_f32_16x16x32_bf16 v[120:123], v[144:147], a[168:171], v[120:123]
    buffer_load_dwordx4 v11, s[32:35], s60 offen offset:1024  lds
    v_mfma_f32_16x16x32_bf16 v[120:123], v[148:151], a[184:187], v[120:123]
    ds_read_b64_tr_b16 v[138:139], v4 offset:33792
    v_mfma_f32_16x16x32_bf16 v[124:127], v[148:151], a[188:191], v[124:127]
    v_mfma_f32_16x16x32_bf16 v[124:127], v[144:147], a[172:175], v[124:127]
    v_mfma_f32_16x16x32_bf16 v[124:127], v[140:143], a[156:159], v[124:127]
    s_waitcnt lgkmcnt(0)
    v_mfma_f32_16x16x32_bf16 v[64:67], v[128:131], a[144:147], v[64:67]
    buffer_load_dwordx4 v12, s[32:35], s60 offen offset:2048  lds
    v_mfma_f32_16x16x32_bf16 v[64:67], v[132:135], a[160:163], v[64:67]
    ds_read_b64_tr_b16 v[140:141], v5 offset:24576
    v_mfma_f32_16x16x32_bf16 v[64:67], v[136:139], a[176:179], v[64:67]
    ds_read_b64_tr_b16 v[142:143], v5 offset:25600
    v_mfma_f32_16x16x32_bf16 v[68:71], v[136:139], a[180:183], v[68:71]
    ds_read_b64_tr_b16 v[144:145], v5 offset:28672
    v_mfma_f32_16x16x32_bf16 v[68:71], v[132:135], a[164:167], v[68:71]
    ds_read_b64_tr_b16 v[146:147], v5 offset:29696
    v_mfma_f32_16x16x32_bf16 v[68:71], v[128:131], a[148:151], v[68:71]
    v_mfma_f32_16x16x32_bf16 v[72:75], v[128:131], a[152:155], v[72:75]
    ds_read_b64_tr_b16 v[148:149], v5 offset:32768
    v_mfma_f32_16x16x32_bf16 v[72:75], v[132:135], a[168:171], v[72:75]
    ds_read_b64_tr_b16 v[150:151], v5 offset:33792
    v_mfma_f32_16x16x32_bf16 v[72:75], v[136:139], a[184:187], v[72:75]
    v_mfma_f32_16x16x32_bf16 v[76:79], v[136:139], a[188:191], v[76:79]
    v_mfma_f32_16x16x32_bf16 v[76:79], v[132:135], a[172:175], v[76:79]
    v_mfma_f32_16x16x32_bf16 v[76:79], v[128:131], a[156:159], v[76:79]
    s_waitcnt lgkmcnt(0)
    s_mov_b32 s60, 256
    v_mfma_f32_16x16x32_bf16 v[80:83], v[140:143], a[144:147], v[80:83]
    s_waitcnt vmcnt(14)
    s_barrier
    s_cmp_eq_u32 s67, 4
    s_cbranch_scc1 L_sigA4
L_sigA4_done:
    v_mfma_f32_16x16x32_bf16 v[80:83], v[144:147], a[160:163], v[80:83]
    ds_read_b64_tr_b16 v[128:129], v4 offset:36864
    s_add_u32 m0, s59, 73728
    v_mfma_f32_16x16x32_bf16 v[80:83], v[148:151], a[176:179], v[80:83]
    buffer_load_dwordx4 v10, s[36:39], s60 offen offset:0  lds
    v_mfma_f32_16x16x32_bf16 v[84:87], v[148:151], a[180:183], v[84:87]
    ds_read_b64_tr_b16 v[130:131], v4 offset:37888
    v_mfma_f32_16x16x32_bf16 v[84:87], v[144:147], a[164:167], v[84:87]
    ds_read_b64_tr_b16 v[132:133], v4 offset:40960
    v_mfma_f32_16x16x32_bf16 v[84:87], v[140:143], a[148:151], v[84:87]
    ds_read_b64_tr_b16 v[134:135], v4 offset:41984
    v_mfma_f32_16x16x32_bf16 v[88:91], v[140:143], a[152:155], v[88:91]
    ds_read_b64_tr_b16 v[136:137], v4 offset:45056
    v_mfma_f32_16x16x32_bf16 v[88:91], v[144:147], a[168:171], v[88:91]
    buffer_load_dwordx4 v11, s[36:39], s60 offen offset:1024  lds
    v_mfma_f32_16x16x32_bf16 v[88:91], v[148:151], a[184:187], v[88:91]
    ds_read_b64_tr_b16 v[138:139], v4 offset:46080
    v_mfma_f32_16x16x32_bf16 v[92:95], v[148:151], a[188:191], v[92:95]
    v_mfma_f32_16x16x32_bf16 v[92:95], v[144:147], a[172:175], v[92:95]
    v_mfma_f32_16x16x32_bf16 v[92:95], v[140:143], a[156:159], v[92:95]
    s_waitcnt lgkmcnt(0)
    v_mfma_f32_16x16x32_bf16 v[96:99], v[128:131], a[192:195], v[96:99]
    buffer_load_dwordx4 v12, s[36:39], s60 offen offset:2048  lds
    v_mfma_f32_16x16x32_bf16 v[96:99], v[132:135], a[208:211], v[96:99]
    ds_read_b64_tr_b16 v[140:141], v5 offset:36864
    s_lshl_b32 s62, s52, 14
    v_mfma_f32_16x16x32_bf16 v[96:99], v[136:139], a[224:227], v[96:99]
    ds_read_b64_tr_b16 v[142:143], v5 offset:37888
    s_add_u32 s62, s62, 37748736
    v_mfma_f32_16x16x32_bf16 v[100:103], v[136:139], a[228:231], v[100:103]
    ds_read_b64_tr_b16 v[144:145], v5 offset:40960
    v_lshl_add_u32 v28, v1, 4, s62
    v_mfma_f32_16x16x32_bf16 v[100:103], v[132:135], a[212:215], v[100:103]
    ds_read_b64_tr_b16 v[146:147], v5 offset:41984
    s_lshl_b32 s62, s52, 11
    v_mfma_f32_16x16x32_bf16 v[100:103], v[128:131], a[196:199], v[100:103]
    v_mfma_f32_16x16x32_bf16 v[104:107], v[128:131], a[200:203], v[104:107]
    ds_read_b64_tr_b16 v[148:149], v5 offset:45056
    s_add_u32 s62, s62, 37814272
    v_mfma_f32_16x16x32_bf16 v[104:107], v[132:135], a[216:219], v[104:107]
    ds_read_b64_tr_b16 v[150:151], v5 offset:46080
    v_and_b32 v31, 31, v1
    v_mfma_f32_16x16x32_bf16 v[104:107], v[136:139], a[232:235], v[104:107]
    v_lshl_add_u32 v29, v31, 4, s62
    s_mul_i32 s62, s52, 20480
    v_mfma_f32_16x16x32_bf16 v[108:111], v[136:139], a[236:239], v[108:111]
    v_mfma_f32_16x16x32_bf16 v[108:111], v[132:135], a[220:223], v[108:111]
    s_add_u32 s62, s62, 37822464
    v_lshrrev_b32 v30, 5, v1
    v_mfma_f32_16x16x32_bf16 v[108:111], v[128:131], a[204:207], v[108:111]
    s_waitcnt lgkmcnt(0)
    s_mov_b32 s60, 884992
    v_mfma_f32_16x16x32_bf16 v[112:115], v[140:143], a[192:195], v[112:115]
    s_waitcnt vmcnt(13)
    s_barrier
    v_mfma_f32_16x16x32_bf16 v[112:115], v[144:147], a[208:211], v[112:115]
    ds_read_b64_tr_b16 v[128:129], v4 offset:49152
    s_add_u32 m0, s59, 86016
    v_mfma_f32_16x16x32_bf16 v[112:115], v[148:151], a[224:227], v[112:115]
    buffer_load_dwordx4 v10, s[32:35], s60 offen offset:0  lds
    v_mfma_f32_16x16x32_bf16 v[116:119], v[148:151], a[228:231], v[116:119]
    ds_read_b64_tr_b16 v[130:131], v4 offset:50176
    v_mul_u32_u24 v30, 19, v30
    v_mfma_f32_16x16x32_bf16 v[116:119], v[144:147], a[212:215], v[116:119]
    ds_read_b64_tr_b16 v[132:133], v4 offset:53248
    v_cmp_eq_u32 vcc, 18, v31
    v_mfma_f32_16x16x32_bf16 v[116:119], v[140:143], a[196:199], v[116:119]
    ds_read_b64_tr_b16 v[134:135], v4 offset:54272
    v_add_u32 v160, 2, v31
    v_mfma_f32_16x16x32_bf16 v[120:123], v[140:143], a[200:203], v[120:123]
    ds_read_b64_tr_b16 v[136:137], v4 offset:57344
    s_nop 0
    v_mfma_f32_16x16x32_bf16 v[120:123], v[144:147], a[216:219], v[120:123]
    buffer_load_dwordx4 v11, s[32:35], s60 offen offset:1024  lds
    v_mfma_f32_16x16x32_bf16 v[120:123], v[148:151], a[232:235], v[120:123]
    ds_read_b64_tr_b16 v[138:139], v4 offset:58368
    v_cndmask_b32 v31, v31, v160, vcc
    v_mfma_f32_16x16x32_bf16 v[124:127], v[148:151], a[236:239], v[124:127]
    v_xor_b32 v160, 6, v31
    v_and_b32 v161, 31, v1
    v_mfma_f32_16x16x32_bf16 v[124:127], v[144:147], a[220:223], v[124:127]
    v_cmp_eq_u32 vcc, 20, v161
    s_nop 1
    v_mfma_f32_16x16x32_bf16 v[124:127], v[140:143], a[204:207], v[124:127]
    s_waitcnt lgkmcnt(0)
    v_cndmask_b32 v31, v31, v160, vcc
    v_mfma_f32_16x16x32_bf16 v[64:67], v[128:131], a[192:195], v[64:67]
    buffer_load_dwordx4 v12, s[32:35], s60 offen offset:2048  lds
    v_mfma_f32_16x16x32_bf16 v[64:67], v[132:135], a[208:211], v[64:67]
    ds_read_b64_tr_b16 v[140:141], v5 offset:49152
    v_add_u32 v30, v30, v31
    v_mfma_f32_16x16x32_bf16 v[64:67], v[136:139], a[224:227], v[64:67]
    ds_read_b64_tr_b16 v[142:143], v5 offset:50176
    v_lshl_add_u32 v30, v30, 4, s62
    v_mfma_f32_16x16x32_bf16 v[68:71], v[136:139], a[228:231], v[68:71]
    ds_read_b64_tr_b16 v[144:145], v5 offset:53248
    v_cmp_gt_u32 vcc, 19, v31
    v_mfma_f32_16x16x32_bf16 v[68:71], v[132:135], a[212:215], v[68:71]
    ds_read_b64_tr_b16 v[146:147], v5 offset:54272
    v_mov_b32 v31, 2146435072
    v_mfma_f32_16x16x32_bf16 v[68:71], v[128:131], a[196:199], v[68:71]
    v_mfma_f32_16x16x32_bf16 v[72:75], v[128:131], a[200:203], v[72:75]
    ds_read_b64_tr_b16 v[148:149], v5 offset:57344
    s_nop 0
    v_mfma_f32_16x16x32_bf16 v[72:75], v[132:135], a[216:219], v[72:75]
    ds_read_b64_tr_b16 v[150:151], v5 offset:58368
    v_cndmask_b32 v30, v31, v30, vcc
    v_mfma_f32_16x16x32_bf16 v[72:75], v[136:139], a[232:235], v[72:75]
    v_mov_b32 v31, 0
    v_mfma_f32_16x16x32_bf16 v[76:79], v[136:139], a[236:239], v[76:79]
    global_load_dword v2, v31, s[24:25] offset:128 sc1
    v_mfma_f32_16x16x32_bf16 v[76:79], v[132:135], a[220:223], v[76:79]
    v_mfma_f32_16x16x32_bf16 v[76:79], v[128:131], a[204:207], v[76:79]
    s_waitcnt lgkmcnt(0)
    s_mov_b32 s60, 884992
    v_mfma_f32_16x16x32_bf16 v[80:83], v[140:143], a[192:195], v[80:83]
    s_waitcnt vmcnt(14)
    s_barrier
    s_cmp_eq_u32 s67, 5
    s_cbranch_scc1 L_sigA5
L_sigA5_done:
    v_mfma_f32_16x16x32_bf16 v[80:83], v[144:147], a[208:211], v[80:83]
    ds_read_b64_tr_b16 v[128:129], v6 offset:0
    s_add_u32 m0, s59, 98304
    v_mfma_f32_16x16x32_bf16 v[80:83], v[148:151], a[224:227], v[80:83]
    buffer_load_dwordx4 v10, s[36:39], s60 offen offset:0  lds
    v_mfma_f32_16x16x32_bf16 v[84:87], v[148:151], a[228:231], v[84:87]
    ds_read_b64_tr_b16 v[130:131], v6 offset:1024
    v_mfma_f32_16x16x32_bf16 v[84:87], v[144:147], a[212:215], v[84:87]
    ds_read_b64_tr_b16 v[132:133], v6 offset:4096
    v_mfma_f32_16x16x32_bf16 v[84:87], v[140:143], a[196:199], v[84:87]
    ds_read_b64_tr_b16 v[134:135], v6 offset:5120
    v_mfma_f32_16x16x32_bf16 v[88:91], v[140:143], a[200:203], v[88:91]
    ds_read_b64_tr_b16 v[136:137], v6 offset:8192
    v_mfma_f32_16x16x32_bf16 v[88:91], v[144:147], a[216:219], v[88:91]
    buffer_load_dwordx4 v11, s[36:39], s60 offen offset:1024  lds
    v_mfma_f32_16x16x32_bf16 v[88:91], v[148:151], a[232:235], v[88:91]
    ds_read_b64_tr_b16 v[138:139], v6 offset:9216
    v_mfma_f32_16x16x32_bf16 v[92:95], v[148:151], a[236:239], v[92:95]
    v_mfma_f32_16x16x32_bf16 v[92:95], v[144:147], a[220:223], v[92:95]
    v_mfma_f32_16x16x32_bf16 v[92:95], v[140:143], a[204:207], v[92:95]
    s_waitcnt lgkmcnt(0)
    v_mfma_f32_16x16x32_bf16 v[96:99], v[128:131], a[240:243], v[96:99]
    buffer_load_dwordx4 v12, s[36:39], s60 offen offset:2048  lds
    v_mfma_f32_16x16x32_bf16 v[96:99], v[132:135], v[224:227], v[96:99]
    ds_read_b64_tr_b16 v[140:141], v7 offset:0
    v_mfma_f32_16x16x32_bf16 v[96:99], v[136:139], v[240:243], v[96:99]
    ds_read_b64_tr_b16 v[142:143], v7 offset:1024
    v_mfma_f32_16x16x32_bf16 v[100:103], v[136:139], v[244:247], v[100:103]
    ds_read_b64_tr_b16 v[144:145], v7 offset:4096
    v_mfma_f32_16x16x32_bf16 v[100:103], v[132:135], v[228:231], v[100:103]
    ds_read_b64_tr_b16 v[146:147], v7 offset:5120
    v_mfma_f32_16x16x32_bf16 v[100:103], v[128:131], a[244:247], v[100:103]
    v_mfma_f32_16x16x32_bf16 v[104:107], v[128:131], a[248:251], v[104:107]
    ds_read_b64_tr_b16 v[148:149], v7 offset:8192
    v_mfma_f32_16x16x32_bf16 v[104:107], v[132:135], v[232:235], v[104:107]
    ds_read_b64_tr_b16 v[150:151], v7 offset:9216
    v_mfma_f32_16x16x32_bf16 v[104:107], v[136:139], v[248:251], v[104:107]
    v_mfma_f32_16x16x32_bf16 v[108:111], v[136:139], v[252:255], v[108:111]
    v_mfma_f32_16x16x32_bf16 v[108:111], v[132:135], v[236:239], v[108:111]
    v_mul_f32 v96, v20, v96
    v_mul_f32 v97, v20, v97
    v_mfma_f32_16x16x32_bf16 v[108:111], v[128:131], a[252:255], v[108:111]
    s_waitcnt lgkmcnt(0)
    s_mov_b32 s60, 1769728
    v_mfma_f32_16x16x32_bf16 v[112:115], v[140:143], a[240:243], v[112:115]
    s_waitcnt vmcnt(14)
    s_barrier
    v_mfma_f32_16x16x32_bf16 v[112:115], v[144:147], v[224:227], v[112:115]
    ds_read_b64_tr_b16 v[128:129], v6 offset:12288
    s_add_u32 m0, s59, 110592
    v_mfma_f32_16x16x32_bf16 v[112:115], v[148:151], v[240:243], v[112:115]
    buffer_load_dwordx4 v10, s[32:35], s60 offen offset:0  lds
    v_mfma_f32_16x16x32_bf16 v[116:119], v[148:151], v[244:247], v[116:119]
    ds_read_b64_tr_b16 v[130:131], v6 offset:13312
    v_mul_f32 v98, v20, v98
    v_mfma_f32_16x16x32_bf16 v[116:119], v[144:147], v[228:231], v[116:119]
    ds_read_b64_tr_b16 v[132:133], v6 offset:16384
    v_mul_f32 v99, v20, v99
    v_mfma_f32_16x16x32_bf16 v[116:119], v[140:143], a[244:247], v[116:119]
    ds_read_b64_tr_b16 v[134:135], v6 offset:17408
    v_mul_f32 v100, v21, v100
    v_mfma_f32_16x16x32_bf16 v[120:123], v[140:143], a[248:251], v[120:123]
    ds_read_b64_tr_b16 v[136:137], v6 offset:20480
    v_mul_f32 v101, v21, v101
    v_mfma_f32_16x16x32_bf16 v[120:123], v[144:147], v[232:235], v[120:123]
    buffer_load_dwordx4 v11, s[32:35], s60 offen offset:1024  lds
    v_mfma_f32_16x16x32_bf16 v[120:123], v[148:151], v[248:251], v[120:123]
    ds_read_b64_tr_b16 v[138:139], v6 offset:21504
    v_mul_f32 v102, v21, v102
    v_mfma_f32_16x16x32_bf16 v[124:127], v[148:151], v[252:255], v[124:127]
    v_mul_f32 v103, v21, v103
    v_mul_f32 v104, v22, v104
    v_mfma_f32_16x16x32_bf16 v[124:127], v[144:147], v[236:239], v[124:127]
    v_mul_f32 v105, v22, v105
    v_mul_f32 v106, v22, v106
    v_mfma_f32_16x16x32_bf16 v[124:127], v[140:143], a[252:255], v[124:127]
    s_waitcnt lgkmcnt(0)
    v_mul_f32 v107, v22, v107
    v_mfma_f32_16x16x32_bf16 v[64:67], v[128:131], a[240:243], v[64:67]
    buffer_load_dwordx4 v12, s[32:35], s60 offen offset:2048  lds
    v_mfma_f32_16x16x32_bf16 v[64:67], v[132:135], v[224:227], v[64:67]
    ds_read_b64_tr_b16 v[140:141], v7 offset:12288
    v_mul_f32 v108, v23, v108
    v_mfma_f32_16x16x32_bf16 v[64:67], v[136:139], v[240:243], v[64:67]
    ds_read_b64_tr_b16 v[142:143], v7 offset:13312
    v_mul_f32 v109, v23, v109
    v_mfma_f32_16x16x32_bf16 v[68:71], v[136:139], v[244:247], v[68:71]
    ds_read_b64_tr_b16 v[144:145], v7 offset:16384
    v_mul_f32 v110, v23, v110
    v_mfma_f32_16x16x32_bf16 v[68:71], v[132:135], v[228:231], v[68:71]
    ds_read_b64_tr_b16 v[146:147], v7 offset:17408
    v_mul_f32 v111, v23, v111
    v_mfma_f32_16x16x32_bf16 v[68:71], v[128:131], a[244:247], v[68:71]
    v_mfma_f32_16x16x32_bf16 v[72:75], v[128:131], a[248:251], v[72:75]
    ds_read_b64_tr_b16 v[148:149], v7 offset:20480
    v_mul_f32 v112, v20, v112
    v_mfma_f32_16x16x32_bf16 v[72:75], v[132:135], v[232:235], v[72:75]
    ds_read_b64_tr_b16 v[150:151], v7 offset:21504
    v_mul_f32 v113, v20, v113
    v_mfma_f32_16x16x32_bf16 v[72:75], v[136:139], v[248:251], v[72:75]
    v_mul_f32 v114, v20, v114
    v_mul_f32 v115, v20, v115
    v_mfma_f32_16x16x32_bf16 v[76:79], v[136:139], v[252:255], v[76:79]
    v_mfma_f32_16x16x32_bf16 v[76:79], v[132:135], v[236:239], v[76:79]
    v_mul_f32 v116, v21, v116
    v_mul_f32 v117, v21, v117
    v_mfma_f32_16x16x32_bf16 v[76:79], v[128:131], a[252:255], v[76:79]
    s_waitcnt lgkmcnt(0)
    s_mov_b32 s60, 1769728
    v_mfma_f32_16x16x32_bf16 v[80:83], v[140:143], a[240:243], v[80:83]
    s_waitcnt vmcnt(13)
    s_barrier
    s_cmp_eq_u32 s67, 6
    s_cbranch_scc1 L_sigA6
L_sigA6_done:
    v_mfma_f32_16x16x32_bf16 v[80:83], v[144:147], v[224:227], v[80:83]
    ds_read_b64_tr_b16 v[128:129], v6 offset:36864
    s_add_u32 m0, s59, 122880
    v_mfma_f32_16x16x32_bf16 v[80:83], v[148:151], v[240:243], v[80:83]
    buffer_load_dwordx4 v10, s[36:39], s60 offen offset:0  lds
    v_mfma_f32_16x16x32_bf16 v[84:87], v[148:151], v[244:247], v[84:87]
    ds_read_b64_tr_b16 v[130:131], v6 offset:37888
    v_mul_f32 v118, v21, v118
    v_mfma_f32_16x16x32_bf16 v[84:87], v[144:147], v[228:231], v[84:87]
    ds_read_b64_tr_b16 v[132:133], v6 offset:40960
    v_mul_f32 v119, v21, v119
    v_mfma_f32_16x16x32_bf16 v[84:87], v[140:143], a[244:247], v[84:87]
    ds_read_b64_tr_b16 v[134:135], v6 offset:41984
    v_mul_f32 v120, v22, v120
    v_mfma_f32_16x16x32_bf16 v[88:91], v[140:143], a[248:251], v[88:91]
    ds_read_b64_tr_b16 v[136:137], v6 offset:45056
    v_mul_f32 v121, v22, v121
    v_mfma_f32_16x16x32_bf16 v[88:91], v[144:147], v[232:235], v[88:91]
    buffer_load_dwordx4 v11, s[36:39], s60 offen offset:1024  lds
    v_mfma_f32_16x16x32_bf16 v[88:91], v[148:151], v[248:251], v[88:91]
    ds_read_b64_tr_b16 v[138:139], v6 offset:46080
    v_mul_f32 v122, v22, v122
    v_mfma_f32_16x16x32_bf16 v[92:95], v[148:151], v[252:255], v[92:95]
    v_mul_f32 v123, v22, v123
    v_mul_f32 v124, v23, v124
    v_mfma_f32_16x16x32_bf16 v[92:95], v[144:147], v[236:239], v[92:95]
    v_mul_f32 v125, v23, v125
    v_mul_f32 v126, v23, v126
    v_mfma_f32_16x16x32_bf16 v[92:95], v[140:143], a[252:255], v[92:95]
    s_waitcnt lgkmcnt(0)
    v_mul_f32 v127, v23, v127
    v_mfma_f32_16x16x32_bf16 v[32:35], v[128:131], a[0:3], 0
    buffer_load_dwordx4 v12, s[36:39], s60 offen offset:2048  lds
    v_mfma_f32_16x16x32_bf16 v[32:35], v[132:135], a[16:19], v[32:35]
    ds_read_b64_tr_b16 v[140:141], v7 offset:36864
    v_mul_f32 v96, v96, v64
    v_mfma_f32_16x16x32_bf16 v[32:35], v[136:139], a[32:35], v[32:35]
    ds_read_b64_tr_b16 v[142:143], v7 offset:37888
    v_mul_f32 v97, v97, v65
    v_mfma_f32_16x16x32_bf16 v[36:39], v[136:139], a[36:39], 0
    ds_read_b64_tr_b16 v[144:145], v7 offset:40960
    v_mul_f32 v98, v98, v66
    v_mfma_f32_16x16x32_bf16 v[36:39], v[132:135], a[20:23], v[36:39]
    ds_read_b64_tr_b16 v[146:147], v7 offset:41984
    v_mul_f32 v99, v99, v67
    v_mfma_f32_16x16x32_bf16 v[36:39], v[128:131], a[4:7], v[36:39]
    v_mfma_f32_16x16x32_bf16 v[40:43], v[128:131], a[8:11], 0
    ds_read_b64_tr_b16 v[148:149], v7 offset:45056
    v_mul_f32 v100, v100, v68
    v_mfma_f32_16x16x32_bf16 v[40:43], v[132:135], a[24:27], v[40:43]
    ds_read_b64_tr_b16 v[150:151], v7 offset:46080
    v_mul_f32 v101, v101, v69
    v_mfma_f32_16x16x32_bf16 v[40:43], v[136:139], a[40:43], v[40:43]
    v_mul_f32 v102, v102, v70
    v_mul_f32 v103, v103, v71
    v_mfma_f32_16x16x32_bf16 v[44:47], v[136:139], a[44:47], 0
    v_mfma_f32_16x16x32_bf16 v[44:47], v[132:135], a[28:31], v[44:47]
    v_mul_f32 v104, v104, v72
    v_mul_f32 v105, v105, v73
    v_mfma_f32_16x16x32_bf16 v[44:47], v[128:131], a[12:15], v[44:47]
    s_waitcnt lgkmcnt(0)
    s_mov_b32 s60, 2654464
    v_mfma_f32_16x16x32_bf16 v[48:51], v[140:143], a[0:3], 0
    s_waitcnt vmcnt(13)
    s_barrier
    v_mfma_f32_16x16x32_bf16 v[48:51], v[144:147], a[16:19], v[48:51]
    ds_read_b64_tr_b16 v[128:129], v4 offset:24576
    s_add_u32 m0, s59, 147456
    v_mfma_f32_16x16x32_bf16 v[48:51], v[148:151], a[32:35], v[48:51]
    buffer_load_dwordx4 v10, s[32:35], s60 offen offset:0  lds
    v_mfma_f32_16x16x32_bf16 v[52:55], v[148:151], a[36:39], 0
    ds_read_b64_tr_b16 v[130:131], v4 offset:25600
    v_mul_f32 v106, v106, v74
    v_mfma_f32_16x16x32_bf16 v[52:55], v[144:147], a[20:23], v[52:55]
    ds_read_b64_tr_b16 v[132:133], v4 offset:28672
    v_mul_f32 v107, v107, v75
    v_mfma_f32_16x16x32_bf16 v[52:55], v[140:143], a[4:7], v[52:55]
    ds_read_b64_tr_b16 v[134:135], v4 offset:29696
    v_mul_f32 v108, v108, v76
    v_mfma_f32_16x16x32_bf16 v[56:59], v[140:143], a[8:11], 0
    ds_read_b64_tr_b16 v[136:137], v4 offset:32768
    v_mul_f32 v109, v109, v77
    v_mfma_f32_16x16x32_bf16 v[56:59], v[144:147], a[24:27], v[56:59]
    buffer_load_dwordx4 v11, s[32:35], s60 offen offset:1024  lds
    v_mfma_f32_16x16x32_bf16 v[56:59], v[148:151], a[40:43], v[56:59]
    ds_read_b64_tr_b16 v[138:139], v4 offset:33792
    v_mul_f32 v110, v110, v78
    v_mfma_f32_16x16x32_bf16 v[60:63], v[148:151], a[44:47], 0
    v_mul_f32 v111, v111, v79
    v_mul_f32 v112, v112, v80
    v_mfma_f32_16x16x32_bf16 v[60:63], v[144:147], a[28:31], v[60:63]
    v_mul_f32 v113, v113, v81
    v_mul_f32 v114, v114, v82
    v_mfma_f32_16x16x32_bf16 v[60:63], v[140:143], a[12:15], v[60:63]
    s_waitcnt lgkmcnt(0)
    v_mul_f32 v115, v115, v83
    v_mfma_f32_16x16x32_bf16 v[64:67], v[128:131], a[0:3], 0
    buffer_load_dwordx4 v12, s[32:35], s60 offen offset:2048  lds
    v_mfma_f32_16x16x32_bf16 v[64:67], v[132:135], a[16:19], v[64:67]
    ds_read_b64_tr_b16 v[140:141], v5 offset:24576
    v_mul_f32 v116, v116, v84
    v_mfma_f32_16x16x32_bf16 v[64:67], v[136:139], a[32:35], v[64:67]
    ds_read_b64_tr_b16 v[142:143], v5 offset:25600
    v_mul_f32 v117, v117, v85
    v_mfma_f32_16x16x32_bf16 v[68:71], v[136:139], a[36:39], 0
    ds_read_b64_tr_b16 v[144:145], v5 offset:28672
    v_mul_f32 v118, v118, v86
    v_mfma_f32_16x16x32_bf16 v[68:71], v[132:135], a[20:23], v[68:71]
    ds_read_b64_tr_b16 v[146:147], v5 offset:29696
    v_mul_f32 v119, v119, v87
    v_mfma_f32_16x16x32_bf16 v[68:71], v[128:131], a[4:7], v[68:71]
    v_mfma_f32_16x16x32_bf16 v[72:75], v[128:131], a[8:11], 0
    ds_read_b64_tr_b16 v[148:149], v5 offset:32768
    v_mul_f32 v120, v120, v88
    v_mfma_f32_16x16x32_bf16 v[72:75], v[132:135], a[24:27], v[72:75]
    ds_read_b64_tr_b16 v[150:151], v5 offset:33792
    v_mul_f32 v121, v121, v89
    v_mfma_f32_16x16x32_bf16 v[72:75], v[136:139], a[40:43], v[72:75]
    v_mul_f32 v122, v122, v90
    v_mul_f32 v123, v123, v91
    v_mfma_f32_16x16x32_bf16 v[76:79], v[136:139], a[44:47], 0
    v_mfma_f32_16x16x32_bf16 v[76:79], v[132:135], a[28:31], v[76:79]
    v_mul_f32 v124, v124, v92
    v_mul_f32 v125, v125, v93
    s_waitcnt vmcnt(12)
    v_cmp_le_u32 vcc, 48, v2
    s_nop 1
    s_cmp_eq_u64 vcc, exec
    s_cbranch_scc0 L_poll
L_poll_ok:
    v_mfma_f32_16x16x32_bf16 v[76:79], v[128:131], a[12:15], v[76:79]
    s_waitcnt lgkmcnt(0)
    s_mov_b32 s60, 2654464
    v_mfma_f32_16x16x32_bf16 v[80:83], v[140:143], a[0:3], 0
    s_barrier
    s_cmp_eq_u32 s67, 7
    s_cbranch_scc1 L_sigA7
L_sigA7_done:
    v_mfma_f32_16x16x32_bf16 v[80:83], v[144:147], a[16:19], v[80:83]
    ds_read_b64_tr_b16 v[128:129], v4 offset:36864
    s_add_u32 m0, s59, 73728
    v_mfma_f32_16x16x32_bf16 v[80:83], v[148:151], a[32:35], v[80:83]
    buffer_load_dwordx4 v10, s[36:39], s60 offen offset:0  lds
    v_mfma_f32_16x16x32_bf16 v[84:87], v[148:151], a[36:39], 0
    ds_read_b64_tr_b16 v[130:131], v4 offset:37888
    v_mul_f32 v126, v126, v94
    v_mfma_f32_16x16x32_bf16 v[84:87], v[144:147], a[20:23], v[84:87]
    ds_read_b64_tr_b16 v[132:133], v4 offset:40960
    v_mul_f32 v127, v127, v95
    v_mfma_f32_16x16x32_bf16 v[84:87], v[140:143], a[4:7], v[84:87]
    ds_read_b64_tr_b16 v[134:135], v4 offset:41984
    v_cvt_pk_bf16_f32 v96, v96, v97
    v_mfma_f32_16x16x32_bf16 v[88:91], v[140:143], a[8:11], 0
    ds_read_b64_tr_b16 v[136:137], v4 offset:45056
    v_cvt_pk_bf16_f32 v97, v98, v99
    v_mfma_f32_16x16x32_bf16 v[88:91], v[144:147], a[24:27], v[88:91]
    buffer_load_dwordx4 v11, s[36:39], s60 offen offset:1024  lds
    v_mfma_f32_16x16x32_bf16 v[88:91], v[148:151], a[40:43], v[88:91]
    ds_read_b64_tr_b16 v[138:139], v4 offset:46080
    v_cvt_pk_bf16_f32 v98, v112, v113
    v_mfma_f32_16x16x32_bf16 v[92:95], v[148:151], a[44:47], 0
    v_cvt_pk_bf16_f32 v99, v114, v115
    s_mov_b32 s72, 0
    v_mfma_f32_16x16x32_bf16 v[92:95], v[144:147], a[28:31], v[92:95]
    ds_write_b128 v24, v[96:99] offset:16384
    v_mfma_f32_16x16x32_bf16 v[92:95], v[140:143], a[12:15], v[92:95]
    s_waitcnt lgkmcnt(1)
    v_cvt_pk_bf16_f32 v100, v100, v101
    v_mfma_f32_16x16x32_bf16 v[32:35], v[128:131], a[48:51], v[32:35]
    buffer_load_dwordx4 v12, s[36:39], s60 offen offset:2048  lds
    v_mfma_f32_16x16x32_bf16 v[32:35], v[132:135], a[64:67], v[32:35]
    ds_read_b64_tr_b16 v[140:141], v5 offset:36864
    v_cvt_pk_bf16_f32 v101, v102, v103
    v_mfma_f32_16x16x32_bf16 v[32:35], v[136:139], a[80:83], v[32:35]
    ds_read_b64_tr_b16 v[142:143], v5 offset:37888
    v_cvt_pk_bf16_f32 v102, v116, v117
    v_mfma_f32_16x16x32_bf16 v[36:39], v[136:139], a[84:87], v[36:39]
    ds_read_b64_tr_b16 v[144:145], v5 offset:40960
    v_cvt_pk_bf16_f32 v103, v118, v119
    v_mfma_f32_16x16x32_bf16 v[36:39], v[132:135], a[68:71], v[36:39]
    ds_read_b64_tr_b16 v[146:147], v5 offset:41984
    s_mov_b32 s73, 4096
    v_mfma_f32_16x16x32_bf16 v[36:39], v[128:131], a[52:55], v[36:39]
    v_mfma_f32_16x16x32_bf16 v[40:43], v[128:131], a[56:59], v[40:43]
    ds_read_b64_tr_b16 v[148:149], v5 offset:45056
    s_mov_b32 s74, 8192
    v_mfma_f32_16x16x32_bf16 v[40:43], v[132:135], a[72:75], v[40:43]
    ds_read_b64_tr_b16 v[150:151], v5 offset:46080
    s_mov_b32 s75, 12288
    v_mfma_f32_16x16x32_bf16 v[40:43], v[136:139], a[88:91], v[40:43]
    s_lshr_b32 s5, s2, 3
    s_lshl_b32 s5, s5, 2
    v_mfma_f32_16x16x32_bf16 v[44:47], v[136:139], a[92:95], v[44:47]
    v_mfma_f32_16x16x32_bf16 v[44:47], v[132:135], a[76:79], v[44:47]
    ds_write_b128 v24, v[100:103] offset:17408
    v_mfma_f32_16x16x32_bf16 v[44:47], v[128:131], a[60:63], v[44:47]
    s_waitcnt lgkmcnt(1)
    s_mov_b32 s60, 3539200
    v_mfma_f32_16x16x32_bf16 v[48:51], v[140:143], a[48:51], v[48:51]
    s_waitcnt vmcnt(12)
    s_barrier
    v_mfma_f32_16x16x32_bf16 v[48:51], v[144:147], a[64:67], v[48:51]
    ds_read_b64_tr_b16 v[128:129], v4 offset:49152
    s_add_u32 m0, s59, 86016
    v_mfma_f32_16x16x32_bf16 v[48:51], v[148:151], a[80:83], v[48:51]
    buffer_load_dwordx4 v10, s[32:35], s60 offen offset:0  lds
    v_mfma_f32_16x16x32_bf16 v[52:55], v[148:151], a[84:87], v[52:55]
    ds_read_b64_tr_b16 v[130:131], v4 offset:50176
    v_cvt_pk_bf16_f32 v104, v104, v105
    v_mfma_f32_16x16x32_bf16 v[52:55], v[144:147], a[68:71], v[52:55]
    ds_read_b64_tr_b16 v[132:133], v4 offset:53248
    v_cvt_pk_bf16_f32 v105, v106, v107
    v_mfma_f32_16x16x32_bf16 v[52:55], v[140:143], a[52:55], v[52:55]
    ds_read_b64_tr_b16 v[134:135], v4 offset:54272
    v_cvt_pk_bf16_f32 v106, v120, v121
    v_mfma_f32_16x16x32_bf16 v[56:59], v[140:143], a[56:59], v[56:59]
    ds_read_b64_tr_b16 v[136:137], v4 offset:57344
    v_cvt_pk_bf16_f32 v107, v122, v123
    v_mfma_f32_16x16x32_bf16 v[56:59], v[144:147], a[72:75], v[56:59]
    buffer_load_dwordx4 v11, s[32:35], s60 offen offset:1024  lds
    v_mfma_f32_16x16x32_bf16 v[56:59], v[148:151], a[88:91], v[56:59]
    ds_read_b64_tr_b16 v[138:139], v4 offset:58368
    s_add_u32 s5, s5, s52
    v_mfma_f32_16x16x32_bf16 v[60:63], v[148:151], a[92:95], v[60:63]
    s_mul_i32 s5, s5, 768
    s_add_u32 s5, s5, 37814272
    v_mfma_f32_16x16x32_bf16 v[60:63], v[144:147], a[76:79], v[60:63]
    ds_write_b128 v24, v[104:107] offset:18432
    v_mfma_f32_16x16x32_bf16 v[60:63], v[140:143], a[60:63], v[60:63]
    s_waitcnt lgkmcnt(1)
    v_cvt_pk_bf16_f32 v108, v108, v109
    v_mfma_f32_16x16x32_bf16 v[64:67], v[128:131], a[48:51], v[64:67]
    buffer_load_dwordx4 v12, s[32:35], s60 offen offset:2048  lds
    v_mfma_f32_16x16x32_bf16 v[64:67], v[132:135], a[64:67], v[64:67]
    ds_read_b64_tr_b16 v[140:141], v5 offset:49152
    v_cvt_pk_bf16_f32 v109, v110, v111
    v_mfma_f32_16x16x32_bf16 v[64:67], v[136:139], a[80:83], v[64:67]
    ds_read_b64_tr_b16 v[142:143], v5 offset:50176
    v_cvt_pk_bf16_f32 v110, v124, v125
    v_mfma_f32_16x16x32_bf16 v[68:71], v[136:139], a[84:87], v[68:71]
    ds_read_b64_tr_b16 v[144:145], v5 offset:53248
    v_cvt_pk_bf16_f32 v111, v126, v127
    v_mfma_f32_16x16x32_bf16 v[68:71], v[132:135], a[68:71], v[68:71]
    ds_read_b64_tr_b16 v[146:147], v5 offset:54272
    v_min_u32 v158, 17, v1
    v_mfma_f32_16x16x32_bf16 v[68:71], v[128:131], a[52:55], v[68:71]
    v_mfma_f32_16x16x32_bf16 v[72:75], v[128:131], a[56:59], v[72:75]
    ds_read_b64_tr_b16 v[148:149], v5 offset:57344
    v_and_b32 v158, 1, v158
    v_mfma_f32_16x16x32_bf16 v[72:75], v[132:135], a[72:75], v[72:75]
    ds_read_b64_tr_b16 v[150:151], v5 offset:58368
    v_mul_u32_u24 v158, 640, v158
    v_mfma_f32_16x16x32_bf16 v[72:75], v[136:139], a[88:91], v[72:75]
    v_sub_u32 v219, v219, v158
    v_min_u32 v223, 5, v1
    v_mfma_f32_16x16x32_bf16 v[76:79], v[136:139], a[92:95], v[76:79]
    buffer_load_dword v2, v219, s[48:51], 0 offen offset:512
    v_mfma_f32_16x16x32_bf16 v[76:79], v[132:135], a[76:79], v[76:79]
    ds_write_b128 v24, v[108:111] offset:19456
    v_mfma_f32_16x16x32_bf16 v[76:79], v[128:131], a[60:63], v[76:79]
    s_waitcnt lgkmcnt(1)
    s_mov_b32 s60, 3539200
    v_mfma_f32_16x16x32_bf16 v[80:83], v[140:143], a[48:51], v[80:83]
    s_waitcnt vmcnt(13)
    s_barrier
    s_cmp_eq_u32 s67, 8
    s_cbranch_scc1 L_sigA8
L_sigA8_done:
    v_mfma_f32_16x16x32_bf16 v[80:83], v[144:147], a[64:67], v[80:83]
    ds_read_b64_tr_b16 v[128:129], v6 offset:0
    s_add_u32 m0, s59, 98304
    v_mfma_f32_16x16x32_bf16 v[80:83], v[148:151], a[80:83], v[80:83]
    buffer_load_dwordx4 v10, s[36:39], s60 offen offset:0  lds
    v_mfma_f32_16x16x32_bf16 v[84:87], v[148:151], a[84:87], v[84:87]
    ds_read_b64_tr_b16 v[130:131], v6 offset:1024
    v_lshl_add_u32 v223, v223, 7, s5
    v_mfma_f32_16x16x32_bf16 v[84:87], v[144:147], a[68:71], v[84:87]
    ds_read_b64_tr_b16 v[132:133], v6 offset:4096
    v_mfma_f32_16x16x32_bf16 v[84:87], v[140:143], a[52:55], v[84:87]
    ds_read_b64_tr_b16 v[134:135], v6 offset:5120
    v_mfma_f32_16x16x32_bf16 v[88:91], v[140:143], a[56:59], v[88:91]
    ds_read_b64_tr_b16 v[136:137], v6 offset:8192
    v_mfma_f32_16x16x32_bf16 v[88:91], v[144:147], a[72:75], v[88:91]
    buffer_load_dwordx4 v11, s[36:39], s60 offen offset:1024  lds
    v_mfma_f32_16x16x32_bf16 v[88:91], v[148:151], a[88:91], v[88:91]
    ds_read_b64_tr_b16 v[138:139], v6 offset:9216
    v_mfma_f32_16x16x32_bf16 v[92:95], v[148:151], a[92:95], v[92:95]
    v_mfma_f32_16x16x32_bf16 v[92:95], v[144:147], a[76:79], v[92:95]
    v_mfma_f32_16x16x32_bf16 v[92:95], v[140:143], a[60:63], v[92:95]
    s_waitcnt lgkmcnt(0)
    v_mfma_f32_16x16x32_bf16 v[32:35], v[128:131], a[96:99], v[32:35]
    buffer_load_dwordx4 v12, s[36:39], s60 offen offset:2048  lds
    v_mfma_f32_16x16x32_bf16 v[32:35], v[132:135], a[112:115], v[32:35]
    ds_read_b64_tr_b16 v[140:141], v7 offset:0
    v_mfma_f32_16x16x32_bf16 v[32:35], v[136:139], a[128:131], v[32:35]
    ds_read_b64_tr_b16 v[142:143], v7 offset:1024
    v_mfma_f32_16x16x32_bf16 v[36:39], v[136:139], a[132:135], v[36:39]
    ds_read_b64_tr_b16 v[144:145], v7 offset:4096
    v_mfma_f32_16x16x32_bf16 v[36:39], v[132:135], a[116:119], v[36:39]
    ds_read_b64_tr_b16 v[146:147], v7 offset:5120
    v_mfma_f32_16x16x32_bf16 v[36:39], v[128:131], a[100:103], v[36:39]
    buffer_load_dword v2, v223, s[44:47], 0 offen sc1
    v_mfma_f32_16x16x32_bf16 v[40:43], v[128:131], a[104:107], v[40:43]
    ds_read_b64_tr_b16 v[148:149], v7 offset:8192
    v_mfma_f32_16x16x32_bf16 v[40:43], v[132:135], a[120:123], v[40:43]
    ds_read_b64_tr_b16 v[150:151], v7 offset:9216
    v_mfma_f32_16x16x32_bf16 v[40:43], v[136:139], a[136:139], v[40:43]
    v_mfma_f32_16x16x32_bf16 v[44:47], v[136:139], a[140:143], v[44:47]
    buffer_load_dwordx4 v[160:163], v28, s[44:47], s72 offen offset:0 sc1
    v_mfma_f32_16x16x32_bf16 v[44:47], v[132:135], a[124:127], v[44:47]
    v_mfma_f32_16x16x32_bf16 v[44:47], v[128:131], a[108:111], v[44:47]
    s_waitcnt lgkmcnt(0)
    s_mov_b32 s60, 4423936
    v_mfma_f32_16x16x32_bf16 v[48:51], v[140:143], a[96:99], v[48:51]
    s_waitcnt vmcnt(15)
    s_barrier
    v_mfma_f32_16x16x32_bf16 v[48:51], v[144:147], a[112:115], v[48:51]
    ds_read_b64_tr_b16 v[128:129], v6 offset:12288
    s_add_u32 m0, s59, 110592
    v_mfma_f32_16x16x32_bf16 v[48:51], v[148:151], a[128:131], v[48:51]
    buffer_load_dwordx4 v10, s[32:35], s60 offen offset:0  lds
    v_mfma_f32_16x16x32_bf16 v[52:55], v[148:151], a[132:135], v[52:55]
    ds_read_b64_tr_b16 v[130:131], v6 offset:13312
    v_mfma_f32_16x16x32_bf16 v[52:55], v[144:147], a[116:119], v[52:55]
    ds_read_b64_tr_b16 v[132:133], v6 offset:16384
    v_mfma_f32_16x16x32_bf16 v[52:55], v[140:143], a[100:103], v[52:55]
    ds_read_b64_tr_b16 v[134:135], v6 offset:17408
    v_mfma_f32_16x16x32_bf16 v[56:59], v[140:143], a[104:107], v[56:59]
    ds_read_b64_tr_b16 v[136:137], v6 offset:20480
    v_mfma_f32_16x16x32_bf16 v[56:59], v[144:147], a[120:123], v[56:59]
    buffer_load_dwordx4 v11, s[32:35], s60 offen offset:1024  lds
    v_mfma_f32_16x16x32_bf16 v[56:59], v[148:151], a[136:139], v[56:59]
    ds_read_b64_tr_b16 v[138:139], v6 offset:21504
    v_mfma_f32_16x16x32_bf16 v[60:63], v[148:151], a[140:143], v[60:63]
    v_mfma_f32_16x16x32_bf16 v[60:63], v[144:147], a[124:127], v[60:63]
    v_mfma_f32_16x16x32_bf16 v[60:63], v[140:143], a[108:111], v[60:63]
    s_waitcnt lgkmcnt(0)
    v_mfma_f32_16x16x32_bf16 v[64:67], v[128:131], a[96:99], v[64:67]
    buffer_load_dwordx4 v12, s[32:35], s60 offen offset:2048  lds
    v_mfma_f32_16x16x32_bf16 v[64:67], v[132:135], a[112:115], v[64:67]
    ds_read_b64_tr_b16 v[140:141], v7 offset:12288
    v_mfma_f32_16x16x32_bf16 v[64:67], v[136:139], a[128:131], v[64:67]
    ds_read_b64_tr_b16 v[142:143], v7 offset:13312
    v_mfma_f32_16x16x32_bf16 v[68:71], v[136:139], a[132:135], v[68:71]
    ds_read_b64_tr_b16 v[144:145], v7 offset:16384
    v_mfma_f32_16x16x32_bf16 v[68:71], v[132:135], a[116:119], v[68:71]
    ds_read_b64_tr_b16 v[146:147], v7 offset:17408
    v_mfma_f32_16x16x32_bf16 v[68:71], v[128:131], a[100:103], v[68:71]
    buffer_load_dwordx4 v[164:167], v28, s[44:47], s72 offen offset:1024 sc1
    v_mfma_f32_16x16x32_bf16 v[72:75], v[128:131], a[104:107], v[72:75]
    ds_read_b64_tr_b16 v[148:149], v7 offset:20480
    v_mfma_f32_16x16x32_bf16 v[72:75], v[132:135], a[120:123], v[72:75]
    ds_read_b64_tr_b16 v[150:151], v7 offset:21504
    v_mfma_f32_16x16x32_bf16 v[72:75], v[136:139], a[136:139], v[72:75]
    v_mfma_f32_16x16x32_bf16 v[76:79], v[136:139], a[140:143], v[76:79]
    buffer_load_dwordx4 v[168:171], v28, s[44:47], s72 offen offset:2048 sc1
    v_mfma_f32_16x16x32_bf16 v[76:79], v[132:135], a[124:127], v[76:79]
    v_mfma_f32_16x16x32_bf16 v[76:79], v[128:131], a[108:111], v[76:79]
    s_waitcnt lgkmcnt(0)
    s_mov_b32 s60, 4423936
    v_mfma_f32_16x16x32_bf16 v[80:83], v[140:143], a[96:99], v[80:83]
    s_waitcnt vmcnt(17)
    s_barrier
    s_cmp_eq_u32 s67, 9
    s_cbranch_scc1 L_sigA9
L_sigA9_done:
    v_mfma_f32_16x16x32_bf16 v[80:83], v[144:147], a[112:115], v[80:83]
    ds_read_b64_tr_b16 v[128:129], v6 offset:36864
    s_add_u32 m0, s59, 122880
    v_mfma_f32_16x16x32_bf16 v[80:83], v[148:151], a[128:131], v[80:83]
    buffer_load_dwordx4 v10, s[36:39], s60 offen offset:0  lds
    v_mfma_f32_16x16x32_bf16 v[84:87], v[148:151], a[132:135], v[84:87]
    ds_read_b64_tr_b16 v[130:131], v6 offset:37888
    v_mfma_f32_16x16x32_bf16 v[84:87], v[144:147], a[116:119], v[84:87]
    ds_read_b64_tr_b16 v[132:133], v6 offset:40960
    v_mfma_f32_16x16x32_bf16 v[84:87], v[140:143], a[100:103], v[84:87]
    ds_read_b64_tr_b16 v[134:135], v6 offset:41984
    v_mfma_f32_16x16x32_bf16 v[88:91], v[140:143], a[104:107], v[88:91]
    ds_read_b64_tr_b16 v[136:137], v6 offset:45056
    v_mfma_f32_16x16x32_bf16 v[88:91], v[144:147], a[120:123], v[88:91]
    buffer_load_dwordx4 v11, s[36:39], s60 offen offset:1024  lds
    v_mfma_f32_16x16x32_bf16 v[88:91], v[148:151], a[136:139], v[88:91]
    ds_read_b64_tr_b16 v[138:139], v6 offset:46080
    v_mfma_f32_16x16x32_bf16 v[92:95], v[148:151], a[140:143], v[92:95]
    v_mfma_f32_16x16x32_bf16 v[92:95], v[144:147], a[124:127], v[92:95]
    v_mfma_f32_16x16x32_bf16 v[92:95], v[140:143], a[108:111], v[92:95]
    s_waitcnt lgkmcnt(0)
    v_mfma_f32_16x16x32_bf16 v[32:35], v[128:131], a[144:147], v[32:35]
    buffer_load_dwordx4 v12, s[36:39], s60 offen offset:2048  lds
    v_mfma_f32_16x16x32_bf16 v[32:35], v[132:135], a[160:163], v[32:35]
    ds_read_b64_tr_b16 v[140:141], v7 offset:36864
    v_mfma_f32_16x16x32_bf16 v[32:35], v[136:139], a[176:179], v[32:35]
    ds_read_b64_tr_b16 v[142:143], v7 offset:37888
    v_mfma_f32_16x16x32_bf16 v[36:39], v[136:139], a[180:183], v[36:39]
    ds_read_b64_tr_b16 v[144:145], v7 offset:40960
    v_mfma_f32_16x16x32_bf16 v[36:39], v[132:135], a[164:167], v[36:39]
    ds_read_b64_tr_b16 v[146:147], v7 offset:41984
    v_mfma_f32_16x16x32_bf16 v[36:39], v[128:131], a[148:151], v[36:39]
    buffer_load_dwordx4 v[172:175], v28, s[44:47], s72 offen offset:3072 sc1
    v_mfma_f32_16x16x32_bf16 v[40:43], v[128:131], a[152:155], v[40:43]
    ds_read_b64_tr_b16 v[148:149], v7 offset:45056
    v_mfma_f32_16x16x32_bf16 v[40:43], v[132:135], a[168:171], v[40:43]
    ds_read_b64_tr_b16 v[150:151], v7 offset:46080
    v_mfma_f32_16x16x32_bf16 v[40:43], v[136:139], a[184:187], v[40:43]
    v_mfma_f32_16x16x32_bf16 v[44:47], v[136:139], a[188:191], v[44:47]
    buffer_load_dwordx4 v[176:179], v28, s[44:47], s73 offen offset:0 sc1
    v_mfma_f32_16x16x32_bf16 v[44:47], v[132:135], a[172:175], v[44:47]
    v_mfma_f32_16x16x32_bf16 v[44:47], v[128:131], a[156:159], v[44:47]
    s_waitcnt lgkmcnt(0)
    s_mov_b32 s60, 384
    v_mfma_f32_16x16x32_bf16 v[48:51], v[140:143], a[144:147], v[48:51]
    s_waitcnt vmcnt(19)
    s_barrier
    v_mfma_f32_16x16x32_bf16 v[48:51], v[144:147], a[160:163], v[48:51]
    ds_read_b64_tr_b16 v[128:129], v4 offset:24576
    s_add_u32 m0, s59, 147456
    v_mfma_f32_16x16x32_bf16 v[48:51], v[148:151], a[176:179], v[48:51]
    buffer_load_dwordx4 v10, s[32:35], s60 offen offset:0  lds
    v_mfma_f32_16x16x32_bf16 v[52:55], v[148:151], a[180:183], v[52:55]
    ds_read_b64_tr_b16 v[130:131], v4 offset:25600
    v_mfma_f32_16x16x32_bf16 v[52:55], v[144:147], a[164:167], v[52:55]
    ds_read_b64_tr_b16 v[132:133], v4 offset:28672
    v_mfma_f32_16x16x32_bf16 v[52:55], v[140:143], a[148:151], v[52:55]
    ds_read_b64_tr_b16 v[134:135], v4 offset:29696
    v_mfma_f32_16x16x32_bf16 v[56:59], v[140:143], a[152:155], v[56:59]
    ds_read_b64_tr_b16 v[136:137], v4 offset:32768
    v_mfma_f32_16x16x32_bf16 v[56:59], v[144:147], a[168:171], v[56:59]
    buffer_load_dwordx4 v11, s[32:35], s60 offen offset:1024  lds
    v_mfma_f32_16x16x32_bf16 v[56:59], v[148:151], a[184:187], v[56:59]
    ds_read_b64_tr_b16 v[138:139], v4 offset:33792
    v_mfma_f32_16x16x32_bf16 v[60:63], v[148:151], a[188:191], v[60:63]
    v_mfma_f32_16x16x32_bf16 v[60:63], v[144:147], a[172:175], v[60:63]
    v_mfma_f32_16x16x32_bf16 v[60:63], v[140:143], a[156:159], v[60:63]
    s_waitcnt lgkmcnt(0)
    v_mfma_f32_16x16x32_bf16 v[64:67], v[128:131], a[144:147], v[64:67]
    buffer_load_dwordx4 v12, s[32:35], s60 offen offset:2048  lds
    v_mfma_f32_16x16x32_bf16 v[64:67], v[132:135], a[160:163], v[64:67]
    ds_read_b64_tr_b16 v[140:141], v5 offset:24576
    v_mfma_f32_16x16x32_bf16 v[64:67], v[136:139], a[176:179], v[64:67]
    ds_read_b64_tr_b16 v[142:143], v5 offset:25600
    v_mfma_f32_16x16x32_bf16 v[68:71], v[136:139], a[180:183], v[68:71]
    ds_read_b64_tr_b16 v[144:145], v5 offset:28672
    v_mfma_f32_16x16x32_bf16 v[68:71], v[132:135], a[164:167], v[68:71]
    ds_read_b64_tr_b16 v[146:147], v5 offset:29696
    v_mfma_f32_16x16x32_bf16 v[68:71], v[128:131], a[148:151], v[68:71]
    buffer_load_dwordx4 v[180:183], v28, s[44:47], s73 offen offset:1024 sc1
    v_mfma_f32_16x16x32_bf16 v[72:75], v[128:131], a[152:155], v[72:75]
    ds_read_b64_tr_b16 v[148:149], v5 offset:32768
    v_mfma_f32_16x16x32_bf16 v[72:75], v[132:135], a[168:171], v[72:75]
    ds_read_b64_tr_b16 v[150:151], v5 offset:33792
    v_mfma_f32_16x16x32_bf16 v[72:75], v[136:139], a[184:187], v[72:75]
    v_mfma_f32_16x16x32_bf16 v[76:79], v[136:139], a[188:191], v[76:79]
    buffer_load_dwordx4 v[184:187], v28, s[44:47], s73 offen offset:2048 sc1
    v_mfma_f32_16x16x32_bf16 v[76:79], v[132:135], a[172:175], v[76:79]
    v_mfma_f32_16x16x32_bf16 v[76:79], v[128:131], a[156:159], v[76:79]
    s_waitcnt lgkmcnt(0)
    s_mov_b32 s60, 384
    v_mfma_f32_16x16x32_bf16 v[80:83], v[140:143], a[144:147], v[80:83]
    s_waitcnt vmcnt(21)
    s_barrier
    s_cmp_eq_u32 s67, 10
    s_cbranch_scc1 L_sigA10
L_sigA10_done:
    v_mfma_f32_16x16x32_bf16 v[80:83], v[144:147], a[160:163], v[80:83]
    ds_read_b64_tr_b16 v[128:129], v4 offset:36864
    s_add_u32 m0, s59, 73728
    v_mfma_f32_16x16x32_bf16 v[80:83], v[148:151], a[176:179], v[80:83]
    buffer_load_dwordx4 v10, s[36:39], s60 offen offset:0  lds
    v_mfma_f32_16x16x32_bf16 v[84:87], v[148:151], a[180:183], v[84:87]
    ds_read_b64_tr_b16 v[130:131], v4 offset:37888
    v_mfma_f32_16x16x32_bf16 v[84:87], v[144:147], a[164:167], v[84:87]
    ds_read_b64_tr_b16 v[132:133], v4 offset:40960
    v_mfma_f32_16x16x32_bf16 v[84:87], v[140:143], a[148:151], v[84:87]
    ds_read_b64_tr_b16 v[134:135], v4 offset:41984
    v_mfma_f32_16x16x32_bf16 v[88:91], v[140:143], a[152:155], v[88:91]
    ds_read_b64_tr_b16 v[136:137], v4 offset:45056
    v_mfma_f32_16x16x32_bf16 v[88:91], v[144:147], a[168:171], v[88:91]
    buffer_load_dwordx4 v11, s[36:39], s60 offen offset:1024  lds
    v_mfma_f32_16x16x32_bf16 v[88:91], v[148:151], a[184:187], v[88:91]
    ds_read_b64_tr_b16 v[138:139], v4 offset:46080
    v_mfma_f32_16x16x32_bf16 v[92:95], v[148:151], a[188:191], v[92:95]
    v_mfma_f32_16x16x32_bf16 v[92:95], v[144:147], a[172:175], v[92:95]
    v_mfma_f32_16x16x32_bf16 v[92:95], v[140:143], a[156:159], v[92:95]
    s_waitcnt lgkmcnt(0)
    v_mfma_f32_16x16x32_bf16 v[32:35], v[128:131], a[192:195], v[32:35]
    buffer_load_dwordx4 v12, s[36:39], s60 offen offset:2048  lds
    v_mfma_f32_16x16x32_bf16 v[32:35], v[132:135], a[208:211], v[32:35]
    ds_read_b64_tr_b16 v[140:141], v5 offset:36864
    v_mfma_f32_16x16x32_bf16 v[32:35], v[136:139], a[224:227], v[32:35]
    ds_read_b64_tr_b16 v[142:143], v5 offset:37888
    v_mfma_f32_16x16x32_bf16 v[36:39], v[136:139], a[228:231], v[36:39]
    ds_read_b64_tr_b16 v[144:145], v5 offset:40960
    v_mfma_f32_16x16x32_bf16 v[36:39], v[132:135], a[212:215], v[36:39]
    ds_read_b64_tr_b16 v[146:147], v5 offset:41984
    v_mfma_f32_16x16x32_bf16 v[36:39], v[128:131], a[196:199], v[36:39]
    buffer_load_dwordx4 v[188:191], v28, s[44:47], s73 offen offset:3072 sc1
    v_mfma_f32_16x16x32_bf16 v[40:43], v[128:131], a[200:203], v[40:43]
    ds_read_b64_tr_b16 v[148:149], v5 offset:45056
    v_mfma_f32_16x16x32_bf16 v[40:43], v[132:135], a[216:219], v[40:43]
    ds_read_b64_tr_b16 v[150:151], v5 offset:46080
    v_mfma_f32_16x16x32_bf16 v[40:43], v[136:139], a[232:235], v[40:43]
    v_mfma_f32_16x16x32_bf16 v[44:47], v[136:139], a[236:239], v[44:47]
    buffer_load_dwordx4 v[192:195], v28, s[44:47], s74 offen offset:0 sc1
    v_mfma_f32_16x16x32_bf16 v[44:47], v[132:135], a[220:223], v[44:47]
    v_mfma_f32_16x16x32_bf16 v[44:47], v[128:131], a[204:207], v[44:47]
    s_waitcnt lgkmcnt(0)
    s_mov_b32 s60, 885120
    v_mfma_f32_16x16x32_bf16 v[48:51], v[140:143], a[192:195], v[48:51]
    s_waitcnt vmcnt(22)
    s_barrier
    v_mfma_f32_16x16x32_bf16 v[48:51], v[144:147], a[208:211], v[48:51]
    ds_read_b64_tr_b16 v[128:129], v4 offset:49152
    s_add_u32 m0, s59, 86016
    v_mfma_f32_16x16x32_bf16 v[48:51], v[148:151], a[224:227], v[48:51]
    buffer_load_dwordx4 v10, s[32:35], s60 offen offset:0  lds
    v_mfma_f32_16x16x32_bf16 v[52:55], v[148:151], a[228:231], v[52:55]
    ds_read_b64_tr_b16 v[130:131], v4 offset:50176
    v_mfma_f32_16x16x32_bf16 v[52:55], v[144:147], a[212:215], v[52:55]
    ds_read_b64_tr_b16 v[132:133], v4 offset:53248
    v_mfma_f32_16x16x32_bf16 v[52:55], v[140:143], a[196:199], v[52:55]
    ds_read_b64_tr_b16 v[134:135], v4 offset:54272
    v_mfma_f32_16x16x32_bf16 v[56:59], v[140:143], a[200:203], v[56:59]
    ds_read_b64_tr_b16 v[136:137], v4 offset:57344
    v_mfma_f32_16x16x32_bf16 v[56:59], v[144:147], a[216:219], v[56:59]
    buffer_load_dwordx4 v11, s[32:35], s60 offen offset:1024  lds
    v_mfma_f32_16x16x32_bf16 v[56:59], v[148:151], a[232:235], v[56:59]
    ds_read_b64_tr_b16 v[138:139], v4 offset:58368
    v_mfma_f32_16x16x32_bf16 v[60:63], v[148:151], a[236:239], v[60:63]
    v_mfma_f32_16x16x32_bf16 v[60:63], v[144:147], a[220:223], v[60:63]
    v_mfma_f32_16x16x32_bf16 v[60:63], v[140:143], a[204:207], v[60:63]
    s_waitcnt lgkmcnt(0)
    v_mfma_f32_16x16x32_bf16 v[64:67], v[128:131], a[192:195], v[64:67]
    buffer_load_dwordx4 v12, s[32:35], s60 offen offset:2048  lds
    v_mfma_f32_16x16x32_bf16 v[64:67], v[132:135], a[208:211], v[64:67]
    ds_read_b64_tr_b16 v[140:141], v5 offset:49152
    v_mfma_f32_16x16x32_bf16 v[64:67], v[136:139], a[224:227], v[64:67]
    ds_read_b64_tr_b16 v[142:143], v5 offset:50176
    v_mfma_f32_16x16x32_bf16 v[68:71], v[136:139], a[228:231], v[68:71]
    ds_read_b64_tr_b16 v[144:145], v5 offset:53248
    v_mfma_f32_16x16x32_bf16 v[68:71], v[132:135], a[212:215], v[68:71]
    ds_read_b64_tr_b16 v[146:147], v5 offset:54272
    v_mfma_f32_16x16x32_bf16 v[68:71], v[128:131], a[196:199], v[68:71]
    buffer_load_dwordx4 v[196:199], v28, s[44:47], s74 offen offset:1024 sc1
    v_mfma_f32_16x16x32_bf16 v[72:75], v[128:131], a[200:203], v[72:75]
    ds_read_b64_tr_b16 v[148:149], v5 offset:57344
    v_mfma_f32_16x16x32_bf16 v[72:75], v[132:135], a[216:219], v[72:75]
    ds_read_b64_tr_b16 v[150:151], v5 offset:58368
    v_mfma_f32_16x16x32_bf16 v[72:75], v[136:139], a[232:235], v[72:75]
    v_mfma_f32_16x16x32_bf16 v[76:79], v[136:139], a[236:239], v[76:79]
    buffer_load_dwordx4 v[200:203], v28, s[44:47], s74 offen offset:2048 sc1
    v_mfma_f32_16x16x32_bf16 v[76:79], v[132:135], a[220:223], v[76:79]
    v_mfma_f32_16x16x32_bf16 v[76:79], v[128:131], a[204:207], v[76:79]
    s_waitcnt lgkmcnt(0)
    s_mov_b32 s60, 885120
    v_mfma_f32_16x16x32_bf16 v[80:83], v[140:143], a[192:195], v[80:83]
    s_waitcnt vmcnt(22)
    s_barrier
    s_cmp_eq_u32 s67, 11
    s_cbranch_scc1 L_sigA11
L_sigA11_done:
    v_mfma_f32_16x16x32_bf16 v[80:83], v[144:147], a[208:211], v[80:83]
    ds_read_b64_tr_b16 v[128:129], v6 offset:0
    s_add_u32 m0, s59, 98304
    v_mfma_f32_16x16x32_bf16 v[80:83], v[148:151], a[224:227], v[80:83]
    buffer_load_dwordx4 v10, s[36:39], s60 offen offset:0  lds
    v_mfma_f32_16x16x32_bf16 v[84:87], v[148:151], a[228:231], v[84:87]
    ds_read_b64_tr_b16 v[130:131], v6 offset:1024
    v_mfma_f32_16x16x32_bf16 v[84:87], v[144:147], a[212:215], v[84:87]
    ds_read_b64_tr_b16 v[132:133], v6 offset:4096
    v_mfma_f32_16x16x32_bf16 v[84:87], v[140:143], a[196:199], v[84:87]
    ds_read_b64_tr_b16 v[134:135], v6 offset:5120
    v_mfma_f32_16x16x32_bf16 v[88:91], v[140:143], a[200:203], v[88:91]
    ds_read_b64_tr_b16 v[136:137], v6 offset:8192
    v_mfma_f32_16x16x32_bf16 v[88:91], v[144:147], a[216:219], v[88:91]
    buffer_load_dwordx4 v11, s[36:39], s60 offen offset:1024  lds
    v_mfma_f32_16x16x32_bf16 v[88:91], v[148:151], a[232:235], v[88:91]
    ds_read_b64_tr_b16 v[138:139], v6 offset:9216
    v_mfma_f32_16x16x32_bf16 v[92:95], v[148:151], a[236:239], v[92:95]
    v_mfma_f32_16x16x32_bf16 v[92:95], v[144:147], a[220:223], v[92:95]
    v_mfma_f32_16x16x32_bf16 v[92:95], v[140:143], a[204:207], v[92:95]
    s_waitcnt lgkmcnt(0)
    v_mfma_f32_16x16x32_bf16 v[32:35], v[128:131], a[240:243], v[32:35]
    buffer_load_dwordx4 v12, s[36:39], s60 offen offset:2048  lds
    v_mfma_f32_16x16x32_bf16 v[32:35], v[132:135], v[224:227], v[32:35]
    ds_read_b64_tr_b16 v[140:141], v7 offset:0
    v_mfma_f32_16x16x32_bf16 v[32:35], v[136:139], v[240:243], v[32:35]
    ds_read_b64_tr_b16 v[142:143], v7 offset:1024
    v_mfma_f32_16x16x32_bf16 v[36:39], v[136:139], v[244:247], v[36:39]
    ds_read_b64_tr_b16 v[144:145], v7 offset:4096
    v_mfma_f32_16x16x32_bf16 v[36:39], v[132:135], v[228:231], v[36:39]
    ds_read_b64_tr_b16 v[146:147], v7 offset:5120
    v_mfma_f32_16x16x32_bf16 v[36:39], v[128:131], a[244:247], v[36:39]
    buffer_load_dwordx4 v[204:207], v28, s[44:47], s74 offen offset:3072 sc1
    v_mfma_f32_16x16x32_bf16 v[40:43], v[128:131], a[248:251], v[40:43]
    ds_read_b64_tr_b16 v[148:149], v7 offset:8192
    v_mfma_f32_16x16x32_bf16 v[40:43], v[132:135], v[232:235], v[40:43]
    ds_read_b64_tr_b16 v[150:151], v7 offset:9216
    v_mfma_f32_16x16x32_bf16 v[40:43], v[136:139], v[248:251], v[40:43]
    v_mfma_f32_16x16x32_bf16 v[44:47], v[136:139], v[252:255], v[44:47]
    buffer_load_dwordx4 v[208:211], v28, s[44:47], s75 offen offset:0 sc1
    v_mfma_f32_16x16x32_bf16 v[44:47], v[132:135], v[236:239], v[44:47]
    v_mul_f32 v32, v20, v32
    v_mul_f32 v33, v20, v33
    v_mfma_f32_16x16x32_bf16 v[44:47], v[128:131], a[252:255], v[44:47]
    s_waitcnt lgkmcnt(0)
    s_mov_b32 s60, 1769856
    v_mfma_f32_16x16x32_bf16 v[48:51], v[140:143], a[240:243], v[48:51]
    s_waitcnt vmcnt(22)
    s_barrier
    v_mfma_f32_16x16x32_bf16 v[48:51], v[144:147], v[224:227], v[48:51]
    ds_read_b64_tr_b16 v[128:129], v6 offset:12288
    s_add_u32 m0, s59, 110592
    v_mfma_f32_16x16x32_bf16 v[48:51], v[148:151], v[240:243], v[48:51]
    buffer_load_dwordx4 v10, s[32:35], s60 offen offset:0  lds
    v_mfma_f32_16x16x32_bf16 v[52:55], v[148:151], v[244:247], v[52:55]
    ds_read_b64_tr_b16 v[130:131], v6 offset:13312
    v_mul_f32 v34, v20, v34
    v_mfma_f32_16x16x32_bf16 v[52:55], v[144:147], v[228:231], v[52:55]
    ds_read_b64_tr_b16 v[132:133], v6 offset:16384
    v_mul_f32 v35, v20, v35
    v_mfma_f32_16x16x32_bf16 v[52:55], v[140:143], a[244:247], v[52:55]
    ds_read_b64_tr_b16 v[134:135], v6 offset:17408
    v_mul_f32 v36, v21, v36
    v_mfma_f32_16x16x32_bf16 v[56:59], v[140:143], a[248:251], v[56:59]
    ds_read_b64_tr_b16 v[136:137], v6 offset:20480
    v_mul_f32 v37, v21, v37
    v_mfma_f32_16x16x32_bf16 v[56:59], v[144:147], v[232:235], v[56:59]
    buffer_load_dwordx4 v11, s[32:35], s60 offen offset:1024  lds
    v_mfma_f32_16x16x32_bf16 v[56:59], v[148:151], v[248:251], v[56:59]
    ds_read_b64_tr_b16 v[138:139], v6 offset:21504
    v_mul_f32 v38, v21, v38
    v_mfma_f32_16x16x32_bf16 v[60:63], v[148:151], v[252:255], v[60:63]
    v_mul_f32 v39, v21, v39
    v_mul_f32 v40, v22, v40
    v_mfma_f32_16x16x32_bf16 v[60:63], v[144:147], v[236:239], v[60:63]
    v_mul_f32 v41, v22, v41
    v_mul_f32 v42, v22, v42
    v_mfma_f32_16x16x32_bf16 v[60:63], v[140:143], a[252:255], v[60:63]
    s_waitcnt lgkmcnt(0)
    v_mul_f32 v43, v22, v43
    v_mfma_f32_16x16x32_bf16 v[64:67], v[128:131], a[240:243], v[64:67]
    buffer_load_dwordx4 v12, s[32:35], s60 offen offset:2048  lds
    v_mfma_f32_16x16x32_bf16 v[64:67], v[132:135], v[224:227], v[64:67]
    ds_read_b64_tr_b16 v[140:141], v7 offset:12288
    v_mul_f32 v44, v23, v44
    v_mfma_f32_16x16x32_bf16 v[64:67], v[136:139], v[240:243], v[64:67]
    ds_read_b64_tr_b16 v[142:143], v7 offset:13312
    v_mul_f32 v45, v23, v45
    v_mfma_f32_16x16x32_bf16 v[68:71], v[136:139], v[244:247], v[68:71]
    ds_read_b64_tr_b16 v[144:145], v7 offset:16384
    v_mul_f32 v46, v23, v46
    v_mfma_f32_16x16x32_bf16 v[68:71], v[132:135], v[228:231], v[68:71]
    ds_read_b64_tr_b16 v[146:147], v7 offset:17408
    v_mul_f32 v47, v23, v47
    v_mfma_f32_16x16x32_bf16 v[68:71], v[128:131], a[244:247], v[68:71]
    buffer_load_dwordx4 v[212:215], v28, s[44:47], s75 offen offset:1024 sc1
    v_mfma_f32_16x16x32_bf16 v[72:75], v[128:131], a[248:251], v[72:75]
    ds_read_b64_tr_b16 v[148:149], v7 offset:20480
    v_mul_f32 v48, v20, v48
    v_mfma_f32_16x16x32_bf16 v[72:75], v[132:135], v[232:235], v[72:75]
    ds_read_b64_tr_b16 v[150:151], v7 offset:21504
    v_mul_f32 v49, v20, v49
    v_mfma_f32_16x16x32_bf16 v[72:75], v[136:139], v[248:251], v[72:75]
    v_mul_f32 v50, v20, v50
    v_mul_f32 v51, v20, v51
    v_mfma_f32_16x16x32_bf16 v[76:79], v[136:139], v[252:255], v[76:79]
    buffer_load_dwordx4 v[216:219], v28, s[44:47], s75 offen offset:2048 sc1
    v_mfma_f32_16x16x32_bf16 v[76:79], v[132:135], v[236:239], v[76:79]
    v_mul_f32 v52, v21, v52
    v_mul_f32 v53, v21, v53
    v_mfma_f32_16x16x32_bf16 v[76:79], v[128:131], a[252:255], v[76:79]
    s_waitcnt lgkmcnt(0)
    s_mov_b32 s60, 1769856
    v_mfma_f32_16x16x32_bf16 v[80:83], v[140:143], a[240:243], v[80:83]
    s_waitcnt vmcnt(22)
    s_barrier
    s_cmp_eq_u32 s67, 12
    s_cbranch_scc1 L_sigA12
L_sigA12_done:
    v_mfma_f32_16x16x32_bf16 v[80:83], v[144:147], v[224:227], v[80:83]
    ds_read_b64_tr_b16 v[128:129], v6 offset:36864
    s_add_u32 m0, s59, 122880
    v_mfma_f32_16x16x32_bf16 v[80:83], v[148:151], v[240:243], v[80:83]
    buffer_load_dwordx4 v10, s[36:39], s60 offen offset:0  lds
    v_mfma_f32_16x16x32_bf16 v[84:87], v[148:151], v[244:247], v[84:87]
    ds_read_b64_tr_b16 v[130:131], v6 offset:37888
    v_mul_f32 v54, v21, v54
    v_mfma_f32_16x16x32_bf16 v[84:87], v[144:147], v[228:231], v[84:87]
    ds_read_b64_tr_b16 v[132:133], v6 offset:40960
    v_mul_f32 v55, v21, v55
    v_mfma_f32_16x16x32_bf16 v[84:87], v[140:143], a[244:247], v[84:87]
    ds_read_b64_tr_b16 v[134:135], v6 offset:41984
    v_mul_f32 v56, v22, v56
    v_mfma_f32_16x16x32_bf16 v[88:91], v[140:143], a[248:251], v[88:91]
    ds_read_b64_tr_b16 v[136:137], v6 offset:45056
    v_mul_f32 v57, v22, v57
    v_mfma_f32_16x16x32_bf16 v[88:91], v[144:147], v[232:235], v[88:91]
    buffer_load_dwordx4 v11, s[36:39], s60 offen offset:1024  lds
    v_mfma_f32_16x16x32_bf16 v[88:91], v[148:151], v[248:251], v[88:91]
    ds_read_b64_tr_b16 v[138:139], v6 offset:46080
    v_mul_f32 v58, v22, v58
    v_mfma_f32_16x16x32_bf16 v[92:95], v[148:151], v[252:255], v[92:95]
    v_mul_f32 v59, v22, v59
    v_mul_f32 v60, v23, v60
    v_mfma_f32_16x16x32_bf16 v[92:95], v[144:147], v[236:239], v[92:95]
    v_mul_f32 v61, v23, v61
    v_mul_f32 v62, v23, v62
    v_mfma_f32_16x16x32_bf16 v[92:95], v[140:143], a[252:255], v[92:95]
    s_waitcnt lgkmcnt(0)
    v_mul_f32 v63, v23, v63
    v_mfma_f32_16x16x32_bf16 v[96:99], v[128:131], a[0:3], 0
    buffer_load_dwordx4 v12, s[36:39], s60 offen offset:2048  lds
    v_mfma_f32_16x16x32_bf16 v[96:99], v[132:135], a[16:19], v[96:99]
    ds_read_b64_tr_b16 v[140:141], v7 offset:36864
    v_mul_f32 v32, v32, v64
    v_mfma_f32_16x16x32_bf16 v[96:99], v[136:139], a[32:35], v[96:99]
    ds_read_b64_tr_b16 v[142:143], v7 offset:37888
    v_mul_f32 v33, v33, v65
    v_mfma_f32_16x16x32_bf16 v[100:103], v[136:139], a[36:39], 0
    ds_read_b64_tr_b16 v[144:145], v7 offset:40960
    v_mul_f32 v34, v34, v66
    v_mfma_f32_16x16x32_bf16 v[100:103], v[132:135], a[20:23], v[100:103]
    ds_read_b64_tr_b16 v[146:147], v7 offset:41984
    v_mul_f32 v35, v35, v67
    v_mfma_f32_16x16x32_bf16 v[100:103], v[128:131], a[4:7], v[100:103]
    buffer_load_dwordx4 v[220:223], v28, s[44:47], s75 offen offset:3072 sc1
    v_mfma_f32_16x16x32_bf16 v[104:107], v[128:131], a[8:11], 0
    ds_read_b64_tr_b16 v[148:149], v7 offset:45056
    v_mul_f32 v36, v36, v68
    v_mfma_f32_16x16x32_bf16 v[104:107], v[132:135], a[24:27], v[104:107]
    ds_read_b64_tr_b16 v[150:151], v7 offset:46080
    v_mul_f32 v37, v37, v69
    v_mfma_f32_16x16x32_bf16 v[104:107], v[136:139], a[40:43], v[104:107]
    v_mul_f32 v38, v38, v70
    v_mul_f32 v39, v39, v71
    v_mfma_f32_16x16x32_bf16 v[108:111], v[136:139], a[44:47], 0
    v_mfma_f32_16x16x32_bf16 v[108:111], v[132:135], a[28:31], v[108:111]
    v_mul_f32 v40, v40, v72
    v_mul_f32 v41, v41, v73
    v_mfma_f32_16x16x32_bf16 v[108:111], v[128:131], a[12:15], v[108:111]
    s_waitcnt lgkmcnt(0)
    s_mov_b32 s60, 2654592
    v_mfma_f32_16x16x32_bf16 v[112:115], v[140:143], a[0:3], 0
    s_waitcnt vmcnt(21)
    s_barrier
    v_mfma_f32_16x16x32_bf16 v[112:115], v[144:147], a[16:19], v[112:115]
    ds_read_b64_tr_b16 v[128:129], v4 offset:24576
    s_add_u32 m0, s59, 147456
    v_mfma_f32_16x16x32_bf16 v[112:115], v[148:151], a[32:35], v[112:115]
    buffer_load_dwordx4 v10, s[32:35], s60 offen offset:0  lds
    v_mfma_f32_16x16x32_bf16 v[116:119], v[148:151], a[36:39], 0
    ds_read_b64_tr_b16 v[130:131], v4 offset:25600
    v_mul_f32 v42, v42, v74
    v_mfma_f32_16x16x32_bf16 v[116:119], v[144:147], a[20:23], v[116:119]
    ds_read_b64_tr_b16 v[132:133], v4 offset:28672
    v_mul_f32 v43, v43, v75
    v_mfma_f32_16x16x32_bf16 v[116:119], v[140:143], a[4:7], v[116:119]
    ds_read_b64_tr_b16 v[134:135], v4 offset:29696
    v_mul_f32 v44, v44, v76
    v_mfma_f32_16x16x32_bf16 v[120:123], v[140:143], a[8:11], 0
    ds_read_b64_tr_b16 v[136:137], v4 offset:32768
    v_mul_f32 v45, v45, v77
    v_mfma_f32_16x16x32_bf16 v[120:123], v[144:147], a[24:27], v[120:123]
    buffer_load_dwordx4 v11, s[32:35], s60 offen offset:1024  lds
    v_mfma_f32_16x16x32_bf16 v[120:123], v[148:151], a[40:43], v[120:123]
    ds_read_b64_tr_b16 v[138:139], v4 offset:33792
    v_mul_f32 v46, v46, v78
    v_mfma_f32_16x16x32_bf16 v[124:127], v[148:151], a[44:47], 0
    v_mul_f32 v47, v47, v79
    v_mul_f32 v48, v48, v80
    v_mfma_f32_16x16x32_bf16 v[124:127], v[144:147], a[28:31], v[124:127]
    v_mul_f32 v49, v49, v81
    v_mul_f32 v50, v50, v82
    v_mfma_f32_16x16x32_bf16 v[124:127], v[140:143], a[12:15], v[124:127]
    s_waitcnt lgkmcnt(0)
    v_mul_f32 v51, v51, v83
    v_mfma_f32_16x16x32_bf16 v[64:67], v[128:131], a[0:3], 0
    buffer_load_dwordx4 v12, s[32:35], s60 offen offset:2048  lds
    v_mfma_f32_16x16x32_bf16 v[64:67], v[132:135], a[16:19], v[64:67]
    ds_read_b64_tr_b16 v[140:141], v5 offset:24576
    v_mul_f32 v52, v52, v84
    v_mfma_f32_16x16x32_bf16 v[64:67], v[136:139], a[32:35], v[64:67]
    ds_read_b64_tr_b16 v[142:143], v5 offset:25600
    v_mul_f32 v53, v53, v85
    v_mfma_f32_16x16x32_bf16 v[68:71], v[136:139], a[36:39], 0
    ds_read_b64_tr_b16 v[144:145], v5 offset:28672
    v_mul_f32 v54, v54, v86
    v_mfma_f32_16x16x32_bf16 v[68:71], v[132:135], a[20:23], v[68:71]
    ds_read_b64_tr_b16 v[146:147], v5 offset:29696
    v_mul_f32 v55, v55, v87
    v_mfma_f32_16x16x32_bf16 v[68:71], v[128:131], a[4:7], v[68:71]
    v_mfma_f32_16x16x32_bf16 v[72:75], v[128:131], a[8:11], 0
    ds_read_b64_tr_b16 v[148:149], v5 offset:32768
    v_mul_f32 v56, v56, v88
    v_mfma_f32_16x16x32_bf16 v[72:75], v[132:135], a[24:27], v[72:75]
    ds_read_b64_tr_b16 v[150:151], v5 offset:33792
    v_mul_f32 v57, v57, v89
    v_mfma_f32_16x16x32_bf16 v[72:75], v[136:139], a[40:43], v[72:75]
    v_mul_f32 v58, v58, v90
    v_mul_f32 v59, v59, v91
    v_mfma_f32_16x16x32_bf16 v[76:79], v[136:139], a[44:47], 0
    v_mfma_f32_16x16x32_bf16 v[76:79], v[132:135], a[28:31], v[76:79]
    v_mul_f32 v60, v60, v92
    v_mul_f32 v61, v61, v93
    v_mfma_f32_16x16x32_bf16 v[76:79], v[128:131], a[12:15], v[76:79]
    s_waitcnt lgkmcnt(0)
    s_mov_b32 s60, 2654592
    v_mfma_f32_16x16x32_bf16 v[80:83], v[140:143], a[0:3], 0
    s_waitcnt vmcnt(19)
    s_barrier
    s_cmp_eq_u32 s67, 13
    s_cbranch_scc1 L_sigA13
L_sigA13_done:
    v_mfma_f32_16x16x32_bf16 v[80:83], v[144:147], a[16:19], v[80:83]
    ds_read_b64_tr_b16 v[128:129], v4 offset:36864
    s_add_u32 m0, s59, 73728
    v_mfma_f32_16x16x32_bf16 v[80:83], v[148:151], a[32:35], v[80:83]
    buffer_load_dwordx4 v10, s[36:39], s60 offen offset:0  lds
    v_mfma_f32_16x16x32_bf16 v[84:87], v[148:151], a[36:39], 0
    ds_read_b64_tr_b16 v[130:131], v4 offset:37888
    v_mul_f32 v62, v62, v94
    v_mfma_f32_16x16x32_bf16 v[84:87], v[144:147], a[20:23], v[84:87]
    ds_read_b64_tr_b16 v[132:133], v4 offset:40960
    v_mul_f32 v63, v63, v95
    v_mfma_f32_16x16x32_bf16 v[84:87], v[140:143], a[4:7], v[84:87]
    ds_read_b64_tr_b16 v[134:135], v4 offset:41984
    v_cvt_pk_bf16_f32 v32, v32, v33
    v_mfma_f32_16x16x32_bf16 v[88:91], v[140:143], a[8:11], 0
    ds_read_b64_tr_b16 v[136:137], v4 offset:45056
    v_cvt_pk_bf16_f32 v33, v34, v35
    v_mfma_f32_16x16x32_bf16 v[88:91], v[144:147], a[24:27], v[88:91]
    buffer_load_dwordx4 v11, s[36:39], s60 offen offset:1024  lds
    v_mfma_f32_16x16x32_bf16 v[88:91], v[148:151], a[40:43], v[88:91]
    ds_read_b64_tr_b16 v[138:139], v4 offset:46080
    v_cvt_pk_bf16_f32 v34, v48, v49
    v_mfma_f32_16x16x32_bf16 v[92:95], v[148:151], a[44:47], 0
    v_cvt_pk_bf16_f32 v35, v50, v51
    v_mfma_f32_16x16x32_bf16 v[92:95], v[144:147], a[28:31], v[92:95]
    ds_write_b128 v24, v[32:35] offset:32768
    v_mfma_f32_16x16x32_bf16 v[92:95], v[140:143], a[12:15], v[92:95]
    s_waitcnt lgkmcnt(1)
    v_cvt_pk_bf16_f32 v36, v36, v37
    v_mfma_f32_16x16x32_bf16 v[96:99], v[128:131], a[48:51], v[96:99]
    buffer_load_dwordx4 v12, s[36:39], s60 offen offset:2048  lds
    v_mfma_f32_16x16x32_bf16 v[96:99], v[132:135], a[64:67], v[96:99]
    ds_read_b64_tr_b16 v[140:141], v5 offset:36864
    v_cvt_pk_bf16_f32 v37, v38, v39
    v_mfma_f32_16x16x32_bf16 v[96:99], v[136:139], a[80:83], v[96:99]
    ds_read_b64_tr_b16 v[142:143], v5 offset:37888
    v_cvt_pk_bf16_f32 v38, v52, v53
    v_mfma_f32_16x16x32_bf16 v[100:103], v[136:139], a[84:87], v[100:103]
    ds_read_b64_tr_b16 v[144:145], v5 offset:40960
    v_cvt_pk_bf16_f32 v39, v54, v55
    v_mfma_f32_16x16x32_bf16 v[100:103], v[132:135], a[68:71], v[100:103]
    ds_read_b64_tr_b16 v[146:147], v5 offset:41984
    v_mfma_f32_16x16x32_bf16 v[100:103], v[128:131], a[52:55], v[100:103]
    v_mfma_f32_16x16x32_bf16 v[104:107], v[128:131], a[56:59], v[104:107]
    ds_read_b64_tr_b16 v[148:149], v5 offset:45056
    v_mfma_f32_16x16x32_bf16 v[104:107], v[132:135], a[72:75], v[104:107]
    ds_read_b64_tr_b16 v[150:151], v5 offset:46080
    v_mfma_f32_16x16x32_bf16 v[104:107], v[136:139], a[88:91], v[104:107]
    v_mfma_f32_16x16x32_bf16 v[108:111], v[136:139], a[92:95], v[108:111]
    v_mfma_f32_16x16x32_bf16 v[108:111], v[132:135], a[76:79], v[108:111]
    ds_write_b128 v24, v[36:39] offset:33792
    v_mfma_f32_16x16x32_bf16 v[108:111], v[128:131], a[60:63], v[108:111]
    s_waitcnt lgkmcnt(1)
    s_mov_b32 s60, 3539328
    v_mfma_f32_16x16x32_bf16 v[112:115], v[140:143], a[48:51], v[112:115]
    s_waitcnt vmcnt(17)
    s_barrier
    v_mfma_f32_16x16x32_bf16 v[112:115], v[144:147], a[64:67], v[112:115]
    ds_read_b64_tr_b16 v[128:129], v4 offset:49152
    s_add_u32 m0, s59, 86016
    v_mfma_f32_16x16x32_bf16 v[112:115], v[148:151], a[80:83], v[112:115]
    buffer_load_dwordx4 v10, s[32:35], s60 offen offset:0  lds
    v_mfma_f32_16x16x32_bf16 v[116:119], v[148:151], a[84:87], v[116:119]
    ds_read_b64_tr_b16 v[130:131], v4 offset:50176
    v_cvt_pk_bf16_f32 v40, v40, v41
    v_mfma_f32_16x16x32_bf16 v[116:119], v[144:147], a[68:71], v[116:119]
    ds_read_b64_tr_b16 v[132:133], v4 offset:53248
    v_cvt_pk_bf16_f32 v41, v42, v43
    v_mfma_f32_16x16x32_bf16 v[116:119], v[140:143], a[52:55], v[116:119]
    ds_read_b64_tr_b16 v[134:135], v4 offset:54272
    v_cvt_pk_bf16_f32 v42, v56, v57
    v_mfma_f32_16x16x32_bf16 v[120:123], v[140:143], a[56:59], v[120:123]
    ds_read_b64_tr_b16 v[136:137], v4 offset:57344
    v_cvt_pk_bf16_f32 v43, v58, v59
    v_mfma_f32_16x16x32_bf16 v[120:123], v[144:147], a[72:75], v[120:123]
    buffer_load_dwordx4 v11, s[32:35], s60 offen offset:1024  lds
    v_mfma_f32_16x16x32_bf16 v[120:123], v[148:151], a[88:91], v[120:123]
    ds_read_b64_tr_b16 v[138:139], v4 offset:58368
    v_mfma_f32_16x16x32_bf16 v[124:127], v[148:151], a[92:95], v[124:127]
    v_mfma_f32_16x16x32_bf16 v[124:127], v[144:147], a[76:79], v[124:127]
    ds_write_b128 v24, v[40:43] offset:34816
    v_mfma_f32_16x16x32_bf16 v[124:127], v[140:143], a[60:63], v[124:127]
    s_waitcnt lgkmcnt(1)
    v_cvt_pk_bf16_f32 v44, v44, v45
    v_mfma_f32_16x16x32_bf16 v[64:67], v[128:131], a[48:51], v[64:67]
    buffer_load_dwordx4 v12, s[32:35], s60 offen offset:2048  lds
    v_mfma_f32_16x16x32_bf16 v[64:67], v[132:135], a[64:67], v[64:67]
    ds_read_b64_tr_b16 v[140:141], v5 offset:49152
    v_cvt_pk_bf16_f32 v45, v46, v47
    v_mfma_f32_16x16x32_bf16 v[64:67], v[136:139], a[80:83], v[64:67]
    ds_read_b64_tr_b16 v[142:143], v5 offset:50176
    v_cvt_pk_bf16_f32 v46, v60, v61
    v_mfma_f32_16x16x32_bf16 v[68:71], v[136:139], a[84:87], v[68:71]
    ds_read_b64_tr_b16 v[144:145], v5 offset:53248
    v_cvt_pk_bf16_f32 v47, v62, v63
    v_mfma_f32_16x16x32_bf16 v[68:71], v[132:135], a[68:71], v[68:71]
    ds_read_b64_tr_b16 v[146:147], v5 offset:54272
    v_mfma_f32_16x16x32_bf16 v[68:71], v[128:131], a[52:55], v[68:71]
    v_mfma_f32_16x16x32_bf16 v[72:75], v[128:131], a[56:59], v[72:75]
    ds_read_b64_tr_b16 v[148:149], v5 offset:57344
    v_mfma_f32_16x16x32_bf16 v[72:75], v[132:135], a[72:75], v[72:75]
    ds_read_b64_tr_b16 v[150:151], v5 offset:58368
    v_mfma_f32_16x16x32_bf16 v[72:75], v[136:139], a[88:91], v[72:75]
    v_mfma_f32_16x16x32_bf16 v[76:79], v[136:139], a[92:95], v[76:79]
    v_mfma_f32_16x16x32_bf16 v[76:79], v[132:135], a[76:79], v[76:79]
    ds_write_b128 v24, v[44:47] offset:35840
    v_mfma_f32_16x16x32_bf16 v[76:79], v[128:131], a[60:63], v[76:79]
    s_waitcnt lgkmcnt(1)
    s_mov_b32 s60, 3539328
    v_mfma_f32_16x16x32_bf16 v[80:83], v[140:143], a[48:51], v[80:83]
    s_waitcnt vmcnt(15)
    s_barrier
    s_cmp_eq_u32 s67, 14
    s_cbranch_scc1 L_sigA14
L_sigA14_done:
    v_mfma_f32_16x16x32_bf16 v[80:83], v[144:147], a[64:67], v[80:83]
    ds_read_b64_tr_b16 v[128:129], v6 offset:0
    s_add_u32 m0, s59, 98304
    v_mfma_f32_16x16x32_bf16 v[80:83], v[148:151], a[80:83], v[80:83]
    buffer_load_dwordx4 v10, s[36:39], s60 offen offset:0  lds
    v_mfma_f32_16x16x32_bf16 v[84:87], v[148:151], a[84:87], v[84:87]
    ds_read_b64_tr_b16 v[130:131], v6 offset:1024
    v_mfma_f32_16x16x32_bf16 v[84:87], v[144:147], a[68:71], v[84:87]
    ds_read_b64_tr_b16 v[132:133], v6 offset:4096
    v_mfma_f32_16x16x32_bf16 v[84:87], v[140:143], a[52:55], v[84:87]
    ds_read_b64_tr_b16 v[134:135], v6 offset:5120
    v_mfma_f32_16x16x32_bf16 v[88:91], v[140:143], a[56:59], v[88:91]
    ds_read_b64_tr_b16 v[136:137], v6 offset:8192
    v_mfma_f32_16x16x32_bf16 v[88:91], v[144:147], a[72:75], v[88:91]
    buffer_load_dwordx4 v11, s[36:39], s60 offen offset:1024  lds
    v_mfma_f32_16x16x32_bf16 v[88:91], v[148:151], a[88:91], v[88:91]
    ds_read_b64_tr_b16 v[138:139], v6 offset:9216
    v_mfma_f32_16x16x32_bf16 v[92:95], v[148:151], a[92:95], v[92:95]
    v_mfma_f32_16x16x32_bf16 v[92:95], v[144:147], a[76:79], v[92:95]
    v_mfma_f32_16x16x32_bf16 v[92:95], v[140:143], a[60:63], v[92:95]
    s_waitcnt lgkmcnt(0)
    v_mfma_f32_16x16x32_bf16 v[96:99], v[128:131], a[96:99], v[96:99]
    buffer_load_dwordx4 v12, s[36:39], s60 offen offset:2048  lds
    v_mfma_f32_16x16x32_bf16 v[96:99], v[132:135], a[112:115], v[96:99]
    ds_read_b64_tr_b16 v[140:141], v7 offset:0
    v_mfma_f32_16x16x32_bf16 v[96:99], v[136:139], a[128:131], v[96:99]
    ds_read_b64_tr_b16 v[142:143], v7 offset:1024
    v_mfma_f32_16x16x32_bf16 v[100:103], v[136:139], a[132:135], v[100:103]
    ds_read_b64_tr_b16 v[144:145], v7 offset:4096
    v_mfma_f32_16x16x32_bf16 v[100:103], v[132:135], a[116:119], v[100:103]
    ds_read_b64_tr_b16 v[146:147], v7 offset:5120
    v_mfma_f32_16x16x32_bf16 v[100:103], v[128:131], a[100:103], v[100:103]
    v_mfma_f32_16x16x32_bf16 v[104:107], v[128:131], a[104:107], v[104:107]
    ds_read_b64_tr_b16 v[148:149], v7 offset:8192
    v_mfma_f32_16x16x32_bf16 v[104:107], v[132:135], a[120:123], v[104:107]
    ds_read_b64_tr_b16 v[150:151], v7 offset:9216
    v_mfma_f32_16x16x32_bf16 v[104:107], v[136:139], a[136:139], v[104:107]
    v_mfma_f32_16x16x32_bf16 v[108:111], v[136:139], a[140:143], v[108:111]
    v_mfma_f32_16x16x32_bf16 v[108:111], v[132:135], a[124:127], v[108:111]
    v_mfma_f32_16x16x32_bf16 v[108:111], v[128:131], a[108:111], v[108:111]
    s_waitcnt lgkmcnt(0)
    s_mov_b32 s60, 4424064
    v_mfma_f32_16x16x32_bf16 v[112:115], v[140:143], a[96:99], v[112:115]
    s_waitcnt vmcnt(13)
    s_barrier
    v_mfma_f32_16x16x32_bf16 v[112:115], v[144:147], a[112:115], v[112:115]
    ds_read_b64_tr_b16 v[128:129], v6 offset:12288
    s_add_u32 m0, s59, 110592
    v_mfma_f32_16x16x32_bf16 v[112:115], v[148:151], a[128:131], v[112:115]
    buffer_load_dwordx4 v10, s[32:35], s60 offen offset:0  lds
    v_mfma_f32_16x16x32_bf16 v[116:119], v[148:151], a[132:135], v[116:119]
    ds_read_b64_tr_b16 v[130:131], v6 offset:13312
    v_mfma_f32_16x16x32_bf16 v[116:119], v[144:147], a[116:119], v[116:119]
    ds_read_b64_tr_b16 v[132:133], v6 offset:16384
    v_mfma_f32_16x16x32_bf16 v[116:119], v[140:143], a[100:103], v[116:119]
    ds_read_b64_tr_b16 v[134:135], v6 offset:17408
    v_mfma_f32_16x16x32_bf16 v[120:123], v[140:143], a[104:107], v[120:123]
    ds_read_b64_tr_b16 v[136:137], v6 offset:20480
    v_mfma_f32_16x16x32_bf16 v[120:123], v[144:147], a[120:123], v[120:123]
    buffer_load_dwordx4 v11, s[32:35], s60 offen offset:1024  lds
    v_mfma_f32_16x16x32_bf16 v[120:123], v[148:151], a[136:139], v[120:123]
    ds_read_b64_tr_b16 v[138:139], v6 offset:21504
    v_mfma_f32_16x16x32_bf16 v[124:127], v[148:151], a[140:143], v[124:127]
    v_mfma_f32_16x16x32_bf16 v[124:127], v[144:147], a[124:127], v[124:127]
    v_mfma_f32_16x16x32_bf16 v[124:127], v[140:143], a[108:111], v[124:127]
    s_waitcnt lgkmcnt(0)
    v_mfma_f32_16x16x32_bf16 v[64:67], v[128:131], a[96:99], v[64:67]
    buffer_load_dwordx4 v12, s[32:35], s60 offen offset:2048  lds
    v_mfma_f32_16x16x32_bf16 v[64:67], v[132:135], a[112:115], v[64:67]
    ds_read_b64_tr_b16 v[140:141], v7 offset:12288
    v_mfma_f32_16x16x32_bf16 v[64:67], v[136:139], a[128:131], v[64:67]
    ds_read_b64_tr_b16 v[142:143], v7 offset:13312
    v_mfma_f32_16x16x32_bf16 v[68:71], v[136:139], a[132:135], v[68:71]
    ds_read_b64_tr_b16 v[144:145], v7 offset:16384
    v_mfma_f32_16x16x32_bf16 v[68:71], v[132:135], a[116:119], v[68:71]
    ds_read_b64_tr_b16 v[146:147], v7 offset:17408
    v_mfma_f32_16x16x32_bf16 v[68:71], v[128:131], a[100:103], v[68:71]
    v_mfma_f32_16x16x32_bf16 v[72:75], v[128:131], a[104:107], v[72:75]
    ds_read_b64_tr_b16 v[148:149], v7 offset:20480
    v_mfma_f32_16x16x32_bf16 v[72:75], v[132:135], a[120:123], v[72:75]
    ds_read_b64_tr_b16 v[150:151], v7 offset:21504
    v_mfma_f32_16x16x32_bf16 v[72:75], v[136:139], a[136:139], v[72:75]
    v_mfma_f32_16x16x32_bf16 v[76:79], v[136:139], a[140:143], v[76:79]
    v_mfma_f32_16x16x32_bf16 v[76:79], v[132:135], a[124:127], v[76:79]
    v_mfma_f32_16x16x32_bf16 v[76:79], v[128:131], a[108:111], v[76:79]
    s_waitcnt lgkmcnt(0)
    s_mov_b32 s60, 4424064
    v_mfma_f32_16x16x32_bf16 v[80:83], v[140:143], a[96:99], v[80:83]
    s_waitcnt vmcnt(12)
    s_barrier
    s_cmp_eq_u32 s67, 15
    s_cbranch_scc1 L_sigA15
L_sigA15_done:
    v_mfma_f32_16x16x32_bf16 v[80:83], v[144:147], a[112:115], v[80:83]
    ds_read_b64_tr_b16 v[128:129], v6 offset:36864
    s_add_u32 m0, s59, 122880
    v_mfma_f32_16x16x32_bf16 v[80:83], v[148:151], a[128:131], v[80:83]
    buffer_load_dwordx4 v10, s[36:39], s60 offen offset:0  lds
    v_mfma_f32_16x16x32_bf16 v[84:87], v[148:151], a[132:135], v[84:87]
    ds_read_b64_tr_b16 v[130:131], v6 offset:37888
    v_mfma_f32_16x16x32_bf16 v[84:87], v[144:147], a[116:119], v[84:87]
    ds_read_b64_tr_b16 v[132:133], v6 offset:40960
    v_mfma_f32_16x16x32_bf16 v[84:87], v[140:143], a[100:103], v[84:87]
    ds_read_b64_tr_b16 v[134:135], v6 offset:41984
    v_mfma_f32_16x16x32_bf16 v[88:91], v[140:143], a[104:107], v[88:91]
    ds_read_b64_tr_b16 v[136:137], v6 offset:45056
    v_mfma_f32_16x16x32_bf16 v[88:91], v[144:147], a[120:123], v[88:91]
    buffer_load_dwordx4 v11, s[36:39], s60 offen offset:1024  lds
    v_mfma_f32_16x16x32_bf16 v[88:91], v[148:151], a[136:139], v[88:91]
    ds_read_b64_tr_b16 v[138:139], v6 offset:46080
    v_mfma_f32_16x16x32_bf16 v[92:95], v[148:151], a[140:143], v[92:95]
    v_mfma_f32_16x16x32_bf16 v[92:95], v[144:147], a[124:127], v[92:95]
    v_mfma_f32_16x16x32_bf16 v[92:95], v[140:143], a[108:111], v[92:95]
    s_waitcnt lgkmcnt(0)
    v_mfma_f32_16x16x32_bf16 v[96:99], v[128:131], a[144:147], v[96:99]
    buffer_load_dwordx4 v12, s[36:39], s60 offen offset:2048  lds
    v_mfma_f32_16x16x32_bf16 v[96:99], v[132:135], a[160:163], v[96:99]
    ds_read_b64_tr_b16 v[140:141], v7 offset:36864
    v_lshrrev_b32 v158, 3, v1
    v_mfma_f32_16x16x32_bf16 v[96:99], v[136:139], a[176:179], v[96:99]
    ds_read_b64_tr_b16 v[142:143], v7 offset:37888
    v_and_b32 v159, 6, v158
    v_mfma_f32_16x16x32_bf16 v[100:103], v[136:139], a[180:183], v[100:103]
    ds_read_b64_tr_b16 v[144:145], v7 offset:40960
    v_xor_b32 v159, v159, v1
    v_mfma_f32_16x16x32_bf16 v[100:103], v[132:135], a[164:167], v[100:103]
    ds_read_b64_tr_b16 v[146:147], v7 offset:41984
    v_and_b32 v159, 7, v159
    v_mfma_f32_16x16x32_bf16 v[100:103], v[128:131], a[148:151], v[100:103]
    v_mfma_f32_16x16x32_bf16 v[104:107], v[128:131], a[152:155], v[104:107]
    ds_read_b64_tr_b16 v[148:149], v7 offset:45056
    v_mul_u32_u24 v158, 1152, v158
    v_mfma_f32_16x16x32_bf16 v[104:107], v[132:135], a[168:171], v[104:107]
    ds_read_b64_tr_b16 v[150:151], v7 offset:46080
    v_lshl_add_u32 v158, v159, 4, v158
    v_mfma_f32_16x16x32_bf16 v[104:107], v[136:139], a[184:187], v[104:107]
    s_mul_i32 s62, s52, 24
    s_add_u32 s62, s62, s57
    v_mfma_f32_16x16x32_bf16 v[108:111], v[136:139], a[188:191], v[108:111]
    v_mfma_f32_16x16x32_bf16 v[108:111], v[132:135], a[172:175], v[108:111]
    s_mul_i32 s62, s62, 1152
    v_add_u32 v152, s62, v158
    v_mfma_f32_16x16x32_bf16 v[108:111], v[128:131], a[156:159], v[108:111]
    s_waitcnt lgkmcnt(0)
    s_mov_b32 s60, 0
    v_mfma_f32_16x16x32_bf16 v[112:115], v[140:143], a[144:147], v[112:115]
    s_waitcnt vmcnt(12)
    s_barrier
    v_mfma_f32_16x16x32_bf16 v[112:115], v[144:147], a[160:163], v[112:115]
    ds_read_b64_tr_b16 v[128:129], v4 offset:24576
    s_add_u32 m0, s59, 147456
    v_mfma_f32_16x16x32_bf16 v[112:115], v[148:151], a[176:179], v[112:115]
    buffer_load_dwordx4 v13, s[48:51], s60 offen offset:0  lds
    v_mfma_f32_16x16x32_bf16 v[116:119], v[148:151], a[180:183], v[116:119]
    ds_read_b64_tr_b16 v[130:131], v4 offset:25600
    v_add_u32 v153, 8192, v152
    v_mfma_f32_16x16x32_bf16 v[116:119], v[144:147], a[164:167], v[116:119]
    ds_read_b64_tr_b16 v[132:133], v4 offset:28672
    v_add_u32 v154, 16384, v152
    v_mfma_f32_16x16x32_bf16 v[116:119], v[140:143], a[148:151], v[116:119]
    ds_read_b64_tr_b16 v[134:135], v4 offset:29696
    s_mul_i32 s62, s52, 24
    v_mfma_f32_16x16x32_bf16 v[120:123], v[140:143], a[152:155], v[120:123]
    ds_read_b64_tr_b16 v[136:137], v4 offset:32768
    s_add_u32 s62, s62, 0
    v_mfma_f32_16x16x32_bf16 v[120:123], v[144:147], a[168:171], v[120:123]
    buffer_load_dwordx4 v14, s[48:51], s60 offen offset:1024  lds
    v_mfma_f32_16x16x32_bf16 v[120:123], v[148:151], a[184:187], v[120:123]
    ds_read_b64_tr_b16 v[138:139], v4 offset:33792
    s_add_u32 s63, s57, 192
    v_mfma_f32_16x16x32_bf16 v[124:127], v[148:151], a[188:191], v[124:127]
    s_sub_u32 s64, s58, 64
    v_mfma_f32_16x16x32_bf16 v[124:127], v[144:147], a[172:175], v[124:127]
    s_cmp_lt_u32 s62, 64
    s_cselect_b32 s63, s63, s64
    v_mfma_f32_16x16x32_bf16 v[124:127], v[140:143], a[156:159], v[124:127]
    s_waitcnt lgkmcnt(0)
    s_add_u32 s62, s62, s63
    v_mfma_f32_16x16x32_bf16 v[64:67], v[128:131], a[144:147], v[64:67]
    buffer_load_dwordx4 v15, s[48:51], s60 offen offset:2048  lds
    v_mfma_f32_16x16x32_bf16 v[64:67], v[132:135], a[160:163], v[64:67]
    ds_read_b64_tr_b16 v[140:141], v5 offset:24576
    s_mul_i32 s62, s62, 1152
    v_mfma_f32_16x16x32_bf16 v[64:67], v[136:139], a[176:179], v[64:67]
    ds_read_b64_tr_b16 v[142:143], v5 offset:25600
    s_sub_u32 s62, s62, 0
    v_mfma_f32_16x16x32_bf16 v[68:71], v[136:139], a[180:183], v[68:71]
    ds_read_b64_tr_b16 v[144:145], v5 offset:28672
    v_add_u32 v155, s62, v158
    v_mfma_f32_16x16x32_bf16 v[68:71], v[132:135], a[164:167], v[68:71]
    ds_read_b64_tr_b16 v[146:147], v5 offset:29696
    s_mul_i32 s62, s52, 24
    v_mfma_f32_16x16x32_bf16 v[68:71], v[128:131], a[148:151], v[68:71]
    v_mfma_f32_16x16x32_bf16 v[72:75], v[128:131], a[152:155], v[72:75]
    ds_read_b64_tr_b16 v[148:149], v5 offset:32768
    s_add_u32 s62, s62, 8
    v_mfma_f32_16x16x32_bf16 v[72:75], v[132:135], a[168:171], v[72:75]
    ds_read_b64_tr_b16 v[150:151], v5 offset:33792
    s_add_u32 s63, s57, 192
    v_mfma_f32_16x16x32_bf16 v[72:75], v[136:139], a[184:187], v[72:75]
    s_sub_u32 s64, s58, 64
    v_mfma_f32_16x16x32_bf16 v[76:79], v[136:139], a[188:191], v[76:79]
    v_mfma_f32_16x16x32_bf16 v[76:79], v[132:135], a[172:175], v[76:79]
    s_cmp_lt_u32 s62, 64
    s_cselect_b32 s63, s63, s64
    v_mfma_f32_16x16x32_bf16 v[76:79], v[128:131], a[156:159], v[76:79]
    s_waitcnt lgkmcnt(0)
    s_mov_b32 s60, 884736
    v_mfma_f32_16x16x32_bf16 v[80:83], v[140:143], a[144:147], v[80:83]
    s_waitcnt vmcnt(12)
    s_barrier
    v_mfma_f32_16x16x32_bf16 v[80:83], v[144:147], a[160:163], v[80:83]
    ds_read_b64_tr_b16 v[128:129], v4 offset:36864
    s_add_u32 m0, s59, 73728
    v_mfma_f32_16x16x32_bf16 v[80:83], v[148:151], a[176:179], v[80:83]
    buffer_load_dwordx4 v13, s[48:51], s60 offen offset:0  lds
    v_mfma_f32_16x16x32_bf16 v[84:87], v[148:151], a[180:183], v[84:87]
    ds_read_b64_tr_b16 v[130:131], v4 offset:37888
    s_add_u32 s62, s62, s63
    v_mfma_f32_16x16x32_bf16 v[84:87], v[144:147], a[164:167], v[84:87]
    ds_read_b64_tr_b16 v[132:133], v4 offset:40960
    s_mul_i32 s62, s62, 1152
    v_mfma_f32_16x16x32_bf16 v[84:87], v[140:143], a[148:151], v[84:87]
    ds_read_b64_tr_b16 v[134:135], v4 offset:41984
    s_sub_u32 s62, s62, 1024
    v_mfma_f32_16x16x32_bf16 v[88:91], v[140:143], a[152:155], v[88:91]
    ds_read_b64_tr_b16 v[136:137], v4 offset:45056
    v_add_u32 v156, s62, v158
    v_mfma_f32_16x16x32_bf16 v[88:91], v[144:147], a[168:171], v[88:91]
    buffer_load_dwordx4 v14, s[48:51], s60 offen offset:1024  lds
    v_mfma_f32_16x16x32_bf16 v[88:91], v[148:151], a[184:187], v[88:91]
    ds_read_b64_tr_b16 v[138:139], v4 offset:46080
    s_mul_i32 s62, s52, 24
    v_mfma_f32_16x16x32_bf16 v[92:95], v[148:151], a[188:191], v[92:95]
    s_add_u32 s62, s62, 16
    s_add_u32 s63, s57, 192
    v_mfma_f32_16x16x32_bf16 v[92:95], v[144:147], a[172:175], v[92:95]
    s_sub_u32 s64, s58, 64
    v_mfma_f32_16x16x32_bf16 v[92:95], v[140:143], a[156:159], v[92:95]
    s_waitcnt lgkmcnt(0)
    v_mfma_f32_16x16x32_bf16 v[96:99], v[128:131], a[192:195], v[96:99]
    buffer_load_dwordx4 v15, s[48:51], s60 offen offset:2048  lds
    v_mfma_f32_16x16x32_bf16 v[96:99], v[132:135], a[208:211], v[96:99]
    ds_read_b64_tr_b16 v[140:141], v5 offset:36864
    v_mfma_f32_16x16x32_bf16 v[96:99], v[136:139], a[224:227], v[96:99]
    ds_read_b64_tr_b16 v[142:143], v5 offset:37888
    v_mfma_f32_16x16x32_bf16 v[100:103], v[136:139], a[228:231], v[100:103]
    ds_read_b64_tr_b16 v[144:145], v5 offset:40960
    v_mfma_f32_16x16x32_bf16 v[100:103], v[132:135], a[212:215], v[100:103]
    ds_read_b64_tr_b16 v[146:147], v5 offset:41984
    v_mfma_f32_16x16x32_bf16 v[100:103], v[128:131], a[196:199], v[100:103]
    v_mfma_f32_16x16x32_bf16 v[104:107], v[128:131], a[200:203], v[104:107]
    ds_read_b64_tr_b16 v[148:149], v5 offset:45056
    v_mfma_f32_16x16x32_bf16 v[104:107], v[132:135], a[216:219], v[104:107]
    ds_read_b64_tr_b16 v[150:151], v5 offset:46080
    v_mfma_f32_16x16x32_bf16 v[104:107], v[136:139], a[232:235], v[104:107]
    s_cmp_lt_u32 s62, 64
    s_cselect_b32 s63, s63, s64
    v_mfma_f32_16x16x32_bf16 v[108:111], v[136:139], a[236:239], v[108:111]
    v_mfma_f32_16x16x32_bf16 v[108:111], v[132:135], a[220:223], v[108:111]
    s_add_u32 s62, s62, s63
    s_mul_i32 s62, s62, 1152
    v_mfma_f32_16x16x32_bf16 v[108:111], v[128:131], a[204:207], v[108:111]
    s_waitcnt lgkmcnt(0)
    s_mov_b32 s60, 1769472
    v_mfma_f32_16x16x32_bf16 v[112:115], v[140:143], a[192:195], v[112:115]
    s_waitcnt vmcnt(12)
    s_barrier
    v_mfma_f32_16x16x32_bf16 v[112:115], v[144:147], a[208:211], v[112:115]
    ds_read_b64_tr_b16 v[128:129], v4 offset:49152
    s_add_u32 m0, s59, 86016
    v_mfma_f32_16x16x32_bf16 v[112:115], v[148:151], a[224:227], v[112:115]
    buffer_load_dwordx4 v13, s[48:51], s60 offen offset:0  lds
    v_mfma_f32_16x16x32_bf16 v[116:119], v[148:151], a[228:231], v[116:119]
    ds_read_b64_tr_b16 v[130:131], v4 offset:50176
    s_sub_u32 s62, s62, 2048
    v_mfma_f32_16x16x32_bf16 v[116:119], v[144:147], a[212:215], v[116:119]
    ds_read_b64_tr_b16 v[132:133], v4 offset:53248
    v_add_u32 v157, s62, v158
    v_mfma_f32_16x16x32_bf16 v[116:119], v[140:143], a[196:199], v[116:119]
    ds_read_b64_tr_b16 v[134:135], v4 offset:54272
    v_mfma_f32_16x16x32_bf16 v[120:123], v[140:143], a[200:203], v[120:123]
    ds_read_b64_tr_b16 v[136:137], v4 offset:57344
    v_mfma_f32_16x16x32_bf16 v[120:123], v[144:147], a[216:219], v[120:123]
    buffer_load_dwordx4 v14, s[48:51], s60 offen offset:1024  lds
    v_mfma_f32_16x16x32_bf16 v[120:123], v[148:151], a[232:235], v[120:123]
    ds_read_b64_tr_b16 v[138:139], v4 offset:58368
    v_mfma_f32_16x16x32_bf16 v[124:127], v[148:151], a[236:239], v[124:127]
    v_mfma_f32_16x16x32_bf16 v[124:127], v[144:147], a[220:223], v[124:127]
    v_mfma_f32_16x16x32_bf16 v[124:127], v[140:143], a[204:207], v[124:127]
    s_waitcnt lgkmcnt(0)
    v_mfma_f32_16x16x32_bf16 v[64:67], v[128:131], a[192:195], v[64:67]
    buffer_load_dwordx4 v15, s[48:51], s60 offen offset:2048  lds
    v_mfma_f32_16x16x32_bf16 v[64:67], v[132:135], a[208:211], v[64:67]
    ds_read_b64_tr_b16 v[140:141], v5 offset:49152
    v_mfma_f32_16x16x32_bf16 v[64:67], v[136:139], a[224:227], v[64:67]
    ds_read_b64_tr_b16 v[142:143], v5 offset:50176
    v_mfma_f32_16x16x32_bf16 v[68:71], v[136:139], a[228:231], v[68:71]
    ds_read_b64_tr_b16 v[144:145], v5 offset:53248
    v_mfma_f32_16x16x32_bf16 v[68:71], v[132:135], a[212:215], v[68:71]
    ds_read_b64_tr_b16 v[146:147], v5 offset:54272
    v_mfma_f32_16x16x32_bf16 v[68:71], v[128:131], a[196:199], v[68:71]
    v_mfma_f32_16x16x32_bf16 v[72:75], v[128:131], a[200:203], v[72:75]
    ds_read_b64_tr_b16 v[148:149], v5 offset:57344
    v_mfma_f32_16x16x32_bf16 v[72:75], v[132:135], a[216:219], v[72:75]
    ds_read_b64_tr_b16 v[150:151], v5 offset:58368
    v_mfma_f32_16x16x32_bf16 v[72:75], v[136:139], a[232:235], v[72:75]
    v_mfma_f32_16x16x32_bf16 v[76:79], v[136:139], a[236:239], v[76:79]
    v_mfma_f32_16x16x32_bf16 v[76:79], v[132:135], a[220:223], v[76:79]
    v_mfma_f32_16x16x32_bf16 v[76:79], v[128:131], a[204:207], v[76:79]
    s_waitcnt lgkmcnt(0)
    s_mov_b32 s60, 2654208
    v_mfma_f32_16x16x32_bf16 v[80:83], v[140:143], a[192:195], v[80:83]
    s_waitcnt vmcnt(12)
    s_barrier
    v_mfma_f32_16x16x32_bf16 v[80:83], v[144:147], a[208:211], v[80:83]
    ds_read_b64_tr_b16 v[128:129], v6 offset:0
    s_add_u32 m0, s59, 98304
    v_mfma_f32_16x16x32_bf16 v[80:83], v[148:151], a[224:227], v[80:83]
    buffer_load_dwordx4 v13, s[48:51], s60 offen offset:0  lds
    v_mfma_f32_16x16x32_bf16 v[84:87], v[148:151], a[228:231], v[84:87]
    ds_read_b64_tr_b16 v[130:131], v6 offset:1024
    v_mfma_f32_16x16x32_bf16 v[84:87], v[144:147], a[212:215], v[84:87]
    ds_read_b64_tr_b16 v[132:133], v6 offset:4096
    v_mfma_f32_16x16x32_bf16 v[84:87], v[140:143], a[196:199], v[84:87]
    ds_read_b64_tr_b16 v[134:135], v6 offset:5120
    v_mfma_f32_16x16x32_bf16 v[88:91], v[140:143], a[200:203], v[88:91]
    ds_read_b64_tr_b16 v[136:137], v6 offset:8192
    v_mfma_f32_16x16x32_bf16 v[88:91], v[144:147], a[216:219], v[88:91]
    buffer_load_dwordx4 v14, s[48:51], s60 offen offset:1024  lds
    v_mfma_f32_16x16x32_bf16 v[88:91], v[148:151], a[232:235], v[88:91]
    ds_read_b64_tr_b16 v[138:139], v6 offset:9216
    v_mfma_f32_16x16x32_bf16 v[92:95], v[148:151], a[236:239], v[92:95]
    v_mfma_f32_16x16x32_bf16 v[92:95], v[144:147], a[220:223], v[92:95]
    v_mfma_f32_16x16x32_bf16 v[92:95], v[140:143], a[204:207], v[92:95]
    s_waitcnt lgkmcnt(0)
    v_mfma_f32_16x16x32_bf16 v[96:99], v[128:131], a[240:243], v[96:99]
    buffer_load_dwordx4 v15, s[48:51], s60 offen offset:2048  lds
    v_mfma_f32_16x16x32_bf16 v[96:99], v[132:135], v[224:227], v[96:99]
    ds_read_b64_tr_b16 v[140:141], v7 offset:0
    v_mfma_f32_16x16x32_bf16 v[96:99], v[136:139], v[240:243], v[96:99]
    ds_read_b64_tr_b16 v[142:143], v7 offset:1024
    v_mfma_f32_16x16x32_bf16 v[100:103], v[136:139], v[244:247], v[100:103]
    ds_read_b64_tr_b16 v[144:145], v7 offset:4096
    v_mfma_f32_16x16x32_bf16 v[100:103], v[132:135], v[228:231], v[100:103]
    ds_read_b64_tr_b16 v[146:147], v7 offset:5120
    v_mfma_f32_16x16x32_bf16 v[100:103], v[128:131], a[244:247], v[100:103]
    v_mfma_f32_16x16x32_bf16 v[104:107], v[128:131], a[248:251], v[104:107]
    ds_read_b64_tr_b16 v[148:149], v7 offset:8192
    v_mfma_f32_16x16x32_bf16 v[104:107], v[132:135], v[232:235], v[104:107]
    ds_read_b64_tr_b16 v[150:151], v7 offset:9216
    v_mfma_f32_16x16x32_bf16 v[104:107], v[136:139], v[248:251], v[104:107]
    v_mfma_f32_16x16x32_bf16 v[108:111], v[136:139], v[252:255], v[108:111]
    v_mfma_f32_16x16x32_bf16 v[108:111], v[132:135], v[236:239], v[108:111]
    v_mul_f32 v96, v20, v96
    v_mul_f32 v97, v20, v97
    v_mfma_f32_16x16x32_bf16 v[108:111], v[128:131], a[252:255], v[108:111]
    s_waitcnt lgkmcnt(0)
    s_mov_b32 s60, 3538944
    v_mfma_f32_16x16x32_bf16 v[112:115], v[140:143], a[240:243], v[112:115]
    s_waitcnt vmcnt(12)
    s_barrier
    v_mfma_f32_16x16x32_bf16 v[112:115], v[144:147], v[224:227], v[112:115]
    ds_read_b64_tr_b16 v[128:129], v6 offset:12288
    s_add_u32 m0, s59, 110592
    v_mfma_f32_16x16x32_bf16 v[112:115], v[148:151], v[240:243], v[112:115]
    buffer_load_dwordx4 v13, s[48:51], s60 offen offset:0  lds
    v_mfma_f32_16x16x32_bf16 v[116:119], v[148:151], v[244:247], v[116:119]
    ds_read_b64_tr_b16 v[130:131], v6 offset:13312
    v_mul_f32 v98, v20, v98
    v_mfma_f32_16x16x32_bf16 v[116:119], v[144:147], v[228:231], v[116:119]
    ds_read_b64_tr_b16 v[132:133], v6 offset:16384
    v_mul_f32 v99, v20, v99
    v_mfma_f32_16x16x32_bf16 v[116:119], v[140:143], a[244:247], v[116:119]
    ds_read_b64_tr_b16 v[134:135], v6 offset:17408
    v_mul_f32 v100, v21, v100
    v_mfma_f32_16x16x32_bf16 v[120:123], v[140:143], a[248:251], v[120:123]
    ds_read_b64_tr_b16 v[136:137], v6 offset:20480
    v_mul_f32 v101, v21, v101
    v_mfma_f32_16x16x32_bf16 v[120:123], v[144:147], v[232:235], v[120:123]
    buffer_load_dwordx4 v14, s[48:51], s60 offen offset:1024  lds
    v_mfma_f32_16x16x32_bf16 v[120:123], v[148:151], v[248:251], v[120:123]
    ds_read_b64_tr_b16 v[138:139], v6 offset:21504
    v_mul_f32 v102, v21, v102
    v_mfma_f32_16x16x32_bf16 v[124:127], v[148:151], v[252:255], v[124:127]
    v_mul_f32 v103, v21, v103
    v_mul_f32 v104, v22, v104
    v_mfma_f32_16x16x32_bf16 v[124:127], v[144:147], v[236:239], v[124:127]
    v_mul_f32 v105, v22, v105
    v_mul_f32 v106, v22, v106
    v_mfma_f32_16x16x32_bf16 v[124:127], v[140:143], a[252:255], v[124:127]
    s_waitcnt lgkmcnt(0)
    v_mul_f32 v107, v22, v107
    v_mfma_f32_16x16x32_bf16 v[64:67], v[128:131], a[240:243], v[64:67]
    buffer_load_dwordx4 v15, s[48:51], s60 offen offset:2048  lds
    v_mfma_f32_16x16x32_bf16 v[64:67], v[132:135], v[224:227], v[64:67]
    ds_read_b64_tr_b16 v[140:141], v7 offset:12288
    v_mul_f32 v108, v23, v108
    v_mfma_f32_16x16x32_bf16 v[64:67], v[136:139], v[240:243], v[64:67]
    ds_read_b64_tr_b16 v[142:143], v7 offset:13312
    v_mul_f32 v109, v23, v109
    v_mfma_f32_16x16x32_bf16 v[68:71], v[136:139], v[244:247], v[68:71]
    ds_read_b64_tr_b16 v[144:145], v7 offset:16384
    v_mul_f32 v110, v23, v110
    v_mfma_f32_16x16x32_bf16 v[68:71], v[132:135], v[228:231], v[68:71]
    ds_read_b64_tr_b16 v[146:147], v7 offset:17408
    v_mul_f32 v111, v23, v111
    v_mfma_f32_16x16x32_bf16 v[68:71], v[128:131], a[244:247], v[68:71]
    v_mul_f32 v112, v20, v112
    v_mul_f32 v113, v20, v113
    v_mfma_f32_16x16x32_bf16 v[72:75], v[128:131], a[248:251], v[72:75]
    ds_read_b64_tr_b16 v[148:149], v7 offset:20480
    v_mul_f32 v114, v20, v114
    v_mfma_f32_16x16x32_bf16 v[72:75], v[132:135], v[232:235], v[72:75]
    ds_read_b64_tr_b16 v[150:151], v7 offset:21504
    v_mul_f32 v115, v20, v115
    v_mfma_f32_16x16x32_bf16 v[72:75], v[136:139], v[248:251], v[72:75]
    v_mul_f32 v116, v21, v116
    v_mul_f32 v117, v21, v117
    v_mfma_f32_16x16x32_bf16 v[76:79], v[136:139], v[252:255], v[76:79]
    v_mul_f32 v118, v21, v118
    v_mul_f32 v119, v21, v119
    v_mfma_f32_16x16x32_bf16 v[76:79], v[132:135], v[236:239], v[76:79]
    v_mul_f32 v120, v22, v120
    v_mul_f32 v121, v22, v121
    v_mfma_f32_16x16x32_bf16 v[76:79], v[128:131], a[252:255], v[76:79]
    s_waitcnt lgkmcnt(0)
    s_mov_b32 s60, 4423680
    v_mfma_f32_16x16x32_bf16 v[80:83], v[140:143], a[240:243], v[80:83]
    s_waitcnt vmcnt(12)
    s_barrier
    v_mfma_f32_16x16x32_bf16 v[80:83], v[144:147], v[224:227], v[80:83]
    ds_read_b64_tr_b16 v[128:129], v9 offset:36864
    s_add_u32 m0, s59, 122880
    v_mfma_f32_16x16x32_bf16 v[80:83], v[148:151], v[240:243], v[80:83]
    buffer_load_dwordx4 v13, s[48:51], s60 offen offset:0  lds
    v_mfma_f32_16x16x32_bf16 v[84:87], v[148:151], v[244:247], v[84:87]
    ds_read_b64_tr_b16 v[130:131], v9 offset:37120
    v_mul_f32 v122, v22, v122
    v_mfma_f32_16x16x32_bf16 v[84:87], v[144:147], v[228:231], v[84:87]
    ds_read_b64_tr_b16 v[132:133], v9 offset:38912
    v_mul_f32 v123, v22, v123
    v_mfma_f32_16x16x32_bf16 v[84:87], v[140:143], a[244:247], v[84:87]
    ds_read_b64_tr_b16 v[134:135], v9 offset:39168
    v_mul_f32 v124, v23, v124
    v_mfma_f32_16x16x32_bf16 v[88:91], v[140:143], a[248:251], v[88:91]
    ds_read_b64_tr_b16 v[136:137], v9 offset:40960
    v_mul_f32 v125, v23, v125
    v_mfma_f32_16x16x32_bf16 v[88:91], v[144:147], v[232:235], v[88:91]
    buffer_load_dwordx4 v14, s[48:51], s60 offen offset:1024  lds
    v_mfma_f32_16x16x32_bf16 v[88:91], v[148:151], v[248:251], v[88:91]
    ds_read_b64_tr_b16 v[138:139], v9 offset:41216
    v_mul_f32 v126, v23, v126
    v_mfma_f32_16x16x32_bf16 v[92:95], v[148:151], v[252:255], v[92:95]
    v_mul_f32 v127, v23, v127
    v_mul_f32 v96, v96, v64
    v_mfma_f32_16x16x32_bf16 v[92:95], v[144:147], v[236:239], v[92:95]
    v_mul_f32 v97, v97, v65
    v_mul_f32 v98, v98, v66
    v_mfma_f32_16x16x32_bf16 v[92:95], v[140:143], a[252:255], v[92:95]
    s_waitcnt lgkmcnt(0)
    v_mul_f32 v99, v99, v67
    v_mfma_f32_16x16x32_bf16 v[32:35], v[128:131], a[0:3], 0
    buffer_load_dwordx4 v15, s[48:51], s60 offen offset:2048  lds
    v_mfma_f32_16x16x32_bf16 v[32:35], v[132:135], a[16:19], v[32:35]
    ds_read_b64_tr_b16 v[140:141], v9 offset:43008
    v_mul_f32 v100, v100, v68
    v_mfma_f32_16x16x32_bf16 v[32:35], v[136:139], a[32:35], v[32:35]
    ds_read_b64_tr_b16 v[142:143], v9 offset:43264
    v_mul_f32 v101, v101, v69
    v_mfma_f32_16x16x32_bf16 v[36:39], v[136:139], a[36:39], 0
    ds_read_b64_tr_b16 v[144:145], v9 offset:45056
    v_mul_f32 v102, v102, v70
    v_mfma_f32_16x16x32_bf16 v[36:39], v[132:135], a[20:23], v[36:39]
    ds_read_b64_tr_b16 v[146:147], v9 offset:45312
    v_mul_f32 v103, v103, v71
    v_mfma_f32_16x16x32_bf16 v[36:39], v[128:131], a[4:7], v[36:39]
    v_mul_f32 v104, v104, v72
    v_mul_f32 v105, v105, v73
    v_mfma_f32_16x16x32_bf16 v[40:43], v[128:131], a[8:11], 0
    ds_read_b64_tr_b16 v[148:149], v9 offset:47104
    v_mul_f32 v106, v106, v74
    v_mfma_f32_16x16x32_bf16 v[40:43], v[132:135], a[24:27], v[40:43]
    ds_read_b64_tr_b16 v[150:151], v9 offset:47360
    v_mul_f32 v107, v107, v75
    v_mfma_f32_16x16x32_bf16 v[40:43], v[136:139], a[40:43], v[40:43]
    v_mul_f32 v108, v108, v76
    v_mul_f32 v109, v109, v77
    v_mfma_f32_16x16x32_bf16 v[44:47], v[136:139], a[44:47], 0
    v_mul_f32 v110, v110, v78
    v_mul_f32 v111, v111, v79
    v_mfma_f32_16x16x32_bf16 v[44:47], v[132:135], a[28:31], v[44:47]
    v_mul_f32 v112, v112, v80
    v_mul_f32 v113, v113, v81
    v_mfma_f32_16x16x32_bf16 v[44:47], v[128:131], a[12:15], v[44:47]
    s_waitcnt lgkmcnt(0)
    s_mov_b32 s60, 0
    v_mfma_f32_16x16x32_bf16 v[48:51], v[140:143], a[0:3], 0
    s_waitcnt vmcnt(12)
    s_barrier
    v_mfma_f32_16x16x32_bf16 v[48:51], v[144:147], a[16:19], v[48:51]
    ds_read_b64_tr_b16 v[128:129], v8 offset:24576
    s_add_u32 m0, s59, 147456
    v_mfma_f32_16x16x32_bf16 v[48:51], v[148:151], a[32:35], v[48:51]
    buffer_load_dwordx4 v152, s[40:43], s60 offen offset:0  lds
    v_mfma_f32_16x16x32_bf16 v[52:55], v[148:151], a[36:39], 0
    ds_read_b64_tr_b16 v[130:131], v8 offset:24832
    v_mul_f32 v114, v114, v82
    v_mfma_f32_16x16x32_bf16 v[52:55], v[144:147], a[20:23], v[52:55]
    ds_read_b64_tr_b16 v[132:133], v8 offset:26624
    v_mul_f32 v115, v115, v83
    v_mfma_f32_16x16x32_bf16 v[52:55], v[140:143], a[4:7], v[52:55]
    ds_read_b64_tr_b16 v[134:135], v8 offset:26880
    v_mul_f32 v116, v116, v84
    v_mfma_f32_16x16x32_bf16 v[56:59], v[140:143], a[8:11], 0
    ds_read_b64_tr_b16 v[136:137], v8 offset:28672
    v_mul_f32 v117, v117, v85
    v_mfma_f32_16x16x32_bf16 v[56:59], v[144:147], a[24:27], v[56:59]
    buffer_load_dwordx4 v153, s[40:43], s60 offen offset:1024  lds
    v_mfma_f32_16x16x32_bf16 v[56:59], v[148:151], a[40:43], v[56:59]
    ds_read_b64_tr_b16 v[138:139], v8 offset:28928
    v_mul_f32 v118, v118, v86
    v_mfma_f32_16x16x32_bf16 v[60:63], v[148:151], a[44:47], 0
    v_mul_f32 v119, v119, v87
    v_mul_f32 v120, v120, v88
    v_mfma_f32_16x16x32_bf16 v[60:63], v[144:147], a[28:31], v[60:63]
    v_mul_f32 v121, v121, v89
    v_mul_f32 v122, v122, v90
    v_mfma_f32_16x16x32_bf16 v[60:63], v[140:143], a[12:15], v[60:63]
    s_waitcnt lgkmcnt(0)
    v_mul_f32 v123, v123, v91
    v_mfma_f32_16x16x32_bf16 v[32:35], v[128:131], a[48:51], v[32:35]
    buffer_load_dwordx4 v154, s[40:43], s60 offen offset:2048  lds
    v_mfma_f32_16x16x32_bf16 v[32:35], v[132:135], a[64:67], v[32:35]
    ds_read_b64_tr_b16 v[140:141], v8 offset:30720
    v_mul_f32 v124, v124, v92
    v_mfma_f32_16x16x32_bf16 v[32:35], v[136:139], a[80:83], v[32:35]
    ds_read_b64_tr_b16 v[142:143], v8 offset:30976
    v_mul_f32 v125, v125, v93
    v_mfma_f32_16x16x32_bf16 v[36:39], v[136:139], a[84:87], v[36:39]
    ds_read_b64_tr_b16 v[144:145], v8 offset:32768
    v_mul_f32 v126, v126, v94
    v_mfma_f32_16x16x32_bf16 v[36:39], v[132:135], a[68:71], v[36:39]
    ds_read_b64_tr_b16 v[146:147], v8 offset:33024
    v_mul_f32 v127, v127, v95
    v_mfma_f32_16x16x32_bf16 v[36:39], v[128:131], a[52:55], v[36:39]
    v_cvt_pk_bf16_f32 v96, v96, v97
    v_cvt_pk_bf16_f32 v97, v98, v99
    v_mfma_f32_16x16x32_bf16 v[40:43], v[128:131], a[56:59], v[40:43]
    ds_read_b64_tr_b16 v[148:149], v8 offset:34816
    v_cvt_pk_bf16_f32 v98, v112, v113
    v_mfma_f32_16x16x32_bf16 v[40:43], v[132:135], a[72:75], v[40:43]
    ds_read_b64_tr_b16 v[150:151], v8 offset:35072
    v_cvt_pk_bf16_f32 v99, v114, v115
    v_mfma_f32_16x16x32_bf16 v[40:43], v[136:139], a[88:91], v[40:43]
    s_getpc_b64 s[70:71]
L_pc2:
    s_lshr_b32 s68, s2, 3
    v_mfma_f32_16x16x32_bf16 v[44:47], v[136:139], a[92:95], v[44:47]
    s_mul_i32 s68, s68, 1024
    s_add_u32 s68, s68, 1024
    v_mfma_f32_16x16x32_bf16 v[44:47], v[132:135], a[76:79], v[44:47]
    ds_write_b128 v24, v[96:99] offset:49152
    v_mfma_f32_16x16x32_bf16 v[44:47], v[128:131], a[60:63], v[44:47]
    s_waitcnt lgkmcnt(1)
    s_mov_b32 s60, 110592
    v_mfma_f32_16x16x32_bf16 v[48:51], v[140:143], a[48:51], v[48:51]
    s_waitcnt vmcnt(12)
    s_barrier
    v_mfma_f32_16x16x32_bf16 v[48:51], v[144:147], a[64:67], v[48:51]
    ds_read_b64_tr_b16 v[128:129], v8 offset:36864
    s_add_u32 m0, s59, 73728
    v_mfma_f32_16x16x32_bf16 v[48:51], v[148:151], a[80:83], v[48:51]
    buffer_load_dwordx4 v152, s[40:43], s60 offen offset:0  lds
    v_mfma_f32_16x16x32_bf16 v[52:55], v[148:151], a[84:87], v[52:55]
    ds_read_b64_tr_b16 v[130:131], v8 offset:37120
    v_cvt_pk_bf16_f32 v100, v100, v101
    v_mfma_f32_16x16x32_bf16 v[52:55], v[144:147], a[68:71], v[52:55]
    ds_read_b64_tr_b16 v[132:133], v8 offset:38912
    v_cvt_pk_bf16_f32 v101, v102, v103
    v_mfma_f32_16x16x32_bf16 v[52:55], v[140:143], a[52:55], v[52:55]
    ds_read_b64_tr_b16 v[134:135], v8 offset:39168
    v_cvt_pk_bf16_f32 v102, v116, v117
    v_mfma_f32_16x16x32_bf16 v[56:59], v[140:143], a[56:59], v[56:59]
    ds_read_b64_tr_b16 v[136:137], v8 offset:40960
    v_cvt_pk_bf16_f32 v103, v118, v119
    v_mfma_f32_16x16x32_bf16 v[56:59], v[144:147], a[72:75], v[56:59]
    buffer_load_dwordx4 v153, s[40:43], s60 offen offset:1024  lds
    v_mfma_f32_16x16x32_bf16 v[56:59], v[148:151], a[88:91], v[56:59]
    ds_read_b64_tr_b16 v[138:139], v8 offset:41216
    v_min_u32 v0, 7, v1
    v_mfma_f32_16x16x32_bf16 v[60:63], v[148:151], a[92:95], v[60:63]
    v_lshl_add_u32 v0, v0, 7, s68
    v_min_u32 v0, 0x8344, v0
    v_mfma_f32_16x16x32_bf16 v[60:63], v[144:147], a[76:79], v[60:63]
    ds_write_b128 v24, v[100:103] offset:50176
    v_mfma_f32_16x16x32_bf16 v[60:63], v[140:143], a[60:63], v[60:63]
    s_waitcnt lgkmcnt(1)
    v_cvt_pk_bf16_f32 v104, v104, v105
    v_mfma_f32_16x16x32_bf16 v[32:35], v[128:131], a[96:99], v[32:35]
    buffer_load_dwordx4 v154, s[40:43], s60 offen offset:2048  lds
    v_mfma_f32_16x16x32_bf16 v[32:35], v[132:135], a[112:115], v[32:35]
    ds_read_b64_tr_b16 v[140:141], v8 offset:43008
    v_cvt_pk_bf16_f32 v105, v106, v107
    v_mfma_f32_16x16x32_bf16 v[32:35], v[136:139], a[128:131], v[32:35]
    ds_read_b64_tr_b16 v[142:143], v8 offset:43264
    v_cvt_pk_bf16_f32 v106, v120, v121
    v_mfma_f32_16x16x32_bf16 v[36:39], v[136:139], a[132:135], v[36:39]
    ds_read_b64_tr_b16 v[144:145], v8 offset:45056
    v_cvt_pk_bf16_f32 v107, v122, v123
    v_mfma_f32_16x16x32_bf16 v[36:39], v[132:135], a[116:119], v[36:39]
    ds_read_b64_tr_b16 v[146:147], v8 offset:45312
    v_lshrrev_b32 v158, 5, v1
    v_mfma_f32_16x16x32_bf16 v[36:39], v[128:131], a[100:103], v[36:39]
    global_load_dword v0, v0, s[70:71]
    v_mfma_f32_16x16x32_bf16 v[40:43], v[128:131], a[104:107], v[40:43]
    ds_read_b64_tr_b16 v[148:149], v8 offset:47104
    v_lshlrev_b32 v158, 10, v158
    v_mfma_f32_16x16x32_bf16 v[40:43], v[132:135], a[120:123], v[40:43]
    ds_read_b64_tr_b16 v[150:151], v8 offset:47360
    v_sub_u32 v4, v4, v158
    v_mfma_f32_16x16x32_bf16 v[40:43], v[136:139], a[136:139], v[40:43]
    v_sub_u32 v5, v5, v158
    v_sub_u32 v6, v6, v158
    v_mfma_f32_16x16x32_bf16 v[44:47], v[136:139], a[140:143], v[44:47]
    v_sub_u32 v7, v7, v158
    s_lshl_b32 s62, s56, 3
    v_mfma_f32_16x16x32_bf16 v[44:47], v[132:135], a[124:127], v[44:47]
    ds_write_b128 v24, v[104:107] offset:51200
    v_mfma_f32_16x16x32_bf16 v[44:47], v[128:131], a[108:111], v[44:47]
    s_waitcnt lgkmcnt(1)
    s_mov_b32 s60, 0
    v_mfma_f32_16x16x32_bf16 v[48:51], v[140:143], a[96:99], v[48:51]
    s_waitcnt vmcnt(13)
    s_barrier
    v_mfma_f32_16x16x32_bf16 v[48:51], v[144:147], a[112:115], v[48:51]
    ds_read_b64_tr_b16 v[128:129], v8 offset:49152
    s_add_u32 m0, s59, 86016
    v_mfma_f32_16x16x32_bf16 v[48:51], v[148:151], a[128:131], v[48:51]
    buffer_load_dwordx4 v155, s[40:43], s60 offen offset:0  lds
    v_mfma_f32_16x16x32_bf16 v[52:55], v[148:151], a[132:135], v[52:55]
    ds_read_b64_tr_b16 v[130:131], v8 offset:49408
    v_cvt_pk_bf16_f32 v108, v108, v109
    v_mfma_f32_16x16x32_bf16 v[52:55], v[144:147], a[116:119], v[52:55]
    ds_read_b64_tr_b16 v[132:133], v8 offset:51200
    v_cvt_pk_bf16_f32 v109, v110, v111
    v_mfma_f32_16x16x32_bf16 v[52:55], v[140:143], a[100:103], v[52:55]
    ds_read_b64_tr_b16 v[134:135], v8 offset:51456
    v_cvt_pk_bf16_f32 v110, v124, v125
    v_mfma_f32_16x16x32_bf16 v[56:59], v[140:143], a[104:107], v[56:59]
    ds_read_b64_tr_b16 v[136:137], v8 offset:53248
    v_cvt_pk_bf16_f32 v111, v126, v127
    v_mfma_f32_16x16x32_bf16 v[56:59], v[144:147], a[120:123], v[56:59]
    buffer_load_dwordx4 v156, s[40:43], s60 offen offset:1024  lds
    v_mfma_f32_16x16x32_bf16 v[56:59], v[148:151], a[136:139], v[56:59]
    ds_read_b64_tr_b16 v[138:139], v8 offset:53504
    v_add_u32 v31, s62, v26
    v_mfma_f32_16x16x32_bf16 v[60:63], v[148:151], a[140:143], v[60:63]
    ds_read_b128 a[0:3], v25 offset:0
    ds_read_b128 a[16:19], v25 offset:8192
    v_mfma_f32_16x16x32_bf16 v[60:63], v[144:147], a[124:127], v[60:63]
    ds_write_b128 v24, v[108:111] offset:52224
    v_mfma_f32_16x16x32_bf16 v[60:63], v[140:143], a[108:111], v[60:63]
    s_waitcnt lgkmcnt(3)
    ds_read_b128 a[4:7], v25 offset:1024
    v_mfma_f32_16x16x32_bf16 v[32:35], v[128:131], a[144:147], v[32:35]
    buffer_load_dwordx4 v157, s[40:43], s60 offen offset:2048  lds
    v_mfma_f32_16x16x32_bf16 v[32:35], v[132:135], a[160:163], v[32:35]
    ds_read_b64_tr_b16 v[140:141], v8 offset:55296
    ds_read_b128 a[8:11], v25 offset:2048
    v_mfma_f32_16x16x32_bf16 v[32:35], v[136:139], a[176:179], v[32:35]
    ds_read_b64_tr_b16 v[142:143], v8 offset:55552
    ds_read_b128 a[12:15], v25 offset:3072
    v_mfma_f32_16x16x32_bf16 v[36:39], v[136:139], a[180:183], v[36:39]
    ds_read_b64_tr_b16 v[144:145], v8 offset:57344
    ds_read_b128 a[20:23], v25 offset:9216
    v_mfma_f32_16x16x32_bf16 v[36:39], v[132:135], a[164:167], v[36:39]
    ds_read_b64_tr_b16 v[146:147], v8 offset:57600
    ds_read_b128 a[24:27], v25 offset:10240
    v_mfma_f32_16x16x32_bf16 v[36:39], v[128:131], a[148:151], v[36:39]
    ds_read_b128 a[28:31], v25 offset:11264
    ds_read_b128 a[32:35], v25 offset:16384
    v_mfma_f32_16x16x32_bf16 v[40:43], v[128:131], a[152:155], v[40:43]
    ds_read_b64_tr_b16 v[148:149], v8 offset:59392
    ds_read_b128 a[36:39], v25 offset:17408
    v_mfma_f32_16x16x32_bf16 v[40:43], v[132:135], a[168:171], v[40:43]
    ds_read_b64_tr_b16 v[150:151], v8 offset:59648
    ds_read_b128 a[40:43], v25 offset:18432
    v_mfma_f32_16x16x32_bf16 v[40:43], v[136:139], a[184:187], v[40:43]
    ds_read_b128 a[44:47], v25 offset:19456
    ds_read_b128 a[48:51], v25 offset:24576
    v_mfma_f32_16x16x32_bf16 v[44:47], v[136:139], a[188:191], v[44:47]
    ds_read_b128 a[52:55], v25 offset:25600
    ds_read_b128 a[64:67], v25 offset:32768
    v_mfma_f32_16x16x32_bf16 v[44:47], v[132:135], a[172:175], v[44:47]
    ds_read_b128 a[56:59], v25 offset:26624
    ds_read_b128 a[68:71], v25 offset:33792
    v_mfma_f32_16x16x32_bf16 v[44:47], v[128:131], a[156:159], v[44:47]
    s_waitcnt lgkmcnt(7)
    s_mov_b32 s60, 128
    v_mfma_f32_16x16x32_bf16 v[48:51], v[140:143], a[144:147], v[48:51]
    s_waitcnt vmcnt(13)
    s_barrier
    v_mfma_f32_16x16x32_bf16 v[48:51], v[144:147], a[160:163], v[48:51]
    ds_read_b64_tr_b16 v[128:129], v9 offset:0
    s_add_u32 m0, s59, 98304
    v_mfma_f32_16x16x32_bf16 v[48:51], v[148:151], a[176:179], v[48:51]
    buffer_load_dwordx4 v152, s[40:43], s60 offen offset:0  lds
    v_mfma_f32_16x16x32_bf16 v[52:55], v[148:151], a[180:183], v[52:55]
    ds_read_b64_tr_b16 v[130:131], v9 offset:256
    ds_read_b128 a[60:63], v25 offset:27648
    v_mfma_f32_16x16x32_bf16 v[52:55], v[144:147], a[164:167], v[52:55]
    ds_read_b64_tr_b16 v[132:133], v9 offset:2048
    ds_read_b128 a[72:75], v25 offset:34816
    v_mfma_f32_16x16x32_bf16 v[52:55], v[140:143], a[148:151], v[52:55]
    ds_read_b64_tr_b16 v[134:135], v9 offset:2304
    ds_read_b128 a[76:79], v25 offset:35840
    v_mfma_f32_16x16x32_bf16 v[56:59], v[140:143], a[152:155], v[56:59]
    ds_read_b64_tr_b16 v[136:137], v9 offset:4096
    ds_read_b128 a[80:83], v25 offset:40960
    v_mfma_f32_16x16x32_bf16 v[56:59], v[144:147], a[168:171], v[56:59]
    buffer_load_dwordx4 v153, s[40:43], s60 offen offset:1024  lds
    v_mfma_f32_16x16x32_bf16 v[56:59], v[148:151], a[184:187], v[56:59]
    ds_read_b64_tr_b16 v[138:139], v9 offset:4352
    ds_read_b128 a[84:87], v25 offset:41984
    v_mfma_f32_16x16x32_bf16 v[60:63], v[148:151], a[188:191], v[60:63]
    ds_read_b128 a[88:91], v25 offset:43008
    ds_read_b128 a[96:99], v25 offset:49152
    v_mfma_f32_16x16x32_bf16 v[60:63], v[144:147], a[172:175], v[60:63]
    ds_read_b128 a[92:95], v25 offset:44032
    ds_read_b128 a[100:103], v25 offset:50176
    v_mfma_f32_16x16x32_bf16 v[60:63], v[140:143], a[156:159], v[60:63]
    s_waitcnt lgkmcnt(5)
    ds_read_b128 a[104:107], v25 offset:51200
    v_mfma_f32_16x16x32_bf16 v[32:35], v[128:131], a[192:195], v[32:35]
    buffer_load_dwordx4 v154, s[40:43], s60 offen offset:2048  lds
    v_mfma_f32_16x16x32_bf16 v[32:35], v[132:135], a[208:211], v[32:35]
    ds_read_b64_tr_b16 v[140:141], v9 offset:6144
    ds_read_b128 a[108:111], v25 offset:52224
    v_mfma_f32_16x16x32_bf16 v[32:35], v[136:139], a[224:227], v[32:35]
    ds_read_b64_tr_b16 v[142:143], v9 offset:6400
    ds_read_b128 a[112:115], v25 offset:57344
    v_mfma_f32_16x16x32_bf16 v[36:39], v[136:139], a[228:231], v[36:39]
    ds_read_b64_tr_b16 v[144:145], v9 offset:8192
    ds_read_b128 a[116:119], v25 offset:58368
    v_mfma_f32_16x16x32_bf16 v[36:39], v[132:135], a[212:215], v[36:39]
    ds_read_b64_tr_b16 v[146:147], v9 offset:8448
    ds_read_b128 a[120:123], v25 offset:59392
    v_mfma_f32_16x16x32_bf16 v[36:39], v[128:131], a[196:199], v[36:39]
    ds_read_b128 a[124:127], v25 offset:60416
    v_mfma_f32_16x16x32_bf16 v[40:43], v[128:131], a[200:203], v[40:43]
    ds_read_b64_tr_b16 v[148:149], v9 offset:10240
    v_mfma_f32_16x16x32_bf16 v[40:43], v[132:135], a[216:219], v[40:43]
    ds_read_b64_tr_b16 v[150:151], v9 offset:10496
    v_mfma_f32_16x16x32_bf16 v[40:43], v[136:139], a[232:235], v[40:43]
    v_mfma_f32_16x16x32_bf16 v[44:47], v[136:139], a[236:239], v[44:47]
    v_mfma_f32_16x16x32_bf16 v[44:47], v[132:135], a[220:223], v[44:47]
    v_mfma_f32_16x16x32_bf16 v[44:47], v[128:131], a[204:207], v[44:47]
    s_waitcnt lgkmcnt(0)
    s_mov_b32 s60, 110720
    v_mfma_f32_16x16x32_bf16 v[48:51], v[140:143], a[192:195], v[48:51]
    s_waitcnt vmcnt(13)
    s_barrier
    v_mfma_f32_16x16x32_bf16 v[48:51], v[144:147], a[208:211], v[48:51]
    ds_read_b64_tr_b16 v[128:129], v9 offset:12288
    s_add_u32 m0, s59, 110592
    v_mfma_f32_16x16x32_bf16 v[48:51], v[148:151], a[224:227], v[48:51]
    buffer_load_dwordx4 v152, s[40:43], s60 offen offset:0  lds
    v_mfma_f32_16x16x32_bf16 v[52:55], v[148:151], a[228:231], v[52:55]
    ds_read_b64_tr_b16 v[130:131], v9 offset:12544
    v_mfma_f32_16x16x32_bf16 v[52:55], v[144:147], a[212:215], v[52:55]
    ds_read_b64_tr_b16 v[132:133], v9 offset:14336
    v_mfma_f32_16x16x32_bf16 v[52:55], v[140:143], a[196:199], v[52:55]
    ds_read_b64_tr_b16 v[134:135], v9 offset:14592
    v_mfma_f32_16x16x32_bf16 v[56:59], v[140:143], a[200:203], v[56:59]
    ds_read_b64_tr_b16 v[136:137], v9 offset:16384
    v_mfma_f32_16x16x32_bf16 v[56:59], v[144:147], a[216:219], v[56:59]
    buffer_load_dwordx4 v153, s[40:43], s60 offen offset:1024  lds
    v_mfma_f32_16x16x32_bf16 v[56:59], v[148:151], a[232:235], v[56:59]
    ds_read_b64_tr_b16 v[138:139], v9 offset:16640
    v_mfma_f32_16x16x32_bf16 v[60:63], v[148:151], a[236:239], v[60:63]
    v_mfma_f32_16x16x32_bf16 v[60:63], v[144:147], a[220:223], v[60:63]
    v_mfma_f32_16x16x32_bf16 v[60:63], v[140:143], a[204:207], v[60:63]
    s_waitcnt lgkmcnt(0)
    v_mfma_f32_16x16x32_bf16 v[32:35], v[128:131], a[240:243], v[32:35]
    buffer_load_dwordx4 v154, s[40:43], s60 offen offset:2048  lds
    v_mfma_f32_16x16x32_bf16 v[32:35], v[132:135], v[224:227], v[32:35]
    ds_read_b64_tr_b16 v[140:141], v9 offset:18432
    v_mfma_f32_16x16x32_bf16 v[32:35], v[136:139], v[240:243], v[32:35]
    ds_read_b64_tr_b16 v[142:143], v9 offset:18688
    v_mfma_f32_16x16x32_bf16 v[36:39], v[136:139], v[244:247], v[36:39]
    ds_read_b64_tr_b16 v[144:145], v9 offset:20480
    v_mfma_f32_16x16x32_bf16 v[36:39], v[132:135], v[228:231], v[36:39]
    ds_read_b64_tr_b16 v[146:147], v9 offset:20736
    v_mfma_f32_16x16x32_bf16 v[36:39], v[128:131], a[244:247], v[36:39]
    v_mfma_f32_16x16x32_bf16 v[40:43], v[128:131], a[248:251], v[40:43]
    ds_read_b64_tr_b16 v[148:149], v9 offset:22528
    v_mfma_f32_16x16x32_bf16 v[40:43], v[132:135], v[232:235], v[40:43]
    ds_read_b64_tr_b16 v[150:151], v9 offset:22784
    v_mfma_f32_16x16x32_bf16 v[40:43], v[136:139], v[248:251], v[40:43]
    v_mfma_f32_16x16x32_bf16 v[44:47], v[136:139], v[252:255], v[44:47]
    v_mfma_f32_16x16x32_bf16 v[44:47], v[132:135], v[236:239], v[44:47]
    v_mul_f32 v32, v20, v32
    v_mul_f32 v33, v20, v33
    v_mfma_f32_16x16x32_bf16 v[44:47], v[128:131], a[252:255], v[44:47]
    s_waitcnt lgkmcnt(0)
    s_mov_b32 s60, 128
    v_mfma_f32_16x16x32_bf16 v[48:51], v[140:143], a[240:243], v[48:51]
    s_waitcnt vmcnt(13)
    s_barrier
    v_mfma_f32_16x16x32_bf16 v[48:51], v[144:147], v[224:227], v[48:51]
    ds_read_b64_tr_b16 v[128:129], v6 offset:36864
    s_add_u32 m0, s59, 122880
    v_mfma_f32_16x16x32_bf16 v[48:51], v[148:151], v[240:243], v[48:51]
    buffer_load_dwordx4 v155, s[40:43], s60 offen offset:0  lds
    v_mfma_f32_16x16x32_bf16 v[52:55], v[148:151], v[244:247], v[52:55]
    ds_read_b64_tr_b16 v[130:131], v6 offset:38912
    v_mul_f32 v34, v20, v34
    v_mfma_f32_16x16x32_bf16 v[52:55], v[144:147], v[228:231], v[52:55]
    ds_read_b64_tr_b16 v[132:133], v6 offset:40960
    v_mul_f32 v35, v20, v35
    v_mfma_f32_16x16x32_bf16 v[52:55], v[140:143], a[244:247], v[52:55]
    ds_read_b64_tr_b16 v[134:135], v6 offset:43008
    v_mul_f32 v36, v21, v36
    v_mfma_f32_16x16x32_bf16 v[56:59], v[140:143], a[248:251], v[56:59]
    ds_read_b64_tr_b16 v[136:137], v6 offset:45056
    v_mul_f32 v37, v21, v37
    v_mfma_f32_16x16x32_bf16 v[56:59], v[144:147], v[232:235], v[56:59]
    buffer_load_dwordx4 v156, s[40:43], s60 offen offset:1024  lds
    v_mfma_f32_16x16x32_bf16 v[56:59], v[148:151], v[248:251], v[56:59]
    ds_read_b64_tr_b16 v[138:139], v6 offset:47104
    v_mul_f32 v38, v21, v38
    v_mfma_f32_16x16x32_bf16 v[60:63], v[148:151], v[252:255], v[60:63]
    v_mul_f32 v39, v21, v39
    v_mul_f32 v40, v22, v40
    v_mfma_f32_16x16x32_bf16 v[60:63], v[144:147], v[236:239], v[60:63]
    v_mul_f32 v41, v22, v41
    v_mul_f32 v42, v22, v42
    v_mfma_f32_16x16x32_bf16 v[60:63], v[140:143], a[252:255], v[60:63]
    s_waitcnt lgkmcnt(0)
    v_mul_f32 v43, v22, v43
    v_mfma_f32_16x16x32_bf16 v[64:67], v[128:131], a[0:3], 0
    buffer_load_dwordx4 v157, s[40:43], s60 offen offset:2048  lds
    v_mfma_f32_16x16x32_bf16 v[64:67], v[132:135], a[16:19], v[64:67]
    ds_read_b64_tr_b16 v[140:141], v7 offset:36864
    v_mul_f32 v44, v23, v44
    v_mfma_f32_16x16x32_bf16 v[64:67], v[136:139], a[32:35], v[64:67]
    ds_read_b64_tr_b16 v[142:143], v7 offset:38912
    v_mul_f32 v45, v23, v45
    v_mfma_f32_16x16x32_bf16 v[68:71], v[136:139], a[36:39], 0
    ds_read_b64_tr_b16 v[144:145], v7 offset:40960
    v_mul_f32 v46, v23, v46
    v_mfma_f32_16x16x32_bf16 v[68:71], v[132:135], a[20:23], v[68:71]
    ds_read_b64_tr_b16 v[146:147], v7 offset:43008
    v_mul_f32 v47, v23, v47
    v_mfma_f32_16x16x32_bf16 v[68:71], v[128:131], a[4:7], v[68:71]
    v_mul_f32 v32, v32, v48
    v_mul_f32 v33, v33, v49
    v_mfma_f32_16x16x32_bf16 v[72:75], v[128:131], a[8:11], 0
    ds_read_b64_tr_b16 v[148:149], v7 offset:45056
    v_mul_f32 v34, v34, v50
    v_mfma_f32_16x16x32_bf16 v[72:75], v[132:135], a[24:27], v[72:75]
    ds_read_b64_tr_b16 v[150:151], v7 offset:47104
    v_mul_f32 v35, v35, v51
    v_mfma_f32_16x16x32_bf16 v[72:75], v[136:139], a[40:43], v[72:75]
    v_cvt_pk_bf16_f32 v32, v32, v33
    v_cvt_pk_bf16_f32 v33, v34, v35
    v_mfma_f32_16x16x32_bf16 v[76:79], v[136:139], a[44:47], 0
    ds_write_b64 v31, v[32:33] offset:0
    v_mul_f32 v36, v36, v52
    v_mfma_f32_16x16x32_bf16 v[76:79], v[132:135], a[28:31], v[76:79]
    v_mul_f32 v37, v37, v53
    v_mul_f32 v38, v38, v54
    v_mfma_f32_16x16x32_bf16 v[76:79], v[128:131], a[12:15], v[76:79]
    s_waitcnt lgkmcnt(1)
    s_mov_b32 s60, 256
    v_mfma_f32_16x16x32_bf16 v[80:83], v[140:143], a[0:3], 0
    s_waitcnt vmcnt(13)
    s_barrier
    v_mfma_f32_16x16x32_bf16 v[80:83], v[144:147], a[16:19], v[80:83]
    ds_read_b64_tr_b16 v[128:129], v4 offset:24576
    s_add_u32 m0, s59, 147456
    v_mfma_f32_16x16x32_bf16 v[80:83], v[148:151], a[32:35], v[80:83]
    buffer_load_dwordx4 v152, s[40:43], s60 offen offset:0  lds
    v_mfma_f32_16x16x32_bf16 v[84:87], v[148:151], a[36:39], 0
    ds_read_b64_tr_b16 v[130:131], v4 offset:26624
    v_mul_f32 v39, v39, v55
    v_mfma_f32_16x16x32_bf16 v[84:87], v[144:147], a[20:23], v[84:87]
    ds_read_b64_tr_b16 v[132:133], v4 offset:28672
    v_cvt_pk_bf16_f32 v36, v36, v37
    v_mfma_f32_16x16x32_bf16 v[84:87], v[140:143], a[4:7], v[84:87]
    ds_read_b64_tr_b16 v[134:135], v4 offset:30720
    v_cvt_pk_bf16_f32 v37, v38, v39
    v_mfma_f32_16x16x32_bf16 v[88:91], v[140:143], a[8:11], 0
    ds_read_b64_tr_b16 v[136:137], v4 offset:32768
    ds_write_b64 v31, v[36:37] offset:1024
    v_mfma_f32_16x16x32_bf16 v[88:91], v[144:147], a[24:27], v[88:91]
    buffer_load_dwordx4 v153, s[40:43], s60 offen offset:1024  lds
    v_mfma_f32_16x16x32_bf16 v[88:91], v[148:151], a[40:43], v[88:91]
    ds_read_b64_tr_b16 v[138:139], v4 offset:34816
    v_mul_f32 v40, v40, v56
    v_mfma_f32_16x16x32_bf16 v[92:95], v[148:151], a[44:47], 0
    v_mul_f32 v41, v41, v57
    v_mul_f32 v42, v42, v58
    v_mfma_f32_16x16x32_bf16 v[92:95], v[144:147], a[28:31], v[92:95]
    v_mul_f32 v43, v43, v59
    v_cvt_pk_bf16_f32 v40, v40, v41
    v_mfma_f32_16x16x32_bf16 v[92:95], v[140:143], a[12:15], v[92:95]
    s_waitcnt lgkmcnt(0)
    v_cvt_pk_bf16_f32 v41, v42, v43
    v_mfma_f32_16x16x32_bf16 v[64:67], v[128:131], a[48:51], v[64:67]
    buffer_load_dwordx4 v154, s[40:43], s60 offen offset:2048  lds
    v_mfma_f32_16x16x32_bf16 v[64:67], v[132:135], a[64:67], v[64:67]
    ds_read_b64_tr_b16 v[140:141], v5 offset:24576
    ds_write_b64 v31, v[40:41] offset:2048
    v_mfma_f32_16x16x32_bf16 v[64:67], v[136:139], a[80:83], v[64:67]
    ds_read_b64_tr_b16 v[142:143], v5 offset:26624
    v_mul_f32 v44, v44, v60
    v_mfma_f32_16x16x32_bf16 v[68:71], v[136:139], a[84:87], v[68:71]
    ds_read_b64_tr_b16 v[144:145], v5 offset:28672
    v_mul_f32 v45, v45, v61
    v_mfma_f32_16x16x32_bf16 v[68:71], v[132:135], a[68:71], v[68:71]
    ds_read_b64_tr_b16 v[146:147], v5 offset:30720
    v_mul_f32 v46, v46, v62
    v_mfma_f32_16x16x32_bf16 v[68:71], v[128:131], a[52:55], v[68:71]
    v_mul_f32 v47, v47, v63
    v_cvt_pk_bf16_f32 v44, v44, v45
    v_mfma_f32_16x16x32_bf16 v[72:75], v[128:131], a[56:59], v[72:75]
    ds_read_b64_tr_b16 v[148:149], v5 offset:32768
    v_cvt_pk_bf16_f32 v45, v46, v47
    v_mfma_f32_16x16x32_bf16 v[72:75], v[132:135], a[72:75], v[72:75]
    ds_read_b64_tr_b16 v[150:151], v5 offset:34816
    ds_write_b64 v31, v[44:45] offset:3072
    v_mfma_f32_16x16x32_bf16 v[72:75], v[136:139], a[88:91], v[72:75]
    v_mfma_f32_16x16x32_bf16 v[76:79], v[136:139], a[92:95], v[76:79]
    v_mfma_f32_16x16x32_bf16 v[76:79], v[132:135], a[76:79], v[76:79]
    v_mfma_f32_16x16x32_bf16 v[76:79], v[128:131], a[60:63], v[76:79]
    s_waitcnt lgkmcnt(1)
    s_mov_b32 s60, 110848
    s_waitcnt lgkmcnt(0)
    v_mfma_f32_16x16x32_bf16 v[80:83], v[140:143], a[48:51], v[80:83]
    s_waitcnt vmcnt(12)
    s_barrier
    v_mfma_f32_16x16x32_bf16 v[80:83], v[144:147], a[64:67], v[80:83]
    ds_read_b64_tr_b16 v[128:129], v4 offset:36864
    s_add_u32 m0, s59, 73728
    v_mfma_f32_16x16x32_bf16 v[80:83], v[148:151], a[80:83], v[80:83]
    buffer_load_dwordx4 v152, s[40:43], s60 offen offset:0  lds
    v_mfma_f32_16x16x32_bf16 v[84:87], v[148:151], a[84:87], v[84:87]
    ds_read_b64_tr_b16 v[130:131], v4 offset:38912
    ds_read_b128 a[128:131], v26 offset:0
    v_mfma_f32_16x16x32_bf16 v[84:87], v[144:147], a[68:71], v[84:87]
    ds_read_b64_tr_b16 v[132:133], v4 offset:40960
    ds_read_b128 a[132:135], v26 offset:1024
    v_mfma_f32_16x16x32_bf16 v[84:87], v[140:143], a[52:55], v[84:87]
    ds_read_b64_tr_b16 v[134:135], v4 offset:43008
    ds_read_b128 a[136:139], v26 offset:2048
    v_mfma_f32_16x16x32_bf16 v[88:91], v[140:143], a[56:59], v[88:91]
    ds_read_b64_tr_b16 v[136:137], v4 offset:45056
    ds_read_b128 a[140:143], v26 offset:3072
    v_mfma_f32_16x16x32_bf16 v[88:91], v[144:147], a[72:75], v[88:91]
    buffer_load_dwordx4 v153, s[40:43], s60 offen offset:1024  lds
    v_mfma_f32_16x16x32_bf16 v[88:91], v[148:151], a[88:91], v[88:91]
    ds_read_b64_tr_b16 v[138:139], v4 offset:47104
    v_mfma_f32_16x16x32_bf16 v[92:95], v[148:151], a[92:95], v[92:95]
    v_mfma_f32_16x16x32_bf16 v[92:95], v[144:147], a[76:79], v[92:95]
    v_mfma_f32_16x16x32_bf16 v[92:95], v[140:143], a[60:63], v[92:95]
    s_waitcnt lgkmcnt(0)
    v_mfma_f32_16x16x32_bf16 v[64:67], v[128:131], a[96:99], v[64:67]
    buffer_load_dwordx4 v154, s[40:43], s60 offen offset:2048  lds
    v_mfma_f32_16x16x32_bf16 v[64:67], v[132:135], a[112:115], v[64:67]
    ds_read_b64_tr_b16 v[140:141], v5 offset:36864
    s_mul_i32 s4, s54, 9
    v_mfma_f32_16x16x32_bf16 v[64:67], v[136:139], a[128:131], v[64:67]
    ds_read_b64_tr_b16 v[142:143], v5 offset:38912
    s_add_u32 s4, s4, 0
    v_mfma_f32_16x16x32_bf16 v[68:71], v[136:139], a[132:135], v[68:71]
    ds_read_b64_tr_b16 v[144:145], v5 offset:40960
    s_and_b32 s72, s4, 3
    v_mfma_f32_16x16x32_bf16 v[68:71], v[132:135], a[116:119], v[68:71]
    ds_read_b64_tr_b16 v[146:147], v5 offset:43008
    s_lshl_b32 s72, s72, 8
    v_mfma_f32_16x16x32_bf16 v[68:71], v[128:131], a[100:103], v[68:71]
    buffer_load_dwordx4 v[224:227], v29, s[44:47], 0 offen offset:0 sc1
    v_mfma_f32_16x16x32_bf16 v[72:75], v[128:131], a[104:107], v[72:75]
    ds_read_b64_tr_b16 v[148:149], v5 offset:45056
    s_bfe_u32 s5, s4, 0x10002
    v_mfma_f32_16x16x32_bf16 v[72:75], v[132:135], a[120:123], v[72:75]
    ds_read_b64_tr_b16 v[150:151], v5 offset:47104
    s_lshl_b32 s5, s5, 11
    v_mfma_f32_16x16x32_bf16 v[72:75], v[136:139], a[136:139], v[72:75]
    s_add_u32 s72, s72, s5
    s_bfe_u32 s5, s4, 0x10003
    v_mfma_f32_16x16x32_bf16 v[76:79], v[136:139], a[140:143], v[76:79]
    buffer_load_dwordx4 v[228:231], v29, s[44:47], 0 offen offset:512 sc1
    v_mfma_f32_16x16x32_bf16 v[76:79], v[132:135], a[124:127], v[76:79]
    s_mul_i32 s5, s5, 36864
    s_add_u32 s72, s72, s5
    v_mfma_f32_16x16x32_bf16 v[76:79], v[128:131], a[108:111], v[76:79]
    s_waitcnt lgkmcnt(0)
    s_mov_b32 s60, 256
    v_mfma_f32_16x16x32_bf16 v[80:83], v[140:143], a[96:99], v[80:83]
    s_waitcnt vmcnt(14)
    s_barrier
    v_mfma_f32_16x16x32_bf16 v[80:83], v[144:147], a[112:115], v[80:83]
    ds_read_b64_tr_b16 v[128:129], v4 offset:49152
    s_add_u32 m0, s59, 86016
    v_mfma_f32_16x16x32_bf16 v[80:83], v[148:151], a[128:131], v[80:83]
    buffer_load_dwordx4 v155, s[40:43], s60 offen offset:0  lds
    v_mfma_f32_16x16x32_bf16 v[84:87], v[148:151], a[132:135], v[84:87]
    ds_read_b64_tr_b16 v[130:131], v4 offset:51200
    v_cvt_pk_bf16_f32 v64, v64, v65
    v_mfma_f32_16x16x32_bf16 v[84:87], v[144:147], a[116:119], v[84:87]
    ds_read_b64_tr_b16 v[132:133], v4 offset:53248
    v_cvt_pk_bf16_f32 v65, v66, v67
    v_mfma_f32_16x16x32_bf16 v[84:87], v[140:143], a[100:103], v[84:87]
    ds_read_b64_tr_b16 v[134:135], v4 offset:55296
    v_cvt_pk_bf16_f32 v66, v68, v69
    v_mfma_f32_16x16x32_bf16 v[88:91], v[140:143], a[104:107], v[88:91]
    ds_read_b64_tr_b16 v[136:137], v4 offset:57344
    v_cvt_pk_bf16_f32 v67, v70, v71
    v_mfma_f32_16x16x32_bf16 v[88:91], v[144:147], a[120:123], v[88:91]
    buffer_load_dwordx4 v156, s[40:43], s60 offen offset:1024  lds
    v_mfma_f32_16x16x32_bf16 v[88:91], v[148:151], a[136:139], v[88:91]
    ds_read_b64_tr_b16 v[138:139], v4 offset:59392
    s_mov_b32 s94, 0
    v_mfma_f32_16x16x32_bf16 v[92:95], v[148:151], a[140:143], v[92:95]
    s_lshr_b32 s5, s4, 4
    s_lshl_b32 s5, s5, 12
    v_mfma_f32_16x16x32_bf16 v[92:95], v[144:147], a[124:127], v[92:95]
    s_add_u32 s72, s72, s5
    s_mul_i32 s4, s54, 9
    v_mfma_f32_16x16x32_bf16 v[92:95], v[140:143], a[108:111], v[92:95]
    s_waitcnt lgkmcnt(0)
    s_add_u32 s4, s4, 1
    v_mfma_f32_16x16x32_bf16 v[96:99], v[128:131], a[0:3], 0
    buffer_load_dwordx4 v157, s[40:43], s60 offen offset:2048  lds
    v_mfma_f32_16x16x32_bf16 v[96:99], v[132:135], a[16:19], v[96:99]
    ds_read_b64_tr_b16 v[140:141], v5 offset:49152
    s_and_b32 s73, s4, 3
    v_mfma_f32_16x16x32_bf16 v[96:99], v[136:139], a[32:35], v[96:99]
    ds_read_b64_tr_b16 v[142:143], v5 offset:51200
    s_lshl_b32 s73, s73, 8
    v_mfma_f32_16x16x32_bf16 v[100:103], v[136:139], a[36:39], 0
    ds_read_b64_tr_b16 v[144:145], v5 offset:53248
    s_bfe_u32 s5, s4, 0x10002
    v_mfma_f32_16x16x32_bf16 v[100:103], v[132:135], a[20:23], v[100:103]
    ds_read_b64_tr_b16 v[146:147], v5 offset:55296
    s_lshl_b32 s5, s5, 11
    v_mfma_f32_16x16x32_bf16 v[100:103], v[128:131], a[4:7], v[100:103]
    buffer_store_dwordx4 v[64:67], v27, s[44:47], s94 offen offset:0 sc1
    v_mfma_f32_16x16x32_bf16 v[104:107], v[128:131], a[8:11], 0
    ds_read_b64_tr_b16 v[148:149], v5 offset:57344
    v_cvt_pk_bf16_f32 v72, v72, v73
    v_mfma_f32_16x16x32_bf16 v[104:107], v[132:135], a[24:27], v[104:107]
    ds_read_b64_tr_b16 v[150:151], v5 offset:59392
    v_cvt_pk_bf16_f32 v73, v74, v75
    v_mfma_f32_16x16x32_bf16 v[104:107], v[136:139], a[40:43], v[104:107]
    v_cvt_pk_bf16_f32 v74, v76, v77
    s_add_u32 s73, s73, s5
    v_mfma_f32_16x16x32_bf16 v[108:111], v[136:139], a[44:47], 0
    buffer_load_dwordx4 v[232:235], v29, s[44:47], 0 offen offset:1024 sc1
    v_mfma_f32_16x16x32_bf16 v[108:111], v[132:135], a[28:31], v[108:111]
    v_cvt_pk_bf16_f32 v75, v78, v79
    s_bfe_u32 s5, s4, 0x10003
    v_mfma_f32_16x16x32_bf16 v[108:111], v[128:131], a[12:15], v[108:111]
    s_waitcnt lgkmcnt(0)
    s_mov_b32 s60, 384
    v_mfma_f32_16x16x32_bf16 v[112:115], v[140:143], a[0:3], 0
    s_waitcnt vmcnt(16)
    s_barrier
    v_mfma_f32_16x16x32_bf16 v[112:115], v[144:147], a[16:19], v[112:115]
    ds_read_b64_tr_b16 v[128:129], v6 offset:0
    s_add_u32 m0, s59, 98304
    v_mfma_f32_16x16x32_bf16 v[112:115], v[148:151], a[32:35], v[112:115]
    buffer_load_dwordx4 v152, s[40:43], s60 offen offset:0  lds
    v_mfma_f32_16x16x32_bf16 v[116:119], v[148:151], a[36:39], 0
    ds_read_b64_tr_b16 v[130:131], v6 offset:2048
    s_mul_i32 s5, s5, 36864
    v_mfma_f32_16x16x32_bf16 v[116:119], v[144:147], a[20:23], v[116:119]
    ds_read_b64_tr_b16 v[132:133], v6 offset:4096
    s_add_u32 s73, s73, s5
    v_mfma_f32_16x16x32_bf16 v[116:119], v[140:143], a[4:7], v[116:119]
    ds_read_b64_tr_b16 v[134:135], v6 offset:6144
    s_lshr_b32 s5, s4, 4
    v_mfma_f32_16x16x32_bf16 v[120:123], v[140:143], a[8:11], 0
    ds_read_b64_tr_b16 v[136:137], v6 offset:8192
    s_lshl_b32 s5, s5, 12
    v_mfma_f32_16x16x32_bf16 v[120:123], v[144:147], a[24:27], v[120:123]
    buffer_load_dwordx4 v153, s[40:43], s60 offen offset:1024  lds
    v_mfma_f32_16x16x32_bf16 v[120:123], v[148:151], a[40:43], v[120:123]
    ds_read_b64_tr_b16 v[138:139], v6 offset:10240
    s_add_u32 s73, s73, s5
    v_mfma_f32_16x16x32_bf16 v[124:127], v[148:151], a[44:47], 0
    s_mul_i32 s4, s54, 9
    s_add_u32 s4, s4, 2
    v_mfma_f32_16x16x32_bf16 v[124:127], v[144:147], a[28:31], v[124:127]
    s_and_b32 s74, s4, 3
    s_lshl_b32 s74, s74, 8
    v_mfma_f32_16x16x32_bf16 v[124:127], v[140:143], a[12:15], v[124:127]
    s_waitcnt lgkmcnt(0)
    s_bfe_u32 s5, s4, 0x10002
    v_mfma_f32_16x16x32_bf16 v[96:99], v[128:131], a[48:51], v[96:99]
    buffer_load_dwordx4 v154, s[40:43], s60 offen offset:2048  lds
    v_mfma_f32_16x16x32_bf16 v[96:99], v[132:135], a[64:67], v[96:99]
    ds_read_b64_tr_b16 v[140:141], v7 offset:0
    s_lshl_b32 s5, s5, 11
    v_mfma_f32_16x16x32_bf16 v[96:99], v[136:139], a[80:83], v[96:99]
    ds_read_b64_tr_b16 v[142:143], v7 offset:2048
    s_add_u32 s74, s74, s5
    v_mfma_f32_16x16x32_bf16 v[100:103], v[136:139], a[84:87], v[100:103]
    ds_read_b64_tr_b16 v[144:145], v7 offset:4096
    s_bfe_u32 s5, s4, 0x10003
    v_mfma_f32_16x16x32_bf16 v[100:103], v[132:135], a[68:71], v[100:103]
    ds_read_b64_tr_b16 v[146:147], v7 offset:6144
    s_mul_i32 s5, s5, 36864
    v_mfma_f32_16x16x32_bf16 v[100:103], v[128:131], a[52:55], v[100:103]
    buffer_store_dwordx4 v[72:75], v27, s[44:47], s94 offen offset:1024 sc1
    v_mfma_f32_16x16x32_bf16 v[104:107], v[128:131], a[56:59], v[104:107]
    ds_read_b64_tr_b16 v[148:149], v7 offset:8192
    v_cvt_pk_bf16_f32 v80, v80, v81
    v_mfma_f32_16x16x32_bf16 v[104:107], v[132:135], a[72:75], v[104:107]
    ds_read_b64_tr_b16 v[150:151], v7 offset:10240
    v_cvt_pk_bf16_f32 v81, v82, v83
    v_mfma_f32_16x16x32_bf16 v[104:107], v[136:139], a[88:91], v[104:107]
    v_cvt_pk_bf16_f32 v82, v84, v85
    s_add_u32 s74, s74, s5
    v_mfma_f32_16x16x32_bf16 v[108:111], v[136:139], a[92:95], v[108:111]
    buffer_load_dwordx4 v[236:239], v29, s[44:47], 0 offen offset:1536 sc1
    v_mfma_f32_16x16x32_bf16 v[108:111], v[132:135], a[76:79], v[108:111]
    v_cvt_pk_bf16_f32 v83, v86, v87
    s_mov_b32 s69, 0
    v_mfma_f32_16x16x32_bf16 v[108:111], v[128:131], a[60:63], v[108:111]
    s_waitcnt lgkmcnt(0)
    s_mov_b32 s60, 110976
    v_mfma_f32_16x16x32_bf16 v[112:115], v[140:143], a[48:51], v[112:115]
    s_waitcnt vmcnt(18)
    s_barrier
    v_mfma_f32_16x16x32_bf16 v[112:115], v[144:147], a[64:67], v[112:115]
    ds_read_b64_tr_b16 v[128:129], v6 offset:12288
    s_add_u32 m0, s59, 110592
    v_mfma_f32_16x16x32_bf16 v[112:115], v[148:151], a[80:83], v[112:115]
    buffer_load_dwordx4 v152, s[40:43], s60 offen offset:0  lds
    v_mfma_f32_16x16x32_bf16 v[116:119], v[148:151], a[84:87], v[116:119]
    ds_read_b64_tr_b16 v[130:131], v6 offset:14336
    s_lshr_b32 s5, s4, 4
    v_mfma_f32_16x16x32_bf16 v[116:119], v[144:147], a[68:71], v[116:119]
    ds_read_b64_tr_b16 v[132:133], v6 offset:16384
    s_lshl_b32 s5, s5, 12
    v_mfma_f32_16x16x32_bf16 v[116:119], v[140:143], a[52:55], v[116:119]
    ds_read_b64_tr_b16 v[134:135], v6 offset:18432
    s_add_u32 s74, s74, s5
    v_mfma_f32_16x16x32_bf16 v[120:123], v[140:143], a[56:59], v[120:123]
    ds_read_b64_tr_b16 v[136:137], v6 offset:20480
    s_mul_i32 s4, s54, 9
    v_mfma_f32_16x16x32_bf16 v[120:123], v[144:147], a[72:75], v[120:123]
    buffer_load_dwordx4 v153, s[40:43], s60 offen offset:1024  lds
    v_mfma_f32_16x16x32_bf16 v[120:123], v[148:151], a[88:91], v[120:123]
    ds_read_b64_tr_b16 v[138:139], v6 offset:22528
    s_add_u32 s4, s4, 3
    v_mfma_f32_16x16x32_bf16 v[124:127], v[148:151], a[92:95], v[124:127]
    s_and_b32 s75, s4, 3
    s_lshl_b32 s75, s75, 8
    v_mfma_f32_16x16x32_bf16 v[124:127], v[144:147], a[76:79], v[124:127]
    s_bfe_u32 s5, s4, 0x10002
    s_lshl_b32 s5, s5, 11
    v_mfma_f32_16x16x32_bf16 v[124:127], v[140:143], a[60:63], v[124:127]
    s_waitcnt lgkmcnt(0)
    s_add_u32 s75, s75, s5
    v_mfma_f32_16x16x32_bf16 v[96:99], v[128:131], a[96:99], v[96:99]
    buffer_load_dwordx4 v154, s[40:43], s60 offen offset:2048  lds
    v_mfma_f32_16x16x32_bf16 v[96:99], v[132:135], a[112:115], v[96:99]
    ds_read_b64_tr_b16 v[140:141], v7 offset:12288
    s_bfe_u32 s5, s4, 0x10003
    v_mfma_f32_16x16x32_bf16 v[96:99], v[136:139], a[128:131], v[96:99]
    ds_read_b64_tr_b16 v[142:143], v7 offset:14336
    s_mul_i32 s5, s5, 36864
    v_mfma_f32_16x16x32_bf16 v[100:103], v[136:139], a[132:135], v[100:103]
    ds_read_b64_tr_b16 v[144:145], v7 offset:16384
    s_add_u32 s75, s75, s5
    v_mfma_f32_16x16x32_bf16 v[100:103], v[132:135], a[116:119], v[100:103]
    ds_read_b64_tr_b16 v[146:147], v7 offset:18432
    s_lshr_b32 s5, s4, 4
    v_mfma_f32_16x16x32_bf16 v[100:103], v[128:131], a[100:103], v[100:103]
    buffer_store_dwordx4 v[80:83], v27, s[44:47], s94 offen offset:2048 sc1
    v_mfma_f32_16x16x32_bf16 v[104:107], v[128:131], a[104:107], v[104:107]
    ds_read_b64_tr_b16 v[148:149], v7 offset:20480
    v_cvt_pk_bf16_f32 v88, v88, v89
    v_mfma_f32_16x16x32_bf16 v[104:107], v[132:135], a[120:123], v[104:107]
    ds_read_b64_tr_b16 v[150:151], v7 offset:22528
    v_cvt_pk_bf16_f32 v89, v90, v91
    v_mfma_f32_16x16x32_bf16 v[104:107], v[136:139], a[136:139], v[104:107]
    v_cvt_pk_bf16_f32 v90, v92, v93
    s_lshl_b32 s5, s5, 12
    v_mfma_f32_16x16x32_bf16 v[108:111], v[136:139], a[140:143], v[108:111]
    buffer_load_dwordx4 a[144:147], v30, s[44:47], s69 offen offset:0 sc1
    v_mfma_f32_16x16x32_bf16 v[108:111], v[132:135], a[124:127], v[108:111]
    v_cvt_pk_bf16_f32 v91, v94, v95
    s_add_u32 s75, s75, s5
    v_mfma_f32_16x16x32_bf16 v[108:111], v[128:131], a[108:111], v[108:111]
    s_waitcnt lgkmcnt(0)
    s_mov_b32 s60, 384
    v_mfma_f32_16x16x32_bf16 v[112:115], v[140:143], a[96:99], v[112:115]
    s_waitcnt vmcnt(20)
    s_barrier
    v_mfma_f32_16x16x32_bf16 v[112:115], v[144:147], a[112:115], v[112:115]
    ds_read_b64_tr_b16 v[128:129], v6 offset:36864
    s_add_u32 m0, s59, 122880
    v_mfma_f32_16x16x32_bf16 v[112:115], v[148:151], a[128:131], v[112:115]
    buffer_load_dwordx4 v155, s[40:43], s60 offen offset:0  lds
    v_mfma_f32_16x16x32_bf16 v[116:119], v[148:151], a[132:135], v[116:119]
    ds_read_b64_tr_b16 v[130:131], v6 offset:38912
    v_cvt_pk_bf16_f32 v96, v96, v97
    v_mfma_f32_16x16x32_bf16 v[116:119], v[144:147], a[116:119], v[116:119]
    ds_read_b64_tr_b16 v[132:133], v6 offset:40960
    v_cvt_pk_bf16_f32 v97, v98, v99
    v_mfma_f32_16x16x32_bf16 v[116:119], v[140:143], a[100:103], v[116:119]
    ds_read_b64_tr_b16 v[134:135], v6 offset:43008
    v_cvt_pk_bf16_f32 v98, v100, v101
    v_mfma_f32_16x16x32_bf16 v[120:123], v[140:143], a[104:107], v[120:123]
    ds_read_b64_tr_b16 v[136:137], v6 offset:45056
    v_cvt_pk_bf16_f32 v99, v102, v103
    v_mfma_f32_16x16x32_bf16 v[120:123], v[144:147], a[120:123], v[120:123]
    buffer_load_dwordx4 v156, s[40:43], s60 offen offset:1024  lds
    v_mfma_f32_16x16x32_bf16 v[120:123], v[148:151], a[136:139], v[120:123]
    ds_read_b64_tr_b16 v[138:139], v6 offset:47104
    s_mov_b32 s95, 4096
    v_mfma_f32_16x16x32_bf16 v[124:127], v[148:151], a[140:143], v[124:127]
    s_mul_i32 s4, s54, 9
    s_add_u32 s4, s4, 4
    v_mfma_f32_16x16x32_bf16 v[124:127], v[144:147], a[124:127], v[124:127]
    s_and_b32 s76, s4, 3
    s_lshl_b32 s76, s76, 8
    v_mfma_f32_16x16x32_bf16 v[124:127], v[140:143], a[108:111], v[124:127]
    s_waitcnt lgkmcnt(0)
    s_bfe_u32 s5, s4, 0x10002
    v_mfma_f32_16x16x32_bf16 v[64:67], v[128:131], a[0:3], 0
    buffer_load_dwordx4 v157, s[40:43], s60 offen offset:2048  lds
    v_mfma_f32_16x16x32_bf16 v[64:67], v[132:135], a[16:19], v[64:67]
    ds_read_b64_tr_b16 v[140:141], v7 offset:36864
    s_lshl_b32 s5, s5, 11
    v_mfma_f32_16x16x32_bf16 v[64:67], v[136:139], a[32:35], v[64:67]
    ds_read_b64_tr_b16 v[142:143], v7 offset:38912
    s_add_u32 s76, s76, s5
    v_mfma_f32_16x16x32_bf16 v[68:71], v[136:139], a[36:39], 0
    ds_read_b64_tr_b16 v[144:145], v7 offset:40960
    s_bfe_u32 s5, s4, 0x10003
    v_mfma_f32_16x16x32_bf16 v[68:71], v[132:135], a[20:23], v[68:71]
    ds_read_b64_tr_b16 v[146:147], v7 offset:43008
    s_mul_i32 s5, s5, 36864
    v_mfma_f32_16x16x32_bf16 v[68:71], v[128:131], a[4:7], v[68:71]
    buffer_store_dwordx4 v[88:91], v27, s[44:47], s94 offen offset:3072 sc1
    v_mfma_f32_16x16x32_bf16 v[72:75], v[128:131], a[8:11], 0
    ds_read_b64_tr_b16 v[148:149], v7 offset:45056
    s_add_u32 s76, s76, s5
    v_mfma_f32_16x16x32_bf16 v[72:75], v[132:135], a[24:27], v[72:75]
    ds_read_b64_tr_b16 v[150:151], v7 offset:47104
    s_lshr_b32 s5, s4, 4
    v_mfma_f32_16x16x32_bf16 v[72:75], v[136:139], a[40:43], v[72:75]
    s_lshl_b32 s5, s5, 12
    s_add_u32 s76, s76, s5
    v_mfma_f32_16x16x32_bf16 v[76:79], v[136:139], a[44:47], 0
    buffer_store_dwordx4 v[96:99], v27, s[44:47], s95 offen offset:0 sc1
    v_mfma_f32_16x16x32_bf16 v[76:79], v[132:135], a[28:31], v[76:79]
    v_cvt_pk_bf16_f32 v104, v104, v105
    s_mul_i32 s4, s54, 9
    v_mfma_f32_16x16x32_bf16 v[76:79], v[128:131], a[12:15], v[76:79]
    s_waitcnt lgkmcnt(0)
    s_mov_b32 s60, 512
    v_mfma_f32_16x16x32_bf16 v[80:83], v[140:143], a[0:3], 0
    s_waitcnt vmcnt(22)
    s_barrier
    v_mfma_f32_16x16x32_bf16 v[80:83], v[144:147], a[16:19], v[80:83]
    ds_read_b64_tr_b16 v[128:129], v4 offset:24576
    s_add_u32 m0, s59, 147456
    v_mfma_f32_16x16x32_bf16 v[80:83], v[148:151], a[32:35], v[80:83]
    buffer_load_dwordx4 v152, s[40:43], s60 offen offset:0  lds
    v_mfma_f32_16x16x32_bf16 v[84:87], v[148:151], a[36:39], 0
    ds_read_b64_tr_b16 v[130:131], v4 offset:26624
    v_cvt_pk_bf16_f32 v105, v106, v107
    v_mfma_f32_16x16x32_bf16 v[84:87], v[144:147], a[20:23], v[84:87]
    ds_read_b64_tr_b16 v[132:133], v4 offset:28672
    v_cvt_pk_bf16_f32 v106, v108, v109
    v_mfma_f32_16x16x32_bf16 v[84:87], v[140:143], a[4:7], v[84:87]
    ds_read_b64_tr_b16 v[134:135], v4 offset:30720
    v_cvt_pk_bf16_f32 v107, v110, v111
    v_mfma_f32_16x16x32_bf16 v[88:91], v[140:143], a[8:11], 0
    ds_read_b64_tr_b16 v[136:137], v4 offset:32768
    s_add_u32 s4, s4, 5
    v_mfma_f32_16x16x32_bf16 v[88:91], v[144:147], a[24:27], v[88:91]
    buffer_load_dwordx4 v153, s[40:43], s60 offen offset:1024  lds
    v_mfma_f32_16x16x32_bf16 v[88:91], v[148:151], a[40:43], v[88:91]
    ds_read_b64_tr_b16 v[138:139], v4 offset:34816
    s_and_b32 s77, s4, 3
    v_mfma_f32_16x16x32_bf16 v[92:95], v[148:151], a[44:47], 0
    s_lshl_b32 s77, s77, 8
    s_bfe_u32 s5, s4, 0x10002
    v_mfma_f32_16x16x32_bf16 v[92:95], v[144:147], a[28:31], v[92:95]
    s_lshl_b32 s5, s5, 11
    s_add_u32 s77, s77, s5
    v_mfma_f32_16x16x32_bf16 v[92:95], v[140:143], a[12:15], v[92:95]
    s_waitcnt lgkmcnt(0)
    s_bfe_u32 s5, s4, 0x10003
    v_mfma_f32_16x16x32_bf16 v[64:67], v[128:131], a[48:51], v[64:67]
    buffer_load_dwordx4 v154, s[40:43], s60 offen offset:2048  lds
    v_mfma_f32_16x16x32_bf16 v[64:67], v[132:135], a[64:67], v[64:67]
    ds_read_b64_tr_b16 v[140:141], v5 offset:24576
    s_mul_i32 s5, s5, 36864
    v_mfma_f32_16x16x32_bf16 v[64:67], v[136:139], a[80:83], v[64:67]
    ds_read_b64_tr_b16 v[142:143], v5 offset:26624
    s_add_u32 s77, s77, s5
    v_mfma_f32_16x16x32_bf16 v[68:71], v[136:139], a[84:87], v[68:71]
    ds_read_b64_tr_b16 v[144:145], v5 offset:28672
    s_lshr_b32 s5, s4, 4
    v_mfma_f32_16x16x32_bf16 v[68:71], v[132:135], a[68:71], v[68:71]
    ds_read_b64_tr_b16 v[146:147], v5 offset:30720
    s_lshl_b32 s5, s5, 12
    v_mfma_f32_16x16x32_bf16 v[68:71], v[128:131], a[52:55], v[68:71]
    buffer_store_dwordx4 v[104:107], v27, s[44:47], s95 offen offset:1024 sc1
    v_mfma_f32_16x16x32_bf16 v[72:75], v[128:131], a[56:59], v[72:75]
    ds_read_b64_tr_b16 v[148:149], v5 offset:32768
    v_cvt_pk_bf16_f32 v112, v112, v113
    v_mfma_f32_16x16x32_bf16 v[72:75], v[132:135], a[72:75], v[72:75]
    ds_read_b64_tr_b16 v[150:151], v5 offset:34816
    v_cvt_pk_bf16_f32 v113, v114, v115
    v_mfma_f32_16x16x32_bf16 v[72:75], v[136:139], a[88:91], v[72:75]
    v_cvt_pk_bf16_f32 v114, v116, v117
    s_add_u32 s77, s77, s5
    v_mfma_f32_16x16x32_bf16 v[76:79], v[136:139], a[92:95], v[76:79]
    buffer_load_dwordx4 a[148:151], v30, s[44:47], s69 offen offset:640 sc1
    v_mfma_f32_16x16x32_bf16 v[76:79], v[132:135], a[76:79], v[76:79]
    v_cvt_pk_bf16_f32 v115, v118, v119
    s_mul_i32 s4, s54, 9
    v_mfma_f32_16x16x32_bf16 v[76:79], v[128:131], a[60:63], v[76:79]
    s_waitcnt lgkmcnt(0)
    s_mov_b32 s60, 111104
    v_mfma_f32_16x16x32_bf16 v[80:83], v[140:143], a[48:51], v[80:83]
    s_waitcnt vmcnt(22)
    s_barrier
    v_mfma_f32_16x16x32_bf16 v[80:83], v[144:147], a[64:67], v[80:83]
    ds_read_b64_tr_b16 v[128:129], v4 offset:36864
    s_add_u32 m0, s59, 73728
    v_mfma_f32_16x16x32_bf16 v[80:83], v[148:151], a[80:83], v[80:83]
    buffer_load_dwordx4 v152, s[40:43], s60 offen offset:0  lds
    v_mfma_f32_16x16x32_bf16 v[84:87], v[148:151], a[84:87], v[84:87]
    ds_read_b64_tr_b16 v[130:131], v4 offset:38912
    s_add_u32 s4, s4, 6
    v_mfma_f32_16x16x32_bf16 v[84:87], v[144:147], a[68:71], v[84:87]
    ds_read_b64_tr_b16 v[132:133], v4 offset:40960
    s_and_b32 s78, s4, 3
    v_mfma_f32_16x16x32_bf16 v[84:87], v[140:143], a[52:55], v[84:87]
    ds_read_b64_tr_b16 v[134:135], v4 offset:43008
    s_lshl_b32 s78, s78, 8
    v_mfma_f32_16x16x32_bf16 v[88:91], v[140:143], a[56:59], v[88:91]
    ds_read_b64_tr_b16 v[136:137], v4 offset:45056
    s_bfe_u32 s5, s4, 0x10002
    v_mfma_f32_16x16x32_bf16 v[88:91], v[144:147], a[72:75], v[88:91]
    buffer_load_dwordx4 v153, s[40:43], s60 offen offset:1024  lds
    v_mfma_f32_16x16x32_bf16 v[88:91], v[148:151], a[88:91], v[88:91]
    ds_read_b64_tr_b16 v[138:139], v4 offset:47104
    s_lshl_b32 s5, s5, 11
    v_mfma_f32_16x16x32_bf16 v[92:95], v[148:151], a[92:95], v[92:95]
    s_add_u32 s78, s78, s5
    s_bfe_u32 s5, s4, 0x10003
    v_mfma_f32_16x16x32_bf16 v[92:95], v[144:147], a[76:79], v[92:95]
    s_mul_i32 s5, s5, 36864
    s_add_u32 s78, s78, s5
    v_mfma_f32_16x16x32_bf16 v[92:95], v[140:143], a[60:63], v[92:95]
    s_waitcnt lgkmcnt(0)
    s_lshr_b32 s5, s4, 4
    v_mfma_f32_16x16x32_bf16 v[64:67], v[128:131], a[96:99], v[64:67]
    buffer_load_dwordx4 v154, s[40:43], s60 offen offset:2048  lds
    v_mfma_f32_16x16x32_bf16 v[64:67], v[132:135], a[112:115], v[64:67]
    ds_read_b64_tr_b16 v[140:141], v5 offset:36864
    s_lshl_b32 s5, s5, 12
    v_mfma_f32_16x16x32_bf16 v[64:67], v[136:139], a[128:131], v[64:67]
    ds_read_b64_tr_b16 v[142:143], v5 offset:38912
    s_add_u32 s78, s78, s5
    v_mfma_f32_16x16x32_bf16 v[68:71], v[136:139], a[132:135], v[68:71]
    ds_read_b64_tr_b16 v[144:145], v5 offset:40960
    s_mul_i32 s4, s54, 9
    v_mfma_f32_16x16x32_bf16 v[68:71], v[132:135], a[116:119], v[68:71]
    ds_read_b64_tr_b16 v[146:147], v5 offset:43008
    s_add_u32 s4, s4, 7
    v_mfma_f32_16x16x32_bf16 v[68:71], v[128:131], a[100:103], v[68:71]
    buffer_store_dwordx4 v[112:115], v27, s[44:47], s95 offen offset:2048 sc1
    v_mfma_f32_16x16x32_bf16 v[72:75], v[128:131], a[104:107], v[72:75]
    ds_read_b64_tr_b16 v[148:149], v5 offset:45056
    v_cvt_pk_bf16_f32 v120, v120, v121
    v_mfma_f32_16x16x32_bf16 v[72:75], v[132:135], a[120:123], v[72:75]
    ds_read_b64_tr_b16 v[150:151], v5 offset:47104
    v_cvt_pk_bf16_f32 v121, v122, v123
    v_mfma_f32_16x16x32_bf16 v[72:75], v[136:139], a[136:139], v[72:75]
    v_cvt_pk_bf16_f32 v122, v124, v125
    s_and_b32 s79, s4, 3
    v_mfma_f32_16x16x32_bf16 v[76:79], v[136:139], a[140:143], v[76:79]
    buffer_load_dwordx4 a[152:155], v30, s[44:47], s69 offen offset:1280 sc1
    v_mfma_f32_16x16x32_bf16 v[76:79], v[132:135], a[124:127], v[76:79]
    v_cvt_pk_bf16_f32 v123, v126, v127
    s_lshl_b32 s79, s79, 8
    v_mfma_f32_16x16x32_bf16 v[76:79], v[128:131], a[108:111], v[76:79]
    s_waitcnt lgkmcnt(0)
    s_mov_b32 s60, 512
    v_mfma_f32_16x16x32_bf16 v[80:83], v[140:143], a[96:99], v[80:83]
    s_waitcnt vmcnt(22)
    s_barrier
    v_mfma_f32_16x16x32_bf16 v[80:83], v[144:147], a[112:115], v[80:83]
    ds_read_b64_tr_b16 v[128:129], v4 offset:49152
    s_add_u32 m0, s59, 86016
    v_mfma_f32_16x16x32_bf16 v[80:83], v[148:151], a[128:131], v[80:83]
    buffer_load_dwordx4 v155, s[40:43], s60 offen offset:0  lds
    v_mfma_f32_16x16x32_bf16 v[84:87], v[148:151], a[132:135], v[84:87]
    ds_read_b64_tr_b16 v[130:131], v4 offset:51200
    v_cvt_pk_bf16_f32 v64, v64, v65
    v_mfma_f32_16x16x32_bf16 v[84:87], v[144:147], a[116:119], v[84:87]
    ds_read_b64_tr_b16 v[132:133], v4 offset:53248
    v_cvt_pk_bf16_f32 v65, v66, v67
    v_mfma_f32_16x16x32_bf16 v[84:87], v[140:143], a[100:103], v[84:87]
    ds_read_b64_tr_b16 v[134:135], v4 offset:55296
    v_cvt_pk_bf16_f32 v66, v68, v69
    v_mfma_f32_16x16x32_bf16 v[88:91], v[140:143], a[104:107], v[88:91]
    ds_read_b64_tr_b16 v[136:137], v4 offset:57344
    v_cvt_pk_bf16_f32 v67, v70, v71
    v_mfma_f32_16x16x32_bf16 v[88:91], v[144:147], a[120:123], v[88:91]
    buffer_load_dwordx4 v156, s[40:43], s60 offen offset:1024  lds
    v_mfma_f32_16x16x32_bf16 v[88:91], v[148:151], a[136:139], v[88:91]
    ds_read_b64_tr_b16 v[138:139], v4 offset:59392
    s_mov_b32 s94, 8192
    v_mfma_f32_16x16x32_bf16 v[92:95], v[148:151], a[140:143], v[92:95]
    s_bfe_u32 s5, s4, 0x10002
    s_lshl_b32 s5, s5, 11
    v_mfma_f32_16x16x32_bf16 v[92:95], v[144:147], a[124:127], v[92:95]
    s_add_u32 s79, s79, s5
    s_bfe_u32 s5, s4, 0x10003
    v_mfma_f32_16x16x32_bf16 v[92:95], v[140:143], a[108:111], v[92:95]
    s_waitcnt lgkmcnt(0)
    s_mul_i32 s5, s5, 36864
    v_mfma_f32_16x16x32_bf16 v[96:99], v[128:131], a[0:3], 0
    buffer_load_dwordx4 v157, s[40:43], s60 offen offset:2048  lds
    v_mfma_f32_16x16x32_bf16 v[96:99], v[132:135], a[16:19], v[96:99]
    ds_read_b64_tr_b16 v[140:141], v5 offset:49152
    s_add_u32 s79, s79, s5
    v_mfma_f32_16x16x32_bf16 v[96:99], v[136:139], a[32:35], v[96:99]
    ds_read_b64_tr_b16 v[142:143], v5 offset:51200
    s_lshr_b32 s5, s4, 4
    v_mfma_f32_16x16x32_bf16 v[100:103], v[136:139], a[36:39], 0
    ds_read_b64_tr_b16 v[144:145], v5 offset:53248
    s_lshl_b32 s5, s5, 12
    v_mfma_f32_16x16x32_bf16 v[100:103], v[132:135], a[20:23], v[100:103]
    ds_read_b64_tr_b16 v[146:147], v5 offset:55296
    s_add_u32 s79, s79, s5
    v_mfma_f32_16x16x32_bf16 v[100:103], v[128:131], a[4:7], v[100:103]
    buffer_store_dwordx4 v[120:123], v27, s[44:47], s95 offen offset:3072 sc1
    v_mfma_f32_16x16x32_bf16 v[104:107], v[128:131], a[8:11], 0
    ds_read_b64_tr_b16 v[148:149], v5 offset:57344
    s_mul_i32 s4, s54, 9
    v_mfma_f32_16x16x32_bf16 v[104:107], v[132:135], a[24:27], v[104:107]
    ds_read_b64_tr_b16 v[150:151], v5 offset:59392
    s_add_u32 s4, s4, 8
    v_mfma_f32_16x16x32_bf16 v[104:107], v[136:139], a[40:43], v[104:107]
    s_and_b32 s80, s4, 3
    s_lshl_b32 s80, s80, 8
    v_mfma_f32_16x16x32_bf16 v[108:111], v[136:139], a[44:47], 0
    buffer_store_dwordx4 v[64:67], v27, s[44:47], s94 offen offset:0 sc1
    v_mfma_f32_16x16x32_bf16 v[108:111], v[132:135], a[28:31], v[108:111]
    v_cvt_pk_bf16_f32 v72, v72, v73
    s_bfe_u32 s5, s4, 0x10002
    v_mfma_f32_16x16x32_bf16 v[108:111], v[128:131], a[12:15], v[108:111]
    s_waitcnt lgkmcnt(0)
    s_mov_b32 s60, 640
    v_mfma_f32_16x16x32_bf16 v[112:115], v[140:143], a[0:3], 0
    s_waitcnt vmcnt(22)
    s_barrier
    v_mfma_f32_16x16x32_bf16 v[112:115], v[144:147], a[16:19], v[112:115]
    ds_read_b64_tr_b16 v[128:129], v6 offset:0
    s_add_u32 m0, s59, 98304
    v_mfma_f32_16x16x32_bf16 v[112:115], v[148:151], a[32:35], v[112:115]
    buffer_load_dwordx4 v152, s[40:43], s60 offen offset:0  lds
    v_mfma_f32_16x16x32_bf16 v[116:119], v[148:151], a[36:39], 0
    ds_read_b64_tr_b16 v[130:131], v6 offset:2048
    v_cvt_pk_bf16_f32 v73, v74, v75
    v_mfma_f32_16x16x32_bf16 v[116:119], v[144:147], a[20:23], v[116:119]
    ds_read_b64_tr_b16 v[132:133], v6 offset:4096
    v_cvt_pk_bf16_f32 v74, v76, v77
    v_mfma_f32_16x16x32_bf16 v[116:119], v[140:143], a[4:7], v[116:119]
    ds_read_b64_tr_b16 v[134:135], v6 offset:6144
    v_cvt_pk_bf16_f32 v75, v78, v79
    v_mfma_f32_16x16x32_bf16 v[120:123], v[140:143], a[8:11], 0
    ds_read_b64_tr_b16 v[136:137], v6 offset:8192
    s_lshl_b32 s5, s5, 11
    v_mfma_f32_16x16x32_bf16 v[120:123], v[144:147], a[24:27], v[120:123]
    buffer_load_dwordx4 v153, s[40:43], s60 offen offset:1024  lds
    v_mfma_f32_16x16x32_bf16 v[120:123], v[148:151], a[40:43], v[120:123]
    ds_read_b64_tr_b16 v[138:139], v6 offset:10240
    s_add_u32 s80, s80, s5
    v_mfma_f32_16x16x32_bf16 v[124:127], v[148:151], a[44:47], 0
    s_bfe_u32 s5, s4, 0x10003
    s_mul_i32 s5, s5, 36864
    v_mfma_f32_16x16x32_bf16 v[124:127], v[144:147], a[28:31], v[124:127]
    s_add_u32 s80, s80, s5
    s_lshr_b32 s5, s4, 4
    v_mfma_f32_16x16x32_bf16 v[124:127], v[140:143], a[12:15], v[124:127]
    s_waitcnt lgkmcnt(0)
    s_lshl_b32 s5, s5, 12
    v_mfma_f32_16x16x32_bf16 v[96:99], v[128:131], a[48:51], v[96:99]
    buffer_load_dwordx4 v154, s[40:43], s60 offen offset:2048  lds
    v_mfma_f32_16x16x32_bf16 v[96:99], v[132:135], a[64:67], v[96:99]
    ds_read_b64_tr_b16 v[140:141], v7 offset:0
    s_add_u32 s80, s80, s5
    v_mfma_f32_16x16x32_bf16 v[96:99], v[136:139], a[80:83], v[96:99]
    ds_read_b64_tr_b16 v[142:143], v7 offset:2048
    s_lshr_b32 s61, s54, 3
    v_mfma_f32_16x16x32_bf16 v[100:103], v[136:139], a[84:87], v[100:103]
    ds_read_b64_tr_b16 v[144:145], v7 offset:4096
    s_mul_i32 s61, s61, 9
    v_mfma_f32_16x16x32_bf16 v[100:103], v[132:135], a[68:71], v[100:103]
    ds_read_b64_tr_b16 v[146:147], v7 offset:6144
    s_add_u32 s4, s52, 0
    v_mfma_f32_16x16x32_bf16 v[100:103], v[128:131], a[52:55], v[100:103]
    buffer_store_dwordx4 v[72:75], v27, s[44:47], s94 offen offset:1024 sc1
    v_mfma_f32_16x16x32_bf16 v[104:107], v[128:131], a[56:59], v[104:107]
    ds_read_b64_tr_b16 v[148:149], v7 offset:8192
    v_cvt_pk_bf16_f32 v80, v80, v81
    v_mfma_f32_16x16x32_bf16 v[104:107], v[132:135], a[72:75], v[104:107]
    ds_read_b64_tr_b16 v[150:151], v7 offset:10240
    v_cvt_pk_bf16_f32 v81, v82, v83
    v_mfma_f32_16x16x32_bf16 v[104:107], v[136:139], a[88:91], v[104:107]
    v_cvt_pk_bf16_f32 v82, v84, v85
    s_mul_i32 s86, s4, 36864
    v_mfma_f32_16x16x32_bf16 v[108:111], v[136:139], a[92:95], v[108:111]
    buffer_load_dwordx4 a[156:159], v30, s[44:47], s69 offen offset:1920 sc1
    v_mfma_f32_16x16x32_bf16 v[108:111], v[132:135], a[76:79], v[108:111]
    v_cvt_pk_bf16_f32 v83, v86, v87
    s_mul_i32 s81, s4, 3072
    v_mfma_f32_16x16x32_bf16 v[108:111], v[128:131], a[60:63], v[108:111]
    s_waitcnt lgkmcnt(0)
    s_mov_b32 s60, 111232
    v_mfma_f32_16x16x32_bf16 v[112:115], v[140:143], a[48:51], v[112:115]
    s_waitcnt vmcnt(22)
    s_barrier
    v_mfma_f32_16x16x32_bf16 v[112:115], v[144:147], a[64:67], v[112:115]
    ds_read_b64_tr_b16 v[128:129], v6 offset:12288
    s_add_u32 m0, s59, 110592
    v_mfma_f32_16x16x32_bf16 v[112:115], v[148:151], a[80:83], v[112:115]
    buffer_load_dwordx4 v152, s[40:43], s60 offen offset:0  lds
    v_mfma_f32_16x16x32_bf16 v[116:119], v[148:151], a[84:87], v[116:119]
    ds_read_b64_tr_b16 v[130:131], v6 offset:14336
    s_add_u32 s81, s81, 0
    v_mfma_f32_16x16x32_bf16 v[116:119], v[144:147], a[68:71], v[116:119]
    ds_read_b64_tr_b16 v[132:133], v6 offset:16384
    s_add_u32 s4, s52, 4
    v_mfma_f32_16x16x32_bf16 v[116:119], v[140:143], a[52:55], v[116:119]
    ds_read_b64_tr_b16 v[134:135], v6 offset:18432
    s_mul_i32 s87, s4, 36864
    v_mfma_f32_16x16x32_bf16 v[120:123], v[140:143], a[56:59], v[120:123]
    ds_read_b64_tr_b16 v[136:137], v6 offset:20480
    s_mul_i32 s82, s4, 3072
    v_mfma_f32_16x16x32_bf16 v[120:123], v[144:147], a[72:75], v[120:123]
    buffer_load_dwordx4 v153, s[40:43], s60 offen offset:1024  lds
    v_mfma_f32_16x16x32_bf16 v[120:123], v[148:151], a[88:91], v[120:123]
    ds_read_b64_tr_b16 v[138:139], v6 offset:22528
    s_add_u32 s82, s82, 0
    v_mfma_f32_16x16x32_bf16 v[124:127], v[148:151], a[92:95], v[124:127]
    s_add_u32 s4, s52, 8
    s_mul_i32 s88, s4, 36864
    v_mfma_f32_16x16x32_bf16 v[124:127], v[144:147], a[76:79], v[124:127]
    s_mul_i32 s83, s4, 3072
    s_add_u32 s83, s83, 0
    v_mfma_f32_16x16x32_bf16 v[124:127], v[140:143], a[60:63], v[124:127]
    s_waitcnt lgkmcnt(0)
    s_add_u32 s4, s52, 12
    v_mfma_f32_16x16x32_bf16 v[96:99], v[128:131], a[96:99], v[96:99]
    buffer_load_dwordx4 v154, s[40:43], s60 offen offset:2048  lds
    v_mfma_f32_16x16x32_bf16 v[96:99], v[132:135], a[112:115], v[96:99]
    ds_read_b64_tr_b16 v[140:141], v7 offset:12288
    s_mul_i32 s89, s4, 36864
    v_mfma_f32_16x16x32_bf16 v[96:99], v[136:139], a[128:131], v[96:99]
    ds_read_b64_tr_b16 v[142:143], v7 offset:14336
    s_mul_i32 s84, s4, 3072
    v_mfma_f32_16x16x32_bf16 v[100:103], v[136:139], a[132:135], v[100:103]
    ds_read_b64_tr_b16 v[144:145], v7 offset:16384
    s_add_u32 s84, s84, 0
    v_mfma_f32_16x16x32_bf16 v[100:103], v[132:135], a[116:119], v[100:103]
    ds_read_b64_tr_b16 v[146:147], v7 offset:18432
    s_add_u32 s4, s52, 16
    v_mfma_f32_16x16x32_bf16 v[100:103], v[128:131], a[100:103], v[100:103]
    buffer_store_dwordx4 v[80:83], v27, s[44:47], s94 offen offset:2048 sc1
    v_mfma_f32_16x16x32_bf16 v[104:107], v[128:131], a[104:107], v[104:107]
    ds_read_b64_tr_b16 v[148:149], v7 offset:20480
    v_cvt_pk_bf16_f32 v88, v88, v89
    v_mfma_f32_16x16x32_bf16 v[104:107], v[132:135], a[120:123], v[104:107]
    ds_read_b64_tr_b16 v[150:151], v7 offset:22528
    v_cvt_pk_bf16_f32 v89, v90, v91
    v_mfma_f32_16x16x32_bf16 v[104:107], v[136:139], a[136:139], v[104:107]
    v_cvt_pk_bf16_f32 v90, v92, v93
    s_sub_u32 s5, s4, 4
    v_mfma_f32_16x16x32_bf16 v[108:111], v[136:139], a[140:143], v[108:111]
    buffer_load_dwordx4 a[160:163], v30, s[44:47], s69 offen offset:2560 sc1
    v_mfma_f32_16x16x32_bf16 v[108:111], v[132:135], a[124:127], v[108:111]
    v_cvt_pk_bf16_f32 v91, v94, v95
    v_add_u32 v13, 0, v1
    v_mfma_f32_16x16x32_bf16 v[108:111], v[128:131], a[108:111], v[108:111]
    s_waitcnt lgkmcnt(0)
    s_mov_b32 s60, 640
    v_mfma_f32_16x16x32_bf16 v[112:115], v[140:143], a[96:99], v[112:115]
    s_waitcnt vmcnt(22)
    s_barrier
    v_mfma_f32_16x16x32_bf16 v[112:115], v[144:147], a[112:115], v[112:115]
    ds_read_b64_tr_b16 v[128:129], v6 offset:36864
    s_add_u32 m0, s59, 122880
    v_mfma_f32_16x16x32_bf16 v[112:115], v[148:151], a[128:131], v[112:115]
    buffer_load_dwordx4 v155, s[40:43], s60 offen offset:0  lds
    v_mfma_f32_16x16x32_bf16 v[116:119], v[148:151], a[132:135], v[116:119]
    ds_read_b64_tr_b16 v[130:131], v6 offset:38912
    v_cvt_pk_bf16_f32 v96, v96, v97
    v_mfma_f32_16x16x32_bf16 v[116:119], v[144:147], a[116:119], v[116:119]
    ds_read_b64_tr_b16 v[132:133], v6 offset:40960
    v_cvt_pk_bf16_f32 v97, v98, v99
    v_mfma_f32_16x16x32_bf16 v[116:119], v[140:143], a[100:103], v[116:119]
    ds_read_b64_tr_b16 v[134:135], v6 offset:43008
    v_cvt_pk_bf16_f32 v98, v100, v101
    v_mfma_f32_16x16x32_bf16 v[120:123], v[140:143], a[104:107], v[120:123]
    ds_read_b64_tr_b16 v[136:137], v6 offset:45056
    v_cvt_pk_bf16_f32 v99, v102, v103
    v_mfma_f32_16x16x32_bf16 v[120:123], v[144:147], a[120:123], v[120:123]
    buffer_load_dwordx4 v156, s[40:43], s60 offen offset:1024  lds
    v_mfma_f32_16x16x32_bf16 v[120:123], v[148:151], a[136:139], v[120:123]
    ds_read_b64_tr_b16 v[138:139], v6 offset:47104
    s_mov_b32 s95, 12288
    v_mfma_f32_16x16x32_bf16 v[124:127], v[148:151], a[140:143], v[124:127]
    s_cmp_lt_u32 s4, 18
    s_cselect_b32 s4, s4, s5
    v_mfma_f32_16x16x32_bf16 v[124:127], v[144:147], a[124:127], v[124:127]
    s_mul_i32 s90, s4, 36864
    s_mul_i32 s85, s4, 3072
    v_mfma_f32_16x16x32_bf16 v[124:127], v[140:143], a[108:111], v[124:127]
    s_waitcnt lgkmcnt(0)
    s_add_u32 s85, s85, 0
    v_mfma_f32_16x16x32_bf16 v[64:67], v[128:131], a[0:3], 0
    buffer_load_dwordx4 v157, s[40:43], s60 offen offset:2048  lds
    v_mfma_f32_16x16x32_bf16 v[64:67], v[132:135], a[16:19], v[64:67]
    ds_read_b64_tr_b16 v[140:141], v7 offset:36864
    v_mul_u32_u24 v14, 171, v13
    v_mfma_f32_16x16x32_bf16 v[64:67], v[136:139], a[32:35], v[64:67]
    ds_read_b64_tr_b16 v[142:143], v7 offset:38912
    v_lshrrev_b32 v14, 10, v14
    v_mfma_f32_16x16x32_bf16 v[68:71], v[136:139], a[36:39], 0
    ds_read_b64_tr_b16 v[144:145], v7 offset:40960
    v_mul_u32_u24 v15, 6, v14
    v_mfma_f32_16x16x32_bf16 v[68:71], v[132:135], a[20:23], v[68:71]
    ds_read_b64_tr_b16 v[146:147], v7 offset:43008
    v_sub_u32 v13, v13, v15
    v_mfma_f32_16x16x32_bf16 v[68:71], v[128:131], a[4:7], v[68:71]
    buffer_store_dwordx4 v[88:91], v27, s[44:47], s94 offen offset:3072 sc1
    v_mfma_f32_16x16x32_bf16 v[72:75], v[128:131], a[8:11], 0
    ds_read_b64_tr_b16 v[148:149], v7 offset:45056
    v_lshrrev_b32 v15, 1, v14
    v_mfma_f32_16x16x32_bf16 v[72:75], v[132:135], a[24:27], v[72:75]
    ds_read_b64_tr_b16 v[150:151], v7 offset:47104
    v_xor_b32 v15, v15, v14
    v_mfma_f32_16x16x32_bf16 v[72:75], v[136:139], a[40:43], v[72:75]
    s_cmp_eq_u32 s4, 17
    s_cselect_b32 s85, 160768, s85
    v_mfma_f32_16x16x32_bf16 v[76:79], v[136:139], a[44:47], 0
    buffer_store_dwordx4 v[96:99], v27, s[44:47], s95 offen offset:0 sc1
    v_mfma_f32_16x16x32_bf16 v[76:79], v[132:135], a[28:31], v[76:79]
    v_cvt_pk_bf16_f32 v104, v104, v105
    s_mov_b32 s32, s12
    v_mfma_f32_16x16x32_bf16 v[76:79], v[128:131], a[12:15], v[76:79]
    s_waitcnt lgkmcnt(0)
    s_mov_b32 s60, 768
    v_mfma_f32_16x16x32_bf16 v[80:83], v[140:143], a[0:3], 0
    s_waitcnt vmcnt(22)
    s_barrier
    v_mfma_f32_16x16x32_bf16 v[80:83], v[144:147], a[16:19], v[80:83]
    ds_read_b64_tr_b16 v[128:129], v4 offset:24576
    s_add_u32 m0, s59, 147456
    v_mfma_f32_16x16x32_bf16 v[80:83], v[148:151], a[32:35], v[80:83]
    buffer_load_dwordx4 v152, s[40:43], s60 offen offset:0  lds
    v_mfma_f32_16x16x32_bf16 v[84:87], v[148:151], a[36:39], 0
    ds_read_b64_tr_b16 v[130:131], v4 offset:26624
    v_cvt_pk_bf16_f32 v105, v106, v107
    v_mfma_f32_16x16x32_bf16 v[84:87], v[144:147], a[20:23], v[84:87]
    ds_read_b64_tr_b16 v[132:133], v4 offset:28672
    v_cvt_pk_bf16_f32 v106, v108, v109
    v_mfma_f32_16x16x32_bf16 v[84:87], v[140:143], a[4:7], v[84:87]
    ds_read_b64_tr_b16 v[134:135], v4 offset:30720
    v_cvt_pk_bf16_f32 v107, v110, v111
    v_mfma_f32_16x16x32_bf16 v[88:91], v[140:143], a[8:11], 0
    ds_read_b64_tr_b16 v[136:137], v4 offset:32768
    s_mov_b32 s33, s13
    v_mfma_f32_16x16x32_bf16 v[88:91], v[144:147], a[24:27], v[88:91]
    buffer_load_dwordx4 v153, s[40:43], s60 offen offset:1024  lds
    v_mfma_f32_16x16x32_bf16 v[88:91], v[148:151], a[40:43], v[88:91]
    ds_read_b64_tr_b16 v[138:139], v4 offset:34816
    s_mov_b32 s34, 663552
    v_mfma_f32_16x16x32_bf16 v[92:95], v[148:151], a[44:47], 0
    s_mov_b32 s35, 0x20000
    s_mov_b32 s36, s22
    v_mfma_f32_16x16x32_bf16 v[92:95], v[144:147], a[28:31], v[92:95]
    s_mov_b32 s37, s23
    s_mov_b32 s38, 2359296
    v_mfma_f32_16x16x32_bf16 v[92:95], v[140:143], a[12:15], v[92:95]
    s_waitcnt lgkmcnt(0)
    s_mov_b32 s39, 0x20000
    v_mfma_f32_16x16x32_bf16 v[64:67], v[128:131], a[48:51], v[64:67]
    buffer_load_dwordx4 v154, s[40:43], s60 offen offset:2048  lds
    v_mfma_f32_16x16x32_bf16 v[64:67], v[132:135], a[64:67], v[64:67]
    ds_read_b64_tr_b16 v[140:141], v5 offset:24576
    v_and_b32 v15, 4, v15
    v_mfma_f32_16x16x32_bf16 v[64:67], v[136:139], a[80:83], v[64:67]
    ds_read_b64_tr_b16 v[142:143], v5 offset:26624
    v_mul_u32_u24 v15, 3, v15
    v_mfma_f32_16x16x32_bf16 v[68:71], v[136:139], a[84:87], v[68:71]
    ds_read_b64_tr_b16 v[144:145], v5 offset:28672
    v_xor_b32 v14, v14, v15
    v_mfma_f32_16x16x32_bf16 v[68:71], v[132:135], a[68:71], v[68:71]
    ds_read_b64_tr_b16 v[146:147], v5 offset:30720
    v_mul_u32_u24 v14, 1152, v14
    v_mfma_f32_16x16x32_bf16 v[68:71], v[128:131], a[52:55], v[68:71]
    buffer_store_dwordx4 v[104:107], v27, s[44:47], s95 offen offset:1024 sc1
    v_mfma_f32_16x16x32_bf16 v[72:75], v[128:131], a[56:59], v[72:75]
    ds_read_b64_tr_b16 v[148:149], v5 offset:32768
    v_cvt_pk_bf16_f32 v112, v112, v113
    v_mfma_f32_16x16x32_bf16 v[72:75], v[132:135], a[72:75], v[72:75]
    ds_read_b64_tr_b16 v[150:151], v5 offset:34816
    v_cvt_pk_bf16_f32 v113, v114, v115
    v_mfma_f32_16x16x32_bf16 v[72:75], v[136:139], a[88:91], v[72:75]
    v_cvt_pk_bf16_f32 v114, v116, v117
    v_lshl_add_u32 v13, v13, 4, v14
    v_mfma_f32_16x16x32_bf16 v[76:79], v[136:139], a[92:95], v[76:79]
    buffer_load_dwordx4 a[164:167], v30, s[44:47], s69 offen offset:3200 sc1
    v_mfma_f32_16x16x32_bf16 v[76:79], v[132:135], a[76:79], v[76:79]
    v_cvt_pk_bf16_f32 v115, v118, v119
    s_mov_b32 s69, 3840
    v_mfma_f32_16x16x32_bf16 v[76:79], v[128:131], a[60:63], v[76:79]
    s_waitcnt lgkmcnt(0)
    s_mov_b32 s60, 111360
    v_mfma_f32_16x16x32_bf16 v[80:83], v[140:143], a[48:51], v[80:83]
    s_waitcnt vmcnt(22)
    s_barrier
    v_mfma_f32_16x16x32_bf16 v[80:83], v[144:147], a[64:67], v[80:83]
    ds_read_b64_tr_b16 v[128:129], v4 offset:36864
    s_add_u32 m0, s59, 73728
    v_mfma_f32_16x16x32_bf16 v[80:83], v[148:151], a[80:83], v[80:83]
    buffer_load_dwordx4 v152, s[40:43], s60 offen offset:0  lds
    v_mfma_f32_16x16x32_bf16 v[84:87], v[148:151], a[84:87], v[84:87]
    ds_read_b64_tr_b16 v[130:131], v4 offset:38912
    s_mul_i32 s62, s54, 72
    v_mfma_f32_16x16x32_bf16 v[84:87], v[144:147], a[68:71], v[84:87]
    ds_read_b64_tr_b16 v[132:133], v4 offset:40960
    s_sub_u32 s62, s62, 0
    v_mfma_f32_16x16x32_bf16 v[84:87], v[140:143], a[52:55], v[84:87]
    ds_read_b64_tr_b16 v[134:135], v4 offset:43008
    v_add_u32 v10, s62, v13
    v_mfma_f32_16x16x32_bf16 v[88:91], v[140:143], a[56:59], v[88:91]
    ds_read_b64_tr_b16 v[136:137], v4 offset:45056
    v_add_u32 v13, 64, v1
    v_mfma_f32_16x16x32_bf16 v[88:91], v[144:147], a[72:75], v[88:91]
    buffer_load_dwordx4 v153, s[40:43], s60 offen offset:1024  lds
    v_mfma_f32_16x16x32_bf16 v[88:91], v[148:151], a[88:91], v[88:91]
    ds_read_b64_tr_b16 v[138:139], v4 offset:47104
    v_mul_u32_u24 v14, 171, v13
    v_mfma_f32_16x16x32_bf16 v[92:95], v[148:151], a[92:95], v[92:95]
    v_lshrrev_b32 v14, 10, v14
    v_mul_u32_u24 v15, 6, v14
    v_mfma_f32_16x16x32_bf16 v[92:95], v[144:147], a[76:79], v[92:95]
    v_sub_u32 v13, v13, v15
    v_lshrrev_b32 v15, 1, v14
    v_mfma_f32_16x16x32_bf16 v[92:95], v[140:143], a[60:63], v[92:95]
    s_waitcnt lgkmcnt(0)
    v_xor_b32 v15, v15, v14
    v_mfma_f32_16x16x32_bf16 v[64:67], v[128:131], a[96:99], v[64:67]
    buffer_load_dwordx4 v154, s[40:43], s60 offen offset:2048  lds
    v_mfma_f32_16x16x32_bf16 v[64:67], v[132:135], a[112:115], v[64:67]
    ds_read_b64_tr_b16 v[140:141], v5 offset:36864
    v_and_b32 v15, 4, v15
    v_mfma_f32_16x16x32_bf16 v[64:67], v[136:139], a[128:131], v[64:67]
    ds_read_b64_tr_b16 v[142:143], v5 offset:38912
    v_mul_u32_u24 v15, 3, v15
    v_mfma_f32_16x16x32_bf16 v[68:71], v[136:139], a[132:135], v[68:71]
    ds_read_b64_tr_b16 v[144:145], v5 offset:40960
    v_xor_b32 v14, v14, v15
    v_mfma_f32_16x16x32_bf16 v[68:71], v[132:135], a[116:119], v[68:71]
    ds_read_b64_tr_b16 v[146:147], v5 offset:43008
    v_mul_u32_u24 v14, 1152, v14
    v_mfma_f32_16x16x32_bf16 v[68:71], v[128:131], a[100:103], v[68:71]
    buffer_store_dwordx4 v[112:115], v27, s[44:47], s95 offen offset:2048 sc1
    v_mfma_f32_16x16x32_bf16 v[72:75], v[128:131], a[104:107], v[72:75]
    ds_read_b64_tr_b16 v[148:149], v5 offset:45056
    v_cvt_pk_bf16_f32 v120, v120, v121
    v_mfma_f32_16x16x32_bf16 v[72:75], v[132:135], a[120:123], v[72:75]
    ds_read_b64_tr_b16 v[150:151], v5 offset:47104
    v_cvt_pk_bf16_f32 v121, v122, v123
    v_mfma_f32_16x16x32_bf16 v[72:75], v[136:139], a[136:139], v[72:75]
    v_cvt_pk_bf16_f32 v122, v124, v125
    v_lshl_add_u32 v13, v13, 4, v14
    v_mfma_f32_16x16x32_bf16 v[76:79], v[136:139], a[140:143], v[76:79]
    buffer_load_dwordx4 a[168:171], v30, s[44:47], s69 offen offset:0 sc1
    v_mfma_f32_16x16x32_bf16 v[76:79], v[132:135], a[124:127], v[76:79]
    v_cvt_pk_bf16_f32 v123, v126, v127
    s_mul_i32 s62, s54, 72
    v_mfma_f32_16x16x32_bf16 v[76:79], v[128:131], a[108:111], v[76:79]
    s_waitcnt lgkmcnt(0)
    s_mov_b32 s60, 768
    v_mfma_f32_16x16x32_bf16 v[80:83], v[140:143], a[96:99], v[80:83]
    s_waitcnt vmcnt(22)
    s_barrier
    v_mfma_f32_16x16x32_bf16 v[80:83], v[144:147], a[112:115], v[80:83]
    ds_read_b64_tr_b16 v[128:129], v4 offset:49152
    s_add_u32 m0, s59, 86016
    v_mfma_f32_16x16x32_bf16 v[80:83], v[148:151], a[128:131], v[80:83]
    buffer_load_dwordx4 v155, s[40:43], s60 offen offset:0  lds
    v_mfma_f32_16x16x32_bf16 v[84:87], v[148:151], a[132:135], v[84:87]
    ds_read_b64_tr_b16 v[130:131], v4 offset:51200
    v_cvt_pk_bf16_f32 v64, v64, v65
    v_mfma_f32_16x16x32_bf16 v[84:87], v[144:147], a[116:119], v[84:87]
    ds_read_b64_tr_b16 v[132:133], v4 offset:53248
    v_cvt_pk_bf16_f32 v65, v66, v67
    v_mfma_f32_16x16x32_bf16 v[84:87], v[140:143], a[100:103], v[84:87]
    ds_read_b64_tr_b16 v[134:135], v4 offset:55296
    v_cvt_pk_bf16_f32 v66, v68, v69
    v_mfma_f32_16x16x32_bf16 v[88:91], v[140:143], a[104:107], v[88:91]
    ds_read_b64_tr_b16 v[136:137], v4 offset:57344
    v_cvt_pk_bf16_f32 v67, v70, v71
    v_mfma_f32_16x16x32_bf16 v[88:91], v[144:147], a[120:123], v[88:91]
    buffer_load_dwordx4 v156, s[40:43], s60 offen offset:1024  lds
    v_mfma_f32_16x16x32_bf16 v[88:91], v[148:151], a[136:139], v[88:91]
    ds_read_b64_tr_b16 v[138:139], v4 offset:59392
    s_mov_b32 s94, 16384
    v_mfma_f32_16x16x32_bf16 v[92:95], v[148:151], a[140:143], v[92:95]
    s_sub_u32 s62, s62, 1024
    v_add_u32 v11, s62, v13
    v_mfma_f32_16x16x32_bf16 v[92:95], v[144:147], a[124:127], v[92:95]
    v_add_u32 v13, 128, v1
    v_mul_u32_u24 v14, 171, v13
    v_mfma_f32_16x16x32_bf16 v[92:95], v[140:143], a[108:111], v[92:95]
    s_waitcnt lgkmcnt(0)
    v_lshrrev_b32 v14, 10, v14
    v_mfma_f32_16x16x32_bf16 v[96:99], v[128:131], a[0:3], 0
    buffer_load_dwordx4 v157, s[40:43], s60 offen offset:2048  lds
    v_mfma_f32_16x16x32_bf16 v[96:99], v[132:135], a[16:19], v[96:99]
    ds_read_b64_tr_b16 v[140:141], v5 offset:49152
    v_mul_u32_u24 v15, 6, v14
    v_mfma_f32_16x16x32_bf16 v[96:99], v[136:139], a[32:35], v[96:99]
    ds_read_b64_tr_b16 v[142:143], v5 offset:51200
    v_sub_u32 v13, v13, v15
    v_mfma_f32_16x16x32_bf16 v[100:103], v[136:139], a[36:39], 0
    ds_read_b64_tr_b16 v[144:145], v5 offset:53248
    v_lshrrev_b32 v15, 1, v14
    v_mfma_f32_16x16x32_bf16 v[100:103], v[132:135], a[20:23], v[100:103]
    ds_read_b64_tr_b16 v[146:147], v5 offset:55296
    v_xor_b32 v15, v15, v14
    v_mfma_f32_16x16x32_bf16 v[100:103], v[128:131], a[4:7], v[100:103]
    buffer_store_dwordx4 v[120:123], v27, s[44:47], s95 offen offset:3072 sc1
    v_mfma_f32_16x16x32_bf16 v[104:107], v[128:131], a[8:11], 0
    ds_read_b64_tr_b16 v[148:149], v5 offset:57344
    v_and_b32 v15, 4, v15
    v_mfma_f32_16x16x32_bf16 v[104:107], v[132:135], a[24:27], v[104:107]
    ds_read_b64_tr_b16 v[150:151], v5 offset:59392
    v_mul_u32_u24 v15, 3, v15
    v_mfma_f32_16x16x32_bf16 v[104:107], v[136:139], a[40:43], v[104:107]
    v_xor_b32 v14, v14, v15
    v_mul_u32_u24 v14, 1152, v14
    v_mfma_f32_16x16x32_bf16 v[108:111], v[136:139], a[44:47], 0
    buffer_store_dwordx4 v[64:67], v27, s[44:47], s94 offen offset:0 sc1
    v_mfma_f32_16x16x32_bf16 v[108:111], v[132:135], a[28:31], v[108:111]
    v_cvt_pk_bf16_f32 v72, v72, v73
    v_lshl_add_u32 v13, v13, 4, v14
    v_mfma_f32_16x16x32_bf16 v[108:111], v[128:131], a[12:15], v[108:111]
    s_waitcnt lgkmcnt(0)
    s_mov_b32 s60, 896
    v_mfma_f32_16x16x32_bf16 v[112:115], v[140:143], a[0:3], 0
    s_waitcnt vmcnt(22)
    s_barrier
    v_mfma_f32_16x16x32_bf16 v[112:115], v[144:147], a[16:19], v[112:115]
    ds_read_b64_tr_b16 v[128:129], v6 offset:0
    s_add_u32 m0, s59, 98304
    v_mfma_f32_16x16x32_bf16 v[112:115], v[148:151], a[32:35], v[112:115]
    buffer_load_dwordx4 v152, s[40:43], s60 offen offset:0  lds
    v_mfma_f32_16x16x32_bf16 v[116:119], v[148:151], a[36:39], 0
    ds_read_b64_tr_b16 v[130:131], v6 offset:2048
    v_cvt_pk_bf16_f32 v73, v74, v75
    v_mfma_f32_16x16x32_bf16 v[116:119], v[144:147], a[20:23], v[116:119]
    ds_read_b64_tr_b16 v[132:133], v6 offset:4096
    v_cvt_pk_bf16_f32 v74, v76, v77
    v_mfma_f32_16x16x32_bf16 v[116:119], v[140:143], a[4:7], v[116:119]
    ds_read_b64_tr_b16 v[134:135], v6 offset:6144
    v_cvt_pk_bf16_f32 v75, v78, v79
    v_mfma_f32_16x16x32_bf16 v[120:123], v[140:143], a[8:11], 0
    ds_read_b64_tr_b16 v[136:137], v6 offset:8192
    s_mul_i32 s62, s54, 72
    v_mfma_f32_16x16x32_bf16 v[120:123], v[144:147], a[24:27], v[120:123]
    buffer_load_dwordx4 v153, s[40:43], s60 offen offset:1024  lds
    v_mfma_f32_16x16x32_bf16 v[120:123], v[148:151], a[40:43], v[120:123]
    ds_read_b64_tr_b16 v[138:139], v6 offset:10240
    s_sub_u32 s62, s62, 2048
    v_mfma_f32_16x16x32_bf16 v[124:127], v[148:151], a[44:47], 0
    v_add_u32 v12, s62, v13
    s_lshl_b32 s62, s53, 1
    v_mfma_f32_16x16x32_bf16 v[124:127], v[144:147], a[28:31], v[124:127]
    s_add_u32 s62, s62, s55
    s_mul_i32 s62, s62, 73728
    v_mfma_f32_16x16x32_bf16 v[124:127], v[140:143], a[12:15], v[124:127]
    s_waitcnt lgkmcnt(0)
    s_lshl_b32 s63, s56, 10
    v_mfma_f32_16x16x32_bf16 v[96:99], v[128:131], a[48:51], v[96:99]
    buffer_load_dwordx4 v154, s[40:43], s60 offen offset:2048  lds
    v_mfma_f32_16x16x32_bf16 v[96:99], v[132:135], a[64:67], v[96:99]
    ds_read_b64_tr_b16 v[140:141], v7 offset:0
    s_add_u32 s62, s62, s63
    v_mfma_f32_16x16x32_bf16 v[96:99], v[136:139], a[80:83], v[96:99]
    ds_read_b64_tr_b16 v[142:143], v7 offset:2048
    v_lshrrev_b32 v13, 4, v1
    v_mfma_f32_16x16x32_bf16 v[100:103], v[136:139], a[84:87], v[100:103]
    ds_read_b64_tr_b16 v[144:145], v7 offset:4096
    s_mov_b32 s63, 2359296
    v_mfma_f32_16x16x32_bf16 v[100:103], v[132:135], a[68:71], v[100:103]
    ds_read_b64_tr_b16 v[146:147], v7 offset:6144
    v_mul_lo_u32 v14, v13, s63
    v_mfma_f32_16x16x32_bf16 v[100:103], v[128:131], a[52:55], v[100:103]
    buffer_store_dwordx4 v[72:75], v27, s[44:47], s94 offen offset:1024 sc1
    v_mfma_f32_16x16x32_bf16 v[104:107], v[128:131], a[56:59], v[104:107]
    ds_read_b64_tr_b16 v[148:149], v7 offset:8192
    v_cvt_pk_bf16_f32 v80, v80, v81
    v_mfma_f32_16x16x32_bf16 v[104:107], v[132:135], a[72:75], v[104:107]
    ds_read_b64_tr_b16 v[150:151], v7 offset:10240
    v_cvt_pk_bf16_f32 v81, v82, v83
    v_mfma_f32_16x16x32_bf16 v[104:107], v[136:139], a[88:91], v[104:107]
    v_cvt_pk_bf16_f32 v82, v84, v85
    v_and_b32 v15, 15, v1
    v_mfma_f32_16x16x32_bf16 v[108:111], v[136:139], a[92:95], v[108:111]
    buffer_load_dwordx4 a[172:175], v30, s[44:47], s69 offen offset:640 sc1
    v_mfma_f32_16x16x32_bf16 v[108:111], v[132:135], a[76:79], v[108:111]
    v_cvt_pk_bf16_f32 v83, v86, v87
    v_lshl_add_u32 v14, v15, 4, v14
    v_mfma_f32_16x16x32_bf16 v[108:111], v[128:131], a[60:63], v[108:111]
    s_waitcnt lgkmcnt(0)
    s_mov_b32 s60, 111488
    v_mfma_f32_16x16x32_bf16 v[112:115], v[140:143], a[48:51], v[112:115]
    s_waitcnt vmcnt(22)
    s_barrier
    v_mfma_f32_16x16x32_bf16 v[112:115], v[144:147], a[64:67], v[112:115]
    ds_read_b64_tr_b16 v[128:129], v6 offset:12288
    s_add_u32 m0, s59, 110592
    v_mfma_f32_16x16x32_bf16 v[112:115], v[148:151], a[80:83], v[112:115]
    buffer_load_dwordx4 v152, s[40:43], s60 offen offset:0  lds
    v_mfma_f32_16x16x32_bf16 v[116:119], v[148:151], a[84:87], v[116:119]
    ds_read_b64_tr_b16 v[130:131], v6 offset:14336
    v_add_u32 v16, s62, v14
    v_mfma_f32_16x16x32_bf16 v[116:119], v[144:147], a[68:71], v[116:119]
    ds_read_b64_tr_b16 v[132:133], v6 offset:16384
    v_add_u32 v17, 9437184, v16
    v_mfma_f32_16x16x32_bf16 v[116:119], v[140:143], a[52:55], v[116:119]
    ds_read_b64_tr_b16 v[134:135], v6 offset:18432
    v_add_u32 v18, 18874368, v16
    v_mfma_f32_16x16x32_bf16 v[120:123], v[140:143], a[56:59], v[120:123]
    ds_read_b64_tr_b16 v[136:137], v6 offset:20480
    v_add_u32 v19, 28311552, v16
    v_mfma_f32_16x16x32_bf16 v[120:123], v[144:147], a[72:75], v[120:123]
    buffer_load_dwordx4 v153, s[40:43], s60 offen offset:1024  lds
    v_mfma_f32_16x16x32_bf16 v[120:123], v[148:151], a[88:91], v[120:123]
    ds_read_b64_tr_b16 v[138:139], v6 offset:22528
    s_lshl_b32 s62, s53, 2
    v_mfma_f32_16x16x32_bf16 v[124:127], v[148:151], a[92:95], v[124:127]
    s_add_u32 s62, s62, s52
    s_mul_i32 s62, s62, 36864
    v_mfma_f32_16x16x32_bf16 v[124:127], v[144:147], a[76:79], v[124:127]
    s_mul_i32 s63, s54, 72
    s_add_u32 s62, s62, s63
    v_mfma_f32_16x16x32_bf16 v[124:127], v[140:143], a[60:63], v[124:127]
    s_waitcnt lgkmcnt(0)
    v_mul_u32_u24 v14, 1152, v15
    v_mfma_f32_16x16x32_bf16 v[96:99], v[128:131], a[96:99], v[96:99]
    buffer_load_dwordx4 v154, s[40:43], s60 offen offset:2048  lds
    v_mfma_f32_16x16x32_bf16 v[96:99], v[132:135], a[112:115], v[96:99]
    ds_read_b64_tr_b16 v[140:141], v7 offset:12288
    v_lshl_add_u32 v14, v13, 3, v14
    v_mfma_f32_16x16x32_bf16 v[96:99], v[136:139], a[128:131], v[96:99]
    ds_read_b64_tr_b16 v[142:143], v7 offset:14336
    v_add_u32 v20, s62, v14
    v_mfma_f32_16x16x32_bf16 v[100:103], v[136:139], a[132:135], v[100:103]
    ds_read_b64_tr_b16 v[144:145], v7 offset:16384
    v_cmp_eq_u32 vcc, 0, v13
    v_mfma_f32_16x16x32_bf16 v[100:103], v[132:135], a[116:119], v[100:103]
    ds_read_b64_tr_b16 v[146:147], v7 offset:18432
    v_mov_b32 v14, 2146435072
    v_mfma_f32_16x16x32_bf16 v[100:103], v[128:131], a[100:103], v[100:103]
    buffer_store_dwordx4 v[80:83], v27, s[44:47], s94 offen offset:2048 sc1
    v_mfma_f32_16x16x32_bf16 v[104:107], v[128:131], a[104:107], v[104:107]
    ds_read_b64_tr_b16 v[148:149], v7 offset:20480
    v_cvt_pk_bf16_f32 v88, v88, v89
    v_mfma_f32_16x16x32_bf16 v[104:107], v[132:135], a[120:123], v[104:107]
    ds_read_b64_tr_b16 v[150:151], v7 offset:22528
    v_cvt_pk_bf16_f32 v89, v90, v91
    v_mfma_f32_16x16x32_bf16 v[104:107], v[136:139], a[136:139], v[104:107]
    v_cvt_pk_bf16_f32 v90, v92, v93
    s_nop 0
    v_mfma_f32_16x16x32_bf16 v[108:111], v[136:139], a[140:143], v[108:111]
    buffer_load_dwordx4 a[176:179], v30, s[44:47], s69 offen offset:1280 sc1
    v_mfma_f32_16x16x32_bf16 v[108:111], v[132:135], a[124:127], v[108:111]
    v_cvt_pk_bf16_f32 v91, v94, v95
    v_cndmask_b32 v21, v14, v20, vcc
    v_mfma_f32_16x16x32_bf16 v[108:111], v[128:131], a[108:111], v[108:111]
    s_waitcnt lgkmcnt(0)
    s_mov_b32 s60, 896
    v_mfma_f32_16x16x32_bf16 v[112:115], v[140:143], a[96:99], v[112:115]
    s_waitcnt vmcnt(22)
    s_barrier
    v_mfma_f32_16x16x32_bf16 v[112:115], v[144:147], a[112:115], v[112:115]
    ds_read_b64_tr_b16 v[128:129], v6 offset:36864
    s_add_u32 m0, s59, 122880
    v_mfma_f32_16x16x32_bf16 v[112:115], v[148:151], a[128:131], v[112:115]
    buffer_load_dwordx4 v155, s[40:43], s60 offen offset:0  lds
    v_mfma_f32_16x16x32_bf16 v[116:119], v[148:151], a[132:135], v[116:119]
    ds_read_b64_tr_b16 v[130:131], v6 offset:38912
    v_cvt_pk_bf16_f32 v96, v96, v97
    v_mfma_f32_16x16x32_bf16 v[116:119], v[144:147], a[116:119], v[116:119]
    ds_read_b64_tr_b16 v[132:133], v6 offset:40960
    v_cvt_pk_bf16_f32 v97, v98, v99
    v_mfma_f32_16x16x32_bf16 v[116:119], v[140:143], a[100:103], v[116:119]
    ds_read_b64_tr_b16 v[134:135], v6 offset:43008
    v_cvt_pk_bf16_f32 v98, v100, v101
    v_mfma_f32_16x16x32_bf16 v[120:123], v[140:143], a[104:107], v[120:123]
    ds_read_b64_tr_b16 v[136:137], v6 offset:45056
    v_cvt_pk_bf16_f32 v99, v102, v103
    v_mfma_f32_16x16x32_bf16 v[120:123], v[144:147], a[120:123], v[120:123]
    buffer_load_dwordx4 v156, s[40:43], s60 offen offset:1024  lds
    v_mfma_f32_16x16x32_bf16 v[120:123], v[148:151], a[136:139], v[120:123]
    ds_read_b64_tr_b16 v[138:139], v6 offset:47104
    s_mov_b32 s95, 20480
    v_mfma_f32_16x16x32_bf16 v[124:127], v[148:151], a[140:143], v[124:127]
    s_lshl_b32 s62, s53, 11
    s_add_u32 s62, s62, 40370176
    v_mfma_f32_16x16x32_bf16 v[124:127], v[144:147], a[124:127], v[124:127]
    v_lshl_add_u32 v22, v15, 7, s62
    s_lshl_b32 s63, s54, 7
    v_mfma_f32_16x16x32_bf16 v[124:127], v[140:143], a[108:111], v[124:127]
    s_waitcnt lgkmcnt(0)
    s_add_u32 s62, s62, s63
    v_mfma_f32_16x16x32_bf16 v[64:67], v[128:131], a[0:3], 0
    buffer_load_dwordx4 v157, s[40:43], s60 offen offset:2048  lds
    v_mfma_f32_16x16x32_bf16 v[64:67], v[132:135], a[16:19], v[64:67]
    ds_read_b64_tr_b16 v[140:141], v7 offset:36864
    v_mov_b32 v13, s62
    v_mfma_f32_16x16x32_bf16 v[64:67], v[136:139], a[32:35], v[64:67]
    ds_read_b64_tr_b16 v[142:143], v7 offset:38912
    s_lshl_b32 s63, s52, 6
    v_mfma_f32_16x16x32_bf16 v[68:71], v[136:139], a[36:39], 0
    ds_read_b64_tr_b16 v[144:145], v7 offset:40960
    v_add_u32 v15, s63, v1
    v_mfma_f32_16x16x32_bf16 v[68:71], v[132:135], a[20:23], v[68:71]
    ds_read_b64_tr_b16 v[146:147], v7 offset:43008
    v_cmp_eq_u32 vcc, 0, v15
    v_mfma_f32_16x16x32_bf16 v[68:71], v[128:131], a[4:7], v[68:71]
    buffer_store_dwordx4 v[88:91], v27, s[44:47], s94 offen offset:3072 sc1
    v_mfma_f32_16x16x32_bf16 v[72:75], v[128:131], a[8:11], 0
    ds_read_b64_tr_b16 v[148:149], v7 offset:45056
    s_nop 1
    v_mfma_f32_16x16x32_bf16 v[72:75], v[132:135], a[24:27], v[72:75]
    ds_read_b64_tr_b16 v[150:151], v7 offset:47104
    v_cndmask_b32 v23, v14, v13, vcc
    v_mfma_f32_16x16x32_bf16 v[72:75], v[136:139], a[40:43], v[72:75]
    v_and_b32 v13, 1, v1
    v_lshlrev_b32 v13, 4, v13
    v_mfma_f32_16x16x32_bf16 v[76:79], v[136:139], a[44:47], 0
    buffer_store_dwordx4 v[96:99], v27, s[44:47], s95 offen offset:0 sc1
    v_mfma_f32_16x16x32_bf16 v[76:79], v[132:135], a[28:31], v[76:79]
    v_cvt_pk_bf16_f32 v104, v104, v105
    v_mov_b32 v14, 0x3f80
    v_mfma_f32_16x16x32_bf16 v[76:79], v[128:131], a[12:15], v[76:79]
    s_waitcnt lgkmcnt(0)
    s_mov_b32 s60, 1024
    v_mfma_f32_16x16x32_bf16 v[80:83], v[140:143], a[0:3], 0
    s_waitcnt vmcnt(22)
    s_barrier
    v_mfma_f32_16x16x32_bf16 v[80:83], v[144:147], a[16:19], v[80:83]
    ds_read_b64_tr_b16 v[128:129], v4 offset:24576
    s_add_u32 m0, s59, 147456
    v_mfma_f32_16x16x32_bf16 v[80:83], v[148:151], a[32:35], v[80:83]
    buffer_load_dwordx4 v152, s[40:43], s60 offen offset:0  lds
    v_mfma_f32_16x16x32_bf16 v[84:87], v[148:151], a[36:39], 0
    ds_read_b64_tr_b16 v[130:131], v4 offset:26624
    v_cvt_pk_bf16_f32 v105, v106, v107
    v_mfma_f32_16x16x32_bf16 v[84:87], v[144:147], a[20:23], v[84:87]
    ds_read_b64_tr_b16 v[132:133], v4 offset:28672
    v_cvt_pk_bf16_f32 v106, v108, v109
    v_mfma_f32_16x16x32_bf16 v[84:87], v[140:143], a[4:7], v[84:87]
    ds_read_b64_tr_b16 v[134:135], v4 offset:30720
    v_cvt_pk_bf16_f32 v107, v110, v111
    v_mfma_f32_16x16x32_bf16 v[88:91], v[140:143], a[8:11], 0
    ds_read_b64_tr_b16 v[136:137], v4 offset:32768
    v_lshlrev_b32 v13, v13, v14
    v_mfma_f32_16x16x32_bf16 v[88:91], v[144:147], a[24:27], v[88:91]
    buffer_load_dwordx4 v153, s[40:43], s60 offen offset:1024  lds
    v_mfma_f32_16x16x32_bf16 v[88:91], v[148:151], a[40:43], v[88:91]
    ds_read_b64_tr_b16 v[138:139], v4 offset:34816
    v_bfe_u32 v14, v1, 1, 3
    v_mfma_f32_16x16x32_bf16 v[92:95], v[148:151], a[44:47], 0
    v_cmp_eq_u32 vcc, 0, v14
    v_accvgpr_write_b32 a236, 0
    v_mfma_f32_16x16x32_bf16 v[92:95], v[144:147], a[28:31], v[92:95]
    s_nop 0
    v_cndmask_b32 v15, 0, v13, vcc
    v_mfma_f32_16x16x32_bf16 v[92:95], v[140:143], a[12:15], v[92:95]
    s_waitcnt lgkmcnt(0)
    v_accvgpr_write_b32 a238, v15
    v_mfma_f32_16x16x32_bf16 v[64:67], v[128:131], a[48:51], v[64:67]
    buffer_load_dwordx4 v154, s[40:43], s60 offen offset:2048  lds
    v_mfma_f32_16x16x32_bf16 v[64:67], v[132:135], a[64:67], v[64:67]
    ds_read_b64_tr_b16 v[140:141], v5 offset:24576
    v_cmp_eq_u32 vcc, 1, v14
    v_mfma_f32_16x16x32_bf16 v[64:67], v[136:139], a[80:83], v[64:67]
    ds_read_b64_tr_b16 v[142:143], v5 offset:26624
    v_accvgpr_write_b32 a237, 0
    v_mfma_f32_16x16x32_bf16 v[68:71], v[136:139], a[84:87], v[68:71]
    ds_read_b64_tr_b16 v[144:145], v5 offset:28672
    s_nop 0
    v_mfma_f32_16x16x32_bf16 v[68:71], v[132:135], a[68:71], v[68:71]
    ds_read_b64_tr_b16 v[146:147], v5 offset:30720
    v_cndmask_b32 v15, 0, v13, vcc
    v_mfma_f32_16x16x32_bf16 v[68:71], v[128:131], a[52:55], v[68:71]
    buffer_store_dwordx4 v[104:107], v27, s[44:47], s95 offen offset:1024 sc1
    v_mfma_f32_16x16x32_bf16 v[72:75], v[128:131], a[56:59], v[72:75]
    ds_read_b64_tr_b16 v[148:149], v5 offset:32768
    v_cvt_pk_bf16_f32 v112, v112, v113
    v_mfma_f32_16x16x32_bf16 v[72:75], v[132:135], a[72:75], v[72:75]
    ds_read_b64_tr_b16 v[150:151], v5 offset:34816
    v_cvt_pk_bf16_f32 v113, v114, v115
    v_mfma_f32_16x16x32_bf16 v[72:75], v[136:139], a[88:91], v[72:75]
    v_cvt_pk_bf16_f32 v114, v116, v117
    v_accvgpr_write_b32 a239, v15
    v_mfma_f32_16x16x32_bf16 v[76:79], v[136:139], a[92:95], v[76:79]
    buffer_load_dwordx4 a[180:183], v30, s[44:47], s69 offen offset:1920 sc1
    v_mfma_f32_16x16x32_bf16 v[76:79], v[132:135], a[76:79], v[76:79]
    v_cvt_pk_bf16_f32 v115, v118, v119
    v_cmp_eq_u32 vcc, 2, v14
    v_mfma_f32_16x16x32_bf16 v[76:79], v[128:131], a[60:63], v[76:79]
    s_waitcnt lgkmcnt(0)
    s_mov_b32 s60, 111616
    v_mfma_f32_16x16x32_bf16 v[80:83], v[140:143], a[48:51], v[80:83]
    s_waitcnt vmcnt(22)
    s_barrier
    v_mfma_f32_16x16x32_bf16 v[80:83], v[144:147], a[64:67], v[80:83]
    ds_read_b64_tr_b16 v[128:129], v4 offset:36864
    s_add_u32 m0, s59, 73728
    v_mfma_f32_16x16x32_bf16 v[80:83], v[148:151], a[80:83], v[80:83]
    buffer_load_dwordx4 v152, s[40:43], s60 offen offset:0  lds
    v_mfma_f32_16x16x32_bf16 v[84:87], v[148:151], a[84:87], v[84:87]
    ds_read_b64_tr_b16 v[130:131], v4 offset:38912
    v_accvgpr_write_b32 a240, 0
    v_mfma_f32_16x16x32_bf16 v[84:87], v[144:147], a[68:71], v[84:87]
    ds_read_b64_tr_b16 v[132:133], v4 offset:40960
    s_nop 0
    v_mfma_f32_16x16x32_bf16 v[84:87], v[140:143], a[52:55], v[84:87]
    ds_read_b64_tr_b16 v[134:135], v4 offset:43008
    v_cndmask_b32 v15, 0, v13, vcc
    v_mfma_f32_16x16x32_bf16 v[88:91], v[140:143], a[56:59], v[88:91]
    ds_read_b64_tr_b16 v[136:137], v4 offset:45056
    v_accvgpr_write_b32 a242, v15
    v_mfma_f32_16x16x32_bf16 v[88:91], v[144:147], a[72:75], v[88:91]
    buffer_load_dwordx4 v153, s[40:43], s60 offen offset:1024  lds
    v_mfma_f32_16x16x32_bf16 v[88:91], v[148:151], a[88:91], v[88:91]
    ds_read_b64_tr_b16 v[138:139], v4 offset:47104
    v_cmp_eq_u32 vcc, 3, v14
    v_mfma_f32_16x16x32_bf16 v[92:95], v[148:151], a[92:95], v[92:95]
    v_accvgpr_write_b32 a241, 0
    s_nop 0
    v_mfma_f32_16x16x32_bf16 v[92:95], v[144:147], a[76:79], v[92:95]
    v_cndmask_b32 v15, 0, v13, vcc
    v_accvgpr_write_b32 a243, v15
    v_mfma_f32_16x16x32_bf16 v[92:95], v[140:143], a[60:63], v[92:95]
    s_waitcnt lgkmcnt(0)
    v_cmp_eq_u32 vcc, 4, v14
    v_mfma_f32_16x16x32_bf16 v[64:67], v[128:131], a[96:99], v[64:67]
    buffer_load_dwordx4 v154, s[40:43], s60 offen offset:2048  lds
    v_mfma_f32_16x16x32_bf16 v[64:67], v[132:135], a[112:115], v[64:67]
    ds_read_b64_tr_b16 v[140:141], v5 offset:36864
    v_accvgpr_write_b32 a244, 0
    v_mfma_f32_16x16x32_bf16 v[64:67], v[136:139], a[128:131], v[64:67]
    ds_read_b64_tr_b16 v[142:143], v5 offset:38912
    s_nop 0
    v_mfma_f32_16x16x32_bf16 v[68:71], v[136:139], a[132:135], v[68:71]
    ds_read_b64_tr_b16 v[144:145], v5 offset:40960
    v_cndmask_b32 v15, 0, v13, vcc
    v_mfma_f32_16x16x32_bf16 v[68:71], v[132:135], a[116:119], v[68:71]
    ds_read_b64_tr_b16 v[146:147], v5 offset:43008
    v_accvgpr_write_b32 a246, v15
    v_mfma_f32_16x16x32_bf16 v[68:71], v[128:131], a[100:103], v[68:71]
    buffer_store_dwordx4 v[112:115], v27, s[44:47], s95 offen offset:2048 sc1
    v_mfma_f32_16x16x32_bf16 v[72:75], v[128:131], a[104:107], v[72:75]
    ds_read_b64_tr_b16 v[148:149], v5 offset:45056
    v_cvt_pk_bf16_f32 v120, v120, v121
    v_mfma_f32_16x16x32_bf16 v[72:75], v[132:135], a[120:123], v[72:75]
    ds_read_b64_tr_b16 v[150:151], v5 offset:47104
    v_cvt_pk_bf16_f32 v121, v122, v123
    v_mfma_f32_16x16x32_bf16 v[72:75], v[136:139], a[136:139], v[72:75]
    v_cvt_pk_bf16_f32 v122, v124, v125
    v_cmp_eq_u32 vcc, 5, v14
    v_mfma_f32_16x16x32_bf16 v[76:79], v[136:139], a[140:143], v[76:79]
    buffer_load_dwordx4 a[184:187], v30, s[44:47], s69 offen offset:2560 sc1
    v_mfma_f32_16x16x32_bf16 v[76:79], v[132:135], a[124:127], v[76:79]
    v_cvt_pk_bf16_f32 v123, v126, v127
    v_accvgpr_write_b32 a245, 0
    v_mfma_f32_16x16x32_bf16 v[76:79], v[128:131], a[108:111], v[76:79]
    s_waitcnt lgkmcnt(0)
    s_mov_b32 s60, 1024
    v_mfma_f32_16x16x32_bf16 v[80:83], v[140:143], a[96:99], v[80:83]
    s_waitcnt vmcnt(22)
    s_barrier
    v_mfma_f32_16x16x32_bf16 v[80:83], v[144:147], a[112:115], v[80:83]
    ds_read_b64_tr_b16 v[128:129], v4 offset:49152
    s_add_u32 m0, s59, 86016
    v_mfma_f32_16x16x32_bf16 v[80:83], v[148:151], a[128:131], v[80:83]
    buffer_load_dwordx4 v155, s[40:43], s60 offen offset:0  lds
    v_mfma_f32_16x16x32_bf16 v[84:87], v[148:151], a[132:135], v[84:87]
    ds_read_b64_tr_b16 v[130:131], v4 offset:51200
    v_cvt_pk_bf16_f32 v32, v64, v65
    v_mfma_f32_16x16x32_bf16 v[84:87], v[144:147], a[116:119], v[84:87]
    ds_read_b64_tr_b16 v[132:133], v4 offset:53248
    v_cvt_pk_bf16_f32 v33, v66, v67
    v_mfma_f32_16x16x32_bf16 v[84:87], v[140:143], a[100:103], v[84:87]
    ds_read_b64_tr_b16 v[134:135], v4 offset:55296
    v_cvt_pk_bf16_f32 v34, v68, v69
    v_mfma_f32_16x16x32_bf16 v[88:91], v[140:143], a[104:107], v[88:91]
    ds_read_b64_tr_b16 v[136:137], v4 offset:57344
    v_cvt_pk_bf16_f32 v35, v70, v71
    v_mfma_f32_16x16x32_bf16 v[88:91], v[144:147], a[120:123], v[88:91]
    buffer_load_dwordx4 v156, s[40:43], s60 offen offset:1024  lds
    v_mfma_f32_16x16x32_bf16 v[88:91], v[148:151], a[136:139], v[88:91]
    ds_read_b64_tr_b16 v[138:139], v4 offset:59392
    v_cvt_pk_bf16_f32 v36, v72, v73
    v_mfma_f32_16x16x32_bf16 v[92:95], v[148:151], a[140:143], v[92:95]
    v_cvt_pk_bf16_f32 v37, v74, v75
    s_nop 0
    v_mfma_f32_16x16x32_bf16 v[92:95], v[144:147], a[124:127], v[92:95]
    v_cvt_pk_bf16_f32 v38, v76, v77
    v_cndmask_b32 v15, 0, v13, vcc
    v_mfma_f32_16x16x32_bf16 v[92:95], v[140:143], a[108:111], v[92:95]
    s_waitcnt lgkmcnt(0)
    v_cvt_pk_bf16_f32 v39, v78, v79
    v_mfma_f32_16x16x32_bf16 v[96:99], v[128:131], a[0:3], 0
    buffer_load_dwordx4 v157, s[40:43], s60 offen offset:2048  lds
    v_mfma_f32_16x16x32_bf16 v[96:99], v[132:135], a[16:19], v[96:99]
    ds_read_b64_tr_b16 v[140:141], v5 offset:49152
    v_cvt_pk_bf16_f32 v40, v80, v81
    v_mfma_f32_16x16x32_bf16 v[96:99], v[136:139], a[32:35], v[96:99]
    ds_read_b64_tr_b16 v[142:143], v5 offset:51200
    v_cvt_pk_bf16_f32 v41, v82, v83
    v_mfma_f32_16x16x32_bf16 v[100:103], v[136:139], a[36:39], 0
    ds_read_b64_tr_b16 v[144:145], v5 offset:53248
    v_cvt_pk_bf16_f32 v42, v84, v85
    v_mfma_f32_16x16x32_bf16 v[100:103], v[132:135], a[20:23], v[100:103]
    ds_read_b64_tr_b16 v[146:147], v5 offset:55296
    v_cvt_pk_bf16_f32 v43, v86, v87
    v_mfma_f32_16x16x32_bf16 v[100:103], v[128:131], a[4:7], v[100:103]
    buffer_store_dwordx4 v[120:123], v27, s[44:47], s95 offen offset:3072 sc1
    v_mfma_f32_16x16x32_bf16 v[104:107], v[128:131], a[8:11], 0
    ds_read_b64_tr_b16 v[148:149], v5 offset:57344
    v_accvgpr_write_b32 a247, v15
    v_mfma_f32_16x16x32_bf16 v[104:107], v[132:135], a[24:27], v[104:107]
    ds_read_b64_tr_b16 v[150:151], v5 offset:59392
    v_cvt_pk_bf16_f32 v44, v88, v89
    v_mfma_f32_16x16x32_bf16 v[104:107], v[136:139], a[40:43], v[104:107]
    v_cvt_pk_bf16_f32 v45, v90, v91
    v_cmp_eq_u32 vcc, 6, v14
    v_mfma_f32_16x16x32_bf16 v[108:111], v[136:139], a[44:47], 0
    buffer_load_dwordx4 a[188:191], v30, s[44:47], s69 offen offset:3200 sc1
    v_mfma_f32_16x16x32_bf16 v[108:111], v[132:135], a[28:31], v[108:111]
    v_cvt_pk_bf16_f32 v46, v92, v93
    s_mov_b32 s69, 7680
    v_mfma_f32_16x16x32_bf16 v[108:111], v[128:131], a[12:15], v[108:111]
    s_waitcnt lgkmcnt(0)
    v_cvt_pk_bf16_f32 v47, v94, v95
    v_mfma_f32_16x16x32_bf16 v[112:115], v[140:143], a[0:3], 0
    s_waitcnt vmcnt(22)
    s_barrier
    v_mfma_f32_16x16x32_bf16 v[112:115], v[144:147], a[16:19], v[112:115]
    ds_read_b64_tr_b16 v[128:129], v6 offset:0
    v_accvgpr_write_b32 a248, 0
    v_mfma_f32_16x16x32_bf16 v[112:115], v[148:151], a[32:35], v[112:115]
    buffer_load_dwordx4 a[192:195], v30, s[44:47], s69 offen offset:0 sc1
    v_mfma_f32_16x16x32_bf16 v[116:119], v[148:151], a[36:39], 0
    ds_read_b64_tr_b16 v[130:131], v6 offset:2048
    s_nop 0
    v_mfma_f32_16x16x32_bf16 v[116:119], v[144:147], a[20:23], v[116:119]
    ds_read_b64_tr_b16 v[132:133], v6 offset:4096
    v_cndmask_b32 v15, 0, v13, vcc
    v_mfma_f32_16x16x32_bf16 v[116:119], v[140:143], a[4:7], v[116:119]
    ds_read_b64_tr_b16 v[134:135], v6 offset:6144
    v_accvgpr_write_b32 a250, v15
    v_mfma_f32_16x16x32_bf16 v[120:123], v[140:143], a[8:11], 0
    ds_read_b64_tr_b16 v[136:137], v6 offset:8192
    v_cmp_eq_u32 vcc, 7, v14
    v_mfma_f32_16x16x32_bf16 v[120:123], v[144:147], a[24:27], v[120:123]
    buffer_load_dwordx4 a[196:199], v30, s[44:47], s69 offen offset:640 sc1
    v_mfma_f32_16x16x32_bf16 v[120:123], v[148:151], a[40:43], v[120:123]
    ds_read_b64_tr_b16 v[138:139], v6 offset:10240
    v_accvgpr_write_b32 a249, 0
    v_mfma_f32_16x16x32_bf16 v[124:127], v[148:151], a[44:47], 0
    s_nop 0
    v_cndmask_b32 v15, 0, v13, vcc
    v_mfma_f32_16x16x32_bf16 v[124:127], v[144:147], a[28:31], v[124:127]
    v_accvgpr_write_b32 a251, v15
    v_accvgpr_write_b32 a252, 0
    v_mfma_f32_16x16x32_bf16 v[124:127], v[140:143], a[12:15], v[124:127]
    s_waitcnt lgkmcnt(0)
    v_accvgpr_write_b32 a253, 0
    v_mfma_f32_16x16x32_bf16 v[96:99], v[128:131], a[48:51], v[96:99]
    buffer_load_dwordx4 a[200:203], v30, s[44:47], s69 offen offset:1280 sc1
    v_mfma_f32_16x16x32_bf16 v[96:99], v[132:135], a[64:67], v[96:99]
    ds_read_b64_tr_b16 v[140:141], v7 offset:0
    s_lshl_b32 s62, s53, 2
    v_mfma_f32_16x16x32_bf16 v[96:99], v[136:139], a[80:83], v[96:99]
    ds_read_b64_tr_b16 v[142:143], v7 offset:2048
    s_add_u32 s62, s62, s52
    v_mfma_f32_16x16x32_bf16 v[100:103], v[136:139], a[84:87], v[100:103]
    ds_read_b64_tr_b16 v[144:145], v7 offset:4096
    s_mul_i32 s62, s62, 36864
    v_mfma_f32_16x16x32_bf16 v[100:103], v[132:135], a[68:71], v[100:103]
    ds_read_b64_tr_b16 v[146:147], v7 offset:6144
    s_add_u32 s62, s62, 38010880
    v_mfma_f32_16x16x32_bf16 v[100:103], v[128:131], a[52:55], v[100:103]
    buffer_load_dwordx4 a[204:207], v30, s[44:47], s69 offen offset:1920 sc1
    v_mfma_f32_16x16x32_bf16 v[104:107], v[128:131], a[56:59], v[104:107]
    ds_read_b64_tr_b16 v[148:149], v7 offset:8192
    v_lshl_add_u32 v15, v1, 4, s62
    v_mfma_f32_16x16x32_bf16 v[104:107], v[132:135], a[72:75], v[104:107]
    ds_read_b64_tr_b16 v[150:151], v7 offset:10240
    s_mul_i32 s63, s54, 9
    v_mfma_f32_16x16x32_bf16 v[104:107], v[136:139], a[88:91], v[104:107]
    s_add_u32 s64, s63, 1
    s_lshr_b32 s64, s64, 1
    v_mfma_f32_16x16x32_bf16 v[108:111], v[136:139], a[92:95], v[108:111]
    buffer_load_dwordx4 a[208:211], v30, s[44:47], s69 offen offset:2560 sc1
    v_mfma_f32_16x16x32_bf16 v[108:111], v[132:135], a[76:79], v[108:111]
    s_lshl_b32 s64, s64, 8
    v_add_u32 v13, s64, v15
    v_mfma_f32_16x16x32_bf16 v[108:111], v[128:131], a[60:63], v[108:111]
    s_waitcnt lgkmcnt(0)
    s_and_b32 s65, s54, 1
    v_mfma_f32_16x16x32_bf16 v[112:115], v[140:143], a[48:51], v[112:115]
    s_waitcnt vmcnt(22)
    s_barrier
    v_mfma_f32_16x16x32_bf16 v[112:115], v[144:147], a[64:67], v[112:115]
    ds_read_b64_tr_b16 v[128:129], v6 offset:12288
    s_lshl_b32 s65, s65, 3
    v_mfma_f32_16x16x32_bf16 v[112:115], v[148:151], a[80:83], v[112:115]
    buffer_load_dwordx4 a[212:215], v30, s[44:47], s69 offen offset:3200 sc1
    v_mfma_f32_16x16x32_bf16 v[116:119], v[148:151], a[84:87], v[116:119]
    ds_read_b64_tr_b16 v[130:131], v6 offset:14336
    s_mov_b32 s69, 11520
    v_mfma_f32_16x16x32_bf16 v[116:119], v[144:147], a[68:71], v[116:119]
    ds_read_b64_tr_b16 v[132:133], v6 offset:16384
    s_xor_b32 s64, s65, 8
    v_mfma_f32_16x16x32_bf16 v[116:119], v[140:143], a[52:55], v[116:119]
    ds_read_b64_tr_b16 v[134:135], v6 offset:18432
    s_add_u32 s63, s63, s64
    v_mfma_f32_16x16x32_bf16 v[120:123], v[140:143], a[56:59], v[120:123]
    ds_read_b64_tr_b16 v[136:137], v6 offset:20480
    s_lshr_b32 s63, s63, 1
    v_mfma_f32_16x16x32_bf16 v[120:123], v[144:147], a[72:75], v[120:123]
    buffer_load_dwordx4 a[216:219], v30, s[44:47], s69 offen offset:0 sc1
    v_mfma_f32_16x16x32_bf16 v[120:123], v[148:151], a[88:91], v[120:123]
    ds_read_b64_tr_b16 v[138:139], v6 offset:22528
    s_lshl_b32 s63, s63, 8
    v_mfma_f32_16x16x32_bf16 v[124:127], v[148:151], a[92:95], v[124:127]
    s_add_u32 s63, s63, s65
    s_add_u32 s63, s63, s62
    v_mfma_f32_16x16x32_bf16 v[124:127], v[144:147], a[76:79], v[124:127]
    v_bfe_u32 v158, v1, 4, 1
    v_mul_u32_u24 v158, 18432, v158
    v_mfma_f32_16x16x32_bf16 v[124:127], v[140:143], a[60:63], v[124:127]
    s_waitcnt lgkmcnt(0)
    v_and_b32 v159, 15, v1
    v_mfma_f32_16x16x32_bf16 v[96:99], v[128:131], a[96:99], v[96:99]
    buffer_load_dwordx4 a[220:223], v30, s[44:47], s69 offen offset:640 sc1
    v_mfma_f32_16x16x32_bf16 v[96:99], v[132:135], a[112:115], v[96:99]
    ds_read_b64_tr_b16 v[140:141], v7 offset:12288
    v_lshl_add_u32 v158, v159, 4, v158
    v_mfma_f32_16x16x32_bf16 v[96:99], v[136:139], a[128:131], v[96:99]
    ds_read_b64_tr_b16 v[142:143], v7 offset:14336
    v_add_u32 v158, s63, v158
    v_mfma_f32_16x16x32_bf16 v[100:103], v[136:139], a[132:135], v[100:103]
    ds_read_b64_tr_b16 v[144:145], v7 offset:16384
    v_cmp_gt_u32 vcc, 32, v1
    v_mfma_f32_16x16x32_bf16 v[100:103], v[132:135], a[116:119], v[100:103]
    ds_read_b64_tr_b16 v[146:147], v7 offset:18432
    v_mov_b32 v159, 2146435072
    v_mfma_f32_16x16x32_bf16 v[100:103], v[128:131], a[100:103], v[100:103]
    buffer_load_dwordx4 a[224:227], v30, s[44:47], s69 offen offset:1280 sc1
    v_mfma_f32_16x16x32_bf16 v[104:107], v[128:131], a[104:107], v[104:107]
    ds_read_b64_tr_b16 v[148:149], v7 offset:20480
    s_nop 0
    v_mfma_f32_16x16x32_bf16 v[104:107], v[132:135], a[120:123], v[104:107]
    ds_read_b64_tr_b16 v[150:151], v7 offset:22528
    v_cndmask_b32 v14, v159, v158, vcc
    v_mfma_f32_16x16x32_bf16 v[104:107], v[136:139], a[136:139], v[104:107]
    s_mov_b32 s5, 18432
    v_and_b32 v25, 31, v1
    v_mfma_f32_16x16x32_bf16 v[108:111], v[136:139], a[140:143], v[108:111]
    buffer_load_dwordx4 a[228:231], v30, s[44:47], s69 offen offset:1920 sc1
    v_mfma_f32_16x16x32_bf16 v[108:111], v[132:135], a[124:127], v[108:111]
    v_lshlrev_b32 v24, 5, v25
    v_lshrrev_b32 v26, 5, v1
    v_mfma_f32_16x16x32_bf16 v[108:111], v[128:131], a[108:111], v[108:111]
    s_waitcnt lgkmcnt(0)
    v_lshl_add_u32 v24, v26, 4, v24
    v_mfma_f32_16x16x32_bf16 v[112:115], v[140:143], a[96:99], v[112:115]
    s_waitcnt vmcnt(22)
    s_barrier
    v_mfma_f32_16x16x32_bf16 v[112:115], v[144:147], a[112:115], v[112:115]
    ds_read_b64_tr_b16 v[128:129], v6 offset:36864
    v_cvt_pk_bf16_f32 v48, v96, v97
    v_mfma_f32_16x16x32_bf16 v[112:115], v[148:151], a[128:131], v[112:115]
    buffer_load_dwordx4 a[232:235], v30, s[44:47], s69 offen offset:2560 sc1
    v_mfma_f32_16x16x32_bf16 v[116:119], v[148:151], a[132:135], v[116:119]
    ds_read_b64_tr_b16 v[130:131], v6 offset:38912
    v_cvt_pk_bf16_f32 v49, v98, v99
    v_mfma_f32_16x16x32_bf16 v[116:119], v[144:147], a[116:119], v[116:119]
    ds_read_b64_tr_b16 v[132:133], v6 offset:40960
    v_cvt_pk_bf16_f32 v50, v100, v101
    v_mfma_f32_16x16x32_bf16 v[116:119], v[140:143], a[100:103], v[116:119]
    ds_read_b64_tr_b16 v[134:135], v6 offset:43008
    v_cvt_pk_bf16_f32 v51, v102, v103
    v_mfma_f32_16x16x32_bf16 v[120:123], v[140:143], a[104:107], v[120:123]
    ds_read_b64_tr_b16 v[136:137], v6 offset:45056
    s_mov_b32 s69, 15360
    v_mfma_f32_16x16x32_bf16 v[120:123], v[144:147], a[120:123], v[120:123]
    buffer_load_dwordx4 v[240:243], v30, s[44:47], s69 offen offset:2560 sc1
    v_mfma_f32_16x16x32_bf16 v[120:123], v[148:151], a[136:139], v[120:123]
    ds_read_b64_tr_b16 v[138:139], v6 offset:47104
    v_cvt_pk_bf16_f32 v52, v104, v105
    v_mfma_f32_16x16x32_bf16 v[124:127], v[148:151], a[140:143], v[124:127]
    v_cvt_pk_bf16_f32 v53, v106, v107
    v_add_u32 v24, 135168, v24
    v_mfma_f32_16x16x32_bf16 v[124:127], v[144:147], a[124:127], v[124:127]
    v_cvt_pk_bf16_f32 v54, v108, v109
    v_lshlrev_b32 v25, 2, v1
    v_mfma_f32_16x16x32_bf16 v[124:127], v[140:143], a[108:111], v[124:127]
    s_waitcnt lgkmcnt(0)
    v_cvt_pk_bf16_f32 v55, v110, v111
    v_mfma_f32_16x16x32_bf16 v[64:67], v[128:131], a[0:3], 0
    buffer_load_dwordx4 v[244:247], v30, s[44:47], s69 offen offset:3200 sc1
    v_mfma_f32_16x16x32_bf16 v[64:67], v[132:135], a[16:19], v[64:67]
    ds_read_b64_tr_b16 v[140:141], v7 offset:36864
    v_cvt_pk_bf16_f32 v56, v112, v113
    v_mfma_f32_16x16x32_bf16 v[64:67], v[136:139], a[32:35], v[64:67]
    ds_read_b64_tr_b16 v[142:143], v7 offset:38912
    v_cvt_pk_bf16_f32 v57, v114, v115
    v_mfma_f32_16x16x32_bf16 v[68:71], v[136:139], a[36:39], 0
    ds_read_b64_tr_b16 v[144:145], v7 offset:40960
    v_cvt_pk_bf16_f32 v58, v116, v117
    v_mfma_f32_16x16x32_bf16 v[68:71], v[132:135], a[20:23], v[68:71]
    ds_read_b64_tr_b16 v[146:147], v7 offset:43008
    v_cvt_pk_bf16_f32 v59, v118, v119
    v_mfma_f32_16x16x32_bf16 v[68:71], v[128:131], a[4:7], v[68:71]
    v_mfma_f32_16x16x32_bf16 v[72:75], v[128:131], a[8:11], 0
    ds_read_b64_tr_b16 v[148:149], v7 offset:45056
    s_mov_b32 s69, 19200
    v_mfma_f32_16x16x32_bf16 v[72:75], v[132:135], a[24:27], v[72:75]
    ds_read_b64_tr_b16 v[150:151], v7 offset:47104
    v_cvt_pk_bf16_f32 v60, v120, v121
    v_mfma_f32_16x16x32_bf16 v[72:75], v[136:139], a[40:43], v[72:75]
    v_cvt_pk_bf16_f32 v61, v122, v123
    v_add_u32 v25, 143360, v25
    v_mfma_f32_16x16x32_bf16 v[76:79], v[136:139], a[44:47], 0
    buffer_load_dwordx4 v[248:251], v30, s[44:47], s69 offen offset:0 sc1
    v_mfma_f32_16x16x32_bf16 v[76:79], v[132:135], a[28:31], v[76:79]
    v_cvt_pk_bf16_f32 v62, v124, v125
    s_mul_i32 s91, s52, 2560
    v_mfma_f32_16x16x32_bf16 v[76:79], v[128:131], a[12:15], v[76:79]
    s_waitcnt lgkmcnt(0)
    v_cvt_pk_bf16_f32 v63, v126, v127
    v_mfma_f32_16x16x32_bf16 v[80:83], v[140:143], a[0:3], 0
    s_waitcnt vmcnt(21)
    s_barrier
    v_mfma_f32_16x16x32_bf16 v[80:83], v[144:147], a[16:19], v[80:83]
    ds_read_b64_tr_b16 v[128:129], v4 offset:24576
    s_add_u32 s91, s91, 53248
    v_mfma_f32_16x16x32_bf16 v[80:83], v[148:151], a[32:35], v[80:83]
    buffer_load_dwordx4 v[252:255], v30, s[44:47], s69 offen offset:640 sc1
    v_mfma_f32_16x16x32_bf16 v[84:87], v[148:151], a[36:39], 0
    ds_read_b64_tr_b16 v[130:131], v4 offset:26624
    v_lshl_add_u32 v26, v1, 4, s91
    v_mfma_f32_16x16x32_bf16 v[84:87], v[144:147], a[20:23], v[84:87]
    ds_read_b64_tr_b16 v[132:133], v4 offset:28672
    v_lshl_add_u32 v0, v1, 3, s91
    v_mfma_f32_16x16x32_bf16 v[84:87], v[140:143], a[4:7], v[84:87]
    ds_read_b64_tr_b16 v[134:135], v4 offset:30720
    v_mov_b32 v153, 0
    v_mfma_f32_16x16x32_bf16 v[88:91], v[140:143], a[8:11], 0
    ds_read_b64_tr_b16 v[136:137], v4 offset:32768
    v_mov_b32 v154, 0
    v_mfma_f32_16x16x32_bf16 v[88:91], v[144:147], a[24:27], v[88:91]
    v_mfma_f32_16x16x32_bf16 v[88:91], v[148:151], a[40:43], v[88:91]
    ds_read_b64_tr_b16 v[138:139], v4 offset:34816
    v_mov_b32 v2, 0xdddd
    v_mfma_f32_16x16x32_bf16 v[92:95], v[148:151], a[44:47], 0
    ds_read_b32 v152, v25
    ds_read_b32 v155, v25
    v_mfma_f32_16x16x32_bf16 v[92:95], v[144:147], a[28:31], v[92:95]
    v_mfma_f32_16x16x32_bf16 v[92:95], v[140:143], a[12:15], v[92:95]
    s_waitcnt lgkmcnt(2)
    v_mfma_f32_16x16x32_bf16 v[64:67], v[128:131], a[48:51], v[64:67]
    v_mfma_f32_16x16x32_bf16 v[64:67], v[132:135], a[64:67], v[64:67]
    ds_read_b64_tr_b16 v[140:141], v5 offset:24576
    v_mfma_f32_16x16x32_bf16 v[64:67], v[136:139], a[80:83], v[64:67]
    ds_read_b64_tr_b16 v[142:143], v5 offset:26624
    v_mfma_f32_16x16x32_bf16 v[68:71], v[136:139], a[84:87], v[68:71]
    ds_read_b64_tr_b16 v[144:145], v5 offset:28672
    v_mfma_f32_16x16x32_bf16 v[68:71], v[132:135], a[68:71], v[68:71]
    ds_read_b64_tr_b16 v[146:147], v5 offset:30720
    v_mfma_f32_16x16x32_bf16 v[68:71], v[128:131], a[52:55], v[68:71]
    v_mfma_f32_16x16x32_bf16 v[72:75], v[128:131], a[56:59], v[72:75]
    ds_read_b64_tr_b16 v[148:149], v5 offset:32768
    v_mfma_f32_16x16x32_bf16 v[72:75], v[132:135], a[72:75], v[72:75]
    ds_read_b64_tr_b16 v[150:151], v5 offset:34816
    v_mfma_f32_16x16x32_bf16 v[72:75], v[136:139], a[88:91], v[72:75]
    v_mfma_f32_16x16x32_bf16 v[76:79], v[136:139], a[92:95], v[76:79]
    v_mfma_f32_16x16x32_bf16 v[76:79], v[132:135], a[76:79], v[76:79]
    v_mfma_f32_16x16x32_bf16 v[76:79], v[128:131], a[60:63], v[76:79]
    s_waitcnt lgkmcnt(0)
    v_mfma_f32_16x16x32_bf16 v[80:83], v[140:143], a[48:51], v[80:83]
    s_waitcnt vmcnt(17)
    s_barrier
    v_mfma_f32_16x16x32_bf16 v[80:83], v[144:147], a[64:67], v[80:83]
    ds_read_b64_tr_b16 v[128:129], v4 offset:36864
    v_mfma_f32_16x16x32_bf16 v[80:83], v[148:151], a[80:83], v[80:83]
    v_mfma_f32_16x16x32_bf16 v[84:87], v[148:151], a[84:87], v[84:87]
    ds_read_b64_tr_b16 v[130:131], v4 offset:38912
    v_mfma_f32_16x16x32_bf16 v[84:87], v[144:147], a[68:71], v[84:87]
    ds_read_b64_tr_b16 v[132:133], v4 offset:40960
    v_mfma_f32_16x16x32_bf16 v[84:87], v[140:143], a[52:55], v[84:87]
    ds_read_b64_tr_b16 v[134:135], v4 offset:43008
    v_mfma_f32_16x16x32_bf16 v[88:91], v[140:143], a[56:59], v[88:91]
    ds_read_b64_tr_b16 v[136:137], v4 offset:45056
    v_mfma_f32_16x16x32_bf16 v[88:91], v[144:147], a[72:75], v[88:91]
    v_mfma_f32_16x16x32_bf16 v[88:91], v[148:151], a[88:91], v[88:91]
    ds_read_b64_tr_b16 v[138:139], v4 offset:47104
    v_mfma_f32_16x16x32_bf16 v[92:95], v[148:151], a[92:95], v[92:95]
    v_mfma_f32_16x16x32_bf16 v[92:95], v[144:147], a[76:79], v[92:95]
    v_mfma_f32_16x16x32_bf16 v[92:95], v[140:143], a[60:63], v[92:95]
    s_waitcnt lgkmcnt(0)
    v_mfma_f32_16x16x32_bf16 v[64:67], v[128:131], a[96:99], v[64:67]
    v_mfma_f32_16x16x32_bf16 v[64:67], v[132:135], a[112:115], v[64:67]
    ds_read_b64_tr_b16 v[140:141], v5 offset:36864
    v_mfma_f32_16x16x32_bf16 v[64:67], v[136:139], a[128:131], v[64:67]
    ds_read_b64_tr_b16 v[142:143], v5 offset:38912
    v_mfma_f32_16x16x32_bf16 v[68:71], v[136:139], a[132:135], v[68:71]
    ds_read_b64_tr_b16 v[144:145], v5 offset:40960
    v_mfma_f32_16x16x32_bf16 v[68:71], v[132:135], a[116:119], v[68:71]
    ds_read_b64_tr_b16 v[146:147], v5 offset:43008
    v_mfma_f32_16x16x32_bf16 v[68:71], v[128:131], a[100:103], v[68:71]
    v_mfma_f32_16x16x32_bf16 v[72:75], v[128:131], a[104:107], v[72:75]
    ds_read_b64_tr_b16 v[148:149], v5 offset:45056
    v_mfma_f32_16x16x32_bf16 v[72:75], v[132:135], a[120:123], v[72:75]
    ds_read_b64_tr_b16 v[150:151], v5 offset:47104
    v_mfma_f32_16x16x32_bf16 v[72:75], v[136:139], a[136:139], v[72:75]
    ds_read_b128 v[4:7], v24
    v_mfma_f32_16x16x32_bf16 v[76:79], v[136:139], a[140:143], v[76:79]
    v_mfma_f32_16x16x32_bf16 v[76:79], v[132:135], a[124:127], v[76:79]
    v_mfma_f32_16x16x32_bf16 v[76:79], v[128:131], a[108:111], v[76:79]
    s_waitcnt lgkmcnt(1)
    v_mfma_f32_16x16x32_bf16 v[80:83], v[140:143], a[96:99], v[80:83]
    v_mfma_f32_16x16x32_bf16 v[80:83], v[144:147], a[112:115], v[80:83]
    v_cvt_pk_bf16_f32 v64, v64, v65
    v_cvt_pk_bf16_f32 v65, v66, v67
    v_mfma_f32_16x16x32_bf16 v[80:83], v[148:151], a[128:131], v[80:83]
    v_mfma_f32_16x16x32_bf16 v[84:87], v[148:151], a[132:135], v[84:87]
    v_cvt_pk_bf16_f32 v66, v68, v69
    v_cvt_pk_bf16_f32 v67, v70, v71
    v_mfma_f32_16x16x32_bf16 v[84:87], v[144:147], a[116:119], v[84:87]
    s_mov_b32 s94, 32768
    v_mfma_f32_16x16x32_bf16 v[84:87], v[140:143], a[100:103], v[84:87]
    v_mfma_f32_16x16x32_bf16 v[88:91], v[140:143], a[104:107], v[88:91]
    v_mfma_f32_16x16x32_bf16 v[88:91], v[144:147], a[120:123], v[88:91]
    buffer_store_dwordx4 v[64:67], v27, s[44:47], s94 offen offset:0 sc1
    v_mfma_f32_16x16x32_bf16 v[88:91], v[148:151], a[136:139], v[88:91]
    v_cvt_pk_bf16_f32 v72, v72, v73
    v_cvt_pk_bf16_f32 v73, v74, v75
    v_mfma_f32_16x16x32_bf16 v[92:95], v[148:151], a[140:143], v[92:95]
    v_cvt_pk_bf16_f32 v74, v76, v77
    v_cvt_pk_bf16_f32 v75, v78, v79
    v_mfma_f32_16x16x32_bf16 v[92:95], v[144:147], a[124:127], v[92:95]
    v_mfma_f32_16x16x32_bf16 v[92:95], v[140:143], a[108:111], v[92:95]
    buffer_store_dwordx4 v[72:75], v27, s[44:47], s94 offen offset:1024 sc1
    s_waitcnt lgkmcnt(0)
    v_mfma_f32_32x32x16_bf16 v[96:111], v[160:163], v[4:7], 0
    v_mfma_f32_32x32x8_bf16 v[96:111], v[224:225], v[152:153], v[96:111]
    s_nop 3
    v_cvt_pk_bf16_f32 v80, v80, v81
    v_cvt_pk_bf16_f32 v81, v82, v83
    v_cvt_pk_bf16_f32 v82, v84, v85
    v_cvt_pk_bf16_f32 v83, v86, v87
    buffer_store_dwordx4 v[80:83], v27, s[44:47], s94 offen offset:2048 sc1
    v_cvt_pk_bf16_f32 v88, v88, v89
    v_cvt_pk_bf16_f32 v89, v90, v91
    v_cvt_pk_bf16_f32 v90, v92, v93
    v_cvt_pk_bf16_f32 v91, v94, v95
    buffer_store_dwordx4 v[88:91], v27, s[44:47], s94 offen offset:3072 sc1
    s_nop 1
    v_mfma_f32_32x32x16_bf16 v[112:127], v[164:167], v[4:7], 0
    v_exp_f32 v96, v96
    v_exp_f32 v97, v97
    v_exp_f32 v98, v98
    v_exp_f32 v99, v99
    v_mfma_f32_32x32x8_bf16 v[112:127], v[224:225], v[154:155], v[112:127]
    v_exp_f32 v100, v100
    v_exp_f32 v101, v101
    s_mov_b32 s69, 11520
    buffer_load_dwordx4 a[0:3], v30, s[44:47], s69 offen offset:3200 sc1
    s_mov_b32 s95, 28672
    buffer_store_dwordx4 v[48:51], v27, s[44:47], s95 offen offset:0 sc1
    v_mov_b64 v[128:129], 0
    v_mov_b64 v[130:131], 0
    v_mov_b64 v[132:133], 0
    v_mov_b64 v[134:135], 0
    v_mov_b64 v[136:137], 0
    v_exp_f32 v102, v102
    v_exp_f32 v103, v103
    v_exp_f32 v104, v104
    v_exp_f32 v105, v105
    v_exp_f32 v106, v106
    v_exp_f32 v107, v107
    v_smfmac_f32_32x32x32_bf16 v[128:143], a[144:147], v[96:103], v2
    v_exp_f32 v108, v108
    v_exp_f32 v109, v109
    s_mov_b32 s69, 15360
    buffer_load_dwordx4 a[4:7], v30, s[44:47], s69 offen offset:0 sc1
    v_exp_f32 v110, v110
    v_exp_f32 v111, v111
    v_mfma_f32_32x32x16_bf16 v[64:79], v[168:171], v[4:7], 0
    v_exp_f32 v112, v112
    v_exp_f32 v113, v113
    v_exp_f32 v114, v114
    v_exp_f32 v115, v115
    v_mfma_f32_32x32x8_bf16 v[64:79], v[226:227], v[152:153], v[64:79]
    v_exp_f32 v116, v116
    v_exp_f32 v117, v117
    buffer_load_dwordx4 a[8:11], v30, s[44:47], s69 offen offset:640 sc1
    buffer_store_dwordx4 v[52:55], v27, s[44:47], s95 offen offset:1024 sc1
    v_exp_f32 v118, v118
    v_exp_f32 v119, v119
    v_smfmac_f32_32x32x32_bf16 v[128:143], a[148:151], v[104:111], v2
    v_exp_f32 v120, v120
    v_exp_f32 v121, v121
    v_exp_f32 v122, v122
    v_exp_f32 v123, v123
    v_smfmac_f32_32x32x32_bf16 v[128:143], a[152:155], v[112:119], v2
    v_exp_f32 v124, v124
    v_exp_f32 v125, v125
    buffer_load_dwordx4 a[12:15], v30, s[44:47], s69 offen offset:1280 sc1
    v_exp_f32 v126, v126
    v_exp_f32 v127, v127
    v_mfma_f32_32x32x16_bf16 v[80:95], v[172:175], v[4:7], 0
    v_exp_f32 v64, v64
    v_exp_f32 v65, v65
    v_exp_f32 v66, v66
    v_exp_f32 v67, v67
    v_mfma_f32_32x32x8_bf16 v[80:95], v[226:227], v[154:155], v[80:95]
    v_exp_f32 v68, v68
    v_exp_f32 v69, v69
    buffer_load_dwordx4 a[16:19], v30, s[44:47], s69 offen offset:1920 sc1
    buffer_store_dwordx4 v[56:59], v27, s[44:47], s95 offen offset:2048 sc1
    v_exp_f32 v70, v70
    v_exp_f32 v71, v71
    v_smfmac_f32_32x32x32_bf16 v[128:143], a[156:159], v[120:127], v2
    v_exp_f32 v72, v72
    v_exp_f32 v73, v73
    v_exp_f32 v74, v74
    v_exp_f32 v75, v75
    v_smfmac_f32_32x32x32_bf16 v[128:143], a[160:163], v[64:71], v2
    v_exp_f32 v76, v76
    v_exp_f32 v77, v77
    v_exp_f32 v78, v78
    v_exp_f32 v79, v79
    v_mfma_f32_32x32x16_bf16 v[96:111], v[176:179], v[4:7], 0
    v_exp_f32 v80, v80
    v_exp_f32 v81, v81
    v_exp_f32 v82, v82
    v_exp_f32 v83, v83
    v_mfma_f32_32x32x8_bf16 v[96:111], v[228:229], v[152:153], v[96:111]
    v_exp_f32 v84, v84
    v_exp_f32 v85, v85
    buffer_store_dwordx4 v[60:63], v27, s[44:47], s95 offen offset:3072 sc1
    v_exp_f32 v86, v86
    v_exp_f32 v87, v87
    v_smfmac_f32_32x32x32_bf16 v[128:143], a[164:167], v[72:79], v2
    v_exp_f32 v88, v88
    v_exp_f32 v89, v89
    v_exp_f32 v90, v90
    v_exp_f32 v91, v91
    v_smfmac_f32_32x32x32_bf16 v[128:143], a[168:171], v[80:87], v2
    v_exp_f32 v92, v92
    v_exp_f32 v93, v93
    s_waitcnt lgkmcnt(0)
    s_barrier
    v_exp_f32 v94, v94
    v_exp_f32 v95, v95
    v_mfma_f32_32x32x16_bf16 v[112:127], v[180:183], v[4:7], 0
    v_exp_f32 v96, v96
    v_exp_f32 v97, v97
    v_exp_f32 v98, v98
    v_exp_f32 v99, v99
    v_mfma_f32_32x32x8_bf16 v[112:127], v[228:229], v[154:155], v[112:127]
    v_exp_f32 v100, v100
    v_exp_f32 v101, v101
    s_waitcnt vmcnt(28)
    v_exp_f32 v102, v102
    v_exp_f32 v103, v103
    v_smfmac_f32_32x32x32_bf16 v[128:143], a[172:175], v[88:95], v2
    v_exp_f32 v104, v104
    v_exp_f32 v105, v105
    v_exp_f32 v106, v106
    v_exp_f32 v107, v107
    v_smfmac_f32_32x32x32_bf16 v[128:143], a[176:179], v[96:103], v2
    v_exp_f32 v108, v108
    v_exp_f32 v109, v109
    v_exp_f32 v110, v110
    v_exp_f32 v111, v111
    v_mfma_f32_32x32x16_bf16 v[64:79], v[184:187], v[4:7], 0
    v_exp_f32 v112, v112
    v_exp_f32 v113, v113
    v_exp_f32 v114, v114
    v_exp_f32 v115, v115
    v_mfma_f32_32x32x8_bf16 v[64:79], v[230:231], v[152:153], v[64:79]
    v_exp_f32 v116, v116
    v_exp_f32 v117, v117
    s_waitcnt vmcnt(26)
    v_exp_f32 v118, v118
    v_exp_f32 v119, v119
    v_smfmac_f32_32x32x32_bf16 v[128:143], a[180:183], v[104:111], v2
    v_exp_f32 v120, v120
    v_exp_f32 v121, v121
    v_exp_f32 v122, v122
    v_exp_f32 v123, v123
    v_smfmac_f32_32x32x32_bf16 v[128:143], a[184:187], v[112:119], v2
    v_exp_f32 v124, v124
    v_exp_f32 v125, v125
    v_exp_f32 v126, v126
    v_exp_f32 v127, v127
    v_mfma_f32_32x32x16_bf16 v[80:95], v[188:191], v[4:7], 0
    v_exp_f32 v64, v64
    v_exp_f32 v65, v65
    v_exp_f32 v66, v66
    v_exp_f32 v67, v67
    v_mfma_f32_32x32x8_bf16 v[80:95], v[230:231], v[154:155], v[80:95]
    v_exp_f32 v68, v68
    v_exp_f32 v69, v69
    s_waitcnt vmcnt(24)
    v_exp_f32 v70, v70
    v_exp_f32 v71, v71
    v_smfmac_f32_32x32x32_bf16 v[128:143], a[188:191], v[120:127], v2
    v_exp_f32 v72, v72
    v_exp_f32 v73, v73
    v_exp_f32 v74, v74
    v_exp_f32 v75, v75
    v_smfmac_f32_32x32x32_bf16 v[128:143], a[192:195], v[64:71], v2
    v_exp_f32 v76, v76
    v_exp_f32 v77, v77
    v_exp_f32 v78, v78
    v_exp_f32 v79, v79
    v_mfma_f32_32x32x16_bf16 v[96:111], v[192:195], v[4:7], 0
    v_exp_f32 v80, v80
    v_exp_f32 v81, v81
    v_exp_f32 v82, v82
    v_exp_f32 v83, v83
    v_mfma_f32_32x32x8_bf16 v[96:111], v[232:233], v[152:153], v[96:111]
    v_exp_f32 v84, v84
    v_exp_f32 v85, v85
    s_waitcnt vmcnt(22)
    v_exp_f32 v86, v86
    v_exp_f32 v87, v87
    v_smfmac_f32_32x32x32_bf16 v[128:143], a[196:199], v[72:79], v2
    v_exp_f32 v88, v88
    v_exp_f32 v89, v89
    v_exp_f32 v90, v90
    v_exp_f32 v91, v91
    v_smfmac_f32_32x32x32_bf16 v[128:143], a[200:203], v[80:87], v2
    v_exp_f32 v92, v92
    v_exp_f32 v93, v93
    v_exp_f32 v94, v94
    v_exp_f32 v95, v95
    v_mfma_f32_32x32x16_bf16 v[112:127], v[196:199], v[4:7], 0
    v_exp_f32 v96, v96
    v_exp_f32 v97, v97
    v_exp_f32 v98, v98
    v_exp_f32 v99, v99
    v_mfma_f32_32x32x8_bf16 v[112:127], v[232:233], v[154:155], v[112:127]
    v_exp_f32 v100, v100
    v_exp_f32 v101, v101
    s_waitcnt vmcnt(20)
    v_exp_f32 v102, v102
    v_exp_f32 v103, v103
    v_smfmac_f32_32x32x32_bf16 v[128:143], a[204:207], v[88:95], v2
    v_exp_f32 v104, v104
    v_exp_f32 v105, v105
    v_exp_f32 v106, v106
    v_exp_f32 v107, v107
    v_smfmac_f32_32x32x32_bf16 v[128:143], a[208:211], v[96:103], v2
    v_exp_f32 v108, v108
    v_exp_f32 v109, v109
    v_mov_b32 v57, 0
    v_mov_b32 v58, 0
    v_mov_b32 v61, 0
    v_mov_b32 v62, 0
    s_mov_b32 m0, s81
    v_exp_f32 v110, v110
    v_exp_f32 v111, v111
    v_mfma_f32_32x32x16_bf16 v[64:79], v[200:203], v[4:7], 0
    v_exp_f32 v112, v112
    v_exp_f32 v113, v113
    v_exp_f32 v114, v114
    v_exp_f32 v115, v115
    v_mfma_f32_32x32x8_bf16 v[64:79], v[234:235], v[152:153], v[64:79]
    v_exp_f32 v116, v116
    v_exp_f32 v117, v117
    s_waitcnt vmcnt(18)
    buffer_load_dwordx4 v10, s[32:35], s86 offen offset:0 lds
    v_exp_f32 v118, v118
    v_exp_f32 v119, v119
    v_smfmac_f32_32x32x32_bf16 v[128:143], a[212:215], v[104:111], v2
    v_exp_f32 v120, v120
    v_exp_f32 v121, v121
    v_exp_f32 v122, v122
    v_exp_f32 v123, v123
    v_smfmac_f32_32x32x32_bf16 v[128:143], a[216:219], v[112:119], v2
    v_exp_f32 v124, v124
    v_exp_f32 v125, v125
    v_exp_f32 v126, v126
    v_exp_f32 v127, v127
    v_mfma_f32_32x32x16_bf16 v[80:95], v[204:207], v[4:7], 0
    v_exp_f32 v64, v64
    v_exp_f32 v65, v65
    v_exp_f32 v66, v66
    v_exp_f32 v67, v67
    v_mfma_f32_32x32x8_bf16 v[80:95], v[234:235], v[154:155], v[80:95]
    v_exp_f32 v68, v68
    v_exp_f32 v69, v69
    s_waitcnt vmcnt(18)
    buffer_load_dwordx4 v11, s[32:35], s86 offen offset:1024 lds
    v_exp_f32 v70, v70
    v_exp_f32 v71, v71
    v_smfmac_f32_32x32x32_bf16 v[128:143], a[220:223], v[120:127], v2
    v_exp_f32 v72, v72
    v_exp_f32 v73, v73
    v_exp_f32 v74, v74
    v_exp_f32 v75, v75
    v_smfmac_f32_32x32x32_bf16 v[128:143], a[224:227], v[64:71], v2
    v_exp_f32 v76, v76
    v_exp_f32 v77, v77
    v_exp_f32 v78, v78
    v_exp_f32 v79, v79
    v_mfma_f32_32x32x16_bf16 v[96:111], v[208:211], v[4:7], 0
    v_exp_f32 v80, v80
    v_exp_f32 v81, v81
    v_exp_f32 v82, v82
    v_exp_f32 v83, v83
    v_mfma_f32_32x32x8_bf16 v[96:111], v[236:237], v[152:153], v[96:111]
    v_exp_f32 v84, v84
    v_exp_f32 v85, v85
    s_waitcnt vmcnt(10)
    buffer_load_dwordx4 v12, s[32:35], s86 offen offset:2048 lds
    v_exp_f32 v86, v86
    v_exp_f32 v87, v87
    v_smfmac_f32_32x32x32_bf16 v[128:143], a[228:231], v[72:79], v2
    v_exp_f32 v88, v88
    v_exp_f32 v89, v89
    v_exp_f32 v90, v90
    v_exp_f32 v91, v91
    v_smfmac_f32_32x32x32_bf16 v[128:143], a[232:235], v[80:87], v2
    v_exp_f32 v92, v92
    v_exp_f32 v93, v93
    s_mov_b32 m0, s82
    v_exp_f32 v94, v94
    v_exp_f32 v95, v95
    v_mfma_f32_32x32x16_bf16 v[112:127], v[212:215], v[4:7], 0
    v_exp_f32 v96, v96
    v_exp_f32 v97, v97
    v_exp_f32 v98, v98
    v_exp_f32 v99, v99
    v_mfma_f32_32x32x8_bf16 v[112:127], v[236:237], v[154:155], v[112:127]
    v_exp_f32 v100, v100
    v_exp_f32 v101, v101
    s_waitcnt vmcnt(8)
    s_mov_b32 s94, 24576
    buffer_store_dwordx4 v[32:35], v27, s[44:47], s94 offen offset:0 sc1
    buffer_load_dwordx4 v10, s[32:35], s87 offen offset:0 lds
    v_exp_f32 v102, v102
    v_exp_f32 v103, v103
    v_smfmac_f32_32x32x32_bf16 v[128:143], a[0:3], v[88:95], v2
    v_exp_f32 v104, v104
    v_exp_f32 v105, v105
    v_exp_f32 v106, v106
    v_exp_f32 v107, v107
    v_smfmac_f32_32x32x32_bf16 v[128:143], a[4:7], v[96:103], v2
    v_exp_f32 v108, v108
    v_exp_f32 v109, v109
    ds_read_b128 v[28:31], v24 offset:1024
    v_exp_f32 v110, v110
    v_exp_f32 v111, v111
    v_mfma_f32_32x32x16_bf16 v[64:79], v[216:219], v[4:7], 0
    v_exp_f32 v112, v112
    v_exp_f32 v113, v113
    v_exp_f32 v114, v114
    v_exp_f32 v115, v115
    v_mfma_f32_32x32x8_bf16 v[64:79], v[238:239], v[152:153], v[64:79]
    v_exp_f32 v116, v116
    v_exp_f32 v117, v117
    s_waitcnt vmcnt(7)
    buffer_load_dwordx4 v11, s[32:35], s87 offen offset:1024 lds
    v_exp_f32 v118, v118
    v_exp_f32 v119, v119
    v_smfmac_f32_32x32x32_bf16 v[128:143], a[8:11], v[104:111], v2
    v_exp_f32 v120, v120
    v_exp_f32 v121, v121
    v_exp_f32 v122, v122
    v_exp_f32 v123, v123
    v_smfmac_f32_32x32x32_bf16 v[128:143], a[12:15], v[112:119], v2
    v_exp_f32 v124, v124
    v_exp_f32 v125, v125
    ds_read_b32 v60, v25 offset:256
    v_exp_f32 v126, v126
    v_exp_f32 v127, v127
    v_mfma_f32_32x32x16_bf16 v[80:95], v[220:223], v[4:7], 0
    v_exp_f32 v64, v64
    v_exp_f32 v65, v65
    v_exp_f32 v66, v66
    v_exp_f32 v67, v67
    v_mfma_f32_32x32x8_bf16 v[80:95], v[238:239], v[154:155], v[80:95]
    v_exp_f32 v68, v68
    v_exp_f32 v69, v69
    buffer_load_dwordx4 v12, s[32:35], s87 offen offset:2048 lds
    v_exp_f32 v70, v70
    v_exp_f32 v71, v71
    v_smfmac_f32_32x32x32_bf16 v[128:143], a[16:19], v[120:127], v2
    v_exp_f32 v72, v72
    v_exp_f32 v73, v73
    v_exp_f32 v74, v74
    v_exp_f32 v75, v75
    v_smfmac_f32_32x32x32_bf16 v[128:143], v[240:243], v[64:71], v2
    v_exp_f32 v76, v76
    v_exp_f32 v77, v77
    s_mov_b32 m0, s83
    v_exp_f32 v78, v78
    v_exp_f32 v79, v79
    s_waitcnt lgkmcnt(0)
    v_mfma_f32_32x32x16_bf16 v[96:111], v[160:163], v[28:31], 0
    v_exp_f32 v80, v80
    v_exp_f32 v81, v81
    v_exp_f32 v82, v82
    v_exp_f32 v83, v83
    v_mfma_f32_32x32x8_bf16 v[96:111], v[224:225], v[60:61], v[96:111]
    v_exp_f32 v84, v84
    v_exp_f32 v85, v85
    buffer_store_dwordx4 v[36:39], v27, s[44:47], s94 offen offset:1024 sc1
    buffer_load_dwordx4 v10, s[32:35], s88 offen offset:0 lds
    v_exp_f32 v86, v86
    v_exp_f32 v87, v87
    v_smfmac_f32_32x32x32_bf16 v[128:143], v[244:247], v[72:79], v2
    v_exp_f32 v88, v88
    v_exp_f32 v89, v89
    v_exp_f32 v90, v90
    v_exp_f32 v91, v91
    v_smfmac_f32_32x32x32_bf16 v[128:143], v[248:251], v[80:87], v2
    v_exp_f32 v92, v92
    v_exp_f32 v93, v93
    v_mov_b32 v63, v60
    v_exp_f32 v94, v94
    v_exp_f32 v95, v95
    v_mfma_f32_32x32x16_bf16 v[112:127], v[164:167], v[28:31], 0
    v_exp_f32 v96, v96
    v_exp_f32 v97, v97
    v_exp_f32 v98, v98
    v_exp_f32 v99, v99
    v_mfma_f32_32x32x8_bf16 v[112:127], v[224:225], v[62:63], v[112:127]
    v_exp_f32 v100, v100
    v_exp_f32 v101, v101
    buffer_load_dwordx4 v11, s[32:35], s88 offen offset:1024 lds
    v_mov_b64 v[144:145], 0
    v_mov_b64 v[146:147], 0
    v_mov_b64 v[148:149], 0
    v_mov_b64 v[150:151], 0
    v_mov_b64 v[152:153], 0
    v_exp_f32 v102, v102
    v_exp_f32 v103, v103
    v_smfmac_f32_32x32x32_bf16 v[128:143], v[252:255], v[88:95], v2
    v_exp_f32 v104, v104
    v_exp_f32 v105, v105
    v_exp_f32 v106, v106
    v_exp_f32 v107, v107
    v_smfmac_f32_32x32x32_bf16 v[144:159], a[144:147], v[96:103], v2
    v_exp_f32 v108, v108
    v_exp_f32 v109, v109
    v_exp_f32 v110, v110
    v_exp_f32 v111, v111
    v_mfma_f32_32x32x16_bf16 v[64:79], v[168:171], v[28:31], 0
    v_exp_f32 v112, v112
    v_exp_f32 v113, v113
    v_exp_f32 v114, v114
    v_exp_f32 v115, v115
    v_mfma_f32_32x32x8_bf16 v[64:79], v[226:227], v[60:61], v[64:79]
    v_exp_f32 v116, v116
    v_exp_f32 v117, v117
    buffer_load_dwordx4 v12, s[32:35], s88 offen offset:2048 lds
    v_exp_f32 v118, v118
    v_exp_f32 v119, v119
    v_smfmac_f32_32x32x32_bf16 v[144:159], a[148:151], v[104:111], v2
    v_exp_f32 v120, v120
    v_exp_f32 v121, v121
    v_exp_f32 v122, v122
    v_exp_f32 v123, v123
    v_smfmac_f32_32x32x32_bf16 v[144:159], a[152:155], v[112:119], v2
    v_exp_f32 v124, v124
    v_exp_f32 v125, v125
    ds_write_b128 v26, v[128:131] offset:0
    s_mov_b32 m0, s84
    v_exp_f32 v126, v126
    v_exp_f32 v127, v127
    v_mfma_f32_32x32x16_bf16 v[80:95], v[172:175], v[28:31], 0
    v_exp_f32 v64, v64
    v_exp_f32 v65, v65
    v_exp_f32 v66, v66
    v_exp_f32 v67, v67
    v_mfma_f32_32x32x8_bf16 v[80:95], v[226:227], v[62:63], v[80:95]
    v_exp_f32 v68, v68
    v_exp_f32 v69, v69
    buffer_store_dwordx4 v[40:43], v27, s[44:47], s94 offen offset:2048 sc1
    buffer_load_dwordx4 v10, s[32:35], s89 offen offset:0 lds
    v_exp_f32 v70, v70
    v_exp_f32 v71, v71
    v_smfmac_f32_32x32x32_bf16 v[144:159], a[156:159], v[120:127], v2
    v_exp_f32 v72, v72
    v_exp_f32 v73, v73
    v_exp_f32 v74, v74
    v_exp_f32 v75, v75
    v_smfmac_f32_32x32x32_bf16 v[144:159], a[160:163], v[64:71], v2
    v_exp_f32 v76, v76
    v_exp_f32 v77, v77
    ds_write_b128 v26, v[132:135] offset:1024
    v_exp_f32 v78, v78
    v_exp_f32 v79, v79
    v_mfma_f32_32x32x16_bf16 v[96:111], v[176:179], v[28:31], 0
    v_exp_f32 v80, v80
    v_exp_f32 v81, v81
    v_exp_f32 v82, v82
    v_exp_f32 v83, v83
    v_mfma_f32_32x32x8_bf16 v[96:111], v[228:229], v[60:61], v[96:111]
    v_exp_f32 v84, v84
    v_exp_f32 v85, v85
    buffer_load_dwordx4 v11, s[32:35], s89 offen offset:1024 lds
    v_exp_f32 v86, v86
    v_exp_f32 v87, v87
    v_smfmac_f32_32x32x32_bf16 v[144:159], a[164:167], v[72:79], v2
    v_exp_f32 v88, v88
    v_exp_f32 v89, v89
    v_exp_f32 v90, v90
    v_exp_f32 v91, v91
    v_smfmac_f32_32x32x32_bf16 v[144:159], a[168:171], v[80:87], v2
    v_exp_f32 v92, v92
    v_exp_f32 v93, v93
    ds_write_b64 v0, v[136:137] offset:2048
    v_exp_f32 v94, v94
    v_exp_f32 v95, v95
    v_mfma_f32_32x32x16_bf16 v[112:127], v[180:183], v[28:31], 0
    v_exp_f32 v96, v96
    v_exp_f32 v97, v97
    v_exp_f32 v98, v98
    v_exp_f32 v99, v99
    v_mfma_f32_32x32x8_bf16 v[112:127], v[228:229], v[62:63], v[112:127]
    v_exp_f32 v100, v100
    v_exp_f32 v101, v101
    buffer_load_dwordx4 v12, s[32:35], s89 offen offset:2048 lds
    v_exp_f32 v102, v102
    v_exp_f32 v103, v103
    v_smfmac_f32_32x32x32_bf16 v[144:159], a[172:175], v[88:95], v2
    v_exp_f32 v104, v104
    v_exp_f32 v105, v105
    v_exp_f32 v106, v106
    v_exp_f32 v107, v107
    v_smfmac_f32_32x32x32_bf16 v[144:159], a[176:179], v[96:103], v2
    v_exp_f32 v108, v108
    v_exp_f32 v109, v109
    s_mov_b32 m0, s85
    v_exp_f32 v110, v110
    v_exp_f32 v111, v111
    v_mfma_f32_32x32x16_bf16 v[64:79], v[184:187], v[28:31], 0
    v_exp_f32 v112, v112
    v_exp_f32 v113, v113
    v_exp_f32 v114, v114
    v_exp_f32 v115, v115
    v_mfma_f32_32x32x8_bf16 v[64:79], v[230:231], v[60:61], v[64:79]
    v_exp_f32 v116, v116
    v_exp_f32 v117, v117
    buffer_store_dwordx4 v[44:47], v27, s[44:47], s94 offen offset:3072 sc1
    buffer_load_dwordx4 v10, s[32:35], s90 offen offset:0 lds
    v_exp_f32 v118, v118
    v_exp_f32 v119, v119
    v_smfmac_f32_32x32x32_bf16 v[144:159], a[180:183], v[104:111], v2
    v_exp_f32 v120, v120
    v_exp_f32 v121, v121
    v_exp_f32 v122, v122
    v_exp_f32 v123, v123
    v_smfmac_f32_32x32x32_bf16 v[144:159], a[184:187], v[112:119], v2
    v_exp_f32 v124, v124
    v_exp_f32 v125, v125
    ds_read_b128 v[4:7], v24 offset:2048
    v_exp_f32 v126, v126
    v_exp_f32 v127, v127
    v_mfma_f32_32x32x16_bf16 v[80:95], v[188:191], v[28:31], 0
    v_exp_f32 v64, v64
    v_exp_f32 v65, v65
    v_exp_f32 v66, v66
    v_exp_f32 v67, v67
    v_mfma_f32_32x32x8_bf16 v[80:95], v[230:231], v[62:63], v[80:95]
    v_exp_f32 v68, v68
    v_exp_f32 v69, v69
    buffer_load_dwordx4 v11, s[32:35], s90 offen offset:1024 lds
    v_exp_f32 v70, v70
    v_exp_f32 v71, v71
    v_smfmac_f32_32x32x32_bf16 v[144:159], a[188:191], v[120:127], v2
    v_exp_f32 v72, v72
    v_exp_f32 v73, v73
    v_exp_f32 v74, v74
    v_exp_f32 v75, v75
    v_smfmac_f32_32x32x32_bf16 v[144:159], a[192:195], v[64:71], v2
    v_exp_f32 v76, v76
    v_exp_f32 v77, v77
    ds_read_b32 v56, v25 offset:512
    v_exp_f32 v78, v78
    v_exp_f32 v79, v79
    v_mfma_f32_32x32x16_bf16 v[96:111], v[192:195], v[28:31], 0
    v_exp_f32 v80, v80
    v_exp_f32 v81, v81
    v_exp_f32 v82, v82
    v_exp_f32 v83, v83
    v_mfma_f32_32x32x8_bf16 v[96:111], v[232:233], v[60:61], v[96:111]
    v_exp_f32 v84, v84
    v_exp_f32 v85, v85
    buffer_load_dwordx4 v12, s[32:35], s90 offen offset:2048 lds
    v_exp_f32 v86, v86
    v_exp_f32 v87, v87
    v_smfmac_f32_32x32x32_bf16 v[144:159], a[196:199], v[72:79], v2
    v_exp_f32 v88, v88
    v_exp_f32 v89, v89
    v_exp_f32 v90, v90
    v_exp_f32 v91, v91
    v_smfmac_f32_32x32x32_bf16 v[144:159], a[200:203], v[80:87], v2
    v_exp_f32 v92, v92
    v_exp_f32 v93, v93
    v_mov_b64 v[32:33], -1
    v_mov_b64 v[34:35], -1
    v_exp_f32 v94, v94
    v_exp_f32 v95, v95
    v_mfma_f32_32x32x16_bf16 v[112:127], v[196:199], v[28:31], 0
    v_exp_f32 v96, v96
    v_exp_f32 v97, v97
    v_exp_f32 v98, v98
    v_exp_f32 v99, v99
    v_mfma_f32_32x32x8_bf16 v[112:127], v[232:233], v[62:63], v[112:127]
    v_exp_f32 v100, v100
    v_exp_f32 v101, v101
    buffer_store_dwordx4 v[32:35], v13, s[44:47], 0 offen sc1
    v_exp_f32 v102, v102
    v_exp_f32 v103, v103
    v_smfmac_f32_32x32x32_bf16 v[144:159], a[204:207], v[88:95], v2
    v_exp_f32 v104, v104
    v_exp_f32 v105, v105
    v_exp_f32 v106, v106
    v_exp_f32 v107, v107
    v_smfmac_f32_32x32x32_bf16 v[144:159], a[208:211], v[96:103], v2
    v_exp_f32 v108, v108
    v_exp_f32 v109, v109
    s_waitcnt lgkmcnt(0)
    v_mov_b32 v59, v56
    v_exp_f32 v110, v110
    v_exp_f32 v111, v111
    v_mfma_f32_32x32x16_bf16 v[64:79], v[200:203], v[28:31], 0
    v_exp_f32 v112, v112
    v_exp_f32 v113, v113
    v_exp_f32 v114, v114
    v_exp_f32 v115, v115
    v_mfma_f32_32x32x8_bf16 v[64:79], v[234:235], v[60:61], v[64:79]
    v_exp_f32 v116, v116
    v_exp_f32 v117, v117
    buffer_store_dwordx4 v[32:35], v13, s[44:47], s5 offen sc1
    v_exp_f32 v118, v118
    v_exp_f32 v119, v119
    v_smfmac_f32_32x32x32_bf16 v[144:159], a[212:215], v[104:111], v2
    v_exp_f32 v120, v120
    v_exp_f32 v121, v121
    v_exp_f32 v122, v122
    v_exp_f32 v123, v123
    v_smfmac_f32_32x32x32_bf16 v[144:159], a[216:219], v[112:119], v2
    v_exp_f32 v124, v124
    v_exp_f32 v125, v125
    v_exp_f32 v126, v126
    v_exp_f32 v127, v127
    v_mfma_f32_32x32x16_bf16 v[80:95], v[204:207], v[28:31], 0
    v_exp_f32 v64, v64
    v_exp_f32 v65, v65
    v_exp_f32 v66, v66
    v_exp_f32 v67, v67
    v_mfma_f32_32x32x8_bf16 v[80:95], v[234:235], v[62:63], v[80:95]
    v_exp_f32 v68, v68
    v_exp_f32 v69, v69
    buffer_store_dwordx2 v[32:33], v14, s[44:47], 0 offen sc1
    v_exp_f32 v70, v70
    v_exp_f32 v71, v71
    v_smfmac_f32_32x32x32_bf16 v[144:159], a[220:223], v[120:127], v2
    v_exp_f32 v72, v72
    v_exp_f32 v73, v73
    v_exp_f32 v74, v74
    v_exp_f32 v75, v75
    v_smfmac_f32_32x32x32_bf16 v[144:159], a[224:227], v[64:71], v2
    v_exp_f32 v76, v76
    v_exp_f32 v77, v77
    v_exp_f32 v78, v78
    v_exp_f32 v79, v79
    v_mfma_f32_32x32x16_bf16 v[96:111], v[208:211], v[28:31], 0
    v_exp_f32 v80, v80
    v_exp_f32 v81, v81
    v_exp_f32 v82, v82
    v_exp_f32 v83, v83
    v_mfma_f32_32x32x8_bf16 v[96:111], v[236:237], v[60:61], v[96:111]
    v_exp_f32 v84, v84
    v_exp_f32 v85, v85
    v_exp_f32 v86, v86
    v_exp_f32 v87, v87
    v_smfmac_f32_32x32x32_bf16 v[144:159], a[228:231], v[72:79], v2
    v_exp_f32 v88, v88
    v_exp_f32 v89, v89
    v_exp_f32 v90, v90
    v_exp_f32 v91, v91
    v_smfmac_f32_32x32x32_bf16 v[144:159], a[232:235], v[80:87], v2
    v_exp_f32 v92, v92
    v_exp_f32 v93, v93
    v_mov_b32 v8, 0
    v_exp_f32 v94, v94
    v_exp_f32 v95, v95
    v_mfma_f32_32x32x16_bf16 v[112:127], v[212:215], v[28:31], 0
    v_exp_f32 v96, v96
    v_exp_f32 v97, v97
    v_exp_f32 v98, v98
    v_exp_f32 v99, v99
    v_mfma_f32_32x32x8_bf16 v[112:127], v[236:237], v[62:63], v[112:127]
    v_exp_f32 v100, v100
    v_exp_f32 v101, v101
    global_load_dword v9, v8, s[24:25] sc1
    v_exp_f32 v102, v102
    v_exp_f32 v103, v103
    v_smfmac_f32_32x32x32_bf16 v[144:159], a[0:3], v[88:95], v2
    v_exp_f32 v104, v104
    v_exp_f32 v105, v105
    v_exp_f32 v106, v106
    v_exp_f32 v107, v107
    v_smfmac_f32_32x32x32_bf16 v[144:159], a[4:7], v[96:103], v2
    v_exp_f32 v108, v108
    v_exp_f32 v109, v109
    v_exp_f32 v110, v110
    v_exp_f32 v111, v111
    v_mfma_f32_32x32x16_bf16 v[64:79], v[216:219], v[28:31], 0
    v_exp_f32 v112, v112
    v_exp_f32 v113, v113
    v_exp_f32 v114, v114
    v_exp_f32 v115, v115
    v_mfma_f32_32x32x8_bf16 v[64:79], v[238:239], v[60:61], v[64:79]
    v_exp_f32 v116, v116
    v_exp_f32 v117, v117
    v_exp_f32 v118, v118
    v_exp_f32 v119, v119
    v_smfmac_f32_32x32x32_bf16 v[144:159], a[8:11], v[104:111], v2
    v_exp_f32 v120, v120
    v_exp_f32 v121, v121
    v_exp_f32 v122, v122
    v_exp_f32 v123, v123
    v_smfmac_f32_32x32x32_bf16 v[144:159], a[12:15], v[112:119], v2
    v_exp_f32 v124, v124
    v_exp_f32 v125, v125
    v_exp_f32 v126, v126
    v_exp_f32 v127, v127
    v_mfma_f32_32x32x16_bf16 v[80:95], v[220:223], v[28:31], 0
    v_exp_f32 v64, v64
    v_exp_f32 v65, v65
    v_exp_f32 v66, v66
    v_exp_f32 v67, v67
    v_mfma_f32_32x32x8_bf16 v[80:95], v[238:239], v[62:63], v[80:95]
    v_exp_f32 v68, v68
    v_exp_f32 v69, v69
    v_exp_f32 v70, v70
    v_exp_f32 v71, v71
    v_smfmac_f32_32x32x32_bf16 v[144:159], a[16:19], v[120:127], v2
    v_exp_f32 v72, v72
    v_exp_f32 v73, v73
    v_exp_f32 v74, v74
    v_exp_f32 v75, v75
    v_smfmac_f32_32x32x32_bf16 v[144:159], v[240:243], v[64:71], v2
    v_exp_f32 v76, v76
    v_exp_f32 v77, v77
    v_exp_f32 v78, v78
    v_exp_f32 v79, v79
    v_mfma_f32_32x32x16_bf16 v[96:111], v[160:163], v[4:7], 0
    v_exp_f32 v80, v80
    v_exp_f32 v81, v81
    v_exp_f32 v82, v82
    v_exp_f32 v83, v83
    v_mfma_f32_32x32x8_bf16 v[96:111], v[224:225], v[56:57], v[96:111]
    v_exp_f32 v84, v84
    v_exp_f32 v85, v85
    v_exp_f32 v86, v86
    v_exp_f32 v87, v87
    v_smfmac_f32_32x32x32_bf16 v[144:159], v[244:247], v[72:79], v2
    v_exp_f32 v88, v88
    v_exp_f32 v89, v89
    v_exp_f32 v90, v90
    v_exp_f32 v91, v91
    v_smfmac_f32_32x32x32_bf16 v[144:159], v[248:251], v[80:87], v2
    v_exp_f32 v92, v92
    v_exp_f32 v93, v93
    v_exp_f32 v94, v94
    v_exp_f32 v95, v95
    v_mfma_f32_32x32x16_bf16 v[112:127], v[164:167], v[4:7], 0
    v_exp_f32 v96, v96
    v_exp_f32 v97, v97
    v_exp_f32 v98, v98
    v_exp_f32 v99, v99
    v_mfma_f32_32x32x8_bf16 v[112:127], v[224:225], v[58:59], v[112:127]
    v_exp_f32 v100, v100
    v_exp_f32 v101, v101
    v_mov_b64 v[128:129], 0
    v_mov_b64 v[130:131], 0
    v_mov_b64 v[132:133], 0
    v_mov_b64 v[134:135], 0
    v_mov_b64 v[136:137], 0
    v_exp_f32 v102, v102
    v_exp_f32 v103, v103
    v_smfmac_f32_32x32x32_bf16 v[144:159], v[252:255], v[88:95], v2
    v_exp_f32 v104, v104
    v_exp_f32 v105, v105
    v_exp_f32 v106, v106
    v_exp_f32 v107, v107
    v_smfmac_f32_32x32x32_bf16 v[128:143], a[144:147], v[96:103], v2
    v_exp_f32 v108, v108
    v_exp_f32 v109, v109
    v_exp_f32 v110, v110
    v_exp_f32 v111, v111
    v_mfma_f32_32x32x16_bf16 v[64:79], v[168:171], v[4:7], 0
    v_exp_f32 v112, v112
    v_exp_f32 v113, v113
    v_exp_f32 v114, v114
    v_exp_f32 v115, v115
    v_mfma_f32_32x32x8_bf16 v[64:79], v[226:227], v[56:57], v[64:79]
    v_exp_f32 v116, v116
    v_exp_f32 v117, v117
    v_exp_f32 v118, v118
    v_exp_f32 v119, v119
    v_smfmac_f32_32x32x32_bf16 v[128:143], a[148:151], v[104:111], v2
    v_exp_f32 v120, v120
    v_exp_f32 v121, v121
    v_exp_f32 v122, v122
    v_exp_f32 v123, v123
    v_smfmac_f32_32x32x32_bf16 v[128:143], a[152:155], v[112:119], v2
    v_exp_f32 v124, v124
    v_exp_f32 v125, v125
    ds_write_b128 v26, v[144:147] offset:10240
    v_exp_f32 v126, v126
    v_exp_f32 v127, v127
    v_mfma_f32_32x32x16_bf16 v[80:95], v[172:175], v[4:7], 0
    v_exp_f32 v64, v64
    v_exp_f32 v65, v65
    v_exp_f32 v66, v66
    v_exp_f32 v67, v67
    v_mfma_f32_32x32x8_bf16 v[80:95], v[226:227], v[58:59], v[80:95]
    v_exp_f32 v68, v68
    v_exp_f32 v69, v69
    v_exp_f32 v70, v70
    v_exp_f32 v71, v71
    v_smfmac_f32_32x32x32_bf16 v[128:143], a[156:159], v[120:127], v2
    v_exp_f32 v72, v72
    v_exp_f32 v73, v73
    v_exp_f32 v74, v74
    v_exp_f32 v75, v75
    v_smfmac_f32_32x32x32_bf16 v[128:143], a[160:163], v[64:71], v2
    v_exp_f32 v76, v76
    v_exp_f32 v77, v77
    ds_write_b128 v26, v[148:151] offset:11264
    v_exp_f32 v78, v78
    v_exp_f32 v79, v79
    v_mfma_f32_32x32x16_bf16 v[96:111], v[176:179], v[4:7], 0
    v_exp_f32 v80, v80
    v_exp_f32 v81, v81
    v_exp_f32 v82, v82
    v_exp_f32 v83, v83
    v_mfma_f32_32x32x8_bf16 v[96:111], v[228:229], v[56:57], v[96:111]
    v_exp_f32 v84, v84
    v_exp_f32 v85, v85
    v_exp_f32 v86, v86
    v_exp_f32 v87, v87
    v_smfmac_f32_32x32x32_bf16 v[128:143], a[164:167], v[72:79], v2
    v_exp_f32 v88, v88
    v_exp_f32 v89, v89
    v_exp_f32 v90, v90
    v_exp_f32 v91, v91
    v_smfmac_f32_32x32x32_bf16 v[128:143], a[168:171], v[80:87], v2
    v_exp_f32 v92, v92
    v_exp_f32 v93, v93
    ds_write_b64 v0, v[152:153] offset:12288
    v_exp_f32 v94, v94
    v_exp_f32 v95, v95
    v_mfma_f32_32x32x16_bf16 v[112:127], v[180:183], v[4:7], 0
    v_exp_f32 v96, v96
    v_exp_f32 v97, v97
    v_exp_f32 v98, v98
    v_exp_f32 v99, v99
    v_mfma_f32_32x32x8_bf16 v[112:127], v[228:229], v[58:59], v[112:127]
    v_exp_f32 v100, v100
    v_exp_f32 v101, v101
    v_exp_f32 v102, v102
    v_exp_f32 v103, v103
    v_smfmac_f32_32x32x32_bf16 v[128:143], a[172:175], v[88:95], v2
    v_exp_f32 v104, v104
    v_exp_f32 v105, v105
    v_exp_f32 v106, v106
    v_exp_f32 v107, v107
    v_smfmac_f32_32x32x32_bf16 v[128:143], a[176:179], v[96:103], v2
    v_exp_f32 v108, v108
    v_exp_f32 v109, v109
    s_waitcnt vmcnt(0)
    s_barrier
    v_mov_b32 v10, 1
    buffer_store_dword v10, v23, s[44:47], 0 offen sc1
    v_exp_f32 v110, v110
    v_exp_f32 v111, v111
    v_mfma_f32_32x32x16_bf16 v[64:79], v[184:187], v[4:7], 0
    v_exp_f32 v112, v112
    v_exp_f32 v113, v113
    v_exp_f32 v114, v114
    v_exp_f32 v115, v115
    v_mfma_f32_32x32x8_bf16 v[64:79], v[230:231], v[56:57], v[64:79]
    v_exp_f32 v116, v116
    v_exp_f32 v117, v117
    s_mov_b32 s4, 18432
    v_exp_f32 v118, v118
    v_exp_f32 v119, v119
    v_smfmac_f32_32x32x32_bf16 v[128:143], a[180:183], v[104:111], v2
    v_exp_f32 v120, v120
    v_exp_f32 v121, v121
    v_exp_f32 v122, v122
    v_exp_f32 v123, v123
    v_smfmac_f32_32x32x32_bf16 v[128:143], a[184:187], v[112:119], v2
    v_exp_f32 v124, v124
    v_exp_f32 v125, v125
    ds_read_b128 v[28:31], v24 offset:3072
    v_cmp_le_u32 vcc, 256, v9
    s_nop 1
    s_cmp_eq_u64 vcc, exec
    s_cbranch_scc0 L_pollA
L_pollA_ok:
    v_exp_f32 v126, v126
    v_exp_f32 v127, v127
    v_mfma_f32_32x32x16_bf16 v[80:95], v[188:191], v[4:7], 0
    v_exp_f32 v64, v64
    v_exp_f32 v65, v65
    v_exp_f32 v66, v66
    v_exp_f32 v67, v67
    v_mfma_f32_32x32x8_bf16 v[80:95], v[230:231], v[58:59], v[80:95]
    v_exp_f32 v68, v68
    v_exp_f32 v69, v69
    buffer_load_dwordx2 v[32:33], v20, s[28:31], 0 offen offset:0
    v_exp_f32 v70, v70
    v_exp_f32 v71, v71
    v_smfmac_f32_32x32x32_bf16 v[128:143], a[188:191], v[120:127], v2
    v_exp_f32 v72, v72
    v_exp_f32 v73, v73
    v_exp_f32 v74, v74
    v_exp_f32 v75, v75
    v_smfmac_f32_32x32x32_bf16 v[128:143], a[192:195], v[64:71], v2
    v_exp_f32 v76, v76
    v_exp_f32 v77, v77
    ds_read_b32 v60, v25 offset:768
    v_exp_f32 v78, v78
    v_exp_f32 v79, v79
    v_mfma_f32_32x32x16_bf16 v[96:111], v[192:195], v[4:7], 0
    v_exp_f32 v80, v80
    v_exp_f32 v81, v81
    v_exp_f32 v82, v82
    v_exp_f32 v83, v83
    v_mfma_f32_32x32x8_bf16 v[96:111], v[232:233], v[56:57], v[96:111]
    v_exp_f32 v84, v84
    v_exp_f32 v85, v85
    buffer_load_dwordx2 v[36:37], v20, s[28:31], s4 offen offset:0
    v_exp_f32 v86, v86
    v_exp_f32 v87, v87
    v_smfmac_f32_32x32x32_bf16 v[128:143], a[196:199], v[72:79], v2
    v_exp_f32 v88, v88
    v_exp_f32 v89, v89
    v_exp_f32 v90, v90
    v_exp_f32 v91, v91
    v_smfmac_f32_32x32x32_bf16 v[128:143], a[200:203], v[80:87], v2
    v_exp_f32 v92, v92
    v_exp_f32 v93, v93
    v_exp_f32 v94, v94
    v_exp_f32 v95, v95
    v_mfma_f32_32x32x16_bf16 v[112:127], v[196:199], v[4:7], 0
    v_exp_f32 v96, v96
    v_exp_f32 v97, v97
    v_exp_f32 v98, v98
    v_exp_f32 v99, v99
    v_mfma_f32_32x32x8_bf16 v[112:127], v[232:233], v[58:59], v[112:127]
    v_exp_f32 v100, v100
    v_exp_f32 v101, v101
    buffer_load_dwordx2 v[40:41], v20, s[28:31], 0 offen offset:32
    v_exp_f32 v102, v102
    v_exp_f32 v103, v103
    v_smfmac_f32_32x32x32_bf16 v[128:143], a[204:207], v[88:95], v2
    v_exp_f32 v104, v104
    v_exp_f32 v105, v105
    v_exp_f32 v106, v106
    v_exp_f32 v107, v107
    v_smfmac_f32_32x32x32_bf16 v[128:143], a[208:211], v[96:103], v2
    v_exp_f32 v108, v108
    v_exp_f32 v109, v109
    s_waitcnt lgkmcnt(0)
    v_mov_b32 v63, v60
    v_exp_f32 v110, v110
    v_exp_f32 v111, v111
    v_mfma_f32_32x32x16_bf16 v[64:79], v[200:203], v[4:7], 0
    v_exp_f32 v112, v112
    v_exp_f32 v113, v113
    v_exp_f32 v114, v114
    v_exp_f32 v115, v115
    v_mfma_f32_32x32x8_bf16 v[64:79], v[234:235], v[56:57], v[64:79]
    v_exp_f32 v116, v116
    v_exp_f32 v117, v117
    buffer_load_dwordx2 v[44:45], v20, s[28:31], s4 offen offset:32
    v_exp_f32 v118, v118
    v_exp_f32 v119, v119
    v_smfmac_f32_32x32x32_bf16 v[128:143], a[212:215], v[104:111], v2
    v_exp_f32 v120, v120
    v_exp_f32 v121, v121
    v_exp_f32 v122, v122
    v_exp_f32 v123, v123
    v_smfmac_f32_32x32x32_bf16 v[128:143], a[216:219], v[112:119], v2
    v_exp_f32 v124, v124
    v_exp_f32 v125, v125
    v_exp_f32 v126, v126
    v_exp_f32 v127, v127
    v_mfma_f32_32x32x16_bf16 v[80:95], v[204:207], v[4:7], 0
    v_exp_f32 v64, v64
    v_exp_f32 v65, v65
    v_exp_f32 v66, v66
    v_exp_f32 v67, v67
    v_mfma_f32_32x32x8_bf16 v[80:95], v[234:235], v[58:59], v[80:95]
    v_exp_f32 v68, v68
    v_exp_f32 v69, v69
    buffer_load_dwordx2 v[48:49], v21, s[28:31], 0 offen offset:64
    v_exp_f32 v70, v70
    v_exp_f32 v71, v71
    v_smfmac_f32_32x32x32_bf16 v[128:143], a[220:223], v[120:127], v2
    v_exp_f32 v72, v72
    v_exp_f32 v73, v73
    v_exp_f32 v74, v74
    v_exp_f32 v75, v75
    v_smfmac_f32_32x32x32_bf16 v[128:143], a[224:227], v[64:71], v2
    v_exp_f32 v76, v76
    v_exp_f32 v77, v77
    v_exp_f32 v78, v78
    v_exp_f32 v79, v79
    v_mfma_f32_32x32x16_bf16 v[96:111], v[208:211], v[4:7], 0
    v_exp_f32 v80, v80
    v_exp_f32 v81, v81
    v_exp_f32 v82, v82
    v_exp_f32 v83, v83
    v_mfma_f32_32x32x8_bf16 v[96:111], v[236:237], v[56:57], v[96:111]
    v_exp_f32 v84, v84
    v_exp_f32 v85, v85
    buffer_load_dwordx2 v[52:53], v21, s[28:31], s4 offen offset:64
    v_exp_f32 v86, v86
    v_exp_f32 v87, v87
    v_smfmac_f32_32x32x32_bf16 v[128:143], a[228:231], v[72:79], v2
    v_exp_f32 v88, v88
    v_exp_f32 v89, v89
    v_exp_f32 v90, v90
    v_exp_f32 v91, v91
    v_smfmac_f32_32x32x32_bf16 v[128:143], a[232:235], v[80:87], v2
    v_exp_f32 v92, v92
    v_exp_f32 v93, v93
    v_exp_f32 v94, v94
    v_exp_f32 v95, v95
    v_mfma_f32_32x32x16_bf16 v[112:127], v[212:215], v[4:7], 0
    v_exp_f32 v96, v96
    v_exp_f32 v97, v97
    v_exp_f32 v98, v98
    v_exp_f32 v99, v99
    v_mfma_f32_32x32x8_bf16 v[112:127], v[236:237], v[58:59], v[112:127]
    v_exp_f32 v100, v100
    v_exp_f32 v101, v101
    v_exp_f32 v102, v102
    v_exp_f32 v103, v103
    v_smfmac_f32_32x32x32_bf16 v[128:143], a[0:3], v[88:95], v2
    v_exp_f32 v104, v104
    v_exp_f32 v105, v105
    v_exp_f32 v106, v106
    v_exp_f32 v107, v107
    v_smfmac_f32_32x32x32_bf16 v[128:143], a[4:7], v[96:103], v2
    v_exp_f32 v108, v108
    v_exp_f32 v109, v109
    v_exp_f32 v110, v110
    v_exp_f32 v111, v111
    v_mfma_f32_32x32x16_bf16 v[64:79], v[216:219], v[4:7], 0
    v_exp_f32 v112, v112
    v_exp_f32 v113, v113
    v_exp_f32 v114, v114
    v_exp_f32 v115, v115
    v_mfma_f32_32x32x8_bf16 v[64:79], v[238:239], v[56:57], v[64:79]
    v_exp_f32 v116, v116
    v_exp_f32 v117, v117
    v_exp_f32 v118, v118
    v_exp_f32 v119, v119
    v_smfmac_f32_32x32x32_bf16 v[128:143], a[8:11], v[104:111], v2
    v_exp_f32 v120, v120
    v_exp_f32 v121, v121
    v_exp_f32 v122, v122
    v_exp_f32 v123, v123
    v_smfmac_f32_32x32x32_bf16 v[128:143], a[12:15], v[112:119], v2
    v_exp_f32 v124, v124
    v_exp_f32 v125, v125
    v_exp_f32 v126, v126
    v_exp_f32 v127, v127
    v_mfma_f32_32x32x16_bf16 v[80:95], v[220:223], v[4:7], 0
    v_exp_f32 v64, v64
    v_exp_f32 v65, v65
    v_exp_f32 v66, v66
    v_exp_f32 v67, v67
    v_mfma_f32_32x32x8_bf16 v[80:95], v[238:239], v[58:59], v[80:95]
    v_exp_f32 v68, v68
    v_exp_f32 v69, v69
    buffer_load_dword v11, v22, s[44:47], 0 offen sc1
    v_exp_f32 v70, v70
    v_exp_f32 v71, v71
    v_smfmac_f32_32x32x32_bf16 v[128:143], a[16:19], v[120:127], v2
    v_exp_f32 v72, v72
    v_exp_f32 v73, v73
    v_exp_f32 v74, v74
    v_exp_f32 v75, v75
    v_smfmac_f32_32x32x32_bf16 v[128:143], v[240:243], v[64:71], v2
    v_exp_f32 v76, v76
    v_exp_f32 v77, v77
    v_exp_f32 v78, v78
    v_exp_f32 v79, v79
    v_mfma_f32_32x32x16_bf16 v[96:111], v[160:163], v[28:31], 0
    v_exp_f32 v80, v80
    v_exp_f32 v81, v81
    v_exp_f32 v82, v82
    v_exp_f32 v83, v83
    v_mfma_f32_32x32x8_bf16 v[96:111], v[224:225], v[60:61], v[96:111]
    v_exp_f32 v84, v84
    v_exp_f32 v85, v85
    v_exp_f32 v86, v86
    v_exp_f32 v87, v87
    v_smfmac_f32_32x32x32_bf16 v[128:143], v[244:247], v[72:79], v2
    v_exp_f32 v88, v88
    v_exp_f32 v89, v89
    v_exp_f32 v90, v90
    v_exp_f32 v91, v91
    v_smfmac_f32_32x32x32_bf16 v[128:143], v[248:251], v[80:87], v2
    v_exp_f32 v92, v92
    v_exp_f32 v93, v93
    s_waitcnt vmcnt(1)
    v_and_b32 v35, 0xffff0000, v33
    v_lshlrev_b32 v34, 16, v33
    v_and_b32 v33, 0xffff0000, v32
    v_lshlrev_b32 v32, 16, v32
    v_and_b32 v39, 0xffff0000, v37
    v_lshlrev_b32 v38, 16, v37
    v_and_b32 v37, 0xffff0000, v36
    v_lshlrev_b32 v36, 16, v36
    v_exp_f32 v94, v94
    v_exp_f32 v95, v95
    v_mfma_f32_32x32x16_bf16 v[112:127], v[164:167], v[28:31], 0
    v_exp_f32 v96, v96
    v_exp_f32 v97, v97
    v_exp_f32 v98, v98
    v_exp_f32 v99, v99
    v_mfma_f32_32x32x8_bf16 v[112:127], v[224:225], v[62:63], v[112:127]
    v_exp_f32 v100, v100
    v_exp_f32 v101, v101
    v_mov_b64 v[144:145], 0
    v_mov_b64 v[146:147], 0
    v_mov_b64 v[148:149], 0
    v_mov_b64 v[150:151], 0
    v_mov_b64 v[152:153], 0
    v_exp_f32 v102, v102
    v_exp_f32 v103, v103
    v_smfmac_f32_32x32x32_bf16 v[128:143], v[252:255], v[88:95], v2
    v_exp_f32 v104, v104
    v_exp_f32 v105, v105
    v_exp_f32 v106, v106
    v_exp_f32 v107, v107
    v_smfmac_f32_32x32x32_bf16 v[144:159], a[144:147], v[96:103], v2
    v_exp_f32 v108, v108
    v_exp_f32 v109, v109
    v_and_b32 v43, 0xffff0000, v41
    v_lshlrev_b32 v42, 16, v41
    v_and_b32 v41, 0xffff0000, v40
    v_lshlrev_b32 v40, 16, v40
    v_and_b32 v47, 0xffff0000, v45
    v_lshlrev_b32 v46, 16, v45
    v_and_b32 v45, 0xffff0000, v44
    v_lshlrev_b32 v44, 16, v44
    v_and_b32 v51, 0xffff0000, v49
    v_exp_f32 v110, v110
    v_exp_f32 v111, v111
    v_mfma_f32_32x32x16_bf16 v[64:79], v[168:171], v[28:31], 0
    v_exp_f32 v112, v112
    v_exp_f32 v113, v113
    v_exp_f32 v114, v114
    v_exp_f32 v115, v115
    v_mfma_f32_32x32x8_bf16 v[64:79], v[226:227], v[60:61], v[64:79]
    v_exp_f32 v116, v116
    v_exp_f32 v117, v117
    v_exp_f32 v118, v118
    v_exp_f32 v119, v119
    v_smfmac_f32_32x32x32_bf16 v[144:159], a[148:151], v[104:111], v2
    v_exp_f32 v120, v120
    v_exp_f32 v121, v121
    v_exp_f32 v122, v122
    v_exp_f32 v123, v123
    v_smfmac_f32_32x32x32_bf16 v[144:159], a[152:155], v[112:119], v2
    v_exp_f32 v124, v124
    v_exp_f32 v125, v125
    ds_write_b128 v26, v[128:131] offset:20480
    v_lshlrev_b32 v50, 16, v49
    v_and_b32 v49, 0xffff0000, v48
    v_lshlrev_b32 v48, 16, v48
    v_and_b32 v55, 0xffff0000, v53
    v_lshlrev_b32 v54, 16, v53
    v_and_b32 v53, 0xffff0000, v52
    v_lshlrev_b32 v52, 16, v52
    v_exp_f32 v126, v126
    v_exp_f32 v127, v127
    v_mfma_f32_32x32x16_bf16 v[80:95], v[172:175], v[28:31], 0
    v_exp_f32 v64, v64
    v_exp_f32 v65, v65
    v_exp_f32 v66, v66
    v_exp_f32 v67, v67
    v_mfma_f32_32x32x8_bf16 v[80:95], v[226:227], v[62:63], v[80:95]
    v_exp_f32 v68, v68
    v_exp_f32 v69, v69
    v_exp_f32 v70, v70
    v_exp_f32 v71, v71
    v_smfmac_f32_32x32x32_bf16 v[144:159], a[156:159], v[120:127], v2
    v_exp_f32 v72, v72
    v_exp_f32 v73, v73
    v_exp_f32 v74, v74
    v_exp_f32 v75, v75
    v_smfmac_f32_32x32x32_bf16 v[144:159], a[160:163], v[64:71], v2
    v_exp_f32 v76, v76
    v_exp_f32 v77, v77
    ds_write_b128 v26, v[132:135] offset:21504
    s_waitcnt vmcnt(0)
    v_cmp_eq_u32 vcc, 1, v11
    s_nop 1
    s_cmp_eq_u64 vcc, exec
    s_cbranch_scc0 L_pollp
L_pollp_ok:
    v_exp_f32 v78, v78
    v_exp_f32 v79, v79
    v_mfma_f32_32x32x16_bf16 v[96:111], v[176:179], v[28:31], 0
    v_exp_f32 v80, v80
    v_exp_f32 v81, v81
    v_exp_f32 v82, v82
    v_exp_f32 v83, v83
    v_mfma_f32_32x32x8_bf16 v[96:111], v[228:229], v[60:61], v[96:111]
    v_exp_f32 v84, v84
    v_exp_f32 v85, v85
    buffer_load_dwordx4 a[20:23], v16, s[44:47], s72 offen sc1
    v_exp_f32 v86, v86
    v_exp_f32 v87, v87
    v_smfmac_f32_32x32x32_bf16 v[144:159], a[164:167], v[72:79], v2
    v_exp_f32 v88, v88
    v_exp_f32 v89, v89
    v_exp_f32 v90, v90
    v_exp_f32 v91, v91
    v_smfmac_f32_32x32x32_bf16 v[144:159], a[168:171], v[80:87], v2
    v_exp_f32 v92, v92
    v_exp_f32 v93, v93
    ds_write_b64 v0, v[136:137] offset:22528
    v_exp_f32 v94, v94
    v_exp_f32 v95, v95
    v_mfma_f32_32x32x16_bf16 v[112:127], v[180:183], v[28:31], 0
    v_exp_f32 v96, v96
    v_exp_f32 v97, v97
    v_exp_f32 v98, v98
    v_exp_f32 v99, v99
    v_mfma_f32_32x32x8_bf16 v[112:127], v[228:229], v[62:63], v[112:127]
    v_exp_f32 v100, v100
    v_exp_f32 v101, v101
    v_exp_f32 v102, v102
    v_exp_f32 v103, v103
    v_smfmac_f32_32x32x32_bf16 v[144:159], a[172:175], v[88:95], v2
    v_exp_f32 v104, v104
    v_exp_f32 v105, v105
    v_exp_f32 v106, v106
    v_exp_f32 v107, v107
    v_smfmac_f32_32x32x32_bf16 v[144:159], a[176:179], v[96:103], v2
    v_exp_f32 v108, v108
    v_exp_f32 v109, v109
    v_exp_f32 v110, v110
    v_exp_f32 v111, v111
    v_mfma_f32_32x32x16_bf16 v[64:79], v[184:187], v[28:31], 0
    v_exp_f32 v112, v112
    v_exp_f32 v113, v113
    v_exp_f32 v114, v114
    v_exp_f32 v115, v115
    v_mfma_f32_32x32x8_bf16 v[64:79], v[230:231], v[60:61], v[64:79]
    v_exp_f32 v116, v116
    v_exp_f32 v117, v117
    buffer_load_dwordx4 a[24:27], v17, s[44:47], s72 offen sc1
    v_exp_f32 v118, v118
    v_exp_f32 v119, v119
    v_smfmac_f32_32x32x32_bf16 v[144:159], a[180:183], v[104:111], v2
    v_exp_f32 v120, v120
    v_exp_f32 v121, v121
    v_exp_f32 v122, v122
    v_exp_f32 v123, v123
    v_smfmac_f32_32x32x32_bf16 v[144:159], a[184:187], v[112:119], v2
    v_exp_f32 v124, v124
    v_exp_f32 v125, v125
    ds_read_b128 v[4:7], v24 offset:4096
    v_exp_f32 v126, v126
    v_exp_f32 v127, v127
    v_mfma_f32_32x32x16_bf16 v[80:95], v[188:191], v[28:31], 0
    v_exp_f32 v64, v64
    v_exp_f32 v65, v65
    v_exp_f32 v66, v66
    v_exp_f32 v67, v67
    v_mfma_f32_32x32x8_bf16 v[80:95], v[230:231], v[62:63], v[80:95]
    v_exp_f32 v68, v68
    v_exp_f32 v69, v69
    v_exp_f32 v70, v70
    v_exp_f32 v71, v71
    v_smfmac_f32_32x32x32_bf16 v[144:159], a[188:191], v[120:127], v2
    v_exp_f32 v72, v72
    v_exp_f32 v73, v73
    v_exp_f32 v74, v74
    v_exp_f32 v75, v75
    v_smfmac_f32_32x32x32_bf16 v[144:159], a[192:195], v[64:71], v2
    v_exp_f32 v76, v76
    v_exp_f32 v77, v77
    ds_read_b32 v56, v25 offset:1024
    v_exp_f32 v78, v78
    v_exp_f32 v79, v79
    v_mfma_f32_32x32x16_bf16 v[96:111], v[192:195], v[28:31], 0
    v_exp_f32 v80, v80
    v_exp_f32 v81, v81
    v_exp_f32 v82, v82
    v_exp_f32 v83, v83
    v_mfma_f32_32x32x8_bf16 v[96:111], v[232:233], v[60:61], v[96:111]
    v_exp_f32 v84, v84
    v_exp_f32 v85, v85
    buffer_load_dwordx4 a[28:31], v18, s[44:47], s72 offen sc1
    v_exp_f32 v86, v86
    v_exp_f32 v87, v87
    v_smfmac_f32_32x32x32_bf16 v[144:159], a[196:199], v[72:79], v2
    v_exp_f32 v88, v88
    v_exp_f32 v89, v89
    v_exp_f32 v90, v90
    v_exp_f32 v91, v91
    v_smfmac_f32_32x32x32_bf16 v[144:159], a[200:203], v[80:87], v2
    v_exp_f32 v92, v92
    v_exp_f32 v93, v93
    v_exp_f32 v94, v94
    v_exp_f32 v95, v95
    v_mfma_f32_32x32x16_bf16 v[112:127], v[196:199], v[28:31], 0
    v_exp_f32 v96, v96
    v_exp_f32 v97, v97
    v_exp_f32 v98, v98
    v_exp_f32 v99, v99
    v_mfma_f32_32x32x8_bf16 v[112:127], v[232:233], v[62:63], v[112:127]
    v_exp_f32 v100, v100
    v_exp_f32 v101, v101
    v_exp_f32 v102, v102
    v_exp_f32 v103, v103
    v_smfmac_f32_32x32x32_bf16 v[144:159], a[204:207], v[88:95], v2
    v_exp_f32 v104, v104
    v_exp_f32 v105, v105
    v_exp_f32 v106, v106
    v_exp_f32 v107, v107
    v_smfmac_f32_32x32x32_bf16 v[144:159], a[208:211], v[96:103], v2
    v_exp_f32 v108, v108
    v_exp_f32 v109, v109
    s_waitcnt lgkmcnt(0)
    v_mov_b32 v59, v56
    v_exp_f32 v110, v110
    v_exp_f32 v111, v111
    v_mfma_f32_32x32x16_bf16 v[64:79], v[200:203], v[28:31], 0
    v_exp_f32 v112, v112
    v_exp_f32 v113, v113
    v_exp_f32 v114, v114
    v_exp_f32 v115, v115
    v_mfma_f32_32x32x8_bf16 v[64:79], v[234:235], v[60:61], v[64:79]
    v_exp_f32 v116, v116
    v_exp_f32 v117, v117
    buffer_load_dwordx4 a[32:35], v19, s[44:47], s72 offen sc1
    v_exp_f32 v118, v118
    v_exp_f32 v119, v119
    v_smfmac_f32_32x32x32_bf16 v[144:159], a[212:215], v[104:111], v2
    v_exp_f32 v120, v120
    v_exp_f32 v121, v121
    v_exp_f32 v122, v122
    v_exp_f32 v123, v123
    v_smfmac_f32_32x32x32_bf16 v[144:159], a[216:219], v[112:119], v2
    v_exp_f32 v124, v124
    v_exp_f32 v125, v125
    v_exp_f32 v126, v126
    v_exp_f32 v127, v127
    v_mfma_f32_32x32x16_bf16 v[80:95], v[204:207], v[28:31], 0
    v_exp_f32 v64, v64
    v_exp_f32 v65, v65
    v_exp_f32 v66, v66
    v_exp_f32 v67, v67
    v_mfma_f32_32x32x8_bf16 v[80:95], v[234:235], v[62:63], v[80:95]
    v_exp_f32 v68, v68
    v_exp_f32 v69, v69
    v_exp_f32 v70, v70
    v_exp_f32 v71, v71
    v_smfmac_f32_32x32x32_bf16 v[144:159], a[220:223], v[120:127], v2
    v_exp_f32 v72, v72
    v_exp_f32 v73, v73
    v_exp_f32 v74, v74
    v_exp_f32 v75, v75
    v_smfmac_f32_32x32x32_bf16 v[144:159], a[224:227], v[64:71], v2
    v_exp_f32 v76, v76
    v_exp_f32 v77, v77
    v_exp_f32 v78, v78
    v_exp_f32 v79, v79
    v_mfma_f32_32x32x16_bf16 v[96:111], v[208:211], v[28:31], 0
    v_exp_f32 v80, v80
    v_exp_f32 v81, v81
    v_exp_f32 v82, v82
    v_exp_f32 v83, v83
    v_mfma_f32_32x32x8_bf16 v[96:111], v[236:237], v[60:61], v[96:111]
    v_exp_f32 v84, v84
    v_exp_f32 v85, v85
    buffer_load_dwordx4 a[36:39], v16, s[44:47], s73 offen sc1
    v_exp_f32 v86, v86
    v_exp_f32 v87, v87
    v_smfmac_f32_32x32x32_bf16 v[144:159], a[228:231], v[72:79], v2
    v_exp_f32 v88, v88
    v_exp_f32 v89, v89
    v_exp_f32 v90, v90
    v_exp_f32 v91, v91
    v_smfmac_f32_32x32x32_bf16 v[144:159], a[232:235], v[80:87], v2
    v_exp_f32 v92, v92
    v_exp_f32 v93, v93
    v_exp_f32 v94, v94
    v_exp_f32 v95, v95
    v_mfma_f32_32x32x16_bf16 v[112:127], v[212:215], v[28:31], 0
    v_exp_f32 v96, v96
    v_exp_f32 v97, v97
    v_exp_f32 v98, v98
    v_exp_f32 v99, v99
    v_mfma_f32_32x32x8_bf16 v[112:127], v[236:237], v[62:63], v[112:127]
    v_exp_f32 v100, v100
    v_exp_f32 v101, v101
    v_exp_f32 v102, v102
    v_exp_f32 v103, v103
    v_smfmac_f32_32x32x32_bf16 v[144:159], a[0:3], v[88:95], v2
    v_exp_f32 v104, v104
    v_exp_f32 v105, v105
    v_exp_f32 v106, v106
    v_exp_f32 v107, v107
    v_smfmac_f32_32x32x32_bf16 v[144:159], a[4:7], v[96:103], v2
    v_exp_f32 v108, v108
    v_exp_f32 v109, v109
    v_exp_f32 v110, v110
    v_exp_f32 v111, v111
    v_mfma_f32_32x32x16_bf16 v[64:79], v[216:219], v[28:31], 0
    v_exp_f32 v112, v112
    v_exp_f32 v113, v113
    v_exp_f32 v114, v114
    v_exp_f32 v115, v115
    v_mfma_f32_32x32x8_bf16 v[64:79], v[238:239], v[60:61], v[64:79]
    v_exp_f32 v116, v116
    v_exp_f32 v117, v117
    buffer_load_dwordx4 a[40:43], v17, s[44:47], s73 offen sc1
    v_exp_f32 v118, v118
    v_exp_f32 v119, v119
    v_smfmac_f32_32x32x32_bf16 v[144:159], a[8:11], v[104:111], v2
    v_exp_f32 v120, v120
    v_exp_f32 v121, v121
    v_exp_f32 v122, v122
    s_waitcnt vmcnt(5)
    v_mfma_f32_16x16x32_bf16 v[32:35], a[238:241], a[20:23], v[32:35]
    v_exp_f32 v123, v123
    v_smfmac_f32_32x32x32_bf16 v[144:159], a[12:15], v[112:119], v2
    v_exp_f32 v124, v124
    v_exp_f32 v125, v125
    v_exp_f32 v126, v126
    v_mfma_f32_16x16x32_bf16 v[36:39], a[236:239], a[20:23], v[36:39]
    v_exp_f32 v127, v127
    v_mfma_f32_32x32x16_bf16 v[80:95], v[220:223], v[28:31], 0
    v_exp_f32 v64, v64
    v_exp_f32 v65, v65
    v_exp_f32 v66, v66
    v_exp_f32 v67, v67
    v_mfma_f32_32x32x8_bf16 v[80:95], v[238:239], v[62:63], v[80:95]
    v_exp_f32 v68, v68
    v_exp_f32 v69, v69
    v_exp_f32 v70, v70
    v_exp_f32 v71, v71
    v_smfmac_f32_32x32x32_bf16 v[144:159], a[16:19], v[120:127], v2
    v_exp_f32 v72, v72
    v_exp_f32 v73, v73
    v_exp_f32 v74, v74
    v_exp_f32 v75, v75
    v_smfmac_f32_32x32x32_bf16 v[144:159], v[240:243], v[64:71], v2
    v_exp_f32 v76, v76
    v_exp_f32 v77, v77
    v_exp_f32 v78, v78
    v_exp_f32 v79, v79
    v_mfma_f32_32x32x16_bf16 v[96:111], v[160:163], v[4:7], 0
    v_exp_f32 v80, v80
    v_exp_f32 v81, v81
    v_exp_f32 v82, v82
    v_exp_f32 v83, v83
    v_mfma_f32_32x32x8_bf16 v[96:111], v[224:225], v[56:57], v[96:111]
    v_exp_f32 v84, v84
    v_exp_f32 v85, v85
    buffer_load_dwordx4 a[44:47], v18, s[44:47], s73 offen sc1
    v_exp_f32 v86, v86
    v_exp_f32 v87, v87
    v_smfmac_f32_32x32x32_bf16 v[144:159], v[244:247], v[72:79], v2
    v_exp_f32 v88, v88
    v_exp_f32 v89, v89
    v_exp_f32 v90, v90
    s_waitcnt vmcnt(5)
    v_mfma_f32_16x16x32_bf16 v[32:35], a[238:241], a[24:27], v[32:35]
    v_exp_f32 v91, v91
    v_smfmac_f32_32x32x32_bf16 v[144:159], v[248:251], v[80:87], v2
    v_exp_f32 v92, v92
    v_exp_f32 v93, v93
    v_exp_f32 v94, v94
    v_mfma_f32_16x16x32_bf16 v[36:39], a[236:239], a[24:27], v[36:39]
    v_exp_f32 v95, v95
    v_mfma_f32_32x32x16_bf16 v[112:127], v[164:167], v[4:7], 0
    v_exp_f32 v96, v96
    v_exp_f32 v97, v97
    v_exp_f32 v98, v98
    v_exp_f32 v99, v99
    v_mfma_f32_32x32x8_bf16 v[112:127], v[224:225], v[58:59], v[112:127]
    v_exp_f32 v100, v100
    v_exp_f32 v101, v101
    v_mov_b64 v[128:129], 0
    v_mov_b64 v[130:131], 0
    v_mov_b64 v[132:133], 0
    v_mov_b64 v[134:135], 0
    v_mov_b64 v[136:137], 0
    v_exp_f32 v102, v102
    v_exp_f32 v103, v103
    v_smfmac_f32_32x32x32_bf16 v[144:159], v[252:255], v[88:95], v2
    v_exp_f32 v104, v104
    v_exp_f32 v105, v105
    v_exp_f32 v106, v106
    v_exp_f32 v107, v107
    v_smfmac_f32_32x32x32_bf16 v[128:143], a[144:147], v[96:103], v2
    v_exp_f32 v108, v108
    v_exp_f32 v109, v109
    v_exp_f32 v110, v110
    v_exp_f32 v111, v111
    v_mfma_f32_32x32x16_bf16 v[64:79], v[168:171], v[4:7], 0
    v_exp_f32 v112, v112
    v_exp_f32 v113, v113
    v_exp_f32 v114, v114
    v_exp_f32 v115, v115
    v_mfma_f32_32x32x8_bf16 v[64:79], v[226:227], v[56:57], v[64:79]
    v_exp_f32 v116, v116
    v_exp_f32 v117, v117
    buffer_load_dwordx4 a[48:51], v19, s[44:47], s73 offen sc1
    v_exp_f32 v118, v118
    v_exp_f32 v119, v119
    v_smfmac_f32_32x32x32_bf16 v[128:143], a[148:151], v[104:111], v2
    v_exp_f32 v120, v120
    v_exp_f32 v121, v121
    v_exp_f32 v122, v122
    s_waitcnt vmcnt(5)
    v_mfma_f32_16x16x32_bf16 v[32:35], a[238:241], a[28:31], v[32:35]
    v_exp_f32 v123, v123
    v_smfmac_f32_32x32x32_bf16 v[128:143], a[152:155], v[112:119], v2
    v_exp_f32 v124, v124
    v_exp_f32 v125, v125
    ds_write_b128 v26, v[144:147] offset:30720
    v_exp_f32 v126, v126
    v_mfma_f32_16x16x32_bf16 v[36:39], a[236:239], a[28:31], v[36:39]
    v_exp_f32 v127, v127
    v_mfma_f32_32x32x16_bf16 v[80:95], v[172:175], v[4:7], 0
    v_exp_f32 v64, v64
    v_exp_f32 v65, v65
    v_exp_f32 v66, v66
    v_exp_f32 v67, v67
    v_mfma_f32_32x32x8_bf16 v[80:95], v[226:227], v[58:59], v[80:95]
    v_exp_f32 v68, v68
    v_exp_f32 v69, v69
    v_exp_f32 v70, v70
    v_exp_f32 v71, v71
    v_smfmac_f32_32x32x32_bf16 v[128:143], a[156:159], v[120:127], v2
    v_exp_f32 v72, v72
    v_exp_f32 v73, v73
    v_exp_f32 v74, v74
    v_exp_f32 v75, v75
    v_smfmac_f32_32x32x32_bf16 v[128:143], a[160:163], v[64:71], v2
    v_exp_f32 v76, v76
    v_exp_f32 v77, v77
    ds_write_b128 v26, v[148:151] offset:31744
    v_exp_f32 v78, v78
    v_exp_f32 v79, v79
    v_mfma_f32_32x32x16_bf16 v[96:111], v[176:179], v[4:7], 0
    v_exp_f32 v80, v80
    v_exp_f32 v81, v81
    v_exp_f32 v82, v82
    v_exp_f32 v83, v83
    v_mfma_f32_32x32x8_bf16 v[96:111], v[228:229], v[56:57], v[96:111]
    v_exp_f32 v84, v84
    v_exp_f32 v85, v85
    buffer_load_dwordx4 a[52:55], v16, s[44:47], s74 offen sc1
    v_exp_f32 v86, v86
    v_exp_f32 v87, v87
    v_smfmac_f32_32x32x32_bf16 v[128:143], a[164:167], v[72:79], v2
    v_exp_f32 v88, v88
    v_exp_f32 v89, v89
    v_exp_f32 v90, v90
    s_waitcnt vmcnt(5)
    v_mfma_f32_16x16x32_bf16 v[32:35], a[238:241], a[32:35], v[32:35]
    v_exp_f32 v91, v91
    v_smfmac_f32_32x32x32_bf16 v[128:143], a[168:171], v[80:87], v2
    v_exp_f32 v92, v92
    v_exp_f32 v93, v93
    ds_write_b64 v0, v[152:153] offset:32768
    v_exp_f32 v94, v94
    v_mfma_f32_16x16x32_bf16 v[36:39], a[236:239], a[32:35], v[36:39]
    v_exp_f32 v95, v95
    v_mfma_f32_32x32x16_bf16 v[112:127], v[180:183], v[4:7], 0
    v_exp_f32 v96, v96
    v_exp_f32 v97, v97
    v_exp_f32 v98, v98
    v_exp_f32 v99, v99
    v_mfma_f32_32x32x8_bf16 v[112:127], v[228:229], v[58:59], v[112:127]
    v_exp_f32 v100, v100
    v_exp_f32 v101, v101
    v_exp_f32 v102, v102
    v_exp_f32 v103, v103
    v_smfmac_f32_32x32x32_bf16 v[128:143], a[172:175], v[88:95], v2
    v_exp_f32 v104, v104
    v_exp_f32 v105, v105
    v_exp_f32 v106, v106
    v_exp_f32 v107, v107
    v_smfmac_f32_32x32x32_bf16 v[128:143], a[176:179], v[96:103], v2
    v_exp_f32 v108, v108
    v_exp_f32 v109, v109
    v_add_u32 v26, 40960, v26
    v_add_u32 v0, 40960, v0
    v_exp_f32 v110, v110
    v_exp_f32 v111, v111
    v_mfma_f32_32x32x16_bf16 v[64:79], v[184:187], v[4:7], 0
    v_exp_f32 v112, v112
    v_exp_f32 v113, v113
    v_exp_f32 v114, v114
    v_exp_f32 v115, v115
    v_mfma_f32_32x32x8_bf16 v[64:79], v[230:231], v[56:57], v[64:79]
    v_exp_f32 v116, v116
    v_exp_f32 v117, v117
    buffer_load_dwordx4 a[56:59], v17, s[44:47], s74 offen sc1
    v_exp_f32 v118, v118
    v_exp_f32 v119, v119
    v_smfmac_f32_32x32x32_bf16 v[128:143], a[180:183], v[104:111], v2
    v_exp_f32 v120, v120
    v_exp_f32 v121, v121
    v_exp_f32 v122, v122
    s_waitcnt vmcnt(5)
    v_mfma_f32_16x16x32_bf16 v[32:35], a[242:245], a[36:39], v[32:35]
    v_exp_f32 v123, v123
    v_smfmac_f32_32x32x32_bf16 v[128:143], a[184:187], v[112:119], v2
    v_exp_f32 v124, v124
    v_exp_f32 v125, v125
    ds_read_b128 v[28:31], v24 offset:5120
    v_exp_f32 v126, v126
    v_mfma_f32_16x16x32_bf16 v[36:39], a[240:243], a[36:39], v[36:39]
    v_exp_f32 v127, v127
    v_mfma_f32_32x32x16_bf16 v[80:95], v[188:191], v[4:7], 0
    v_exp_f32 v64, v64
    v_exp_f32 v65, v65
    v_exp_f32 v66, v66
    v_exp_f32 v67, v67
    v_mfma_f32_32x32x8_bf16 v[80:95], v[230:231], v[58:59], v[80:95]
    v_exp_f32 v68, v68
    v_exp_f32 v69, v69
    v_exp_f32 v70, v70
    v_exp_f32 v71, v71
    v_smfmac_f32_32x32x32_bf16 v[128:143], a[188:191], v[120:127], v2
    v_exp_f32 v72, v72
    v_exp_f32 v73, v73
    v_exp_f32 v74, v74
    v_exp_f32 v75, v75
    v_smfmac_f32_32x32x32_bf16 v[128:143], a[192:195], v[64:71], v2
    v_exp_f32 v76, v76
    v_exp_f32 v77, v77
    ds_read_b32 v60, v25 offset:1280
    v_exp_f32 v78, v78
    v_exp_f32 v79, v79
    v_mfma_f32_32x32x16_bf16 v[96:111], v[192:195], v[4:7], 0
    v_exp_f32 v80, v80
    v_exp_f32 v81, v81
    v_exp_f32 v82, v82
    v_exp_f32 v83, v83
    v_mfma_f32_32x32x8_bf16 v[96:111], v[232:233], v[56:57], v[96:111]
    v_exp_f32 v84, v84
    v_exp_f32 v85, v85
    buffer_load_dwordx4 a[60:63], v18, s[44:47], s74 offen sc1
    v_exp_f32 v86, v86
    v_exp_f32 v87, v87
    v_smfmac_f32_32x32x32_bf16 v[128:143], a[196:199], v[72:79], v2
    v_exp_f32 v88, v88
    v_exp_f32 v89, v89
    v_exp_f32 v90, v90
    s_waitcnt vmcnt(5)
    v_mfma_f32_16x16x32_bf16 v[32:35], a[242:245], a[40:43], v[32:35]
    v_exp_f32 v91, v91
    v_smfmac_f32_32x32x32_bf16 v[128:143], a[200:203], v[80:87], v2
    v_exp_f32 v92, v92
    v_exp_f32 v93, v93
    v_exp_f32 v94, v94
    v_mfma_f32_16x16x32_bf16 v[36:39], a[240:243], a[40:43], v[36:39]
    v_exp_f32 v95, v95
    v_mfma_f32_32x32x16_bf16 v[112:127], v[196:199], v[4:7], 0
    v_exp_f32 v96, v96
    v_exp_f32 v97, v97
    v_exp_f32 v98, v98
    v_exp_f32 v99, v99
    v_mfma_f32_32x32x8_bf16 v[112:127], v[232:233], v[58:59], v[112:127]
    v_exp_f32 v100, v100
    v_exp_f32 v101, v101
    v_exp_f32 v102, v102
    v_exp_f32 v103, v103
    v_smfmac_f32_32x32x32_bf16 v[128:143], a[204:207], v[88:95], v2
    v_exp_f32 v104, v104
    v_exp_f32 v105, v105
    v_exp_f32 v106, v106
    v_exp_f32 v107, v107
    v_smfmac_f32_32x32x32_bf16 v[128:143], a[208:211], v[96:103], v2
    v_exp_f32 v108, v108
    v_exp_f32 v109, v109
    s_waitcnt lgkmcnt(0)
    v_mov_b32 v63, v60
    v_exp_f32 v110, v110
    v_exp_f32 v111, v111
    v_mfma_f32_32x32x16_bf16 v[64:79], v[200:203], v[4:7], 0
    v_exp_f32 v112, v112
    v_exp_f32 v113, v113
    v_exp_f32 v114, v114
    v_exp_f32 v115, v115
    v_mfma_f32_32x32x8_bf16 v[64:79], v[234:235], v[56:57], v[64:79]
    v_exp_f32 v116, v116
    v_exp_f32 v117, v117
    buffer_load_dwordx4 a[64:67], v19, s[44:47], s74 offen sc1
    v_exp_f32 v118, v118
    v_exp_f32 v119, v119
    v_smfmac_f32_32x32x32_bf16 v[128:143], a[212:215], v[104:111], v2
    v_exp_f32 v120, v120
    v_exp_f32 v121, v121
    v_exp_f32 v122, v122
    s_waitcnt vmcnt(5)
    v_mfma_f32_16x16x32_bf16 v[32:35], a[242:245], a[44:47], v[32:35]
    v_exp_f32 v123, v123
    v_smfmac_f32_32x32x32_bf16 v[128:143], a[216:219], v[112:119], v2
    v_exp_f32 v124, v124
    v_exp_f32 v125, v125
    v_exp_f32 v126, v126
    v_mfma_f32_16x16x32_bf16 v[36:39], a[240:243], a[44:47], v[36:39]
    v_exp_f32 v127, v127
    v_mfma_f32_32x32x16_bf16 v[80:95], v[204:207], v[4:7], 0
    v_exp_f32 v64, v64
    v_exp_f32 v65, v65
    v_exp_f32 v66, v66
    v_exp_f32 v67, v67
    v_mfma_f32_32x32x8_bf16 v[80:95], v[234:235], v[58:59], v[80:95]
    v_exp_f32 v68, v68
    v_exp_f32 v69, v69
    v_exp_f32 v70, v70
    v_exp_f32 v71, v71
    v_smfmac_f32_32x32x32_bf16 v[128:143], a[220:223], v[120:127], v2
    v_exp_f32 v72, v72
    v_exp_f32 v73, v73
    v_exp_f32 v74, v74
    v_exp_f32 v75, v75
    v_smfmac_f32_32x32x32_bf16 v[128:143], a[224:227], v[64:71], v2
    v_exp_f32 v76, v76
    v_exp_f32 v77, v77
    v_exp_f32 v78, v78
    v_exp_f32 v79, v79
    v_mfma_f32_32x32x16_bf16 v[96:111], v[208:211], v[4:7], 0
    v_exp_f32 v80, v80
    v_exp_f32 v81, v81
    v_exp_f32 v82, v82
    v_exp_f32 v83, v83
    v_mfma_f32_32x32x8_bf16 v[96:111], v[236:237], v[56:57], v[96:111]
    v_exp_f32 v84, v84
    v_exp_f32 v85, v85
    buffer_load_dwordx4 a[68:71], v16, s[44:47], s75 offen sc1
    v_exp_f32 v86, v86
    v_exp_f32 v87, v87
    v_smfmac_f32_32x32x32_bf16 v[128:143], a[228:231], v[72:79], v2
    v_exp_f32 v88, v88
    v_exp_f32 v89, v89
    v_exp_f32 v90, v90
    s_waitcnt vmcnt(5)
    v_mfma_f32_16x16x32_bf16 v[32:35], a[242:245], a[48:51], v[32:35]
    v_exp_f32 v91, v91
    v_smfmac_f32_32x32x32_bf16 v[128:143], a[232:235], v[80:87], v2
    v_exp_f32 v92, v92
    v_exp_f32 v93, v93
    v_exp_f32 v94, v94
    v_mfma_f32_16x16x32_bf16 v[36:39], a[240:243], a[48:51], v[36:39]
    v_exp_f32 v95, v95
    v_mfma_f32_32x32x16_bf16 v[112:127], v[212:215], v[4:7], 0
    v_exp_f32 v96, v96
    v_exp_f32 v97, v97
    v_exp_f32 v98, v98
    v_exp_f32 v99, v99
    v_mfma_f32_32x32x8_bf16 v[112:127], v[236:237], v[58:59], v[112:127]
    v_exp_f32 v100, v100
    v_exp_f32 v101, v101
    v_exp_f32 v102, v102
    v_exp_f32 v103, v103
    v_smfmac_f32_32x32x32_bf16 v[128:143], a[0:3], v[88:95], v2
    v_exp_f32 v104, v104
    v_exp_f32 v105, v105
    v_exp_f32 v106, v106
    v_exp_f32 v107, v107
    v_smfmac_f32_32x32x32_bf16 v[128:143], a[4:7], v[96:103], v2
    v_exp_f32 v108, v108
    v_exp_f32 v109, v109
    v_exp_f32 v110, v110
    v_exp_f32 v111, v111
    v_mfma_f32_32x32x16_bf16 v[64:79], v[216:219], v[4:7], 0
    v_exp_f32 v112, v112
    v_exp_f32 v113, v113
    v_exp_f32 v114, v114
    v_exp_f32 v115, v115
    v_mfma_f32_32x32x8_bf16 v[64:79], v[238:239], v[56:57], v[64:79]
    v_exp_f32 v116, v116
    v_exp_f32 v117, v117
    buffer_load_dwordx4 a[72:75], v17, s[44:47], s75 offen sc1
    v_exp_f32 v118, v118
    v_exp_f32 v119, v119
    v_smfmac_f32_32x32x32_bf16 v[128:143], a[8:11], v[104:111], v2
    v_exp_f32 v120, v120
    v_exp_f32 v121, v121
    v_exp_f32 v122, v122
    s_waitcnt vmcnt(5)
    v_mfma_f32_16x16x32_bf16 v[32:35], a[246:249], a[52:55], v[32:35]
    v_exp_f32 v123, v123
    v_smfmac_f32_32x32x32_bf16 v[128:143], a[12:15], v[112:119], v2
    v_exp_f32 v124, v124
    v_exp_f32 v125, v125
    v_exp_f32 v126, v126
    v_mfma_f32_16x16x32_bf16 v[36:39], a[244:247], a[52:55], v[36:39]
    v_exp_f32 v127, v127
    v_mfma_f32_32x32x16_bf16 v[80:95], v[220:223], v[4:7], 0
    v_exp_f32 v64, v64
    v_exp_f32 v65, v65
    v_exp_f32 v66, v66
    v_exp_f32 v67, v67
    v_mfma_f32_32x32x8_bf16 v[80:95], v[238:239], v[58:59], v[80:95]
    v_exp_f32 v68, v68
    v_exp_f32 v69, v69
    v_exp_f32 v70, v70
    v_exp_f32 v71, v71
    v_smfmac_f32_32x32x32_bf16 v[128:143], a[16:19], v[120:127], v2
    v_exp_f32 v72, v72
    v_exp_f32 v73, v73
    v_exp_f32 v74, v74
    v_exp_f32 v75, v75
    v_smfmac_f32_32x32x32_bf16 v[128:143], v[240:243], v[64:71], v2
    v_exp_f32 v76, v76
    v_exp_f32 v77, v77
    v_exp_f32 v78, v78
    v_exp_f32 v79, v79
    v_mfma_f32_32x32x16_bf16 v[96:111], v[160:163], v[28:31], 0
    v_exp_f32 v80, v80
    v_exp_f32 v81, v81
    v_exp_f32 v82, v82
    v_exp_f32 v83, v83
    v_mfma_f32_32x32x8_bf16 v[96:111], v[224:225], v[60:61], v[96:111]
    v_exp_f32 v84, v84
    v_exp_f32 v85, v85
    buffer_load_dwordx4 a[76:79], v18, s[44:47], s75 offen sc1
    v_exp_f32 v86, v86
    v_exp_f32 v87, v87
    v_smfmac_f32_32x32x32_bf16 v[128:143], v[244:247], v[72:79], v2
    v_exp_f32 v88, v88
    v_exp_f32 v89, v89
    v_exp_f32 v90, v90
    s_waitcnt vmcnt(5)
    v_mfma_f32_16x16x32_bf16 v[32:35], a[246:249], a[56:59], v[32:35]
    v_exp_f32 v91, v91
    v_smfmac_f32_32x32x32_bf16 v[128:143], v[248:251], v[80:87], v2
    v_exp_f32 v92, v92
    v_exp_f32 v93, v93
    v_exp_f32 v94, v94
    v_mfma_f32_16x16x32_bf16 v[36:39], a[244:247], a[56:59], v[36:39]
    v_exp_f32 v95, v95
    v_mfma_f32_32x32x16_bf16 v[112:127], v[164:167], v[28:31], 0
    v_exp_f32 v96, v96
    v_exp_f32 v97, v97
    v_exp_f32 v98, v98
    v_exp_f32 v99, v99
    v_mfma_f32_32x32x8_bf16 v[112:127], v[224:225], v[62:63], v[112:127]
    v_exp_f32 v100, v100
    v_exp_f32 v101, v101
    v_mov_b64 v[144:145], 0
    v_mov_b64 v[146:147], 0
    v_mov_b64 v[148:149], 0
    v_mov_b64 v[150:151], 0
    v_mov_b64 v[152:153], 0
    v_exp_f32 v102, v102
    v_exp_f32 v103, v103
    v_smfmac_f32_32x32x32_bf16 v[128:143], v[252:255], v[88:95], v2
    v_exp_f32 v104, v104
    v_exp_f32 v105, v105
    v_exp_f32 v106, v106
    v_exp_f32 v107, v107
    v_smfmac_f32_32x32x32_bf16 v[144:159], a[144:147], v[96:103], v2
    v_exp_f32 v108, v108
    v_exp_f32 v109, v109
    v_exp_f32 v110, v110
    v_exp_f32 v111, v111
    v_mfma_f32_32x32x16_bf16 v[64:79], v[168:171], v[28:31], 0
    v_exp_f32 v112, v112
    v_exp_f32 v113, v113
    v_exp_f32 v114, v114
    v_exp_f32 v115, v115
    v_mfma_f32_32x32x8_bf16 v[64:79], v[226:227], v[60:61], v[64:79]
    v_exp_f32 v116, v116
    v_exp_f32 v117, v117
    buffer_load_dwordx4 a[80:83], v19, s[44:47], s75 offen sc1
    v_exp_f32 v118, v118
    v_exp_f32 v119, v119
    v_smfmac_f32_32x32x32_bf16 v[144:159], a[148:151], v[104:111], v2
    v_exp_f32 v120, v120
    v_exp_f32 v121, v121
    v_exp_f32 v122, v122
    s_waitcnt vmcnt(5)
    v_mfma_f32_16x16x32_bf16 v[32:35], a[246:249], a[60:63], v[32:35]
    v_exp_f32 v123, v123
    v_smfmac_f32_32x32x32_bf16 v[144:159], a[152:155], v[112:119], v2
    v_exp_f32 v124, v124
    v_exp_f32 v125, v125
    ds_write_b128 v26, v[128:131] offset:0
    v_exp_f32 v126, v126
    v_mfma_f32_16x16x32_bf16 v[36:39], a[244:247], a[60:63], v[36:39]
    v_exp_f32 v127, v127
    v_mfma_f32_32x32x16_bf16 v[80:95], v[172:175], v[28:31], 0
    v_exp_f32 v64, v64
    v_exp_f32 v65, v65
    v_exp_f32 v66, v66
    v_exp_f32 v67, v67
    v_mfma_f32_32x32x8_bf16 v[80:95], v[226:227], v[62:63], v[80:95]
    v_exp_f32 v68, v68
    v_exp_f32 v69, v69
    v_exp_f32 v70, v70
    v_exp_f32 v71, v71
    v_smfmac_f32_32x32x32_bf16 v[144:159], a[156:159], v[120:127], v2
    v_exp_f32 v72, v72
    v_exp_f32 v73, v73
    v_exp_f32 v74, v74
    v_exp_f32 v75, v75
    v_smfmac_f32_32x32x32_bf16 v[144:159], a[160:163], v[64:71], v2
    v_exp_f32 v76, v76
    v_exp_f32 v77, v77
    ds_write_b128 v26, v[132:135] offset:1024
    v_exp_f32 v78, v78
    v_exp_f32 v79, v79
    v_mfma_f32_32x32x16_bf16 v[96:111], v[176:179], v[28:31], 0
    v_exp_f32 v80, v80
    v_exp_f32 v81, v81
    v_exp_f32 v82, v82
    v_exp_f32 v83, v83
    v_mfma_f32_32x32x8_bf16 v[96:111], v[228:229], v[60:61], v[96:111]
    v_exp_f32 v84, v84
    v_exp_f32 v85, v85
    buffer_load_dwordx4 a[84:87], v16, s[44:47], s76 offen sc1
    v_exp_f32 v86, v86
    v_exp_f32 v87, v87
    v_smfmac_f32_32x32x32_bf16 v[144:159], a[164:167], v[72:79], v2
    v_exp_f32 v88, v88
    v_exp_f32 v89, v89
    v_exp_f32 v90, v90
    s_waitcnt vmcnt(5)
    v_mfma_f32_16x16x32_bf16 v[32:35], a[246:249], a[64:67], v[32:35]
    v_exp_f32 v91, v91
    v_smfmac_f32_32x32x32_bf16 v[144:159], a[168:171], v[80:87], v2
    v_exp_f32 v92, v92
    v_exp_f32 v93, v93
    ds_write_b64 v0, v[136:137] offset:2048
    v_exp_f32 v94, v94
    v_mfma_f32_16x16x32_bf16 v[36:39], a[244:247], a[64:67], v[36:39]
    v_exp_f32 v95, v95
    v_mfma_f32_32x32x16_bf16 v[112:127], v[180:183], v[28:31], 0
    v_exp_f32 v96, v96
    v_exp_f32 v97, v97
    v_exp_f32 v98, v98
    v_exp_f32 v99, v99
    v_mfma_f32_32x32x8_bf16 v[112:127], v[228:229], v[62:63], v[112:127]
    v_exp_f32 v100, v100
    v_exp_f32 v101, v101
    v_exp_f32 v102, v102
    v_exp_f32 v103, v103
    v_smfmac_f32_32x32x32_bf16 v[144:159], a[172:175], v[88:95], v2
    v_exp_f32 v104, v104
    v_exp_f32 v105, v105
    v_exp_f32 v106, v106
    v_exp_f32 v107, v107
    v_smfmac_f32_32x32x32_bf16 v[144:159], a[176:179], v[96:103], v2
    v_exp_f32 v108, v108
    v_exp_f32 v109, v109
    v_exp_f32 v110, v110
    v_exp_f32 v111, v111
    v_mfma_f32_32x32x16_bf16 v[64:79], v[184:187], v[28:31], 0
    v_exp_f32 v112, v112
    v_exp_f32 v113, v113
    v_exp_f32 v114, v114
    v_exp_f32 v115, v115
    v_mfma_f32_32x32x8_bf16 v[64:79], v[230:231], v[60:61], v[64:79]
    v_exp_f32 v116, v116
    v_exp_f32 v117, v117
    buffer_load_dwordx4 a[88:91], v17, s[44:47], s76 offen sc1
    v_exp_f32 v118, v118
    v_exp_f32 v119, v119
    v_smfmac_f32_32x32x32_bf16 v[144:159], a[180:183], v[104:111], v2
    v_exp_f32 v120, v120
    v_exp_f32 v121, v121
    v_exp_f32 v122, v122
    v_exp_f32 v123, v123
    v_smfmac_f32_32x32x32_bf16 v[144:159], a[184:187], v[112:119], v2
    v_exp_f32 v124, v124
    v_exp_f32 v125, v125
    ds_read_b128 v[4:7], v24 offset:6144
    v_exp_f32 v126, v126
    v_exp_f32 v127, v127
    v_mfma_f32_32x32x16_bf16 v[80:95], v[188:191], v[28:31], 0
    v_exp_f32 v64, v64
    v_exp_f32 v65, v65
    v_exp_f32 v66, v66
    v_exp_f32 v67, v67
    v_mfma_f32_32x32x8_bf16 v[80:95], v[230:231], v[62:63], v[80:95]
    v_exp_f32 v68, v68
    v_exp_f32 v69, v69
    v_exp_f32 v70, v70
    v_exp_f32 v71, v71
    v_smfmac_f32_32x32x32_bf16 v[144:159], a[188:191], v[120:127], v2
    v_exp_f32 v72, v72
    v_exp_f32 v73, v73
    v_exp_f32 v74, v74
    v_exp_f32 v75, v75
    v_smfmac_f32_32x32x32_bf16 v[144:159], a[192:195], v[64:71], v2
    v_exp_f32 v76, v76
    v_exp_f32 v77, v77
    ds_read_b32 v56, v25 offset:1536
    v_exp_f32 v78, v78
    v_exp_f32 v79, v79
    v_mfma_f32_32x32x16_bf16 v[96:111], v[192:195], v[28:31], 0
    v_exp_f32 v80, v80
    v_exp_f32 v81, v81
    v_exp_f32 v82, v82
    v_exp_f32 v83, v83
    v_mfma_f32_32x32x8_bf16 v[96:111], v[232:233], v[60:61], v[96:111]
    v_exp_f32 v84, v84
    v_exp_f32 v85, v85
    buffer_load_dwordx4 a[92:95], v18, s[44:47], s76 offen sc1
    v_exp_f32 v86, v86
    v_exp_f32 v87, v87
    v_smfmac_f32_32x32x32_bf16 v[144:159], a[196:199], v[72:79], v2
    v_exp_f32 v88, v88
    v_exp_f32 v89, v89
    v_exp_f32 v90, v90
    v_exp_f32 v91, v91
    v_smfmac_f32_32x32x32_bf16 v[144:159], a[200:203], v[80:87], v2
    v_exp_f32 v92, v92
    v_exp_f32 v93, v93
    v_exp_f32 v94, v94
    v_exp_f32 v95, v95
    v_mfma_f32_32x32x16_bf16 v[112:127], v[196:199], v[28:31], 0
    v_exp_f32 v96, v96
    v_exp_f32 v97, v97
    v_exp_f32 v98, v98
    v_exp_f32 v99, v99
    v_mfma_f32_32x32x8_bf16 v[112:127], v[232:233], v[62:63], v[112:127]
    v_exp_f32 v100, v100
    v_exp_f32 v101, v101
    v_exp_f32 v102, v102
    v_exp_f32 v103, v103
    v_smfmac_f32_32x32x32_bf16 v[144:159], a[204:207], v[88:95], v2
    v_exp_f32 v104, v104
    v_exp_f32 v105, v105
    v_exp_f32 v106, v106
    v_exp_f32 v107, v107
    v_smfmac_f32_32x32x32_bf16 v[144:159], a[208:211], v[96:103], v2
    v_exp_f32 v108, v108
    v_exp_f32 v109, v109
    s_waitcnt lgkmcnt(0)
    v_mov_b32 v59, v56
    v_exp_f32 v110, v110
    v_exp_f32 v111, v111
    v_mfma_f32_32x32x16_bf16 v[64:79], v[200:203], v[28:31], 0
    v_exp_f32 v112, v112
    v_exp_f32 v113, v113
    v_exp_f32 v114, v114
    v_exp_f32 v115, v115
    v_mfma_f32_32x32x8_bf16 v[64:79], v[234:235], v[60:61], v[64:79]
    v_exp_f32 v116, v116
    v_exp_f32 v117, v117
    buffer_load_dwordx4 a[96:99], v19, s[44:47], s76 offen sc1
    v_exp_f32 v118, v118
    v_exp_f32 v119, v119
    v_smfmac_f32_32x32x32_bf16 v[144:159], a[212:215], v[104:111], v2
    v_exp_f32 v120, v120
    v_exp_f32 v121, v121
    v_exp_f32 v122, v122
    v_exp_f32 v123, v123
    v_smfmac_f32_32x32x32_bf16 v[144:159], a[216:219], v[112:119], v2
    v_exp_f32 v124, v124
    v_exp_f32 v125, v125
    v_exp_f32 v126, v126
    v_exp_f32 v127, v127
    v_mfma_f32_32x32x16_bf16 v[80:95], v[204:207], v[28:31], 0
    v_exp_f32 v64, v64
    v_exp_f32 v65, v65
    v_exp_f32 v66, v66
    v_exp_f32 v67, v67
    v_mfma_f32_32x32x8_bf16 v[80:95], v[234:235], v[62:63], v[80:95]
    v_exp_f32 v68, v68
    v_exp_f32 v69, v69
    v_exp_f32 v70, v70
    v_exp_f32 v71, v71
    v_smfmac_f32_32x32x32_bf16 v[144:159], a[220:223], v[120:127], v2
    v_exp_f32 v72, v72
    v_exp_f32 v73, v73
    v_exp_f32 v74, v74
    v_exp_f32 v75, v75
    v_smfmac_f32_32x32x32_bf16 v[144:159], a[224:227], v[64:71], v2
    v_exp_f32 v76, v76
    v_exp_f32 v77, v77
    v_exp_f32 v78, v78
    v_exp_f32 v79, v79
    v_mfma_f32_32x32x16_bf16 v[96:111], v[208:211], v[28:31], 0
    v_exp_f32 v80, v80
    v_exp_f32 v81, v81
    v_exp_f32 v82, v82
    v_exp_f32 v83, v83
    v_mfma_f32_32x32x8_bf16 v[96:111], v[236:237], v[60:61], v[96:111]
    v_exp_f32 v84, v84
    v_exp_f32 v85, v85
    buffer_load_dwordx4 a[100:103], v16, s[44:47], s77 offen sc1
    v_exp_f32 v86, v86
    v_exp_f32 v87, v87
    v_smfmac_f32_32x32x32_bf16 v[144:159], a[228:231], v[72:79], v2
    v_exp_f32 v88, v88
    v_exp_f32 v89, v89
    v_exp_f32 v90, v90
    v_exp_f32 v91, v91
    v_smfmac_f32_32x32x32_bf16 v[144:159], a[232:235], v[80:87], v2
    v_exp_f32 v92, v92
    v_exp_f32 v93, v93
    v_exp_f32 v94, v94
    v_exp_f32 v95, v95
    v_mfma_f32_32x32x16_bf16 v[112:127], v[212:215], v[28:31], 0
    v_exp_f32 v96, v96
    v_exp_f32 v97, v97
    v_exp_f32 v98, v98
    v_exp_f32 v99, v99
    v_mfma_f32_32x32x8_bf16 v[112:127], v[236:237], v[62:63], v[112:127]
    v_exp_f32 v100, v100
    v_exp_f32 v101, v101
    v_exp_f32 v102, v102
    v_exp_f32 v103, v103
    v_smfmac_f32_32x32x32_bf16 v[144:159], a[0:3], v[88:95], v2
    v_exp_f32 v104, v104
    v_exp_f32 v105, v105
    v_exp_f32 v106, v106
    v_exp_f32 v107, v107
    v_smfmac_f32_32x32x32_bf16 v[144:159], a[4:7], v[96:103], v2
    v_exp_f32 v108, v108
    v_exp_f32 v109, v109
    v_exp_f32 v110, v110
    v_exp_f32 v111, v111
    v_mfma_f32_32x32x16_bf16 v[64:79], v[216:219], v[28:31], 0
    v_exp_f32 v112, v112
    v_exp_f32 v113, v113
    v_exp_f32 v114, v114
    v_exp_f32 v115, v115
    v_mfma_f32_32x32x8_bf16 v[64:79], v[238:239], v[60:61], v[64:79]
    v_exp_f32 v116, v116
    v_exp_f32 v117, v117
    buffer_load_dwordx4 a[104:107], v17, s[44:47], s77 offen sc1
    v_exp_f32 v118, v118
    v_exp_f32 v119, v119
    v_smfmac_f32_32x32x32_bf16 v[144:159], a[8:11], v[104:111], v2
    v_exp_f32 v120, v120
    v_exp_f32 v121, v121
    v_exp_f32 v122, v122
    v_exp_f32 v123, v123
    v_smfmac_f32_32x32x32_bf16 v[144:159], a[12:15], v[112:119], v2
    v_exp_f32 v124, v124
    v_exp_f32 v125, v125
    v_exp_f32 v126, v126
    v_exp_f32 v127, v127
    v_mfma_f32_32x32x16_bf16 v[80:95], v[220:223], v[28:31], 0
    v_exp_f32 v64, v64
    v_exp_f32 v65, v65
    v_exp_f32 v66, v66
    v_exp_f32 v67, v67
    v_mfma_f32_32x32x8_bf16 v[80:95], v[238:239], v[62:63], v[80:95]
    v_exp_f32 v68, v68
    v_exp_f32 v69, v69
    v_exp_f32 v70, v70
    v_exp_f32 v71, v71
    v_smfmac_f32_32x32x32_bf16 v[144:159], a[16:19], v[120:127], v2
    v_exp_f32 v72, v72
    v_exp_f32 v73, v73
    v_exp_f32 v74, v74
    v_exp_f32 v75, v75
    v_smfmac_f32_32x32x32_bf16 v[144:159], v[240:243], v[64:71], v2
    v_exp_f32 v76, v76
    v_exp_f32 v77, v77
    v_exp_f32 v78, v78
    v_exp_f32 v79, v79
    v_mfma_f32_32x32x16_bf16 v[96:111], v[160:163], v[4:7], 0
    v_exp_f32 v80, v80
    v_exp_f32 v81, v81
    v_exp_f32 v82, v82
    v_exp_f32 v83, v83
    v_mfma_f32_32x32x8_bf16 v[96:111], v[224:225], v[56:57], v[96:111]
    v_exp_f32 v84, v84
    v_exp_f32 v85, v85
    buffer_load_dwordx4 a[108:111], v18, s[44:47], s77 offen sc1
    v_exp_f32 v86, v86
    v_exp_f32 v87, v87
    v_smfmac_f32_32x32x32_bf16 v[144:159], v[244:247], v[72:79], v2
    v_exp_f32 v88, v88
    v_exp_f32 v89, v89
    v_exp_f32 v90, v90
    v_exp_f32 v91, v91
    v_smfmac_f32_32x32x32_bf16 v[144:159], v[248:251], v[80:87], v2
    v_exp_f32 v92, v92
    v_exp_f32 v93, v93
    v_exp_f32 v94, v94
    v_exp_f32 v95, v95
    v_mfma_f32_32x32x16_bf16 v[112:127], v[164:167], v[4:7], 0
    v_exp_f32 v96, v96
    v_exp_f32 v97, v97
    v_exp_f32 v98, v98
    v_exp_f32 v99, v99
    v_mfma_f32_32x32x8_bf16 v[112:127], v[224:225], v[58:59], v[112:127]
    v_exp_f32 v100, v100
    v_exp_f32 v101, v101
    v_mov_b64 v[128:129], 0
    v_mov_b64 v[130:131], 0
    v_mov_b64 v[132:133], 0
    v_mov_b64 v[134:135], 0
    v_mov_b64 v[136:137], 0
    v_exp_f32 v102, v102
    v_exp_f32 v103, v103
    v_smfmac_f32_32x32x32_bf16 v[144:159], v[252:255], v[88:95], v2
    v_exp_f32 v104, v104
    v_exp_f32 v105, v105
    v_exp_f32 v106, v106
    v_exp_f32 v107, v107
    v_smfmac_f32_32x32x32_bf16 v[128:143], a[144:147], v[96:103], v2
    v_exp_f32 v108, v108
    v_exp_f32 v109, v109
    v_exp_f32 v110, v110
    v_exp_f32 v111, v111
    v_mfma_f32_32x32x16_bf16 v[64:79], v[168:171], v[4:7], 0
    v_exp_f32 v112, v112
    v_exp_f32 v113, v113
    v_exp_f32 v114, v114
    v_exp_f32 v115, v115
    v_mfma_f32_32x32x8_bf16 v[64:79], v[226:227], v[56:57], v[64:79]
    v_exp_f32 v116, v116
    v_exp_f32 v117, v117
    buffer_load_dwordx4 a[112:115], v19, s[44:47], s77 offen sc1
    v_exp_f32 v118, v118
    v_exp_f32 v119, v119
    v_smfmac_f32_32x32x32_bf16 v[128:143], a[148:151], v[104:111], v2
    v_exp_f32 v120, v120
    v_exp_f32 v121, v121
    v_exp_f32 v122, v122
    v_exp_f32 v123, v123
    v_smfmac_f32_32x32x32_bf16 v[128:143], a[152:155], v[112:119], v2
    v_exp_f32 v124, v124
    v_exp_f32 v125, v125
    ds_write_b128 v26, v[144:147] offset:10240
    v_exp_f32 v126, v126
    v_exp_f32 v127, v127
    v_mfma_f32_32x32x16_bf16 v[80:95], v[172:175], v[4:7], 0
    v_exp_f32 v64, v64
    v_exp_f32 v65, v65
    v_exp_f32 v66, v66
    v_exp_f32 v67, v67
    v_mfma_f32_32x32x8_bf16 v[80:95], v[226:227], v[58:59], v[80:95]
    v_exp_f32 v68, v68
    v_exp_f32 v69, v69
    v_exp_f32 v70, v70
    v_exp_f32 v71, v71
    v_smfmac_f32_32x32x32_bf16 v[128:143], a[156:159], v[120:127], v2
    v_exp_f32 v72, v72
    v_exp_f32 v73, v73
    v_exp_f32 v74, v74
    v_exp_f32 v75, v75
    v_smfmac_f32_32x32x32_bf16 v[128:143], a[160:163], v[64:71], v2
    v_exp_f32 v76, v76
    v_exp_f32 v77, v77
    ds_write_b128 v26, v[148:151] offset:11264
    v_exp_f32 v78, v78
    v_exp_f32 v79, v79
    v_mfma_f32_32x32x16_bf16 v[96:111], v[176:179], v[4:7], 0
    v_exp_f32 v80, v80
    v_exp_f32 v81, v81
    v_exp_f32 v82, v82
    v_exp_f32 v83, v83
    v_mfma_f32_32x32x8_bf16 v[96:111], v[228:229], v[56:57], v[96:111]
    v_exp_f32 v84, v84
    v_exp_f32 v85, v85
    buffer_load_dwordx4 a[116:119], v16, s[44:47], s78 offen sc1
    v_exp_f32 v86, v86
    v_exp_f32 v87, v87
    v_smfmac_f32_32x32x32_bf16 v[128:143], a[164:167], v[72:79], v2
    v_exp_f32 v88, v88
    v_exp_f32 v89, v89
    v_exp_f32 v90, v90
    v_exp_f32 v91, v91
    v_smfmac_f32_32x32x32_bf16 v[128:143], a[168:171], v[80:87], v2
    v_exp_f32 v92, v92
    v_exp_f32 v93, v93
    ds_write_b64 v0, v[152:153] offset:12288
    v_exp_f32 v94, v94
    v_exp_f32 v95, v95
    v_mfma_f32_32x32x16_bf16 v[112:127], v[180:183], v[4:7], 0
    v_exp_f32 v96, v96
    v_exp_f32 v97, v97
    v_exp_f32 v98, v98
    v_exp_f32 v99, v99
    v_mfma_f32_32x32x8_bf16 v[112:127], v[228:229], v[58:59], v[112:127]
    v_exp_f32 v100, v100
    v_exp_f32 v101, v101
    v_exp_f32 v102, v102
    v_exp_f32 v103, v103
    v_smfmac_f32_32x32x32_bf16 v[128:143], a[172:175], v[88:95], v2
    v_exp_f32 v104, v104
    v_exp_f32 v105, v105
    v_exp_f32 v106, v106
    v_exp_f32 v107, v107
    v_smfmac_f32_32x32x32_bf16 v[128:143], a[176:179], v[96:103], v2
    v_exp_f32 v108, v108
    v_exp_f32 v109, v109
    v_exp_f32 v110, v110
    v_exp_f32 v111, v111
    v_mfma_f32_32x32x16_bf16 v[64:79], v[184:187], v[4:7], 0
    v_exp_f32 v112, v112
    v_exp_f32 v113, v113
    v_exp_f32 v114, v114
    v_exp_f32 v115, v115
    v_mfma_f32_32x32x8_bf16 v[64:79], v[230:231], v[56:57], v[64:79]
    v_exp_f32 v116, v116
    v_exp_f32 v117, v117
    buffer_load_dwordx4 a[120:123], v17, s[44:47], s78 offen sc1
    v_exp_f32 v118, v118
    v_exp_f32 v119, v119
    v_smfmac_f32_32x32x32_bf16 v[128:143], a[180:183], v[104:111], v2
    v_exp_f32 v120, v120
    v_exp_f32 v121, v121
    v_exp_f32 v122, v122
    v_exp_f32 v123, v123
    v_smfmac_f32_32x32x32_bf16 v[128:143], a[184:187], v[112:119], v2
    v_exp_f32 v124, v124
    v_exp_f32 v125, v125
    ds_read_b128 v[28:31], v24 offset:7168
    v_exp_f32 v126, v126
    v_exp_f32 v127, v127
    v_mfma_f32_32x32x16_bf16 v[80:95], v[188:191], v[4:7], 0
    v_exp_f32 v64, v64
    v_exp_f32 v65, v65
    v_exp_f32 v66, v66
    v_exp_f32 v67, v67
    v_mfma_f32_32x32x8_bf16 v[80:95], v[230:231], v[58:59], v[80:95]
    v_exp_f32 v68, v68
    v_exp_f32 v69, v69
    v_exp_f32 v70, v70
    v_exp_f32 v71, v71
    v_smfmac_f32_32x32x32_bf16 v[128:143], a[188:191], v[120:127], v2
    v_exp_f32 v72, v72
    v_exp_f32 v73, v73
    v_exp_f32 v74, v74
    v_exp_f32 v75, v75
    v_smfmac_f32_32x32x32_bf16 v[128:143], a[192:195], v[64:71], v2
    v_exp_f32 v76, v76
    v_exp_f32 v77, v77
    ds_read_b32 v60, v25 offset:1792
    v_exp_f32 v78, v78
    v_exp_f32 v79, v79
    v_mfma_f32_32x32x16_bf16 v[96:111], v[192:195], v[4:7], 0
    v_exp_f32 v80, v80
    v_exp_f32 v81, v81
    v_exp_f32 v82, v82
    v_exp_f32 v83, v83
    v_mfma_f32_32x32x8_bf16 v[96:111], v[232:233], v[56:57], v[96:111]
    v_exp_f32 v84, v84
    v_exp_f32 v85, v85
    buffer_load_dwordx4 a[124:127], v18, s[44:47], s78 offen sc1
    v_exp_f32 v86, v86
    v_exp_f32 v87, v87
    v_smfmac_f32_32x32x32_bf16 v[128:143], a[196:199], v[72:79], v2
    v_exp_f32 v88, v88
    v_exp_f32 v89, v89
    v_exp_f32 v90, v90
    v_exp_f32 v91, v91
    v_smfmac_f32_32x32x32_bf16 v[128:143], a[200:203], v[80:87], v2
    v_exp_f32 v92, v92
    v_exp_f32 v93, v93
    v_exp_f32 v94, v94
    v_exp_f32 v95, v95
    v_mfma_f32_32x32x16_bf16 v[112:127], v[196:199], v[4:7], 0
    v_exp_f32 v96, v96
    v_exp_f32 v97, v97
    v_exp_f32 v98, v98
    v_exp_f32 v99, v99
    v_mfma_f32_32x32x8_bf16 v[112:127], v[232:233], v[58:59], v[112:127]
    v_exp_f32 v100, v100
    v_exp_f32 v101, v101
    v_exp_f32 v102, v102
    v_exp_f32 v103, v103
    v_smfmac_f32_32x32x32_bf16 v[128:143], a[204:207], v[88:95], v2
    v_exp_f32 v104, v104
    v_exp_f32 v105, v105
    v_exp_f32 v106, v106
    v_exp_f32 v107, v107
    v_smfmac_f32_32x32x32_bf16 v[128:143], a[208:211], v[96:103], v2
    v_exp_f32 v108, v108
    v_exp_f32 v109, v109
    s_waitcnt lgkmcnt(0)
    v_mov_b32 v63, v60
    v_exp_f32 v110, v110
    v_exp_f32 v111, v111
    v_mfma_f32_32x32x16_bf16 v[64:79], v[200:203], v[4:7], 0
    v_exp_f32 v112, v112
    v_exp_f32 v113, v113
    v_exp_f32 v114, v114
    v_exp_f32 v115, v115
    v_mfma_f32_32x32x8_bf16 v[64:79], v[234:235], v[56:57], v[64:79]
    v_exp_f32 v116, v116
    v_exp_f32 v117, v117
    buffer_load_dwordx4 a[128:131], v19, s[44:47], s78 offen sc1
    v_exp_f32 v118, v118
    v_exp_f32 v119, v119
    v_smfmac_f32_32x32x32_bf16 v[128:143], a[212:215], v[104:111], v2
    v_exp_f32 v120, v120
    v_exp_f32 v121, v121
    v_exp_f32 v122, v122
    v_exp_f32 v123, v123
    v_smfmac_f32_32x32x32_bf16 v[128:143], a[216:219], v[112:119], v2
    v_exp_f32 v124, v124
    v_exp_f32 v125, v125
    v_exp_f32 v126, v126
    v_exp_f32 v127, v127
    v_mfma_f32_32x32x16_bf16 v[80:95], v[204:207], v[4:7], 0
    v_exp_f32 v64, v64
    v_exp_f32 v65, v65
    v_exp_f32 v66, v66
    v_exp_f32 v67, v67
    v_mfma_f32_32x32x8_bf16 v[80:95], v[234:235], v[58:59], v[80:95]
    v_exp_f32 v68, v68
    v_exp_f32 v69, v69
    v_exp_f32 v70, v70
    v_exp_f32 v71, v71
    v_smfmac_f32_32x32x32_bf16 v[128:143], a[220:223], v[120:127], v2
    v_exp_f32 v72, v72
    v_exp_f32 v73, v73
    v_exp_f32 v74, v74
    v_exp_f32 v75, v75
    v_smfmac_f32_32x32x32_bf16 v[128:143], a[224:227], v[64:71], v2
    v_exp_f32 v76, v76
    v_exp_f32 v77, v77
    v_exp_f32 v78, v78
    v_exp_f32 v79, v79
    v_mfma_f32_32x32x16_bf16 v[96:111], v[208:211], v[4:7], 0
    v_exp_f32 v80, v80
    v_exp_f32 v81, v81
    v_exp_f32 v82, v82
    v_exp_f32 v83, v83
    v_mfma_f32_32x32x8_bf16 v[96:111], v[236:237], v[56:57], v[96:111]
    v_exp_f32 v84, v84
    v_exp_f32 v85, v85
    buffer_load_dwordx4 a[132:135], v16, s[44:47], s79 offen sc1
    v_exp_f32 v86, v86
    v_exp_f32 v87, v87
    v_smfmac_f32_32x32x32_bf16 v[128:143], a[228:231], v[72:79], v2
    v_exp_f32 v88, v88
    v_exp_f32 v89, v89
    v_exp_f32 v90, v90
    v_exp_f32 v91, v91
    v_smfmac_f32_32x32x32_bf16 v[128:143], a[232:235], v[80:87], v2
    v_exp_f32 v92, v92
    v_exp_f32 v93, v93
    v_exp_f32 v94, v94
    v_exp_f32 v95, v95
    v_mfma_f32_32x32x16_bf16 v[112:127], v[212:215], v[4:7], 0
    v_exp_f32 v96, v96
    v_exp_f32 v97, v97
    v_exp_f32 v98, v98
    v_exp_f32 v99, v99
    v_mfma_f32_32x32x8_bf16 v[112:127], v[236:237], v[58:59], v[112:127]
    v_exp_f32 v100, v100
    v_exp_f32 v101, v101
    v_exp_f32 v102, v102
    v_exp_f32 v103, v103
    v_smfmac_f32_32x32x32_bf16 v[128:143], a[0:3], v[88:95], v2
    v_exp_f32 v104, v104
    v_exp_f32 v105, v105
    v_exp_f32 v106, v106
    v_exp_f32 v107, v107
    v_smfmac_f32_32x32x32_bf16 v[128:143], a[4:7], v[96:103], v2
    v_exp_f32 v108, v108
    v_exp_f32 v109, v109
    v_exp_f32 v110, v110
    v_exp_f32 v111, v111
    v_mfma_f32_32x32x16_bf16 v[64:79], v[216:219], v[4:7], 0
    v_exp_f32 v112, v112
    v_exp_f32 v113, v113
    v_exp_f32 v114, v114
    v_exp_f32 v115, v115
    v_mfma_f32_32x32x8_bf16 v[64:79], v[238:239], v[56:57], v[64:79]
    v_exp_f32 v116, v116
    v_exp_f32 v117, v117
    buffer_load_dwordx4 a[136:139], v17, s[44:47], s79 offen sc1
    v_exp_f32 v118, v118
    v_exp_f32 v119, v119
    v_smfmac_f32_32x32x32_bf16 v[128:143], a[8:11], v[104:111], v2
    v_exp_f32 v120, v120
    v_exp_f32 v121, v121
    v_exp_f32 v122, v122
    v_exp_f32 v123, v123
    v_smfmac_f32_32x32x32_bf16 v[128:143], a[12:15], v[112:119], v2
    v_exp_f32 v124, v124
    v_exp_f32 v125, v125
    v_exp_f32 v126, v126
    v_exp_f32 v127, v127
    v_mfma_f32_32x32x16_bf16 v[80:95], v[220:223], v[4:7], 0
    v_exp_f32 v64, v64
    v_exp_f32 v65, v65
    v_exp_f32 v66, v66
    v_exp_f32 v67, v67
    v_mfma_f32_32x32x8_bf16 v[80:95], v[238:239], v[58:59], v[80:95]
    v_exp_f32 v68, v68
    v_exp_f32 v69, v69
    v_exp_f32 v70, v70
    v_exp_f32 v71, v71
    v_smfmac_f32_32x32x32_bf16 v[128:143], a[16:19], v[120:127], v2
    v_exp_f32 v72, v72
    v_exp_f32 v73, v73
    v_exp_f32 v74, v74
    v_exp_f32 v75, v75
    v_smfmac_f32_32x32x32_bf16 v[128:143], v[240:243], v[64:71], v2
    v_exp_f32 v76, v76
    v_exp_f32 v77, v77
    v_exp_f32 v78, v78
    v_exp_f32 v79, v79
    v_mfma_f32_32x32x16_bf16 v[96:111], v[160:163], v[28:31], 0
    v_exp_f32 v80, v80
    v_exp_f32 v81, v81
    v_exp_f32 v82, v82
    v_exp_f32 v83, v83
    v_mfma_f32_32x32x8_bf16 v[96:111], v[224:225], v[60:61], v[96:111]
    v_exp_f32 v84, v84
    v_exp_f32 v85, v85
    buffer_load_dwordx4 a[140:143], v18, s[44:47], s79 offen sc1
    v_exp_f32 v86, v86
    v_exp_f32 v87, v87
    v_smfmac_f32_32x32x32_bf16 v[128:143], v[244:247], v[72:79], v2
    v_exp_f32 v88, v88
    v_exp_f32 v89, v89
    v_exp_f32 v90, v90
    v_exp_f32 v91, v91
    v_smfmac_f32_32x32x32_bf16 v[128:143], v[248:251], v[80:87], v2
    v_exp_f32 v92, v92
    v_exp_f32 v93, v93
    v_exp_f32 v94, v94
    v_exp_f32 v95, v95
    v_mfma_f32_32x32x16_bf16 v[112:127], v[164:167], v[28:31], 0
    v_exp_f32 v96, v96
    v_exp_f32 v97, v97
    v_exp_f32 v98, v98
    v_exp_f32 v99, v99
    v_mfma_f32_32x32x8_bf16 v[112:127], v[224:225], v[62:63], v[112:127]
    v_exp_f32 v100, v100
    v_exp_f32 v101, v101
    v_mov_b64 v[144:145], 0
    v_mov_b64 v[146:147], 0
    v_mov_b64 v[148:149], 0
    v_mov_b64 v[150:151], 0
    v_mov_b64 v[152:153], 0
    v_exp_f32 v102, v102
    v_exp_f32 v103, v103
    v_smfmac_f32_32x32x32_bf16 v[128:143], v[252:255], v[88:95], v2
    v_exp_f32 v104, v104
    v_exp_f32 v105, v105
    v_exp_f32 v106, v106
    v_exp_f32 v107, v107
    v_smfmac_f32_32x32x32_bf16 v[144:159], a[144:147], v[96:103], v2
    v_exp_f32 v108, v108
    v_exp_f32 v109, v109
    v_exp_f32 v110, v110
    v_exp_f32 v111, v111
    v_mfma_f32_32x32x16_bf16 v[64:79], v[168:171], v[28:31], 0
    v_exp_f32 v112, v112
    v_exp_f32 v113, v113
    v_exp_f32 v114, v114
    v_exp_f32 v115, v115
    v_mfma_f32_32x32x8_bf16 v[64:79], v[226:227], v[60:61], v[64:79]
    v_exp_f32 v116, v116
    v_exp_f32 v117, v117
    buffer_load_dwordx4 a[20:23], v19, s[44:47], s79 offen sc1
    v_exp_f32 v118, v118
    v_exp_f32 v119, v119
    v_smfmac_f32_32x32x32_bf16 v[144:159], a[148:151], v[104:111], v2
    v_exp_f32 v120, v120
    v_exp_f32 v121, v121
    v_exp_f32 v122, v122
    v_exp_f32 v123, v123
    v_smfmac_f32_32x32x32_bf16 v[144:159], a[152:155], v[112:119], v2
    v_exp_f32 v124, v124
    v_exp_f32 v125, v125
    ds_write_b128 v26, v[128:131] offset:20480
    v_exp_f32 v126, v126
    v_exp_f32 v127, v127
    v_mfma_f32_32x32x16_bf16 v[80:95], v[172:175], v[28:31], 0
    v_exp_f32 v64, v64
    v_exp_f32 v65, v65
    v_exp_f32 v66, v66
    v_exp_f32 v67, v67
    v_mfma_f32_32x32x8_bf16 v[80:95], v[226:227], v[62:63], v[80:95]
    v_exp_f32 v68, v68
    v_exp_f32 v69, v69
    v_exp_f32 v70, v70
    v_exp_f32 v71, v71
    v_smfmac_f32_32x32x32_bf16 v[144:159], a[156:159], v[120:127], v2
    v_exp_f32 v72, v72
    v_exp_f32 v73, v73
    v_exp_f32 v74, v74
    v_exp_f32 v75, v75
    v_smfmac_f32_32x32x32_bf16 v[144:159], a[160:163], v[64:71], v2
    v_exp_f32 v76, v76
    v_exp_f32 v77, v77
    ds_write_b128 v26, v[132:135] offset:21504
    v_exp_f32 v78, v78
    v_exp_f32 v79, v79
    v_mfma_f32_32x32x16_bf16 v[96:111], v[176:179], v[28:31], 0
    v_exp_f32 v80, v80
    v_exp_f32 v81, v81
    v_exp_f32 v82, v82
    v_exp_f32 v83, v83
    v_mfma_f32_32x32x8_bf16 v[96:111], v[228:229], v[60:61], v[96:111]
    v_exp_f32 v84, v84
    v_exp_f32 v85, v85
    buffer_load_dwordx4 a[24:27], v16, s[44:47], s80 offen sc1
    v_exp_f32 v86, v86
    v_exp_f32 v87, v87
    v_smfmac_f32_32x32x32_bf16 v[144:159], a[164:167], v[72:79], v2
    v_exp_f32 v88, v88
    v_exp_f32 v89, v89
    v_exp_f32 v90, v90
    v_exp_f32 v91, v91
    v_smfmac_f32_32x32x32_bf16 v[144:159], a[168:171], v[80:87], v2
    v_exp_f32 v92, v92
    v_exp_f32 v93, v93
    ds_write_b64 v0, v[136:137] offset:22528
    v_exp_f32 v94, v94
    v_exp_f32 v95, v95
    v_mfma_f32_32x32x16_bf16 v[112:127], v[180:183], v[28:31], 0
    v_exp_f32 v96, v96
    v_exp_f32 v97, v97
    v_exp_f32 v98, v98
    v_exp_f32 v99, v99
    v_mfma_f32_32x32x8_bf16 v[112:127], v[228:229], v[62:63], v[112:127]
    v_exp_f32 v100, v100
    v_exp_f32 v101, v101
    v_exp_f32 v102, v102
    v_exp_f32 v103, v103
    v_smfmac_f32_32x32x32_bf16 v[144:159], a[172:175], v[88:95], v2
    v_exp_f32 v104, v104
    v_exp_f32 v105, v105
    v_exp_f32 v106, v106
    v_exp_f32 v107, v107
    v_smfmac_f32_32x32x32_bf16 v[144:159], a[176:179], v[96:103], v2
    v_exp_f32 v108, v108
    v_exp_f32 v109, v109
    v_exp_f32 v110, v110
    v_exp_f32 v111, v111
    v_mfma_f32_32x32x16_bf16 v[64:79], v[184:187], v[28:31], 0
    v_exp_f32 v112, v112
    v_exp_f32 v113, v113
    v_exp_f32 v114, v114
    v_exp_f32 v115, v115
    v_mfma_f32_32x32x8_bf16 v[64:79], v[230:231], v[60:61], v[64:79]
    v_exp_f32 v116, v116
    v_exp_f32 v117, v117
    buffer_load_dwordx4 a[28:31], v17, s[44:47], s80 offen sc1
    v_exp_f32 v118, v118
    v_exp_f32 v119, v119
    v_smfmac_f32_32x32x32_bf16 v[144:159], a[180:183], v[104:111], v2
    v_exp_f32 v120, v120
    v_exp_f32 v121, v121
    v_exp_f32 v122, v122
    v_exp_f32 v123, v123
    v_smfmac_f32_32x32x32_bf16 v[144:159], a[184:187], v[112:119], v2
    v_exp_f32 v124, v124
    v_exp_f32 v125, v125
    v_exp_f32 v126, v126
    v_exp_f32 v127, v127
    v_mfma_f32_32x32x16_bf16 v[80:95], v[188:191], v[28:31], 0
    v_exp_f32 v64, v64
    v_exp_f32 v65, v65
    v_exp_f32 v66, v66
    v_exp_f32 v67, v67
    v_mfma_f32_32x32x8_bf16 v[80:95], v[230:231], v[62:63], v[80:95]
    v_exp_f32 v68, v68
    v_exp_f32 v69, v69
    v_exp_f32 v70, v70
    v_exp_f32 v71, v71
    v_smfmac_f32_32x32x32_bf16 v[144:159], a[188:191], v[120:127], v2
    v_exp_f32 v72, v72
    v_exp_f32 v73, v73
    v_exp_f32 v74, v74
    v_exp_f32 v75, v75
    v_smfmac_f32_32x32x32_bf16 v[144:159], a[192:195], v[64:71], v2
    v_exp_f32 v76, v76
    v_exp_f32 v77, v77
    v_exp_f32 v78, v78
    v_exp_f32 v79, v79
    v_mfma_f32_32x32x16_bf16 v[96:111], v[192:195], v[28:31], 0
    v_exp_f32 v80, v80
    v_exp_f32 v81, v81
    v_exp_f32 v82, v82
    v_exp_f32 v83, v83
    v_mfma_f32_32x32x8_bf16 v[96:111], v[232:233], v[60:61], v[96:111]
    v_exp_f32 v84, v84
    v_exp_f32 v85, v85
    buffer_load_dwordx4 a[32:35], v18, s[44:47], s80 offen sc1
    v_exp_f32 v86, v86
    v_exp_f32 v87, v87
    v_smfmac_f32_32x32x32_bf16 v[144:159], a[196:199], v[72:79], v2
    v_exp_f32 v88, v88
    v_exp_f32 v89, v89
    v_exp_f32 v90, v90
    v_exp_f32 v91, v91
    v_smfmac_f32_32x32x32_bf16 v[144:159], a[200:203], v[80:87], v2
    v_exp_f32 v92, v92
    v_exp_f32 v93, v93
    v_exp_f32 v94, v94
    v_exp_f32 v95, v95
    v_mfma_f32_32x32x16_bf16 v[112:127], v[196:199], v[28:31], 0
    v_exp_f32 v96, v96
    v_exp_f32 v97, v97
    v_exp_f32 v98, v98
    v_exp_f32 v99, v99
    v_mfma_f32_32x32x8_bf16 v[112:127], v[232:233], v[62:63], v[112:127]
    v_exp_f32 v100, v100
    v_exp_f32 v101, v101
    v_exp_f32 v102, v102
    v_exp_f32 v103, v103
    v_smfmac_f32_32x32x32_bf16 v[144:159], a[204:207], v[88:95], v2
    v_exp_f32 v104, v104
    v_exp_f32 v105, v105
    v_exp_f32 v106, v106
    v_exp_f32 v107, v107
    v_smfmac_f32_32x32x32_bf16 v[144:159], a[208:211], v[96:103], v2
    v_exp_f32 v108, v108
    v_exp_f32 v109, v109
    v_exp_f32 v110, v110
    v_exp_f32 v111, v111
    v_mfma_f32_32x32x16_bf16 v[64:79], v[200:203], v[28:31], 0
    v_exp_f32 v112, v112
    v_exp_f32 v113, v113
    v_exp_f32 v114, v114
    v_exp_f32 v115, v115
    v_mfma_f32_32x32x8_bf16 v[64:79], v[234:235], v[60:61], v[64:79]
    v_exp_f32 v116, v116
    v_exp_f32 v117, v117
    buffer_load_dwordx4 a[36:39], v19, s[44:47], s80 offen sc1
    v_exp_f32 v118, v118
    v_exp_f32 v119, v119
    v_smfmac_f32_32x32x32_bf16 v[144:159], a[212:215], v[104:111], v2
    v_exp_f32 v120, v120
    v_exp_f32 v121, v121
    v_exp_f32 v122, v122
    v_exp_f32 v123, v123
    v_smfmac_f32_32x32x32_bf16 v[144:159], a[216:219], v[112:119], v2
    v_exp_f32 v124, v124
    v_exp_f32 v125, v125
    v_exp_f32 v126, v126
    v_exp_f32 v127, v127
    v_mfma_f32_32x32x16_bf16 v[80:95], v[204:207], v[28:31], 0
    v_exp_f32 v64, v64
    v_exp_f32 v65, v65
    v_exp_f32 v66, v66
    v_exp_f32 v67, v67
    v_mfma_f32_32x32x8_bf16 v[80:95], v[234:235], v[62:63], v[80:95]
    v_exp_f32 v68, v68
    v_exp_f32 v69, v69
    v_exp_f32 v70, v70
    v_exp_f32 v71, v71
    v_smfmac_f32_32x32x32_bf16 v[144:159], a[220:223], v[120:127], v2
    v_exp_f32 v72, v72
    v_exp_f32 v73, v73
    v_exp_f32 v74, v74
    v_exp_f32 v75, v75
    v_smfmac_f32_32x32x32_bf16 v[144:159], a[224:227], v[64:71], v2
    v_exp_f32 v76, v76
    v_exp_f32 v77, v77
    v_exp_f32 v78, v78
    v_exp_f32 v79, v79
    v_mfma_f32_32x32x16_bf16 v[96:111], v[208:211], v[28:31], 0
    v_exp_f32 v80, v80
    v_exp_f32 v81, v81
    v_exp_f32 v82, v82
    v_exp_f32 v83, v83
    v_mfma_f32_32x32x8_bf16 v[96:111], v[236:237], v[60:61], v[96:111]
    v_exp_f32 v84, v84
    v_exp_f32 v85, v85
    v_exp_f32 v86, v86
    v_exp_f32 v87, v87
    v_smfmac_f32_32x32x32_bf16 v[144:159], a[228:231], v[72:79], v2
    v_exp_f32 v88, v88
    v_exp_f32 v89, v89
    v_exp_f32 v90, v90
    v_exp_f32 v91, v91
    v_smfmac_f32_32x32x32_bf16 v[144:159], a[232:235], v[80:87], v2
    v_exp_f32 v92, v92
    v_exp_f32 v93, v93
    s_mul_i32 s63, s53, 6144
    s_add_u32 s63, s63, 32768
    v_add_u32 v22, s63, v22
    s_lshl_b32 s64, s54, 7
    s_lshl_b32 s65, s53, 11
    s_add_u32 s63, s63, s65
    s_add_u32 s63, s63, s64
    s_add_u32 s63, s63, 40370176
    s_cmp_eq_u32 s52, 0
    s_cselect_b32 s63, s63, 2146435072
    v_mov_b32 v23, s63
    v_exp_f32 v94, v94
    v_exp_f32 v95, v95
    v_mfma_f32_32x32x16_bf16 v[112:127], v[212:215], v[28:31], 0
    v_exp_f32 v96, v96
    v_exp_f32 v97, v97
    v_exp_f32 v98, v98
    v_exp_f32 v99, v99
    v_mfma_f32_32x32x8_bf16 v[112:127], v[236:237], v[62:63], v[112:127]
    v_exp_f32 v100, v100
    v_exp_f32 v101, v101
    v_exp_f32 v102, v102
    v_exp_f32 v103, v103
    v_smfmac_f32_32x32x32_bf16 v[144:159], a[0:3], v[88:95], v2
    v_exp_f32 v104, v104
    v_exp_f32 v105, v105
    v_exp_f32 v106, v106
    v_exp_f32 v107, v107
    v_smfmac_f32_32x32x32_bf16 v[144:159], a[4:7], v[96:103], v2
    v_exp_f32 v108, v108
    v_exp_f32 v109, v109
    s_mov_b64 exec, 1
    buffer_store_dword v10, v23, s[44:47], 0 offen sc1
    s_mov_b64 exec, -1
    v_exp_f32 v110, v110
    v_exp_f32 v111, v111
    v_mfma_f32_32x32x16_bf16 v[64:79], v[216:219], v[28:31], 0
    v_exp_f32 v112, v112
    v_exp_f32 v113, v113
    v_exp_f32 v114, v114
    v_exp_f32 v115, v115
    v_mfma_f32_32x32x8_bf16 v[64:79], v[238:239], v[60:61], v[64:79]
    v_exp_f32 v116, v116
    v_exp_f32 v117, v117
    v_exp_f32 v118, v118
    v_exp_f32 v119, v119
    v_smfmac_f32_32x32x32_bf16 v[144:159], a[8:11], v[104:111], v2
    v_exp_f32 v120, v120
    v_exp_f32 v121, v121
    v_exp_f32 v122, v122
    v_exp_f32 v123, v123
    v_smfmac_f32_32x32x32_bf16 v[144:159], a[12:15], v[112:119], v2
    v_exp_f32 v124, v124
    v_exp_f32 v125, v125
    v_exp_f32 v126, v126
    v_exp_f32 v127, v127
    v_mfma_f32_32x32x16_bf16 v[80:95], v[220:223], v[28:31], 0
    v_exp_f32 v64, v64
    v_exp_f32 v65, v65
    v_exp_f32 v66, v66
    v_exp_f32 v67, v67
    v_mfma_f32_32x32x8_bf16 v[80:95], v[238:239], v[62:63], v[80:95]
    v_exp_f32 v68, v68
    v_exp_f32 v69, v69
    v_exp_f32 v70, v70
    v_exp_f32 v71, v71
    v_smfmac_f32_32x32x32_bf16 v[144:159], a[16:19], v[120:127], v2
    v_exp_f32 v72, v72
    v_exp_f32 v73, v73
    v_exp_f32 v74, v74
    v_exp_f32 v75, v75
    v_smfmac_f32_32x32x32_bf16 v[144:159], v[240:243], v[64:71], v2
    v_exp_f32 v76, v76
    v_exp_f32 v77, v77
    v_exp_f32 v78, v78
    v_exp_f32 v79, v79
    v_exp_f32 v80, v80
    v_exp_f32 v81, v81
    v_exp_f32 v82, v82
    v_exp_f32 v83, v83
    v_exp_f32 v84, v84
    v_exp_f32 v85, v85
    v_exp_f32 v86, v86
    v_exp_f32 v87, v87
    v_smfmac_f32_32x32x32_bf16 v[144:159], v[244:247], v[72:79], v2
    v_exp_f32 v88, v88
    v_exp_f32 v89, v89
    v_exp_f32 v90, v90
    v_exp_f32 v91, v91
    v_smfmac_f32_32x32x32_bf16 v[144:159], v[248:251], v[80:87], v2
    v_exp_f32 v92, v92
    v_exp_f32 v93, v93
    v_exp_f32 v94, v94
    v_exp_f32 v95, v95
    s_nop 1
    v_smfmac_f32_32x32x32_bf16 v[144:159], v[252:255], v[88:95], v2
    s_mul_i32 s62, s52, 10240
    s_add_u32 s62, s62, 53248
    v_and_b32 v64, 31, v1
    v_lshl_add_u32 v70, v1, 4, s62
    v_lshl_add_u32 v71, v1, 3, s62
    s_and_b32 s64, s54, 1
    s_lshl_b32 s65, s64, 3
    s_mul_i32 s62, s52, 2560
    s_add_u32 s62, s62, s65
    s_add_u32 s62, s62, 147456
    s_nop 1
    ds_write_b128 v26, v[144:147] offset:30720
    ds_write_b128 v26, v[148:151] offset:31744
    ds_write_b64 v0, v[152:153] offset:32768
    s_waitcnt lgkmcnt(0)
    s_barrier
    ds_read_b128 v[160:163], v70 offset:0
    ds_read_b128 v[164:167], v70 offset:1024
    ds_read_b64 v[168:169], v71 offset:2048
    ds_read_b128 v[172:175], v70 offset:2560
    ds_read_b128 v[176:179], v70 offset:3584
    ds_read_b64 v[180:181], v71 offset:4608
    ds_read_b128 v[184:187], v70 offset:5120
    ds_read_b128 v[188:191], v70 offset:6144
    ds_read_b64 v[192:193], v71 offset:7168
    ds_read_b128 v[196:199], v70 offset:7680
    ds_read_b128 v[200:203], v70 offset:8704
    ds_read_b64 v[204:205], v71 offset:9728
    ds_read_b128 v[208:211], v70 offset:40960
    ds_read_b128 v[212:215], v70 offset:41984
    ds_read_b64 v[216:217], v71 offset:43008
    ds_read_b128 v[220:223], v70 offset:43520
    ds_read_b128 v[224:227], v70 offset:44544
    ds_read_b64 v[228:229], v71 offset:45568
    ds_read_b128 v[232:235], v70 offset:46080
    ds_read_b128 v[236:239], v70 offset:47104
    ds_read_b64 v[240:241], v71 offset:48128
    ds_read_b128 v[244:247], v70 offset:48640
    ds_read_b128 v[248:251], v70 offset:49664
    ds_read_b64 v[252:253], v71 offset:50688
    v_mul_u32_u24 v65, 80, v64
    v_lshrrev_b32 v66, 5, v1
    v_lshl_add_u32 v72, v66, 3, v65
    v_add_u32 v72, s62, v72
    s_mul_i32 s62, s52, 2560
    s_add_u32 s62, s62, 147456
    s_lshl_b32 s63, s64, 4
    s_add_u32 s63, s63, s62
    v_and_b32 v67, 15, v1
    v_lshrrev_b32 v68, 4, v1
    v_mul_u32_u24 v69, 80, v67
    v_lshl_add_u32 v69, v68, 4, v69
    v_add_u32 v73, s63, v69
    s_xor_b32 s63, s64, 1
    s_mul_i32 s63, s63, 56
    s_add_u32 s63, s63, 8
    s_add_u32 s63, s63, s62
    v_add_u32 v74, s63, v65
    s_mov_b32 s64, 394264576
    s_mov_b32 s65, 1904214016
    s_waitcnt lgkmcnt(12)
    v_pk_add_f32 v[136:137], v[168:169], v[180:181]
    v_pk_add_f32 v[168:169], v[192:193], v[204:205]
    v_pk_add_f32 v[128:129], v[160:161], v[172:173]
    v_pk_add_f32 v[160:161], v[184:185], v[196:197]
    v_pk_add_f32 v[130:131], v[162:163], v[174:175]
    v_pk_add_f32 v[162:163], v[186:187], v[198:199]
    v_pk_add_f32 v[132:133], v[164:165], v[176:177]
    v_pk_add_f32 v[164:165], v[188:189], v[200:201]
    v_pk_add_f32 v[134:135], v[166:167], v[178:179]
    v_pk_add_f32 v[166:167], v[190:191], v[202:203]
    v_pk_add_f32 v[136:137], v[136:137], v[168:169]
    v_mov_b32 v138, v136
    v_mov_b32 v139, v136
    v_pk_add_f32 v[128:129], v[128:129], v[160:161]
    v_pk_add_f32 v[130:131], v[130:131], v[162:163]
    v_pk_add_f32 v[132:133], v[132:133], v[164:165]
    v_pk_add_f32 v[134:135], v[134:135], v[166:167]
    v_permlane32_swap_b32 v139, v138
    v_pk_add_f32 v[160:161], v[128:129], v[130:131]
    v_pk_add_f32 v[162:163], v[132:133], v[134:135]
    v_pk_add_f32 v[160:161], v[160:161], v[136:137]
    v_pk_add_f32 v[160:161], v[160:161], v[162:163]
    v_add_f32 v160, v160, v161
    v_fma_f32 v140, v160, 0, v138
    v_cmp_le_f32 vcc, s64, v140
    v_cmp_ge_f32 s[70:71], s65, v140
    s_nop 1
    s_and_b64 vcc, vcc, s[70:71]
    s_cmp_eq_u64 vcc, exec
    s_cbranch_scc0 L_slow_0
L_back_0:
    v_rcp_f32 v138, v138
    s_nop 0
    v_pk_mul_f32 v[128:129], v[128:129], v[138:139] op_sel_hi:[1,0]
    v_pk_mul_f32 v[130:131], v[130:131], v[138:139] op_sel_hi:[1,0]
    v_pk_mul_f32 v[132:133], v[132:133], v[138:139] op_sel_hi:[1,0]
    v_pk_mul_f32 v[134:135], v[134:135], v[138:139] op_sel_hi:[1,0]
    v_pk_mul_f32 v[136:137], v[136:137], v[138:139] op_sel_hi:[1,0]
    v_cvt_pk_bf16_f32 v128, v128, v129
    ds_write_b32 v72, v128 offset:0
    v_cvt_pk_bf16_f32 v130, v130, v131
    ds_write_b32 v72, v130 offset:4
    v_cvt_pk_bf16_f32 v132, v132, v133
    ds_write_b32 v72, v132 offset:16
    v_cvt_pk_bf16_f32 v134, v134, v135
    ds_write_b32 v72, v134 offset:20
    v_cvt_pk_bf16_f32 v136, v136, v137
    s_mov_b32 exec_hi, 0
    ds_write_b32 v72, v136 offset:32
    s_mov_b32 exec_hi, -1
    s_waitcnt lgkmcnt(5)
    v_pk_add_f32 v[152:153], v[216:217], v[228:229]
    v_pk_add_f32 v[216:217], v[240:241], v[252:253]
    v_pk_add_f32 v[144:145], v[208:209], v[220:221]
    v_pk_add_f32 v[208:209], v[232:233], v[244:245]
    v_pk_add_f32 v[146:147], v[210:211], v[222:223]
    v_pk_add_f32 v[210:211], v[234:235], v[246:247]
    v_pk_add_f32 v[148:149], v[212:213], v[224:225]
    v_pk_add_f32 v[212:213], v[236:237], v[248:249]
    v_pk_add_f32 v[150:151], v[214:215], v[226:227]
    v_pk_add_f32 v[214:215], v[238:239], v[250:251]
    v_pk_add_f32 v[152:153], v[152:153], v[216:217]
    v_mov_b32 v154, v152
    v_mov_b32 v155, v152
    v_pk_add_f32 v[144:145], v[144:145], v[208:209]
    v_pk_add_f32 v[146:147], v[146:147], v[210:211]
    v_pk_add_f32 v[148:149], v[148:149], v[212:213]
    v_pk_add_f32 v[150:151], v[150:151], v[214:215]
    v_permlane32_swap_b32 v155, v154
    v_pk_add_f32 v[208:209], v[144:145], v[146:147]
    v_pk_add_f32 v[210:211], v[148:149], v[150:151]
    v_pk_add_f32 v[208:209], v[208:209], v[152:153]
    v_pk_add_f32 v[208:209], v[208:209], v[210:211]
    v_add_f32 v208, v208, v209
    v_fma_f32 v156, v208, 0, v154
    v_cmp_le_f32 vcc, s64, v156
    v_cmp_ge_f32 s[70:71], s65, v156
    s_nop 1
    s_and_b64 vcc, vcc, s[70:71]
    s_cmp_eq_u64 vcc, exec
    s_cbranch_scc0 L_slow_1
L_back_1:
    v_rcp_f32 v154, v154
    s_nop 0
    v_pk_mul_f32 v[144:145], v[144:145], v[154:155] op_sel_hi:[1,0]
    v_pk_mul_f32 v[146:147], v[146:147], v[154:155] op_sel_hi:[1,0]
    v_pk_mul_f32 v[148:149], v[148:149], v[154:155] op_sel_hi:[1,0]
    v_pk_mul_f32 v[150:151], v[150:151], v[154:155] op_sel_hi:[1,0]
    v_pk_mul_f32 v[152:153], v[152:153], v[154:155] op_sel_hi:[1,0]
    v_cvt_pk_bf16_f32 v144, v144, v145
    ds_write_b32 v72, v144 offset:36
    v_cvt_pk_bf16_f32 v146, v146, v147
    ds_write_b32 v72, v146 offset:40
    v_cvt_pk_bf16_f32 v148, v148, v149
    ds_write_b32 v72, v148 offset:52
    v_cvt_pk_bf16_f32 v150, v150, v151
    ds_write_b32 v72, v150 offset:56
    v_cvt_pk_bf16_f32 v152, v152, v153
    s_mov_b32 exec_hi, 0
    ds_write_b32 v72, v152 offset:68
    s_mov_b32 exec_hi, -1
    ds_read_b128 v[80:83], v73
    ds_read_b128 v[84:87], v73 offset:1280
    ds_read_b64 v[88:89], v74
    s_mov_b32 s62, 18432
    s_waitcnt lgkmcnt(0)
    buffer_store_dwordx4 v[80:83], v13, s[44:47], 0 offen sc1
    buffer_store_dwordx4 v[84:87], v13, s[44:47], s62 offen sc1
    buffer_store_dwordx2 v[88:89], v14, s[44:47], 0 offen sc1
    v_lshrrev_b32 v69, 2, v1
    v_and_b32 v68, 8, v69
    v_add_u32 v69, v69, v68
    v_mul_u32_u24 v69, 96, v69
    v_and_b32 v68, 3, v1
    v_lshl_add_u32 v69, v68, 3, v69
    v_add_u32 v78, 0, v69
    v_add_u32 v79, 160768, v69
    v_add_u32 v94, 18432, v15
    buffer_load_dword v92, v22, s[44:47], 0 offen sc1
    s_waitcnt vmcnt(5)
    v_mfma_f32_16x16x32_bf16 v[32:35], a[250:253], a[68:71], v[32:35]
    ds_read_b64_tr_b16 a[144:145], v78 offset:0
    v_mfma_f32_16x16x32_bf16 v[36:39], a[248:251], a[68:71], v[36:39]
    ds_read_b64_tr_b16 a[146:147], v78 offset:768
    v_mfma_f32_16x16x32_bf16 v[32:35], a[250:253], a[72:75], v[32:35]
    ds_read_b64_tr_b16 a[148:149], v78 offset:32
    v_mfma_f32_16x16x32_bf16 v[36:39], a[248:251], a[72:75], v[36:39]
    ds_read_b64_tr_b16 a[150:151], v78 offset:800
    v_mfma_f32_16x16x32_bf16 v[32:35], a[250:253], a[76:79], v[32:35]
    ds_read_b64_tr_b16 a[152:153], v78 offset:64
    v_mfma_f32_16x16x32_bf16 v[36:39], a[248:251], a[76:79], v[36:39]
    ds_read_b64_tr_b16 a[154:155], v78 offset:832
    v_mfma_f32_16x16x32_bf16 v[32:35], a[250:253], a[80:83], v[32:35]
    ds_read_b64_tr_b16 a[156:157], v78 offset:3072
    v_mfma_f32_16x16x32_bf16 v[36:39], a[248:251], a[80:83], v[36:39]
    ds_read_b64_tr_b16 a[158:159], v78 offset:3840
    v_mfma_f32_16x16x32_bf16 v[40:43], a[238:241], a[84:87], v[40:43]
    ds_read_b64_tr_b16 a[160:161], v78 offset:3104
    v_mfma_f32_16x16x32_bf16 v[44:47], a[236:239], a[84:87], v[44:47]
    ds_read_b64_tr_b16 a[162:163], v78 offset:3872
    v_mfma_f32_16x16x32_bf16 v[40:43], a[238:241], a[88:91], v[40:43]
    ds_read_b64_tr_b16 a[164:165], v78 offset:3136
    v_mfma_f32_16x16x32_bf16 v[44:47], a[236:239], a[88:91], v[44:47]
    ds_read_b64_tr_b16 a[166:167], v78 offset:3904
    v_mfma_f32_16x16x32_bf16 v[40:43], a[238:241], a[92:95], v[40:43]
    ds_read_b64_tr_b16 a[168:169], v78 offset:6144
    v_mfma_f32_16x16x32_bf16 v[44:47], a[236:239], a[92:95], v[44:47]
    ds_read_b64_tr_b16 a[170:171], v78 offset:6912
    v_mfma_f32_16x16x32_bf16 v[40:43], a[238:241], a[96:99], v[40:43]
    ds_read_b64_tr_b16 a[172:173], v78 offset:6176
    v_mfma_f32_16x16x32_bf16 v[44:47], a[236:239], a[96:99], v[44:47]
    ds_read_b64_tr_b16 a[174:175], v78 offset:6944
    v_mfma_f32_16x16x32_bf16 v[40:43], a[242:245], a[100:103], v[40:43]
    ds_read_b64_tr_b16 a[176:177], v78 offset:6208
    v_mfma_f32_16x16x32_bf16 v[44:47], a[240:243], a[100:103], v[44:47]
    ds_read_b64_tr_b16 a[178:179], v78 offset:6976
    v_mfma_f32_16x16x32_bf16 v[40:43], a[242:245], a[104:107], v[40:43]
    ds_read_b64_tr_b16 a[180:181], v78 offset:9216
    v_mfma_f32_16x16x32_bf16 v[44:47], a[240:243], a[104:107], v[44:47]
    ds_read_b64_tr_b16 a[182:183], v78 offset:9984
    v_mfma_f32_16x16x32_bf16 v[40:43], a[242:245], a[108:111], v[40:43]
    ds_read_b64_tr_b16 a[184:185], v78 offset:9248
    v_mfma_f32_16x16x32_bf16 v[44:47], a[240:243], a[108:111], v[44:47]
    ds_read_b64_tr_b16 a[186:187], v78 offset:10016
    v_mfma_f32_16x16x32_bf16 v[40:43], a[242:245], a[112:115], v[40:43]
    ds_read_b64_tr_b16 a[188:189], v78 offset:9280
    v_mfma_f32_16x16x32_bf16 v[44:47], a[240:243], a[112:115], v[44:47]
    ds_read_b64_tr_b16 a[190:191], v78 offset:10048
    v_mfma_f32_16x16x32_bf16 v[40:43], a[246:249], a[116:119], v[40:43]
    ds_read_b64_tr_b16 a[192:193], v78 offset:12288
    v_mfma_f32_16x16x32_bf16 v[44:47], a[244:247], a[116:119], v[44:47]
    ds_read_b64_tr_b16 a[194:195], v78 offset:13056
    v_mfma_f32_16x16x32_bf16 v[40:43], a[246:249], a[120:123], v[40:43]
    ds_read_b64_tr_b16 a[196:197], v78 offset:12320
    v_mfma_f32_16x16x32_bf16 v[44:47], a[244:247], a[120:123], v[44:47]
    ds_read_b64_tr_b16 a[198:199], v78 offset:13088
    v_mfma_f32_16x16x32_bf16 v[40:43], a[246:249], a[124:127], v[40:43]
    ds_read_b64_tr_b16 a[200:201], v78 offset:12352
    v_mfma_f32_16x16x32_bf16 v[44:47], a[244:247], a[124:127], v[44:47]
    ds_read_b64_tr_b16 a[202:203], v78 offset:13120
    v_mfma_f32_16x16x32_bf16 v[40:43], a[246:249], a[128:131], v[40:43]
    ds_read_b64_tr_b16 a[204:205], v78 offset:15360
    v_mfma_f32_16x16x32_bf16 v[44:47], a[244:247], a[128:131], v[44:47]
    ds_read_b64_tr_b16 a[206:207], v78 offset:16128
    v_mfma_f32_16x16x32_bf16 v[40:43], a[250:253], a[132:135], v[40:43]
    ds_read_b64_tr_b16 a[208:209], v78 offset:15392
    v_mfma_f32_16x16x32_bf16 v[44:47], a[248:251], a[132:135], v[44:47]
    ds_read_b64_tr_b16 a[210:211], v78 offset:16160
    v_mfma_f32_16x16x32_bf16 v[40:43], a[250:253], a[136:139], v[40:43]
    ds_read_b64_tr_b16 a[212:213], v78 offset:15424
    v_mfma_f32_16x16x32_bf16 v[44:47], a[248:251], a[136:139], v[44:47]
    ds_read_b64_tr_b16 a[214:215], v78 offset:16192
    v_mfma_f32_16x16x32_bf16 v[40:43], a[250:253], a[140:143], v[40:43]
    ds_read_b64_tr_b16 a[216:217], v78 offset:18432
    v_mfma_f32_16x16x32_bf16 v[44:47], a[248:251], a[140:143], v[44:47]
    ds_read_b64_tr_b16 a[218:219], v78 offset:19200
    v_mfma_f32_16x16x32_bf16 v[40:43], a[250:253], a[20:23], v[40:43]
    ds_read_b64_tr_b16 a[220:221], v78 offset:18464
    v_mfma_f32_16x16x32_bf16 v[44:47], a[248:251], a[20:23], v[44:47]
    ds_read_b64_tr_b16 a[222:223], v78 offset:19232
    v_mfma_f32_16x16x32_bf16 v[48:51], a[238:241], a[24:27], v[48:51]
    ds_read_b64_tr_b16 a[224:225], v78 offset:18496
    v_mfma_f32_16x16x32_bf16 v[52:55], a[236:239], a[24:27], v[52:55]
    ds_read_b64_tr_b16 a[226:227], v78 offset:19264
    v_mfma_f32_16x16x32_bf16 v[48:51], a[238:241], a[28:31], v[48:51]
    ds_read_b64_tr_b16 a[228:229], v78 offset:21504
    v_mfma_f32_16x16x32_bf16 v[52:55], a[236:239], a[28:31], v[52:55]
    ds_read_b64_tr_b16 a[230:231], v78 offset:22272
    v_mfma_f32_16x16x32_bf16 v[48:51], a[238:241], a[32:35], v[48:51]
    ds_read_b64_tr_b16 a[232:233], v78 offset:21536
    v_mfma_f32_16x16x32_bf16 v[52:55], a[236:239], a[32:35], v[52:55]
    ds_read_b64_tr_b16 a[234:235], v78 offset:22304
    v_mfma_f32_16x16x32_bf16 v[48:51], a[238:241], a[36:39], v[48:51]
    v_mfma_f32_16x16x32_bf16 v[52:55], a[236:239], a[36:39], v[52:55]
    s_nop 7
    s_mov_b32 s60, 0
    s_waitcnt vmcnt(0)
    v_cmp_eq_u32 vcc, 1, v92
    s_nop 1
    s_cmp_eq_u64 vcc, exec
    s_cbranch_scc0 L_pollo
L_pollo_ok:
L_proj:
    s_mov_b32 s62, 0
    s_mov_b32 s63, 18432
    buffer_load_dwordx4 v[96:99], v15, s[44:47], s62 offen offset:0 sc1
    ds_read_b64_tr_b16 a[0:1], v78 offset:21568
    ds_read_b64_tr_b16 a[2:3], v78 offset:22336
    ds_read_b64_tr_b16 a[4:5], v78 offset:24576
    ds_read_b64_tr_b16 a[6:7], v78 offset:25344
    ds_read_b64_tr_b16 a[8:9], v78 offset:24608
    ds_read_b64_tr_b16 a[10:11], v78 offset:25376
    buffer_load_dwordx4 v[100:103], v15, s[44:47], s63 offen offset:0 sc1
    ds_read_b64_tr_b16 a[12:13], v78 offset:24640
    ds_read_b64_tr_b16 a[14:15], v78 offset:25408
    ds_read_b64_tr_b16 a[16:17], v78 offset:27648
    ds_read_b64_tr_b16 a[18:19], v78 offset:28416
    ds_read_b64_tr_b16 a[20:21], v78 offset:27680
    ds_read_b64_tr_b16 a[22:23], v78 offset:28448
    buffer_load_dwordx4 v[104:107], v15, s[44:47], s62 offen offset:1024 sc1
    ds_read_b64_tr_b16 a[24:25], v78 offset:27712
    ds_read_b64_tr_b16 a[26:27], v78 offset:28480
    ds_read_b64_tr_b16 a[28:29], v78 offset:30720
    ds_read_b64_tr_b16 a[30:31], v78 offset:31488
    ds_read_b64_tr_b16 a[32:33], v78 offset:30752
    ds_read_b64_tr_b16 a[34:35], v78 offset:31520
    buffer_load_dwordx4 v[108:111], v15, s[44:47], s63 offen offset:1024 sc1
    ds_read_b64_tr_b16 a[36:37], v78 offset:30784
    ds_read_b64_tr_b16 a[38:39], v78 offset:31552
    ds_read_b64_tr_b16 a[40:41], v78 offset:33792
    ds_read_b64_tr_b16 a[42:43], v78 offset:34560
    ds_read_b64_tr_b16 a[44:45], v78 offset:33824
    ds_read_b64_tr_b16 a[46:47], v78 offset:34592
    buffer_load_dwordx4 v[112:115], v15, s[44:47], s62 offen offset:2048 sc1
    ds_read_b64_tr_b16 a[48:49], v78 offset:33856
    ds_read_b64_tr_b16 a[50:51], v78 offset:34624
    ds_read_b64_tr_b16 a[52:53], v78 offset:36864
    ds_read_b64_tr_b16 a[54:55], v78 offset:37632
    ds_read_b64_tr_b16 a[56:57], v78 offset:36896
    ds_read_b64_tr_b16 a[58:59], v78 offset:37664
    buffer_load_dwordx4 v[116:119], v15, s[44:47], s63 offen offset:2048 sc1
    ds_read_b64_tr_b16 a[60:61], v78 offset:36928
    ds_read_b64_tr_b16 a[62:63], v78 offset:37696
    ds_read_b64_tr_b16 a[64:65], v78 offset:39936
    ds_read_b64_tr_b16 a[66:67], v78 offset:40704
    ds_read_b64_tr_b16 a[68:69], v78 offset:39968
    ds_read_b64_tr_b16 a[70:71], v78 offset:40736
    buffer_load_dwordx4 v[120:123], v15, s[44:47], s62 offen offset:3072 sc1
    ds_read_b64_tr_b16 a[72:73], v78 offset:40000
    ds_read_b64_tr_b16 a[74:75], v78 offset:40768
    ds_read_b64_tr_b16 a[76:77], v78 offset:43008
    ds_read_b64_tr_b16 a[78:79], v78 offset:43776
    ds_read_b64_tr_b16 a[80:81], v78 offset:43040
    ds_read_b64_tr_b16 a[82:83], v78 offset:43808
    buffer_load_dwordx4 v[124:127], v15, s[44:47], s63 offen offset:3072 sc1
    ds_read_b64_tr_b16 a[84:85], v78 offset:43072
    ds_read_b64_tr_b16 a[86:87], v78 offset:43840
    ds_read_b64_tr_b16 a[88:89], v78 offset:46080
    ds_read_b64_tr_b16 a[90:91], v78 offset:46848
    ds_read_b64_tr_b16 a[92:93], v78 offset:46112
    ds_read_b64_tr_b16 a[94:95], v78 offset:46880
    s_mov_b32 s62, 4096
    s_mov_b32 s63, 22528
    buffer_load_dwordx4 v[128:131], v15, s[44:47], s62 offen offset:0 sc1
    ds_read_b64_tr_b16 a[96:97], v78 offset:46144
    ds_read_b64_tr_b16 a[98:99], v78 offset:46912
    ds_read_b64_tr_b16 a[100:101], v78 offset:49152
    ds_read_b64_tr_b16 a[102:103], v78 offset:49920
    ds_read_b64_tr_b16 a[104:105], v78 offset:49184
    ds_read_b64_tr_b16 a[106:107], v78 offset:49952
    buffer_load_dwordx4 v[132:135], v15, s[44:47], s63 offen offset:0 sc1
    ds_read_b64_tr_b16 a[108:109], v78 offset:49216
    ds_read_b64_tr_b16 a[110:111], v78 offset:49984
    ds_read_b64_tr_b16 a[112:113], v79 offset:0
    ds_read_b64_tr_b16 a[114:115], v79 offset:768
    ds_read_b64_tr_b16 a[116:117], v79 offset:32
    ds_read_b64_tr_b16 a[118:119], v79 offset:800
    buffer_load_dwordx4 v[136:139], v15, s[44:47], s62 offen offset:1024 sc1
    ds_read_b64_tr_b16 a[120:121], v79 offset:64
    ds_read_b64_tr_b16 a[122:123], v79 offset:832
    buffer_load_dwordx4 v[140:143], v15, s[44:47], s63 offen offset:1024 sc1
    s_waitcnt vmcnt(10)
    v_max3_u32 v93, v96, v97, v98
    v_max3_u32 v95, v99, v100, v101
    v_max3_u32 v93, v93, v102, v103
    v_max_u32 v93, v93, v95
    v_cmp_eq_u32 vcc, -1, v93
    s_nop 1
    s_cmp_lg_u64 vcc, 0
    s_cbranch_scc1 L_ore0
L_ore0_done:
    s_waitcnt lgkmcnt(15)
    v_mfma_f32_16x16x32_bf16 v[32:35], a[144:147], v[96:99], v[32:35]
    buffer_load_dwordx4 v[144:147], v15, s[44:47], s62 offen offset:2048 sc1
    v_mfma_f32_16x16x32_bf16 v[36:39], a[144:147], v[100:103], v[36:39]
    buffer_load_dwordx4 v[148:151], v15, s[44:47], s63 offen offset:2048 sc1
    v_mfma_f32_16x16x32_bf16 v[40:43], a[148:151], v[96:99], v[40:43]
    s_waitcnt vmcnt(10)
    v_max3_u32 v93, v104, v105, v106
    v_mfma_f32_16x16x32_bf16 v[44:47], a[148:151], v[100:103], v[44:47]
    v_max3_u32 v95, v107, v108, v109
    v_max3_u32 v93, v93, v110, v111
    v_mfma_f32_16x16x32_bf16 v[48:51], a[152:155], v[96:99], v[48:51]
    v_max_u32 v93, v93, v95
    v_cmp_eq_u32 vcc, -1, v93
    v_mfma_f32_16x16x32_bf16 v[52:55], a[152:155], v[100:103], v[52:55]
    s_nop 0
    s_cmp_lg_u64 vcc, 0
    s_cbranch_scc1 L_ore1
L_ore1_done:
    v_mfma_f32_16x16x32_bf16 v[32:35], a[156:159], v[104:107], v[32:35]
    buffer_load_dwordx4 v[152:155], v15, s[44:47], s62 offen offset:3072 sc1
    v_mfma_f32_16x16x32_bf16 v[36:39], a[156:159], v[108:111], v[36:39]
    buffer_load_dwordx4 v[156:159], v15, s[44:47], s63 offen offset:3072 sc1
    v_mfma_f32_16x16x32_bf16 v[40:43], a[160:163], v[104:107], v[40:43]
    s_waitcnt vmcnt(10)
    v_max3_u32 v93, v112, v113, v114
    v_mfma_f32_16x16x32_bf16 v[44:47], a[160:163], v[108:111], v[44:47]
    v_max3_u32 v95, v115, v116, v117
    v_max3_u32 v93, v93, v118, v119
    v_mfma_f32_16x16x32_bf16 v[48:51], a[164:167], v[104:107], v[48:51]
    v_max_u32 v93, v93, v95
    v_cmp_eq_u32 vcc, -1, v93
    v_mfma_f32_16x16x32_bf16 v[52:55], a[164:167], v[108:111], v[52:55]
    s_nop 0
    s_cmp_lg_u64 vcc, 0
    s_cbranch_scc1 L_ore2
L_ore2_done:
    v_mfma_f32_16x16x32_bf16 v[32:35], a[168:171], v[112:115], v[32:35]
    s_mov_b32 s62, 8192
    s_mov_b32 s63, 26624
    buffer_load_dwordx4 v[160:163], v15, s[44:47], s62 offen offset:0 sc1
    v_mfma_f32_16x16x32_bf16 v[36:39], a[168:171], v[116:119], v[36:39]
    buffer_load_dwordx4 v[164:167], v15, s[44:47], s63 offen offset:0 sc1
    v_mfma_f32_16x16x32_bf16 v[40:43], a[172:175], v[112:115], v[40:43]
    s_waitcnt vmcnt(10)
    v_max3_u32 v93, v120, v121, v122
    v_mfma_f32_16x16x32_bf16 v[44:47], a[172:175], v[116:119], v[44:47]
    v_max3_u32 v95, v123, v124, v125
    v_max3_u32 v93, v93, v126, v127
    v_mfma_f32_16x16x32_bf16 v[48:51], a[176:179], v[112:115], v[48:51]
    v_max_u32 v93, v93, v95
    v_cmp_eq_u32 vcc, -1, v93
    v_mfma_f32_16x16x32_bf16 v[52:55], a[176:179], v[116:119], v[52:55]
    s_nop 0
    s_cmp_lg_u64 vcc, 0
    s_cbranch_scc1 L_ore3
L_ore3_done:
    v_mfma_f32_16x16x32_bf16 v[32:35], a[180:183], v[120:123], v[32:35]
    buffer_load_dwordx4 v[168:171], v15, s[44:47], s62 offen offset:1024 sc1
    v_mfma_f32_16x16x32_bf16 v[36:39], a[180:183], v[124:127], v[36:39]
    buffer_load_dwordx4 v[172:175], v15, s[44:47], s63 offen offset:1024 sc1
    v_mfma_f32_16x16x32_bf16 v[40:43], a[184:187], v[120:123], v[40:43]
    s_waitcnt vmcnt(10)
    v_max3_u32 v93, v128, v129, v130
    v_mfma_f32_16x16x32_bf16 v[44:47], a[184:187], v[124:127], v[44:47]
    v_max3_u32 v95, v131, v132, v133
    v_max3_u32 v93, v93, v134, v135
    v_mfma_f32_16x16x32_bf16 v[48:51], a[188:191], v[120:123], v[48:51]
    v_max_u32 v93, v93, v95
    v_cmp_eq_u32 vcc, -1, v93
    v_mfma_f32_16x16x32_bf16 v[52:55], a[188:191], v[124:127], v[52:55]
    s_nop 0
    s_cmp_lg_u64 vcc, 0
    s_cbranch_scc1 L_ore4
L_ore4_done:
    v_mfma_f32_16x16x32_bf16 v[32:35], a[192:195], v[128:131], v[32:35]
    buffer_load_dwordx4 v[176:179], v15, s[44:47], s62 offen offset:2048 sc1
    v_mfma_f32_16x16x32_bf16 v[36:39], a[192:195], v[132:135], v[36:39]
    buffer_load_dwordx4 v[180:183], v15, s[44:47], s63 offen offset:2048 sc1
    v_mfma_f32_16x16x32_bf16 v[40:43], a[196:199], v[128:131], v[40:43]
    s_waitcnt vmcnt(10)
    v_max3_u32 v93, v136, v137, v138
    v_mfma_f32_16x16x32_bf16 v[44:47], a[196:199], v[132:135], v[44:47]
    v_max3_u32 v95, v139, v140, v141
    v_max3_u32 v93, v93, v142, v143
    v_mfma_f32_16x16x32_bf16 v[48:51], a[200:203], v[128:131], v[48:51]
    v_max_u32 v93, v93, v95
    v_cmp_eq_u32 vcc, -1, v93
    v_mfma_f32_16x16x32_bf16 v[52:55], a[200:203], v[132:135], v[52:55]
    s_nop 0
    s_cmp_lg_u64 vcc, 0
    s_cbranch_scc1 L_ore5
L_ore5_done:
    v_mfma_f32_16x16x32_bf16 v[32:35], a[204:207], v[136:139], v[32:35]
    buffer_load_dwordx4 v[184:187], v15, s[44:47], s62 offen offset:3072 sc1
    v_mfma_f32_16x16x32_bf16 v[36:39], a[204:207], v[140:143], v[36:39]
    buffer_load_dwordx4 v[188:191], v15, s[44:47], s63 offen offset:3072 sc1
    v_mfma_f32_16x16x32_bf16 v[40:43], a[208:211], v[136:139], v[40:43]
    s_waitcnt vmcnt(10)
    v_max3_u32 v93, v144, v145, v146
    v_mfma_f32_16x16x32_bf16 v[44:47], a[208:211], v[140:143], v[44:47]
    v_max3_u32 v95, v147, v148, v149
    v_max3_u32 v93, v93, v150, v151
    v_mfma_f32_16x16x32_bf16 v[48:51], a[212:215], v[136:139], v[48:51]
    v_max_u32 v93, v93, v95
    v_cmp_eq_u32 vcc, -1, v93
    v_mfma_f32_16x16x32_bf16 v[52:55], a[212:215], v[140:143], v[52:55]
    s_nop 0
    s_cmp_lg_u64 vcc, 0
    s_cbranch_scc1 L_ore6
L_ore6_done:
    v_mfma_f32_16x16x32_bf16 v[32:35], a[216:219], v[144:147], v[32:35]
    s_mov_b32 s62, 12288
    s_mov_b32 s63, 30720
    buffer_load_dwordx4 v[192:195], v15, s[44:47], s62 offen offset:0 sc1
    v_mfma_f32_16x16x32_bf16 v[36:39], a[216:219], v[148:151], v[36:39]
    buffer_load_dwordx4 v[196:199], v15, s[44:47], s63 offen offset:0 sc1
    v_mfma_f32_16x16x32_bf16 v[40:43], a[220:223], v[144:147], v[40:43]
    s_waitcnt vmcnt(10)
    v_max3_u32 v93, v152, v153, v154
    v_mfma_f32_16x16x32_bf16 v[44:47], a[220:223], v[148:151], v[44:47]
    v_max3_u32 v95, v155, v156, v157
    v_max3_u32 v93, v93, v158, v159
    v_mfma_f32_16x16x32_bf16 v[48:51], a[224:227], v[144:147], v[48:51]
    v_max_u32 v93, v93, v95
    v_cmp_eq_u32 vcc, -1, v93
    v_mfma_f32_16x16x32_bf16 v[52:55], a[224:227], v[148:151], v[52:55]
    s_nop 0
    s_cmp_lg_u64 vcc, 0
    s_cbranch_scc1 L_ore7
L_ore7_done:
    v_mfma_f32_16x16x32_bf16 v[32:35], a[228:231], v[152:155], v[32:35]
    buffer_load_dwordx4 v[200:203], v15, s[44:47], s62 offen offset:1024 sc1
    v_mfma_f32_16x16x32_bf16 v[36:39], a[228:231], v[156:159], v[36:39]
    buffer_load_dwordx4 v[204:207], v15, s[44:47], s63 offen offset:1024 sc1
    v_mfma_f32_16x16x32_bf16 v[40:43], a[232:235], v[152:155], v[40:43]
    s_waitcnt vmcnt(10)
    v_max3_u32 v93, v160, v161, v162
    v_mfma_f32_16x16x32_bf16 v[44:47], a[232:235], v[156:159], v[44:47]
    v_max3_u32 v95, v163, v164, v165
    v_max3_u32 v93, v93, v166, v167
    v_mfma_f32_16x16x32_bf16 v[48:51], a[0:3], v[152:155], v[48:51]
    v_max_u32 v93, v93, v95
    v_cmp_eq_u32 vcc, -1, v93
    v_mfma_f32_16x16x32_bf16 v[52:55], a[0:3], v[156:159], v[52:55]
    s_nop 0
    s_cmp_lg_u64 vcc, 0
    s_cbranch_scc1 L_ore8
L_ore8_done:
    v_mfma_f32_16x16x32_bf16 v[32:35], a[4:7], v[160:163], v[32:35]
    buffer_load_dwordx4 v[208:211], v15, s[44:47], s62 offen offset:2048 sc1
    v_mfma_f32_16x16x32_bf16 v[36:39], a[4:7], v[164:167], v[36:39]
    buffer_load_dwordx4 v[212:215], v15, s[44:47], s63 offen offset:2048 sc1
    v_mfma_f32_16x16x32_bf16 v[40:43], a[8:11], v[160:163], v[40:43]
    s_waitcnt vmcnt(10)
    v_max3_u32 v93, v168, v169, v170
    v_mfma_f32_16x16x32_bf16 v[44:47], a[8:11], v[164:167], v[44:47]
    v_max3_u32 v95, v171, v172, v173
    v_max3_u32 v93, v93, v174, v175
    v_mfma_f32_16x16x32_bf16 v[48:51], a[12:15], v[160:163], v[48:51]
    v_max_u32 v93, v93, v95
    v_cmp_eq_u32 vcc, -1, v93
    v_mfma_f32_16x16x32_bf16 v[52:55], a[12:15], v[164:167], v[52:55]
    s_nop 0
    s_cmp_lg_u64 vcc, 0
    s_cbranch_scc1 L_ore9
L_ore9_done:
    v_mfma_f32_16x16x32_bf16 v[32:35], a[16:19], v[168:171], v[32:35]
    buffer_load_dwordx4 v[216:219], v15, s[44:47], s62 offen offset:3072 sc1
    v_mfma_f32_16x16x32_bf16 v[36:39], a[16:19], v[172:175], v[36:39]
    buffer_load_dwordx4 v[220:223], v15, s[44:47], s63 offen offset:3072 sc1
    v_mfma_f32_16x16x32_bf16 v[40:43], a[20:23], v[168:171], v[40:43]
    s_waitcnt vmcnt(10)
    v_max3_u32 v93, v176, v177, v178
    v_mfma_f32_16x16x32_bf16 v[44:47], a[20:23], v[172:175], v[44:47]
    v_max3_u32 v95, v179, v180, v181
    v_max3_u32 v93, v93, v182, v183
    v_mfma_f32_16x16x32_bf16 v[48:51], a[24:27], v[168:171], v[48:51]
    v_max_u32 v93, v93, v95
    v_cmp_eq_u32 vcc, -1, v93
    v_mfma_f32_16x16x32_bf16 v[52:55], a[24:27], v[172:175], v[52:55]
    s_nop 0
    s_cmp_lg_u64 vcc, 0
    s_cbranch_scc1 L_ore10
L_ore10_done:
    v_mfma_f32_16x16x32_bf16 v[32:35], a[28:31], v[176:179], v[32:35]
    s_mov_b32 s62, 16384
    s_mov_b32 s63, 34816
    buffer_load_dwordx4 v[224:227], v15, s[44:47], s62 offen offset:0 sc1
    v_mfma_f32_16x16x32_bf16 v[36:39], a[28:31], v[180:183], v[36:39]
    buffer_load_dwordx4 v[228:231], v15, s[44:47], s63 offen offset:0 sc1
    v_mfma_f32_16x16x32_bf16 v[40:43], a[32:35], v[176:179], v[40:43]
    s_waitcnt vmcnt(10)
    v_max3_u32 v93, v184, v185, v186
    v_mfma_f32_16x16x32_bf16 v[44:47], a[32:35], v[180:183], v[44:47]
    v_max3_u32 v95, v187, v188, v189
    v_max3_u32 v93, v93, v190, v191
    v_mfma_f32_16x16x32_bf16 v[48:51], a[36:39], v[176:179], v[48:51]
    v_max_u32 v93, v93, v95
    v_cmp_eq_u32 vcc, -1, v93
    v_mfma_f32_16x16x32_bf16 v[52:55], a[36:39], v[180:183], v[52:55]
    s_nop 0
    s_cmp_lg_u64 vcc, 0
    s_cbranch_scc1 L_ore11
L_ore11_done:
    v_mfma_f32_16x16x32_bf16 v[32:35], a[40:43], v[184:187], v[32:35]
    buffer_load_dwordx4 v[232:235], v15, s[44:47], s62 offen offset:1024 sc1
    v_mfma_f32_16x16x32_bf16 v[36:39], a[40:43], v[188:191], v[36:39]
    buffer_load_dwordx4 v[236:239], v15, s[44:47], s63 offen offset:1024 sc1
    v_mfma_f32_16x16x32_bf16 v[40:43], a[44:47], v[184:187], v[40:43]
    s_waitcnt vmcnt(10)
    v_max3_u32 v93, v192, v193, v194
    v_mfma_f32_16x16x32_bf16 v[44:47], a[44:47], v[188:191], v[44:47]
    v_max3_u32 v95, v195, v196, v197
    v_max3_u32 v93, v93, v198, v199
    v_mfma_f32_16x16x32_bf16 v[48:51], a[48:51], v[184:187], v[48:51]
    v_max_u32 v93, v93, v95
    v_cmp_eq_u32 vcc, -1, v93
    v_mfma_f32_16x16x32_bf16 v[52:55], a[48:51], v[188:191], v[52:55]
    s_nop 0
    s_cmp_lg_u64 vcc, 0
    s_cbranch_scc1 L_ore12
L_ore12_done:
    v_mfma_f32_16x16x32_bf16 v[32:35], a[52:55], v[192:195], v[32:35]
    v_mfma_f32_16x16x32_bf16 v[36:39], a[52:55], v[196:199], v[36:39]
    v_mfma_f32_16x16x32_bf16 v[40:43], a[56:59], v[192:195], v[40:43]
    s_waitcnt vmcnt(8)
    v_max3_u32 v93, v200, v201, v202
    v_mfma_f32_16x16x32_bf16 v[44:47], a[56:59], v[196:199], v[44:47]
    v_max3_u32 v95, v203, v204, v205
    v_max3_u32 v93, v93, v206, v207
    v_mfma_f32_16x16x32_bf16 v[48:51], a[60:63], v[192:195], v[48:51]
    v_max_u32 v93, v93, v95
    v_cmp_eq_u32 vcc, -1, v93
    v_mfma_f32_16x16x32_bf16 v[52:55], a[60:63], v[196:199], v[52:55]
    s_nop 0
    s_cmp_lg_u64 vcc, 0
    s_cbranch_scc1 L_ore13
L_ore13_done:
    v_mfma_f32_16x16x32_bf16 v[32:35], a[64:67], v[200:203], v[32:35]
    v_mfma_f32_16x16x32_bf16 v[36:39], a[64:67], v[204:207], v[36:39]
    v_mfma_f32_16x16x32_bf16 v[40:43], a[68:71], v[200:203], v[40:43]
    s_waitcnt vmcnt(6)
    v_max3_u32 v93, v208, v209, v210
    v_mfma_f32_16x16x32_bf16 v[44:47], a[68:71], v[204:207], v[44:47]
    v_max3_u32 v95, v211, v212, v213
    v_max3_u32 v93, v93, v214, v215
    v_mfma_f32_16x16x32_bf16 v[48:51], a[72:75], v[200:203], v[48:51]
    v_max_u32 v93, v93, v95
    v_cmp_eq_u32 vcc, -1, v93
    v_mfma_f32_16x16x32_bf16 v[52:55], a[72:75], v[204:207], v[52:55]
    s_nop 0
    s_cmp_lg_u64 vcc, 0
    s_cbranch_scc1 L_ore14
L_ore14_done:
    v_mfma_f32_16x16x32_bf16 v[32:35], a[76:79], v[208:211], v[32:35]
    v_mfma_f32_16x16x32_bf16 v[36:39], a[76:79], v[212:215], v[36:39]
    v_mfma_f32_16x16x32_bf16 v[40:43], a[80:83], v[208:211], v[40:43]
    s_waitcnt vmcnt(4)
    v_max3_u32 v93, v216, v217, v218
    v_mfma_f32_16x16x32_bf16 v[44:47], a[80:83], v[212:215], v[44:47]
    v_max3_u32 v95, v219, v220, v221
    v_max3_u32 v93, v93, v222, v223
    v_mfma_f32_16x16x32_bf16 v[48:51], a[84:87], v[208:211], v[48:51]
    v_max_u32 v93, v93, v95
    v_cmp_eq_u32 vcc, -1, v93
    v_mfma_f32_16x16x32_bf16 v[52:55], a[84:87], v[212:215], v[52:55]
    s_nop 0
    s_cmp_lg_u64 vcc, 0
    s_cbranch_scc1 L_ore15
L_ore15_done:
    s_waitcnt lgkmcnt(12)
    v_mfma_f32_16x16x32_bf16 v[32:35], a[88:91], v[216:219], v[32:35]
    v_mfma_f32_16x16x32_bf16 v[36:39], a[88:91], v[220:223], v[36:39]
    v_mfma_f32_16x16x32_bf16 v[40:43], a[92:95], v[216:219], v[40:43]
    s_waitcnt vmcnt(2)
    v_max3_u32 v93, v224, v225, v226
    v_mfma_f32_16x16x32_bf16 v[44:47], a[92:95], v[220:223], v[44:47]
    v_max3_u32 v95, v227, v228, v229
    v_max3_u32 v93, v93, v230, v231
    v_mfma_f32_16x16x32_bf16 v[48:51], a[96:99], v[216:219], v[48:51]
    v_max_u32 v93, v93, v95
    v_cmp_eq_u32 vcc, -1, v93
    v_mfma_f32_16x16x32_bf16 v[52:55], a[96:99], v[220:223], v[52:55]
    s_nop 0
    s_cmp_lg_u64 vcc, 0
    s_cbranch_scc1 L_ore16
L_ore16_done:
    s_waitcnt lgkmcnt(6)
    v_mfma_f32_16x16x32_bf16 v[32:35], a[100:103], v[224:227], v[32:35]
    v_mfma_f32_16x16x32_bf16 v[36:39], a[100:103], v[228:231], v[36:39]
    v_mfma_f32_16x16x32_bf16 v[40:43], a[104:107], v[224:227], v[40:43]
    s_waitcnt vmcnt(0)
    v_max3_u32 v93, v232, v233, v234
    v_mfma_f32_16x16x32_bf16 v[44:47], a[104:107], v[228:231], v[44:47]
    v_max3_u32 v95, v235, v236, v237
    v_max3_u32 v93, v93, v238, v239
    v_mfma_f32_16x16x32_bf16 v[48:51], a[108:111], v[224:227], v[48:51]
    v_max_u32 v93, v93, v95
    v_cmp_eq_u32 vcc, -1, v93
    v_mfma_f32_16x16x32_bf16 v[52:55], a[108:111], v[228:231], v[52:55]
    s_nop 0
    s_cmp_lg_u64 vcc, 0
    s_cbranch_scc1 L_ore17
L_ore17_done:
    s_waitcnt lgkmcnt(0)
    v_mfma_f32_16x16x32_bf16 v[32:35], a[112:115], v[232:235], v[32:35]
    v_mfma_f32_16x16x32_bf16 v[36:39], a[112:115], v[236:239], v[36:39]
    v_mfma_f32_16x16x32_bf16 v[40:43], a[116:119], v[232:235], v[40:43]
    v_mfma_f32_16x16x32_bf16 v[44:47], a[116:119], v[236:239], v[44:47]
    v_mfma_f32_16x16x32_bf16 v[48:51], a[120:123], v[232:235], v[48:51]
    v_mfma_f32_16x16x32_bf16 v[52:55], a[120:123], v[236:239], v[52:55]
    s_mov_b32 s62, 18432
    s_nop 1
    v_cvt_pk_bf16_f32 v32, v32, v33
    v_cvt_pk_bf16_f32 v33, v34, v35
    buffer_store_dwordx2 v[32:33], v20, s[36:39], 0 offen offset:0
    v_cvt_pk_bf16_f32 v36, v36, v37
    v_cvt_pk_bf16_f32 v37, v38, v39
    buffer_store_dwordx2 v[36:37], v20, s[36:39], s62 offen offset:0
    v_cvt_pk_bf16_f32 v40, v40, v41
    v_cvt_pk_bf16_f32 v41, v42, v43
    buffer_store_dwordx2 v[40:41], v20, s[36:39], 0 offen offset:32
    v_cvt_pk_bf16_f32 v44, v44, v45
    v_cvt_pk_bf16_f32 v45, v46, v47
    buffer_store_dwordx2 v[44:45], v20, s[36:39], s62 offen offset:32
    v_cvt_pk_bf16_f32 v48, v48, v49
    v_cvt_pk_bf16_f32 v49, v50, v51
    buffer_store_dwordx2 v[48:49], v21, s[36:39], 0 offen offset:64
    v_cvt_pk_bf16_f32 v52, v52, v53
    v_cvt_pk_bf16_f32 v53, v54, v55
    buffer_store_dwordx2 v[52:53], v21, s[36:39], s62 offen offset:64
L_main_end:
    s_endpgm
L_slow_0:
    s_add_u32 s62, s52, 0
    s_lshl_b32 s63, s62, 10
    s_lshl_b32 s62, s62, 8
    v_and_b32 v66, 31, v1
    v_lshlrev_b32 v67, 5, v66
    v_lshrrev_b32 v68, 5, v1
    v_lshl_add_u32 v67, v68, 4, v67
    v_add_u32 v67, s63, v67
    v_add_u32 v67, 135168, v67
    ds_read_b128 v[4:7], v67
    v_lshl_add_u32 v67, v1, 2, s62
    v_add_u32 v67, 143360, v67
    ds_read_b32 v56, v67
    v_mov_b32 v86, 31
    v_cmp_eq_u32 vcc, 18, v66
    s_nop 1
    v_cndmask_b32 v67, v66, v86, vcc
    v_mov_b32 v86, 18
    v_cmp_eq_u32 vcc, 20, v66
    s_nop 1
    v_cndmask_b32 v67, v67, v86, vcc
    v_mul_u32_u24 v68, 19, v68
    v_add_u32 v68, v68, v67
    v_lshlrev_b32 v68, 4, v68
    v_add_u32 v68, 37822464, v68
    v_cmp_gt_u32 vcc, 19, v67
    v_mov_b32 v67, 2146435072
    v_lshlrev_b32 v66, 4, v66
    v_cndmask_b32 v68, v67, v68, vcc
    v_add_u32 v66, 37814272, v66
    v_lshlrev_b32 v67, 4, v1
    v_add_u32 v67, 37748736, v67
    v_mov_b32 v86, 0xff800000
    v_mov_b32 v85, 0
    v_mov_b32 v57, 0
    s_waitcnt lgkmcnt(0)
    s_mov_b32 s62, 0
L_s1_0:
    s_lshl_b32 s60, s62, 10
    s_lshr_b32 s63, s62, 2
    s_lshl_b32 s63, s63, 9
    s_and_b32 s69, s62, 3
    s_lshl_b32 s69, s69, 2
    s_add_u32 s69, s69, s63
    buffer_load_dwordx4 v[80:83], v67, s[44:47], s60 offen sc1
    buffer_load_dword v84, v66, s[44:47], s69 offen sc1
    s_waitcnt vmcnt(0)
    v_mfma_f32_32x32x16_bf16 v[96:111], v[80:83], v[4:7], 0
    v_mfma_f32_32x32x8_bf16 v[96:111], v[84:85], v[56:57], v[96:111]
    s_nop 15
    v_max3_f32 v86, v86, v96, v97
    v_max3_f32 v86, v86, v98, v99
    v_max3_f32 v86, v86, v100, v101
    v_max3_f32 v86, v86, v102, v103
    v_max3_f32 v86, v86, v104, v105
    v_max3_f32 v86, v86, v106, v107
    v_max3_f32 v86, v86, v108, v109
    v_max3_f32 v86, v86, v110, v111
    s_add_u32 s62, s62, 1
    s_cmp_lt_u32 s62, 64
    s_cbranch_scc1 L_s1_0
    v_mov_b32 v112, v86
    s_nop 1
    v_permlane32_swap_b32 v86, v112
    s_nop 0
    v_max_f32 v86, v86, v112
    v_sub_f32 v112, 0, v86
    v_mov_b32 v128, 0
    v_sub_f32 v113, 0, v86
    v_mov_b32 v129, 0
    v_sub_f32 v114, 0, v86
    v_mov_b32 v130, 0
    v_sub_f32 v115, 0, v86
    v_mov_b32 v131, 0
    v_sub_f32 v116, 0, v86
    v_mov_b32 v132, 0
    v_sub_f32 v117, 0, v86
    v_mov_b32 v133, 0
    v_sub_f32 v118, 0, v86
    v_mov_b32 v134, 0
    v_sub_f32 v119, 0, v86
    v_mov_b32 v135, 0
    v_sub_f32 v120, 0, v86
    v_mov_b32 v136, 0
    v_sub_f32 v121, 0, v86
    v_mov_b32 v137, 0
    v_sub_f32 v122, 0, v86
    v_mov_b32 v138, 0
    v_sub_f32 v123, 0, v86
    v_mov_b32 v139, 0
    v_sub_f32 v124, 0, v86
    v_mov_b32 v140, 0
    v_sub_f32 v125, 0, v86
    v_mov_b32 v141, 0
    v_sub_f32 v126, 0, v86
    v_mov_b32 v142, 0
    v_sub_f32 v127, 0, v86
    v_mov_b32 v143, 0
    s_mov_b32 s62, 0
L_s2_0:
    s_lshl_b32 s60, s62, 10
    s_lshr_b32 s63, s62, 2
    s_lshl_b32 s63, s63, 9
    s_and_b32 s69, s62, 3
    s_lshl_b32 s69, s69, 2
    s_add_u32 s69, s69, s63
    buffer_load_dwordx4 v[80:83], v67, s[44:47], s60 offen sc1
    buffer_load_dword v84, v66, s[44:47], s69 offen sc1
    s_mul_i32 s60, s62, 1280
    buffer_load_dwordx4 v[88:91], v68, s[44:47], s60 offen sc1
    buffer_load_dwordx4 v[92:95], v68, s[44:47], s60 offen offset:640 sc1
    s_waitcnt vmcnt(0)
    v_mfma_f32_32x32x16_bf16 v[96:111], v[80:83], v[4:7], v[112:127]
    v_mfma_f32_32x32x8_bf16 v[96:111], v[84:85], v[56:57], v[96:111]
    s_nop 15
    v_exp_f32 v96, v96
    v_exp_f32 v97, v97
    v_exp_f32 v98, v98
    v_exp_f32 v99, v99
    v_exp_f32 v100, v100
    v_exp_f32 v101, v101
    v_exp_f32 v102, v102
    v_exp_f32 v103, v103
    v_exp_f32 v104, v104
    v_exp_f32 v105, v105
    v_exp_f32 v106, v106
    v_exp_f32 v107, v107
    v_exp_f32 v108, v108
    v_exp_f32 v109, v109
    v_exp_f32 v110, v110
    v_exp_f32 v111, v111
    s_nop 1
    v_smfmac_f32_32x32x32_bf16 v[128:143], v[88:91], v[96:103], v2
    v_smfmac_f32_32x32x32_bf16 v[128:143], v[92:95], v[104:111], v2
    s_nop 15
    s_add_u32 s62, s62, 1
    s_cmp_lt_u32 s62, 64
    s_cbranch_scc1 L_s2_0
    v_mov_b32 v138, v136
    v_mov_b32 v139, v136
    s_nop 1
    v_permlane32_swap_b32 v139, v138
    s_nop 0
    s_branch L_back_0
L_slow_1:
    s_add_u32 s62, s52, 4
    s_lshl_b32 s63, s62, 10
    s_lshl_b32 s62, s62, 8
    v_and_b32 v66, 31, v1
    v_lshlrev_b32 v67, 5, v66
    v_lshrrev_b32 v68, 5, v1
    v_lshl_add_u32 v67, v68, 4, v67
    v_add_u32 v67, s63, v67
    v_add_u32 v67, 135168, v67
    ds_read_b128 v[4:7], v67
    v_lshl_add_u32 v67, v1, 2, s62
    v_add_u32 v67, 143360, v67
    ds_read_b32 v56, v67
    v_mov_b32 v86, 31
    v_cmp_eq_u32 vcc, 18, v66
    s_nop 1
    v_cndmask_b32 v67, v66, v86, vcc
    v_mov_b32 v86, 18
    v_cmp_eq_u32 vcc, 20, v66
    s_nop 1
    v_cndmask_b32 v67, v67, v86, vcc
    v_mul_u32_u24 v68, 19, v68
    v_add_u32 v68, v68, v67
    v_lshlrev_b32 v68, 4, v68
    v_add_u32 v68, 37822464, v68
    v_cmp_gt_u32 vcc, 19, v67
    v_mov_b32 v67, 2146435072
    v_lshlrev_b32 v66, 4, v66
    v_cndmask_b32 v68, v67, v68, vcc
    v_add_u32 v66, 37814272, v66
    v_lshlrev_b32 v67, 4, v1
    v_add_u32 v67, 37748736, v67
    v_mov_b32 v86, 0xff800000
    v_mov_b32 v85, 0
    v_mov_b32 v57, 0
    s_waitcnt lgkmcnt(0)
    s_mov_b32 s62, 0
L_s1_1:
    s_lshl_b32 s60, s62, 10
    s_lshr_b32 s63, s62, 2
    s_lshl_b32 s63, s63, 9
    s_and_b32 s69, s62, 3
    s_lshl_b32 s69, s69, 2
    s_add_u32 s69, s69, s63
    buffer_load_dwordx4 v[80:83], v67, s[44:47], s60 offen sc1
    buffer_load_dword v84, v66, s[44:47], s69 offen sc1
    s_waitcnt vmcnt(0)
    v_mfma_f32_32x32x16_bf16 v[96:111], v[80:83], v[4:7], 0
    v_mfma_f32_32x32x8_bf16 v[96:111], v[84:85], v[56:57], v[96:111]
    s_nop 15
    v_max3_f32 v86, v86, v96, v97
    v_max3_f32 v86, v86, v98, v99
    v_max3_f32 v86, v86, v100, v101
    v_max3_f32 v86, v86, v102, v103
    v_max3_f32 v86, v86, v104, v105
    v_max3_f32 v86, v86, v106, v107
    v_max3_f32 v86, v86, v108, v109
    v_max3_f32 v86, v86, v110, v111
    s_add_u32 s62, s62, 1
    s_cmp_lt_u32 s62, 64
    s_cbranch_scc1 L_s1_1
    v_mov_b32 v112, v86
    s_nop 1
    v_permlane32_swap_b32 v86, v112
    s_nop 0
    v_max_f32 v86, v86, v112
    v_sub_f32 v112, 0, v86
    v_mov_b32 v144, 0
    v_sub_f32 v113, 0, v86
    v_mov_b32 v145, 0
    v_sub_f32 v114, 0, v86
    v_mov_b32 v146, 0
    v_sub_f32 v115, 0, v86
    v_mov_b32 v147, 0
    v_sub_f32 v116, 0, v86
    v_mov_b32 v148, 0
    v_sub_f32 v117, 0, v86
    v_mov_b32 v149, 0
    v_sub_f32 v118, 0, v86
    v_mov_b32 v150, 0
    v_sub_f32 v119, 0, v86
    v_mov_b32 v151, 0
    v_sub_f32 v120, 0, v86
    v_mov_b32 v152, 0
    v_sub_f32 v121, 0, v86
    v_mov_b32 v153, 0
    v_sub_f32 v122, 0, v86
    v_mov_b32 v154, 0
    v_sub_f32 v123, 0, v86
    v_mov_b32 v155, 0
    v_sub_f32 v124, 0, v86
    v_mov_b32 v156, 0
    v_sub_f32 v125, 0, v86
    v_mov_b32 v157, 0
    v_sub_f32 v126, 0, v86
    v_mov_b32 v158, 0
    v_sub_f32 v127, 0, v86
    v_mov_b32 v159, 0
    s_mov_b32 s62, 0
L_s2_1:
    s_lshl_b32 s60, s62, 10
    s_lshr_b32 s63, s62, 2
    s_lshl_b32 s63, s63, 9
    s_and_b32 s69, s62, 3
    s_lshl_b32 s69, s69, 2
    s_add_u32 s69, s69, s63
    buffer_load_dwordx4 v[80:83], v67, s[44:47], s60 offen sc1
    buffer_load_dword v84, v66, s[44:47], s69 offen sc1
    s_mul_i32 s60, s62, 1280
    buffer_load_dwordx4 v[88:91], v68, s[44:47], s60 offen sc1
    buffer_load_dwordx4 v[92:95], v68, s[44:47], s60 offen offset:640 sc1
    s_waitcnt vmcnt(0)
    v_mfma_f32_32x32x16_bf16 v[96:111], v[80:83], v[4:7], v[112:127]
    v_mfma_f32_32x32x8_bf16 v[96:111], v[84:85], v[56:57], v[96:111]
    s_nop 15
    v_exp_f32 v96, v96
    v_exp_f32 v97, v97
    v_exp_f32 v98, v98
    v_exp_f32 v99, v99
    v_exp_f32 v100, v100
    v_exp_f32 v101, v101
    v_exp_f32 v102, v102
    v_exp_f32 v103, v103
    v_exp_f32 v104, v104
    v_exp_f32 v105, v105
    v_exp_f32 v106, v106
    v_exp_f32 v107, v107
    v_exp_f32 v108, v108
    v_exp_f32 v109, v109
    v_exp_f32 v110, v110
    v_exp_f32 v111, v111
    s_nop 1
    v_smfmac_f32_32x32x32_bf16 v[144:159], v[88:91], v[96:103], v2
    v_smfmac_f32_32x32x32_bf16 v[144:159], v[92:95], v[104:111], v2
    s_nop 15
    s_add_u32 s62, s62, 1
    s_cmp_lt_u32 s62, 64
    s_cbranch_scc1 L_s2_1
    v_mov_b32 v154, v152
    v_mov_b32 v155, v152
    s_nop 1
    v_permlane32_swap_b32 v155, v154
    s_nop 0
    s_branch L_back_1
L_kvaddr:
    v_lshrrev_b32 v39, 2, v36
    s_lshl_b32 s63, s61, 1
    v_add_u32 v39, s63, v39
    v_and_b32 v42, 3, v36
    v_cmp_eq_u32 s[70:71], 3, v42
    v_cmp_le_u32 vcc, 3, v39
    v_mov_b32 v42, s8
    v_mov_b32 v43, s10
    v_cndmask_b32 v42, v42, v43, vcc
    v_cndmask_b32 v40, v40, v42, s[70:71]
    v_mov_b32 v42, s9
    v_mov_b32 v43, s11
    v_cndmask_b32 v42, v42, v43, vcc
    v_cndmask_b32 v41, v41, v42, s[70:71]
    v_subrev_u32 v42, 3, v39
    v_cndmask_b32 v39, v39, v42, vcc
    v_lshlrev_b32 v39, 4, v39
    v_min_u32 v39, 20, v39
    v_mov_b32 v42, 36
    v_cndmask_b32 v38, v38, v39, s[70:71]
    v_cndmask_b32 v28, v28, v42, s[70:71]
    s_branch L_nokv
L_kv_blk:
    s_lshl_b32 s62, s61, 1
    s_add_u32 s62, s62, s56
    v_mul_f32 v184, v16, v112
    v_mul_f32 v185, v16, v113
    v_mul_f32 v186, v16, v114
    v_mul_f32 v187, v16, v115
    v_cvt_pk_bf16_f32 v184, v184, v185
    v_cvt_pk_bf16_f32 v185, v186, v187
    v_mul_f32 v188, v17, v116
    v_mul_f32 v189, v17, v117
    v_mul_f32 v190, v17, v118
    v_mul_f32 v191, v17, v119
    v_cvt_pk_bf16_f32 v188, v188, v189
    v_cvt_pk_bf16_f32 v189, v190, v191
    v_mul_f32 v192, v18, v120
    v_mul_f32 v193, v18, v121
    v_mul_f32 v194, v18, v122
    v_mul_f32 v195, v18, v123
    v_cvt_pk_bf16_f32 v192, v192, v193
    v_cvt_pk_bf16_f32 v193, v194, v195
    v_mul_f32 v196, v19, v124
    v_mul_f32 v197, v19, v125
    v_mul_f32 v198, v19, v126
    v_mul_f32 v199, v19, v127
    v_cvt_pk_bf16_f32 v196, v196, v197
    v_cvt_pk_bf16_f32 v197, v198, v199
    v_and_b32 v200, 15, v1
    v_lshrrev_b32 v201, 4, v1
    v_mov_b32 v203, 2146435072
    s_lshl_b32 s63, s53, 1
    s_add_u32 s63, s63, s55
    s_cmp_ge_u32 s62, 3
    s_cbranch_scc1 L_kv_v
    s_cmp_eq_u32 s62, 2
    s_cbranch_scc1 L_kv_kr
    s_lshl_b32 s63, s63, 11
    s_lshl_b32 s64, s62, 9
    s_add_u32 s63, s63, s64
    s_add_u32 s63, s63, 37748720
    v_lshlrev_b32 v202, 4, v200
    v_lshl_add_u32 v202, v201, 3, v202
    v_add_u32 v202, s63, v202
    v_cmp_le_u32 vcc, 2, v201
    s_nop 1
    v_cndmask_b32 v202, v203, v202, vcc
    buffer_store_dwordx2 v[184:185], v202, s[44:47], 0 offen offset:0 sc1
    buffer_store_dwordx2 v[188:189], v202, s[44:47], 0 offen offset:256 sc1
    buffer_store_dwordx2 v[192:193], v202, s[44:47], 0 offen offset:1024 sc1
    buffer_store_dwordx2 v[196:197], v202, s[44:47], 0 offen offset:1280 sc1
    s_branch L_kv_skip
L_kv_kr:
    s_lshr_b32 s64, s63, 1
    s_lshl_b32 s64, s64, 9
    s_and_b32 s63, s63, 1
    s_lshl_b32 s63, s63, 3
    s_add_u32 s63, s63, s64
    s_add_u32 s63, s63, 37814272
    v_lshl_add_u32 v202, v200, 4, s63
    v_cmp_eq_u32 vcc, 3, v201
    s_nop 1
    v_cndmask_b32 v202, v203, v202, vcc
    buffer_store_dword v185, v202, s[44:47], 0 offen offset:0 sc1
    buffer_store_dword v189, v202, s[44:47], 0 offen offset:256 sc1
    buffer_store_dword v193, v202, s[44:47], 0 offen offset:4 sc1
    buffer_store_dword v197, v202, s[44:47], 0 offen offset:260 sc1
    s_branch L_kv_skip
L_kv_v:
    s_lshl_b32 s64, s52, 11
    v_lshlrev_b32 v202, 5, v200
    v_lshl_add_u32 v202, v201, 3, v202
    v_add_u32 v202, s64, v202
    ds_write_b64 v202, v[184:185] offset:0
    ds_write_b64 v202, v[188:189] offset:512
    ds_write_b64 v202, v[192:193] offset:1024
    ds_write_b64 v202, v[196:197] offset:1536
    v_lshl_add_u32 v202, v1, 3, s64
    s_waitcnt lgkmcnt(0)
    ds_read_b64_tr_b16 v[184:185], v202 offset:0
    ds_read_b64_tr_b16 v[188:189], v202 offset:512
    ds_read_b64_tr_b16 v[192:193], v202 offset:1024
    ds_read_b64_tr_b16 v[196:197], v202 offset:1536
    s_sub_u32 s62, s62, 3
    s_lshl_b32 s64, s62, 3
    s_min_u32 s64, s64, 10
    s_mul_i32 s63, s63, 2560
    s_add_u32 s63, s63, 37822336
    v_add_u32 v204, s64, v200
    s_cmp_eq_u32 s62, 2
    s_cselect_b32 s64, 14, 8
    s_cselect_b32 s65, 8, 99
    v_cmp_eq_u32 s[70:71], s65, v200
    v_mov_b32 v205, 26
    v_mov_b32 v206, s66
    v_cndmask_b32 v204, v204, v205, s[70:71]
    v_lshrrev_b32 v205, 1, v201
    v_mul_u32_u24 v205, 19, v205
    v_add_u32 v204, v204, v205
    v_lshlrev_b32 v204, 4, v204
    v_and_b32 v205, 1, v201
    v_lshl_add_u32 v204, v205, 3, v204
    v_add_u32 v204, s63, v204
    v_cmp_le_u32 vcc, s64, v200
    s_nop 1
    s_or_b64 vcc, vcc, s[70:71]
    s_nop 1
    v_cndmask_b32 v204, v203, v204, vcc
    s_waitcnt lgkmcnt(0)
    v_cndmask_b32 v184, v184, v206, s[70:71]
    v_cndmask_b32 v185, v185, v206, s[70:71]
    v_cndmask_b32 v188, v188, v206, s[70:71]
    v_cndmask_b32 v189, v189, v206, s[70:71]
    v_cndmask_b32 v192, v192, v206, s[70:71]
    v_cndmask_b32 v193, v193, v206, s[70:71]
    v_cndmask_b32 v196, v196, v206, s[70:71]
    v_cndmask_b32 v197, v197, v206, s[70:71]
    buffer_store_dwordx2 v[184:185], v204, s[44:47], 0 offen offset:0 sc1
    buffer_store_dwordx2 v[188:189], v204, s[44:47], 0 offen offset:640 sc1
    buffer_store_dwordx2 v[192:193], v204, s[44:47], 0 offen offset:1280 sc1
    buffer_store_dwordx2 v[196:197], v204, s[44:47], 0 offen offset:1920 sc1
    s_branch L_kv_skip
L_sigB0:
    s_mov_b64 exec, 1
    v_mov_b32 v156, 0
    v_mov_b32 v157, 1
    global_atomic_add v156, v157, s[24:25] offset:128 sc1
    s_mov_b64 exec, -1
    s_branch L_sigB0_done
L_sigB1:
    s_mov_b64 exec, 1
    v_mov_b32 v156, 0
    v_mov_b32 v157, 1
    global_atomic_add v156, v157, s[24:25] offset:128 sc1
    s_mov_b64 exec, -1
    s_branch L_sigB1_done
L_sigB2:
    s_mov_b64 exec, 1
    v_mov_b32 v156, 0
    v_mov_b32 v157, 1
    global_atomic_add v156, v157, s[24:25] offset:128 sc1
    s_mov_b64 exec, -1
    s_branch L_sigB2_done
L_sigA0:
    s_mov_b64 exec, 1
    v_mov_b32 v156, 0
    v_mov_b32 v157, 1
    global_atomic_add v156, v157, s[24:25] offset:0 sc1
    s_mov_b64 exec, -1
    s_branch L_sigA0_done
L_sigA1:
    s_mov_b64 exec, 1
    v_mov_b32 v156, 0
    v_mov_b32 v157, 1
    global_atomic_add v156, v157, s[24:25] offset:0 sc1
    s_mov_b64 exec, -1
    s_branch L_sigA1_done
L_sigA2:
    s_mov_b64 exec, 1
    v_mov_b32 v156, 0
    v_mov_b32 v157, 1
    global_atomic_add v156, v157, s[24:25] offset:0 sc1
    s_mov_b64 exec, -1
    s_branch L_sigA2_done
L_sigA3:
    s_mov_b64 exec, 1
    v_mov_b32 v156, 0
    v_mov_b32 v157, 1
    global_atomic_add v156, v157, s[24:25] offset:0 sc1
    s_mov_b64 exec, -1
    s_branch L_sigA3_done
L_sigA4:
    s_mov_b64 exec, 1
    v_mov_b32 v156, 0
    v_mov_b32 v157, 1
    global_atomic_add v156, v157, s[24:25] offset:0 sc1
    s_mov_b64 exec, -1
    s_branch L_sigA4_done
L_sigA5:
    s_mov_b64 exec, 1
    v_mov_b32 v156, 0
    v_mov_b32 v157, 1
    global_atomic_add v156, v157, s[24:25] offset:0 sc1
    s_mov_b64 exec, -1
    s_branch L_sigA5_done
L_sigA6:
    s_mov_b64 exec, 1
    v_mov_b32 v156, 0
    v_mov_b32 v157, 1
    global_atomic_add v156, v157, s[24:25] offset:0 sc1
    s_mov_b64 exec, -1
    s_branch L_sigA6_done
L_sigA7:
    s_mov_b64 exec, 1
    v_mov_b32 v156, 0
    v_mov_b32 v157, 1
    global_atomic_add v156, v157, s[24:25] offset:0 sc1
    s_mov_b64 exec, -1
    s_branch L_sigA7_done
L_sigA8:
    s_mov_b64 exec, 1
    v_mov_b32 v156, 0
    v_mov_b32 v157, 1
    global_atomic_add v156, v157, s[24:25] offset:0 sc1
    s_mov_b64 exec, -1
    s_branch L_sigA8_done
L_sigA9:
    s_mov_b64 exec, 1
    v_mov_b32 v156, 0
    v_mov_b32 v157, 1
    global_atomic_add v156, v157, s[24:25] offset:0 sc1
    s_mov_b64 exec, -1
    s_branch L_sigA9_done
L_sigA10:
    s_mov_b64 exec, 1
    v_mov_b32 v156, 0
    v_mov_b32 v157, 1
    global_atomic_add v156, v157, s[24:25] offset:0 sc1
    s_mov_b64 exec, -1
    s_branch L_sigA10_done
L_sigA11:
    s_mov_b64 exec, 1
    v_mov_b32 v156, 0
    v_mov_b32 v157, 1
    global_atomic_add v156, v157, s[24:25] offset:0 sc1
    s_mov_b64 exec, -1
    s_branch L_sigA11_done
L_sigA12:
    s_mov_b64 exec, 1
    v_mov_b32 v156, 0
    v_mov_b32 v157, 1
    global_atomic_add v156, v157, s[24:25] offset:0 sc1
    s_mov_b64 exec, -1
    s_branch L_sigA12_done
L_sigA13:
    s_mov_b64 exec, 1
    v_mov_b32 v156, 0
    v_mov_b32 v157, 1
    global_atomic_add v156, v157, s[24:25] offset:0 sc1
    s_mov_b64 exec, -1
    s_branch L_sigA13_done
L_sigA14:
    s_mov_b64 exec, 1
    v_mov_b32 v156, 0
    v_mov_b32 v157, 1
    global_atomic_add v156, v157, s[24:25] offset:0 sc1
    s_mov_b64 exec, -1
    s_branch L_sigA14_done
L_sigA15:
    s_mov_b64 exec, 1
    v_mov_b32 v156, 0
    v_mov_b32 v157, 1
    global_atomic_add v156, v157, s[24:25] offset:0 sc1
    s_mov_b64 exec, -1
    s_branch L_sigA15_done
L_poll:
    s_mov_b32 s8, 0
L_poll_l:
    s_sleep 1
    global_load_dword v2, v31, s[24:25] offset:128 sc1
    s_add_u32 s8, s8, 1
    s_cmp_ge_u32 s8, 0x40000
    s_cbranch_scc1 L_poll_ok
    s_waitcnt vmcnt(0)
    v_cmp_le_u32 vcc, 48, v2
    s_nop 1
    s_cmp_eq_u64 vcc, exec
    s_cbranch_scc0 L_poll_l
    s_branch L_poll_ok
L_pollA:
    s_mov_b32 s8, 0
L_pollA_l:
    s_sleep 1
    global_load_dword v9, v8, s[24:25] sc1
    s_add_u32 s8, s8, 1
    s_cmp_ge_u32 s8, 0x40000
    s_cbranch_scc1 L_pollA_ok
    s_waitcnt vmcnt(0)
    v_cmp_le_u32 vcc, 256, v9
    s_nop 1
    s_cmp_eq_u64 vcc, exec
    s_cbranch_scc0 L_pollA_l
    s_branch L_pollA_ok
L_pollp:
    s_mov_b32 s8, 0
L_pollp_l:
    s_sleep 1
    buffer_load_dword v11, v22, s[44:47], 0 offen sc1
    s_add_u32 s8, s8, 1
    s_cmp_ge_u32 s8, 0x40000
    s_cbranch_scc1 L_pollp_ok
    s_waitcnt vmcnt(0)
    v_cmp_eq_u32 vcc, 1, v11
    s_nop 1
    s_cmp_eq_u64 vcc, exec
    s_cbranch_scc0 L_pollp_l
    s_branch L_pollp_ok
L_pollo:
    s_mov_b32 s8, 0
L_pollo_l:
    s_sleep 1
    buffer_load_dword v92, v22, s[44:47], 0 offen sc1
    s_add_u32 s8, s8, 1
    s_cmp_ge_u32 s8, 0x40000
    s_cbranch_scc1 L_pollo_ok
    s_waitcnt vmcnt(0)
    v_cmp_eq_u32 vcc, 1, v92
    s_nop 1
    s_cmp_eq_u64 vcc, exec
    s_cbranch_scc0 L_pollo_l
    s_branch L_pollo_ok
L_ore0:
    s_add_u32 s60, s60, 1
    s_cmp_ge_u32 s60, 0x20000
    s_cbranch_scc1 L_ore0_done
    s_mov_b32 s64, 0
    s_mov_b32 s65, 18432
    buffer_load_dwordx4 v[96:99], v15, s[44:47], s64 offen sc1
    buffer_load_dwordx4 v[100:103], v15, s[44:47], s65 offen sc1
    s_waitcnt vmcnt(0)
    v_max3_u32 v93, v96, v97, v98
    v_max3_u32 v95, v99, v100, v101
    v_max3_u32 v93, v93, v102, v103
    v_max_u32 v93, v93, v95
    v_cmp_eq_u32 vcc, -1, v93
    s_nop 1
    s_cmp_lg_u64 vcc, 0
    s_cbranch_scc1 L_ore0
    s_branch L_ore0_done
L_ore1:
    s_add_u32 s60, s60, 1
    s_cmp_ge_u32 s60, 0x20000
    s_cbranch_scc1 L_ore1_done
    s_mov_b32 s64, 1024
    s_mov_b32 s65, 19456
    buffer_load_dwordx4 v[104:107], v15, s[44:47], s64 offen sc1
    buffer_load_dwordx4 v[108:111], v15, s[44:47], s65 offen sc1
    s_waitcnt vmcnt(0)
    v_max3_u32 v93, v104, v105, v106
    v_max3_u32 v95, v107, v108, v109
    v_max3_u32 v93, v93, v110, v111
    v_max_u32 v93, v93, v95
    v_cmp_eq_u32 vcc, -1, v93
    s_nop 1
    s_cmp_lg_u64 vcc, 0
    s_cbranch_scc1 L_ore1
    s_branch L_ore1_done
L_ore2:
    s_add_u32 s60, s60, 1
    s_cmp_ge_u32 s60, 0x20000
    s_cbranch_scc1 L_ore2_done
    s_mov_b32 s64, 2048
    s_mov_b32 s65, 20480
    buffer_load_dwordx4 v[112:115], v15, s[44:47], s64 offen sc1
    buffer_load_dwordx4 v[116:119], v15, s[44:47], s65 offen sc1
    s_waitcnt vmcnt(0)
    v_max3_u32 v93, v112, v113, v114
    v_max3_u32 v95, v115, v116, v117
    v_max3_u32 v93, v93, v118, v119
    v_max_u32 v93, v93, v95
    v_cmp_eq_u32 vcc, -1, v93
    s_nop 1
    s_cmp_lg_u64 vcc, 0
    s_cbranch_scc1 L_ore2
    s_branch L_ore2_done
L_ore3:
    s_add_u32 s60, s60, 1
    s_cmp_ge_u32 s60, 0x20000
    s_cbranch_scc1 L_ore3_done
    s_mov_b32 s64, 3072
    s_mov_b32 s65, 21504
    buffer_load_dwordx4 v[120:123], v15, s[44:47], s64 offen sc1
    buffer_load_dwordx4 v[124:127], v15, s[44:47], s65 offen sc1
    s_waitcnt vmcnt(0)
    v_max3_u32 v93, v120, v121, v122
    v_max3_u32 v95, v123, v124, v125
    v_max3_u32 v93, v93, v126, v127
    v_max_u32 v93, v93, v95
    v_cmp_eq_u32 vcc, -1, v93
    s_nop 1
    s_cmp_lg_u64 vcc, 0
    s_cbranch_scc1 L_ore3
    s_branch L_ore3_done
L_ore4:
    s_add_u32 s60, s60, 1
    s_cmp_ge_u32 s60, 0x20000
    s_cbranch_scc1 L_ore4_done
    s_mov_b32 s64, 4096
    s_mov_b32 s65, 22528
    buffer_load_dwordx4 v[128:131], v15, s[44:47], s64 offen sc1
    buffer_load_dwordx4 v[132:135], v15, s[44:47], s65 offen sc1
    s_waitcnt vmcnt(0)
    v_max3_u32 v93, v128, v129, v130
    v_max3_u32 v95, v131, v132, v133
    v_max3_u32 v93, v93, v134, v135
    v_max_u32 v93, v93, v95
    v_cmp_eq_u32 vcc, -1, v93
    s_nop 1
    s_cmp_lg_u64 vcc, 0
    s_cbranch_scc1 L_ore4
    s_branch L_ore4_done
L_ore5:
    s_add_u32 s60, s60, 1
    s_cmp_ge_u32 s60, 0x20000
    s_cbranch_scc1 L_ore5_done
    s_mov_b32 s64, 5120
    s_mov_b32 s65, 23552
    buffer_load_dwordx4 v[136:139], v15, s[44:47], s64 offen sc1
    buffer_load_dwordx4 v[140:143], v15, s[44:47], s65 offen sc1
    s_waitcnt vmcnt(0)
    v_max3_u32 v93, v136, v137, v138
    v_max3_u32 v95, v139, v140, v141
    v_max3_u32 v93, v93, v142, v143
    v_max_u32 v93, v93, v95
    v_cmp_eq_u32 vcc, -1, v93
    s_nop 1
    s_cmp_lg_u64 vcc, 0
    s_cbranch_scc1 L_ore5
    s_branch L_ore5_done
L_ore6:
    s_add_u32 s60, s60, 1
    s_cmp_ge_u32 s60, 0x20000
    s_cbranch_scc1 L_ore6_done
    s_mov_b32 s64, 6144
    s_mov_b32 s65, 24576
    buffer_load_dwordx4 v[144:147], v15, s[44:47], s64 offen sc1
    buffer_load_dwordx4 v[148:151], v15, s[44:47], s65 offen sc1
    s_waitcnt vmcnt(0)
    v_max3_u32 v93, v144, v145, v146
    v_max3_u32 v95, v147, v148, v149
    v_max3_u32 v93, v93, v150, v151
    v_max_u32 v93, v93, v95
    v_cmp_eq_u32 vcc, -1, v93
    s_nop 1
    s_cmp_lg_u64 vcc, 0
    s_cbranch_scc1 L_ore6
    s_branch L_ore6_done
L_ore7:
    s_add_u32 s60, s60, 1
    s_cmp_ge_u32 s60, 0x20000
    s_cbranch_scc1 L_ore7_done
    s_mov_b32 s64, 7168
    s_mov_b32 s65, 25600
    buffer_load_dwordx4 v[152:155], v15, s[44:47], s64 offen sc1
    buffer_load_dwordx4 v[156:159], v15, s[44:47], s65 offen sc1
    s_waitcnt vmcnt(0)
    v_max3_u32 v93, v152, v153, v154
    v_max3_u32 v95, v155, v156, v157
    v_max3_u32 v93, v93, v158, v159
    v_max_u32 v93, v93, v95
    v_cmp_eq_u32 vcc, -1, v93
    s_nop 1
    s_cmp_lg_u64 vcc, 0
    s_cbranch_scc1 L_ore7
    s_branch L_ore7_done
L_ore8:
    s_add_u32 s60, s60, 1
    s_cmp_ge_u32 s60, 0x20000
    s_cbranch_scc1 L_ore8_done
    s_mov_b32 s64, 8192
    s_mov_b32 s65, 26624
    buffer_load_dwordx4 v[160:163], v15, s[44:47], s64 offen sc1
    buffer_load_dwordx4 v[164:167], v15, s[44:47], s65 offen sc1
    s_waitcnt vmcnt(0)
    v_max3_u32 v93, v160, v161, v162
    v_max3_u32 v95, v163, v164, v165
    v_max3_u32 v93, v93, v166, v167
    v_max_u32 v93, v93, v95
    v_cmp_eq_u32 vcc, -1, v93
    s_nop 1
    s_cmp_lg_u64 vcc, 0
    s_cbranch_scc1 L_ore8
    s_branch L_ore8_done
L_ore9:
    s_add_u32 s60, s60, 1
    s_cmp_ge_u32 s60, 0x20000
    s_cbranch_scc1 L_ore9_done
    s_mov_b32 s64, 9216
    s_mov_b32 s65, 27648
    buffer_load_dwordx4 v[168:171], v15, s[44:47], s64 offen sc1
    buffer_load_dwordx4 v[172:175], v15, s[44:47], s65 offen sc1
    s_waitcnt vmcnt(0)
    v_max3_u32 v93, v168, v169, v170
    v_max3_u32 v95, v171, v172, v173
    v_max3_u32 v93, v93, v174, v175
    v_max_u32 v93, v93, v95
    v_cmp_eq_u32 vcc, -1, v93
    s_nop 1
    s_cmp_lg_u64 vcc, 0
    s_cbranch_scc1 L_ore9
    s_branch L_ore9_done
L_ore10:
    s_add_u32 s60, s60, 1
    s_cmp_ge_u32 s60, 0x20000
    s_cbranch_scc1 L_ore10_done
    s_mov_b32 s64, 10240
    s_mov_b32 s65, 28672
    buffer_load_dwordx4 v[176:179], v15, s[44:47], s64 offen sc1
    buffer_load_dwordx4 v[180:183], v15, s[44:47], s65 offen sc1
    s_waitcnt vmcnt(0)
    v_max3_u32 v93, v176, v177, v178
    v_max3_u32 v95, v179, v180, v181
    v_max3_u32 v93, v93, v182, v183
    v_max_u32 v93, v93, v95
    v_cmp_eq_u32 vcc, -1, v93
    s_nop 1
    s_cmp_lg_u64 vcc, 0
    s_cbranch_scc1 L_ore10
    s_branch L_ore10_done
L_ore11:
    s_add_u32 s60, s60, 1
    s_cmp_ge_u32 s60, 0x20000
    s_cbranch_scc1 L_ore11_done
    s_mov_b32 s64, 11264
    s_mov_b32 s65, 29696
    buffer_load_dwordx4 v[184:187], v15, s[44:47], s64 offen sc1
    buffer_load_dwordx4 v[188:191], v15, s[44:47], s65 offen sc1
    s_waitcnt vmcnt(0)
    v_max3_u32 v93, v184, v185, v186
    v_max3_u32 v95, v187, v188, v189
    v_max3_u32 v93, v93, v190, v191
    v_max_u32 v93, v93, v95
    v_cmp_eq_u32 vcc, -1, v93
    s_nop 1
    s_cmp_lg_u64 vcc, 0
    s_cbranch_scc1 L_ore11
    s_branch L_ore11_done
L_ore12:
    s_add_u32 s60, s60, 1
    s_cmp_ge_u32 s60, 0x20000
    s_cbranch_scc1 L_ore12_done
    s_mov_b32 s64, 12288
    s_mov_b32 s65, 30720
    buffer_load_dwordx4 v[192:195], v15, s[44:47], s64 offen sc1
    buffer_load_dwordx4 v[196:199], v15, s[44:47], s65 offen sc1
    s_waitcnt vmcnt(0)
    v_max3_u32 v93, v192, v193, v194
    v_max3_u32 v95, v195, v196, v197
    v_max3_u32 v93, v93, v198, v199
    v_max_u32 v93, v93, v95
    v_cmp_eq_u32 vcc, -1, v93
    s_nop 1
    s_cmp_lg_u64 vcc, 0
    s_cbranch_scc1 L_ore12
    s_branch L_ore12_done
L_ore13:
    s_add_u32 s60, s60, 1
    s_cmp_ge_u32 s60, 0x20000
    s_cbranch_scc1 L_ore13_done
    s_mov_b32 s64, 13312
    s_mov_b32 s65, 31744
    buffer_load_dwordx4 v[200:203], v15, s[44:47], s64 offen sc1
    buffer_load_dwordx4 v[204:207], v15, s[44:47], s65 offen sc1
    s_waitcnt vmcnt(0)
    v_max3_u32 v93, v200, v201, v202
    v_max3_u32 v95, v203, v204, v205
    v_max3_u32 v93, v93, v206, v207
    v_max_u32 v93, v93, v95
    v_cmp_eq_u32 vcc, -1, v93
    s_nop 1
    s_cmp_lg_u64 vcc, 0
    s_cbranch_scc1 L_ore13
    s_branch L_ore13_done
L_ore14:
    s_add_u32 s60, s60, 1
    s_cmp_ge_u32 s60, 0x20000
    s_cbranch_scc1 L_ore14_done
    s_mov_b32 s64, 14336
    s_mov_b32 s65, 32768
    buffer_load_dwordx4 v[208:211], v15, s[44:47], s64 offen sc1
    buffer_load_dwordx4 v[212:215], v15, s[44:47], s65 offen sc1
    s_waitcnt vmcnt(0)
    v_max3_u32 v93, v208, v209, v210
    v_max3_u32 v95, v211, v212, v213
    v_max3_u32 v93, v93, v214, v215
    v_max_u32 v93, v93, v95
    v_cmp_eq_u32 vcc, -1, v93
    s_nop 1
    s_cmp_lg_u64 vcc, 0
    s_cbranch_scc1 L_ore14
    s_branch L_ore14_done
L_ore15:
    s_add_u32 s60, s60, 1
    s_cmp_ge_u32 s60, 0x20000
    s_cbranch_scc1 L_ore15_done
    s_mov_b32 s64, 15360
    s_mov_b32 s65, 33792
    buffer_load_dwordx4 v[216:219], v15, s[44:47], s64 offen sc1
    buffer_load_dwordx4 v[220:223], v15, s[44:47], s65 offen sc1
    s_waitcnt vmcnt(0)
    v_max3_u32 v93, v216, v217, v218
    v_max3_u32 v95, v219, v220, v221
    v_max3_u32 v93, v93, v222, v223
    v_max_u32 v93, v93, v95
    v_cmp_eq_u32 vcc, -1, v93
    s_nop 1
    s_cmp_lg_u64 vcc, 0
    s_cbranch_scc1 L_ore15
    s_branch L_ore15_done
L_ore16:
    s_add_u32 s60, s60, 1
    s_cmp_ge_u32 s60, 0x20000
    s_cbranch_scc1 L_ore16_done
    s_mov_b32 s64, 16384
    s_mov_b32 s65, 34816
    buffer_load_dwordx4 v[224:227], v15, s[44:47], s64 offen sc1
    buffer_load_dwordx4 v[228:231], v15, s[44:47], s65 offen sc1
    s_waitcnt vmcnt(0)
    v_max3_u32 v93, v224, v225, v226
    v_max3_u32 v95, v227, v228, v229
    v_max3_u32 v93, v93, v230, v231
    v_max_u32 v93, v93, v95
    v_cmp_eq_u32 vcc, -1, v93
    s_nop 1
    s_cmp_lg_u64 vcc, 0
    s_cbranch_scc1 L_ore16
    s_branch L_ore16_done
L_ore17:
    s_add_u32 s60, s60, 1
    s_cmp_ge_u32 s60, 0x20000
    s_cbranch_scc1 L_ore17_done
    s_mov_b32 s64, 17408
    s_mov_b32 s65, 35840
    buffer_load_dwordx4 v[232:235], v15, s[44:47], s64 offen sc1
    buffer_load_dwordx4 v[236:239], v15, s[44:47], s65 offen sc1
    s_waitcnt vmcnt(0)
    v_max3_u32 v93, v232, v233, v234
    v_max3_u32 v95, v235, v236, v237
    v_max3_u32 v93, v93, v238, v239
    v_max_u32 v93, v93, v95
    v_cmp_eq_u32 vcc, -1, v93
    s_nop 1
    s_cmp_lg_u64 vcc, 0
    s_cbranch_scc1 L_ore17
    s_branch L_ore17_done
.section .rodata,"a"
.p2align 6
.amdhsa_kernel parallel_sum__grouped_kv_mqa__glu_gated_bilinear__prompt_kernel
  .amdhsa_next_free_vgpr 512
  .amdhsa_next_free_sgpr 96
  .amdhsa_accum_offset 256
  .amdhsa_group_segment_fixed_size 0
  .amdhsa_kernarg_size 96
  .amdhsa_user_sgpr_count 2
  .amdhsa_user_sgpr_kernarg_segment_ptr 1
  .amdhsa_system_sgpr_workgroup_id_x 1
  .amdhsa_float_denorm_mode_32 3
.end_amdhsa_kernel
```
